```python
import torch

def _softmax(x, axis=-1):
    return torch.softmax(x, dim=axis)
def _gelu(x):
    return torch.nn.functional.gelu(x, approximate="tanh")
def _silu(x):
    return torch.nn.functional.silu(x)
def _sigmoid(x):
    return torch.sigmoid(x)
def _layernorm(x, axis=-1, eps=1e-5):
    m = x.mean(dim=axis, keepdim=True)
    v = x.var(dim=axis, keepdim=True, unbiased=False)
    return (x - m) / torch.sqrt(v + eps)
def _scatter_add(tgt, idx, src, axis=0):
    return tgt.clone().index_add_(axis, idx, src)
def _segment_sum(src, seg, n):
    out = torch.zeros((n,) + src.shape[1:], dtype=src.dtype)
    return out.index_add_(0, seg, src)
def _pad(x, pw):
    flat = tuple(v for pair in reversed(pw) for v in pair)
    return torch.nn.functional.pad(x, flat)

kernel_name = 'interleave_layers__ssm_conv_h3__glu_gated_bilinear__prompt'

def setup_inputs():

    _w = (lambda a: (lambda t: t.to(torch.bfloat16) if t.is_floating_point() else t)(torch.as_tensor(a)))
    def _A_setup():
        B, S, D = 1, 2048, 640
        ks = 4
        return {
            "q": _w((lambda *s: torch.randn(*s, dtype=torch.bfloat16) * 0.05)(B, S, D)),
            "k": _w((lambda *s: torch.randn(*s, dtype=torch.bfloat16) * 0.2)(B, S, D)),
            "v": _w((lambda *s: torch.randn(*s, dtype=torch.bfloat16) * 0.2)(B, S, D)),
            "shift_k": _w((lambda *s: torch.randn(*s, dtype=torch.bfloat16) * 0.2)(D, ks) * 0.5),
            "ssm_k": _w((lambda *s: torch.randn(*s, dtype=torch.bfloat16) * 0.8)(D, S) * (1.0 / S ** 0.5)),
            "ssm_D": _w((lambda *s: torch.randn(*s, dtype=torch.bfloat16) * 0.2)(D)),
        }
    _A_in = _A_setup()

    def _B_setup():
        B, S, D, F = 1, 2048, 640, 1728
        return {
            "x": _w((lambda *s: torch.randn(*s, dtype=torch.bfloat16) * 0.05)(B, S, D)),
            "w_gate": _w((lambda *s: torch.randn(*s, dtype=torch.bfloat16) * 0.4)(D, F) * (D ** -0.5)),
            "w_up": _w((lambda *s: torch.randn(*s, dtype=torch.bfloat16) * 0.4)(D, F) * (D ** -0.5)),
            "w_down": _w((lambda *s: torch.randn(*s, dtype=torch.bfloat16) * 0.4)(F, D) * (F ** -0.5)),
        }
    _B_in = _B_setup()

    return {
        "A_q": _A_in["q"],
        "A_k": _A_in["k"],
        "A_v": _A_in["v"],
        "A_shift_k": _A_in["shift_k"],
        "A_ssm_k": _A_in["ssm_k"],
        "A_ssm_D": _A_in["ssm_D"],
        "B_x": _B_in["x"],
        "B_w_gate": _B_in["w_gate"],
        "B_w_up": _B_in["w_up"],
        "B_w_down": _B_in["w_down"],
    }

def reference(A_q, A_k, A_v, A_shift_k, A_ssm_k, A_ssm_D, B_x, B_w_gate, B_w_up, B_w_down):
    def _A_ref(q, k, v, shift_k, ssm_k, ssm_D):
        B, S, D = q.shape
        ks = shift_k.shape[-1]
        k_pad = _pad(k, ((0, 0), (ks - 1, 0), (0, 0)))
        k_shift = torch.zeros_like(k)
        for t in range(ks):
            k_shift = k_shift + k_pad[:, t:t + S, :] * shift_k[:, ks - 1 - t][None, None, :]
        kv = k_shift * v
        L = 2 * S
        kv_pad = _pad(kv, ((0, 0), (0, S), (0, 0)))
        kf_pad = _pad(ssm_k, ((0, 0), (0, S)))
        kv_f = (lambda x, axes=(-2,-1): torch.fft.rfft2(x.float(), dim=axes))(kv_pad[:, None, :, :], axes=(1, 2))
        kf_f = (lambda x, axes=(-2,-1): torch.fft.rfft2(x.float(), dim=axes))(kf_pad[:, None, :], axes=(1, 2))
        kf_f = (lambda x, *d: x.permute(*d))(kf_f, 1, 2, 0)
        y_f = kv_f * kf_f[None, :, :, :]
        y = (lambda x, s, axes=(-2,-1): torch.fft.irfft2(x, s=s, dim=axes).to(torch.bfloat16))(y_f, (1, L), axes=(1, 2))[:, 0, :S, :]
        y = y + kv * ssm_D[None, None, :]
        return q * y

    def _B_ref(x, w_gate, w_up, w_down):
        g = torch.einsum("bsd,df->bsf", x, w_gate)
        u = torch.einsum("bsd,df->bsf", x, w_up)
        h = g * u
        return torch.einsum("bsf,fd->bsd", h, w_down)

    x = A_q
    x = x + _A_ref(_layernorm(x, axis=-1), A_k, A_v, A_shift_k, A_ssm_k, A_ssm_D)
    x = x + _B_ref(_layernorm(x, axis=-1), B_w_gate, B_w_up, B_w_down)
    x = x + _A_ref(_layernorm(x, axis=-1), A_k, A_v, A_shift_k, A_ssm_k, A_ssm_D)
    x = x + _B_ref(_layernorm(x, axis=-1), B_w_gate, B_w_up, B_w_down)
    return x
```

```asm
; @launch grid=(256,1,1) block=(256,1,1) lds=163840
.amdgcn_target "amdgcn-amd-amdhsa--gfx950"
.text
.globl interleave_layers__ssm_conv_h3__glu_gated_bilinear__prompt_kernel
.p2align 8
.type interleave_layers__ssm_conv_h3__glu_gated_bilinear__prompt_kernel,@function
interleave_layers__ssm_conv_h3__glu_gated_bilinear__prompt_kernel:
    s_cmp_ge_u32 s2, 256
    s_cbranch_scc1 L_end
    s_load_dwordx16 s[8:23], s[0:1], 0
    s_load_dwordx8 s[24:31], s[0:1], 64
    s_load_dwordx2 s[32:33], s[0:1], 96
    s_getpc_b64 s[64:65]
L_pc:
    v_and_b32 v1, 63, v0
    v_lshrrev_b32 v6, 6, v0
    s_lshr_b32 s3, s2, 3
    s_mul_i32 s3, s3, 2560
    v_mul_u32_u24 v7, 640, v6
    v_lshl_add_u32 v7, v1, 7, v7
    v_add_u32 v7, s3, v7
    v_min_u32 v7, L_end-L_pc, v7
    v_readfirstlane_b32 s6, v6
    s_mov_b64 exec, 31
    global_load_dword v7, v7, s[64:65]
    s_mov_b64 exec, -1
    v_lshlrev_b32 v2, 4, v1
    v_and_b32 v3, 15, v1
    v_lshrrev_b32 v4, 4, v1
    s_and_b32 s4, s2, 7
    s_lshr_b32 s5, s2, 3
    s_lshr_b32 s3, s5, 3
    s_and_b32 s63, s5, 7
    s_mov_b32 s60, s4
    s_lshl_b32 s7, s4, 2
    s_add_u32 s61, s7, s5
    s_and_b32 s61, s61, 31
    s_lshl_b32 s7, s4, 2
    s_add_u32 s62, s7, s3
    s_mul_i32 s34, s4, 20
    s_add_u32 s34, s34, s5
    s_cmp_ge_u32 s5, 20
    s_cbranch_scc1 L_helper
    s_and_b32 s70, s34, 15
    s_lshr_b32 s71, s34, 4
    s_lshl_b32 s75, s6, 2
    s_lshl_b32 s76, s71, 4
    s_add_u32 s79, s75, s76
    v_add_u32 v28, s79, v4
    v_mul_u32_u24 v16, 16384, v28
    s_lshl_b32 s72, s70, 8
    v_lshl_add_u32 v16, v3, 4, v16
    v_add_u32 v16, s72, v16
    v_lshrrev_b32 v20, 3, v1
    v_mul_u32_u24 v21, 1280, v20
    v_and_b32 v22, 0x70, v2
    v_or_b32 v21, v21, v22
    s_and_b32 s3, s6, 1
    s_lshl_b32 s3, s3, 6
    v_xor_b32 v24, s3, v21
    v_xor_b32 v25, 16, v24
    v_xor_b32 v26, 32, v24
    v_xor_b32 v27, 48, v24
    s_mul_i32 s72, s70, 163840
    s_lshl_b32 s73, s71, 7
    s_add_u32 s72, s72, s73
    s_mul_i32 s73, s6, 40960
    s_add_u32 s73, s73, s72
    s_lshl_b32 s74, s6, 12
    s_add_u32 s74, s74, 87040
    s_mov_b32 s7, 6602752
    s_waitcnt lgkmcnt(0)
    s_load_dword s97, s[32:33], s7
    s_mov_b32 s48, s10
    s_mov_b32 s49, s11
    s_mov_b32 s50, 2621440
    s_mov_b32 s51, 0x20000
    s_mov_b32 s52, s12
    s_mov_b32 s53, s13
    s_mov_b32 s54, 2621440
    s_mov_b32 s55, 0x20000
    s_add_u32 s75, s73, 0
    s_add_u32 m0, s74, 0
    s_nop 0
    buffer_load_dwordx4 v24, s[48:51], s75 offen nt lds
    s_add_u32 m0, s74, 16384
    s_nop 0
    buffer_load_dwordx4 v24, s[52:55], s75 offen nt lds
    s_add_u32 s75, s73, 10240
    s_add_u32 m0, s74, 1024
    s_nop 0
    buffer_load_dwordx4 v25, s[48:51], s75 offen nt lds
    s_add_u32 m0, s74, 17408
    s_nop 0
    buffer_load_dwordx4 v25, s[52:55], s75 offen nt lds
    s_add_u32 s75, s73, 20480
    s_add_u32 m0, s74, 2048
    s_nop 0
    buffer_load_dwordx4 v26, s[48:51], s75 offen nt lds
    s_add_u32 m0, s74, 18432
    s_nop 0
    buffer_load_dwordx4 v26, s[52:55], s75 offen nt lds
    s_add_u32 s75, s73, 30720
    s_add_u32 m0, s74, 3072
    s_nop 0
    buffer_load_dwordx4 v27, s[48:51], s75 offen nt lds
    s_add_u32 m0, s74, 19456
    s_nop 0
    buffer_load_dwordx4 v27, s[52:55], s75 offen nt lds
    s_cmp_lg_u32 s6, 3
    s_cbranch_scc1 L_nohalo
    v_xor_b32 v23, 0x70, v21
    v_add_u32 v23, s72, v23
    v_subrev_u32 v23, 10240, v23
    s_mov_b32 m0, 86016
    s_mov_b32 exec_lo, 0
    s_mov_b32 exec_hi, 0xffffff00
    buffer_load_dwordx4 v23, s[48:51], 0 offen nt lds
    s_mov_b64 exec, -1
L_nohalo:
    s_mov_b32 s56, s14
    s_mov_b32 s57, s15
    s_mov_b32 s58, 5120
    s_mov_b32 s59, 0x20000
    s_mov_b32 s40, s16
    s_mov_b32 s41, s17
    s_mov_b32 s42, 2621440
    s_mov_b32 s43, 0x20000
    v_lshlrev_b32 v29, 5, v28
    buffer_load_dwordx4 v[72:75], v29, s[56:59], 0 offen
    buffer_load_dwordx4 v[76:79], v29, s[56:59], 0 offen offset:16
    s_lshl_b32 s75, s34, 2
    s_add_u32 s75, s75, s6
    s_lshl_b32 s76, s75, 12
    s_mov_b32 s52, s8
    s_mov_b32 s53, s9
    s_mov_b32 s54, 2621440
    s_mov_b32 s55, 0x20000
    v_lshrrev_b32 v22, 1, v20
    v_lshlrev_b32 v22, 4, v22
    v_xor_b32 v26, v22, v21
    v_xor_b32 v27, 64, v26
    s_add_u32 s72, s73, 0
    s_add_u32 m0, s74, 32768
    s_nop 0
    buffer_load_dwordx4 v26, s[52:55], s72 offen nt lds
    s_add_u32 s72, s73, 10240
    s_add_u32 m0, s74, 33792
    s_nop 0
    buffer_load_dwordx4 v27, s[52:55], s72 offen nt lds
    s_add_u32 s72, s73, 20480
    s_add_u32 m0, s74, 34816
    s_nop 0
    buffer_load_dwordx4 v26, s[52:55], s72 offen nt lds
    s_add_u32 s72, s73, 30720
    s_add_u32 m0, s74, 35840
    s_nop 0
    buffer_load_dwordx4 v27, s[52:55], s72 offen nt lds
    buffer_load_dwordx4 v[160:163], v2, s[40:43], s76 offen offset:0 nt
    buffer_load_dwordx4 v[168:171], v2, s[40:43], s76 offen offset:1024 nt
    buffer_load_dwordx4 v[176:179], v2, s[40:43], s76 offen offset:2048 nt
    buffer_load_dwordx4 v[184:187], v2, s[40:43], s76 offen offset:3072 nt
    s_lshr_b32 s72, s75, 1
    s_lshl_b32 s72, s72, 2
    s_load_dword s77, s[18:19], s72
    s_mov_b32 s36, s32
    s_mov_b32 s37, s33
    s_mov_b32 s38, 268435456
    s_mov_b32 s39, 0x20000
    s_mov_b32 s44, s28
    s_mov_b32 s45, s29
    s_mov_b32 s46, 2621440
    s_mov_b32 s47, 0x20000
    s_lshl_b32 s3, s60, 2
    s_add_u32 s3, s3, s6
    s_mul_i32 s90, s3, 40960
    s_mul_i32 s95, s3, 114688
    s_mul_i32 s7, s61, 1792
    s_add_u32 s95, s95, s7
    s_lshl_b32 s3, s3, 12
    s_add_u32 s35, s3, 6029312
    s_lshl_b32 s7, s61, 7
    s_add_u32 s3, s3, s7
    s_add_u32 s66, s3, 5505024
    s_lshl_b32 s3, s62, 12
    s_lshl_b32 s7, s6, 10
    s_add_u32 s7, s7, s3
    s_add_u32 s64, s7, 5505024
    s_lshl_b32 s7, s63, 9
    s_add_u32 s3, s3, s7
    s_lshl_b32 s7, s6, 7
    s_add_u32 s3, s3, s7
    s_add_u32 s67, s3, 6029312
    s_lshl_b32 s3, s34, 7
    s_mul_i32 s7, s6, 24576
    s_add_u32 s3, s3, s7
    s_add_u32 s68, s3, 7733248
    s_lshr_b32 s3, s60, 1
    s_mul_i32 s3, s3, 24576
    s_mul_i32 s7, s6, 5120
    s_add_u32 s3, s3, s7
    s_add_u32 s65, s3, 7733248
    s_lshl_b32 s3, s62, 15
    s_lshl_b32 s7, s6, 13
    s_add_u32 s3, s3, s7
    s_add_u32 s69, s3, 20971520
    s_mul_i32 s91, s62, 114688
    s_mul_i32 s7, s6, 14336
    s_add_u32 s91, s91, s7
    s_mul_i32 s92, s63, 286720
    s_mul_i32 s7, s6, 71680
    s_add_u32 s92, s92, s7
    s_mul_i32 s78, s6, 21248
    v_add_u32 v30, s78, v2
    s_lshl_b32 s72, s6, 1
    v_lshrrev_b32 v20, 1, v4
    v_add_u32 v20, s72, v20
    v_and_b32 v21, 1, v4
    v_lshlrev_b32 v21, 3, v21
    v_lshl_add_u32 v21, v3, 10, v21
    v_add_u32 v21, 86016, v21
    v_xor_b32 v22, v20, v3
    v_and_b32 v22, 7, v22
    v_lshl_add_u32 v22, v22, 4, v21
    v_add_u32 v23, 7, v3
    v_xor_b32 v23, v20, v23
    v_and_b32 v23, 7, v23
    v_lshl_add_u32 v23, v23, 4, v21
    v_lshrrev_b32 v24, 1, v4
    v_xor_b32 v24, v24, v3
    v_and_b32 v24, 7, v24
    v_lshlrev_b32 v24, 4, v24
    v_lshl_add_u32 v24, v3, 8, v24
    v_and_b32 v25, 1, v4
    v_lshl_add_u32 v24, v25, 3, v24
    s_lshl_b32 s72, s6, 12
    s_add_u32 s72, s72, 119808
    v_add_u32 v24, s72, v24
    v_lshl_add_u32 v25, v1, 6, s72
    v_mul_u32_u24 v19, 16384, v4
    v_lshl_add_u32 v19, v3, 4, v19
    v_lshlrev_b32 v18, 3, v1
    s_waitcnt lgkmcnt(0)
    s_add_u32 s97, s97, 0x9e3779b1
    v_mov_b32 v14, s97
    s_waitcnt vmcnt(8)
    s_barrier
    ds_read_b64 v[32:33], v23 offset:640
    ds_read_b64 v[34:35], v23 offset:768
    ds_read_b64 v[36:37], v23 offset:896
    ds_read_b64 v[38:39], v22 offset:1024
    ds_read_b64 v[54:55], v22 offset:17408
    ds_read_b64 v[40:41], v22 offset:1152
    ds_read_b64 v[56:57], v22 offset:17536
    ds_read_b64 v[42:43], v22 offset:1280
    ds_read_b64 v[58:59], v22 offset:17664
    ds_read_b64 v[44:45], v22 offset:1408
    ds_read_b64 v[60:61], v22 offset:17792
    ds_read_b64 v[46:47], v22 offset:1536
    ds_read_b64 v[62:63], v22 offset:17920
    ds_read_b64 v[48:49], v22 offset:1664
    ds_read_b64 v[64:65], v22 offset:18048
    ds_read_b64 v[50:51], v22 offset:1792
    ds_read_b64 v[66:67], v22 offset:18176
    ds_read_b64 v[52:53], v22 offset:1920
    ds_read_b64 v[68:69], v22 offset:18304
    v_lshlrev_b32 v80, 16, v72
    v_and_b32 v84, 0xffff0000, v72
    v_lshlrev_b32 v88, 16, v73
    v_and_b32 v92, 0xffff0000, v73
    v_lshlrev_b32 v81, 16, v74
    v_and_b32 v85, 0xffff0000, v74
    v_lshlrev_b32 v89, 16, v75
    v_and_b32 v93, 0xffff0000, v75
    v_lshlrev_b32 v82, 16, v76
    v_and_b32 v86, 0xffff0000, v76
    v_lshlrev_b32 v90, 16, v77
    v_and_b32 v94, 0xffff0000, v77
    v_lshlrev_b32 v83, 16, v78
    v_and_b32 v87, 0xffff0000, v78
    v_lshlrev_b32 v91, 16, v79
    v_and_b32 v95, 0xffff0000, v79
    s_waitcnt lgkmcnt(15)
    v_lshlrev_b32 v96, 16, v32
    v_and_b32 v97, 0xffff0000, v32
    v_lshlrev_b32 v98, 16, v33
    v_and_b32 v99, 0xffff0000, v33
    v_lshlrev_b32 v100, 16, v34
    v_and_b32 v101, 0xffff0000, v34
    v_lshlrev_b32 v102, 16, v35
    v_and_b32 v103, 0xffff0000, v35
    v_lshlrev_b32 v104, 16, v36
    v_and_b32 v105, 0xffff0000, v36
    v_lshlrev_b32 v106, 16, v37
    v_and_b32 v107, 0xffff0000, v37
    v_lshlrev_b32 v108, 16, v38
    v_and_b32 v109, 0xffff0000, v38
    v_lshlrev_b32 v110, 16, v39
    v_and_b32 v111, 0xffff0000, v39
    s_waitcnt lgkmcnt(14)
    v_lshlrev_b32 v140, 16, v54
    v_and_b32 v141, 0xffff0000, v54
    v_lshlrev_b32 v142, 16, v55
    v_and_b32 v143, 0xffff0000, v55
    v_pk_mul_f32 v[96:97], v[96:97], v[92:93]
    v_pk_mul_f32 v[98:99], v[98:99], v[94:95]
    v_pk_fma_f32 v[96:97], v[100:101], v[88:89], v[96:97]
    v_pk_fma_f32 v[98:99], v[102:103], v[90:91], v[98:99]
    v_pk_fma_f32 v[96:97], v[104:105], v[84:85], v[96:97]
    v_pk_fma_f32 v[98:99], v[106:107], v[86:87], v[98:99]
    v_pk_fma_f32 v[96:97], v[108:109], v[80:81], v[96:97]
    v_pk_fma_f32 v[98:99], v[110:111], v[82:83], v[98:99]
    v_pk_mul_f32 v[96:97], v[96:97], v[140:141]
    v_pk_mul_f32 v[98:99], v[98:99], v[142:143]
    s_waitcnt lgkmcnt(13)
    v_lshlrev_b32 v112, 16, v40
    v_and_b32 v113, 0xffff0000, v40
    v_lshlrev_b32 v114, 16, v41
    v_and_b32 v115, 0xffff0000, v41
    s_waitcnt lgkmcnt(12)
    v_lshlrev_b32 v140, 16, v56
    v_and_b32 v141, 0xffff0000, v56
    v_lshlrev_b32 v142, 16, v57
    v_and_b32 v143, 0xffff0000, v57
    v_pk_mul_f32 v[100:101], v[100:101], v[92:93]
    v_pk_mul_f32 v[102:103], v[102:103], v[94:95]
    v_pk_fma_f32 v[100:101], v[104:105], v[88:89], v[100:101]
    v_pk_fma_f32 v[102:103], v[106:107], v[90:91], v[102:103]
    v_pk_fma_f32 v[100:101], v[108:109], v[84:85], v[100:101]
    v_pk_fma_f32 v[102:103], v[110:111], v[86:87], v[102:103]
    v_pk_fma_f32 v[100:101], v[112:113], v[80:81], v[100:101]
    v_pk_fma_f32 v[102:103], v[114:115], v[82:83], v[102:103]
    v_pk_mul_f32 v[100:101], v[100:101], v[140:141]
    v_pk_mul_f32 v[102:103], v[102:103], v[142:143]
    s_waitcnt lgkmcnt(11)
    v_lshlrev_b32 v116, 16, v42
    v_and_b32 v117, 0xffff0000, v42
    v_lshlrev_b32 v118, 16, v43
    v_and_b32 v119, 0xffff0000, v43
    s_waitcnt lgkmcnt(10)
    v_lshlrev_b32 v140, 16, v58
    v_and_b32 v141, 0xffff0000, v58
    v_lshlrev_b32 v142, 16, v59
    v_and_b32 v143, 0xffff0000, v59
    v_pk_mul_f32 v[104:105], v[104:105], v[92:93]
    v_pk_mul_f32 v[106:107], v[106:107], v[94:95]
    v_pk_fma_f32 v[104:105], v[108:109], v[88:89], v[104:105]
    v_pk_fma_f32 v[106:107], v[110:111], v[90:91], v[106:107]
    v_pk_fma_f32 v[104:105], v[112:113], v[84:85], v[104:105]
    v_pk_fma_f32 v[106:107], v[114:115], v[86:87], v[106:107]
    v_pk_fma_f32 v[104:105], v[116:117], v[80:81], v[104:105]
    v_pk_fma_f32 v[106:107], v[118:119], v[82:83], v[106:107]
    v_pk_mul_f32 v[104:105], v[104:105], v[140:141]
    v_pk_mul_f32 v[106:107], v[106:107], v[142:143]
    s_waitcnt lgkmcnt(9)
    v_lshlrev_b32 v120, 16, v44
    v_and_b32 v121, 0xffff0000, v44
    v_lshlrev_b32 v122, 16, v45
    v_and_b32 v123, 0xffff0000, v45
    s_waitcnt lgkmcnt(8)
    v_lshlrev_b32 v140, 16, v60
    v_and_b32 v141, 0xffff0000, v60
    v_lshlrev_b32 v142, 16, v61
    v_and_b32 v143, 0xffff0000, v61
    v_pk_mul_f32 v[108:109], v[108:109], v[92:93]
    v_pk_mul_f32 v[110:111], v[110:111], v[94:95]
    v_pk_fma_f32 v[108:109], v[112:113], v[88:89], v[108:109]
    v_pk_fma_f32 v[110:111], v[114:115], v[90:91], v[110:111]
    v_pk_fma_f32 v[108:109], v[116:117], v[84:85], v[108:109]
    v_pk_fma_f32 v[110:111], v[118:119], v[86:87], v[110:111]
    v_pk_fma_f32 v[108:109], v[120:121], v[80:81], v[108:109]
    v_pk_fma_f32 v[110:111], v[122:123], v[82:83], v[110:111]
    v_pk_mul_f32 v[108:109], v[108:109], v[140:141]
    v_pk_mul_f32 v[110:111], v[110:111], v[142:143]
    s_waitcnt lgkmcnt(7)
    v_lshlrev_b32 v124, 16, v46
    v_and_b32 v125, 0xffff0000, v46
    v_lshlrev_b32 v126, 16, v47
    v_and_b32 v127, 0xffff0000, v47
    s_waitcnt lgkmcnt(6)
    v_lshlrev_b32 v140, 16, v62
    v_and_b32 v141, 0xffff0000, v62
    v_lshlrev_b32 v142, 16, v63
    v_and_b32 v143, 0xffff0000, v63
    v_pk_mul_f32 v[112:113], v[112:113], v[92:93]
    v_pk_mul_f32 v[114:115], v[114:115], v[94:95]
    v_pk_fma_f32 v[112:113], v[116:117], v[88:89], v[112:113]
    v_pk_fma_f32 v[114:115], v[118:119], v[90:91], v[114:115]
    v_pk_fma_f32 v[112:113], v[120:121], v[84:85], v[112:113]
    v_pk_fma_f32 v[114:115], v[122:123], v[86:87], v[114:115]
    v_pk_fma_f32 v[112:113], v[124:125], v[80:81], v[112:113]
    v_pk_fma_f32 v[114:115], v[126:127], v[82:83], v[114:115]
    v_pk_mul_f32 v[112:113], v[112:113], v[140:141]
    v_pk_mul_f32 v[114:115], v[114:115], v[142:143]
    s_waitcnt lgkmcnt(5)
    v_lshlrev_b32 v128, 16, v48
    v_and_b32 v129, 0xffff0000, v48
    v_lshlrev_b32 v130, 16, v49
    v_and_b32 v131, 0xffff0000, v49
    s_waitcnt lgkmcnt(4)
    v_lshlrev_b32 v140, 16, v64
    v_and_b32 v141, 0xffff0000, v64
    v_lshlrev_b32 v142, 16, v65
    v_and_b32 v143, 0xffff0000, v65
    v_pk_mul_f32 v[116:117], v[116:117], v[92:93]
    v_pk_mul_f32 v[118:119], v[118:119], v[94:95]
    v_pk_fma_f32 v[116:117], v[120:121], v[88:89], v[116:117]
    v_pk_fma_f32 v[118:119], v[122:123], v[90:91], v[118:119]
    v_pk_fma_f32 v[116:117], v[124:125], v[84:85], v[116:117]
    v_pk_fma_f32 v[118:119], v[126:127], v[86:87], v[118:119]
    v_pk_fma_f32 v[116:117], v[128:129], v[80:81], v[116:117]
    v_pk_fma_f32 v[118:119], v[130:131], v[82:83], v[118:119]
    v_pk_mul_f32 v[116:117], v[116:117], v[140:141]
    v_pk_mul_f32 v[118:119], v[118:119], v[142:143]
    s_waitcnt lgkmcnt(3)
    v_lshlrev_b32 v132, 16, v50
    v_and_b32 v133, 0xffff0000, v50
    v_lshlrev_b32 v134, 16, v51
    v_and_b32 v135, 0xffff0000, v51
    s_waitcnt lgkmcnt(2)
    v_lshlrev_b32 v140, 16, v66
    v_and_b32 v141, 0xffff0000, v66
    v_lshlrev_b32 v142, 16, v67
    v_and_b32 v143, 0xffff0000, v67
    v_pk_mul_f32 v[120:121], v[120:121], v[92:93]
    v_pk_mul_f32 v[122:123], v[122:123], v[94:95]
    v_pk_fma_f32 v[120:121], v[124:125], v[88:89], v[120:121]
    v_pk_fma_f32 v[122:123], v[126:127], v[90:91], v[122:123]
    v_pk_fma_f32 v[120:121], v[128:129], v[84:85], v[120:121]
    v_pk_fma_f32 v[122:123], v[130:131], v[86:87], v[122:123]
    v_pk_fma_f32 v[120:121], v[132:133], v[80:81], v[120:121]
    v_pk_fma_f32 v[122:123], v[134:135], v[82:83], v[122:123]
    v_pk_mul_f32 v[120:121], v[120:121], v[140:141]
    v_pk_mul_f32 v[122:123], v[122:123], v[142:143]
    s_waitcnt lgkmcnt(1)
    v_lshlrev_b32 v136, 16, v52
    v_and_b32 v137, 0xffff0000, v52
    v_lshlrev_b32 v138, 16, v53
    v_and_b32 v139, 0xffff0000, v53
    s_waitcnt lgkmcnt(0)
    v_lshlrev_b32 v140, 16, v68
    v_and_b32 v141, 0xffff0000, v68
    v_lshlrev_b32 v142, 16, v69
    v_and_b32 v143, 0xffff0000, v69
    v_pk_mul_f32 v[124:125], v[124:125], v[92:93]
    v_pk_mul_f32 v[126:127], v[126:127], v[94:95]
    v_pk_fma_f32 v[124:125], v[128:129], v[88:89], v[124:125]
    v_pk_fma_f32 v[126:127], v[130:131], v[90:91], v[126:127]
    v_pk_fma_f32 v[124:125], v[132:133], v[84:85], v[124:125]
    v_pk_fma_f32 v[126:127], v[134:135], v[86:87], v[126:127]
    v_pk_fma_f32 v[124:125], v[136:137], v[80:81], v[124:125]
    v_pk_fma_f32 v[126:127], v[138:139], v[82:83], v[126:127]
    v_pk_mul_f32 v[124:125], v[124:125], v[140:141]
    v_pk_mul_f32 v[126:127], v[126:127], v[142:143]
    v_cvt_pk_bf16_f32 v144, v124, v120
    v_cvt_pk_bf16_f32 v145, v116, v112
    v_cvt_pk_bf16_f32 v146, v108, v104
    v_cvt_pk_bf16_f32 v147, v100, v96
    s_mov_b32 s72, 33554432
    buffer_store_dwordx4 v[144:147], v16, s[36:39], s72 offen sc1
    v_cvt_pk_bf16_f32 v148, v125, v121
    v_cvt_pk_bf16_f32 v149, v117, v113
    v_cvt_pk_bf16_f32 v150, v109, v105
    v_cvt_pk_bf16_f32 v151, v101, v97
    s_mov_b32 s72, 33558528
    buffer_store_dwordx4 v[148:151], v16, s[36:39], s72 offen sc1
    v_cvt_pk_bf16_f32 v152, v126, v122
    v_cvt_pk_bf16_f32 v153, v118, v114
    v_cvt_pk_bf16_f32 v154, v110, v106
    v_cvt_pk_bf16_f32 v155, v102, v98
    s_mov_b32 s72, 33562624
    buffer_store_dwordx4 v[152:155], v16, s[36:39], s72 offen sc1
    v_cvt_pk_bf16_f32 v156, v127, v123
    v_cvt_pk_bf16_f32 v157, v119, v115
    v_cvt_pk_bf16_f32 v158, v111, v107
    v_cvt_pk_bf16_f32 v159, v103, v99
    s_mov_b32 s72, 33566720
    buffer_store_dwordx4 v[156:159], v16, s[36:39], s72 offen sc1
    s_waitcnt vmcnt(8)
    ds_read2_b64 v[112:115], v24 offset0:0 offset1:16
    v_xor_b32 v20, 32, v24
    ds_read2_b64 v[116:119], v20 offset0:0 offset1:16
    v_xor_b32 v21, 64, v24
    ds_read2_b64 v[120:123], v21 offset0:0 offset1:16
    v_xor_b32 v22, 96, v24
    ds_read2_b64 v[124:127], v22 offset0:0 offset1:16
    ds_read_b128 v[192:195], v25 offset:0
    ds_read_b128 v[196:199], v25 offset:16
    ds_read_b128 v[200:203], v25 offset:32
    ds_read_b128 v[204:207], v25 offset:48
    v_mov_b32 v136, 0x3f803f80
    s_waitcnt lgkmcnt(3)
    v_dot2_f32_bf16 v132, v192, v136, 0
    v_dot2_f32_bf16 v133, v192, v192, 0
    v_dot2_f32_bf16 v132, v193, v136, v132
    v_dot2_f32_bf16 v133, v193, v193, v133
    v_dot2_f32_bf16 v132, v194, v136, v132
    v_dot2_f32_bf16 v133, v194, v194, v133
    v_dot2_f32_bf16 v132, v195, v136, v132
    v_dot2_f32_bf16 v133, v195, v195, v133
    s_waitcnt lgkmcnt(2)
    v_dot2_f32_bf16 v132, v196, v136, v132
    v_dot2_f32_bf16 v133, v196, v196, v133
    v_dot2_f32_bf16 v132, v197, v136, v132
    v_dot2_f32_bf16 v133, v197, v197, v133
    v_dot2_f32_bf16 v132, v198, v136, v132
    v_dot2_f32_bf16 v133, v198, v198, v133
    v_dot2_f32_bf16 v132, v199, v136, v132
    v_dot2_f32_bf16 v133, v199, v199, v133
    s_waitcnt lgkmcnt(1)
    v_dot2_f32_bf16 v132, v200, v136, v132
    v_dot2_f32_bf16 v133, v200, v200, v133
    v_dot2_f32_bf16 v132, v201, v136, v132
    v_dot2_f32_bf16 v133, v201, v201, v133
    v_dot2_f32_bf16 v132, v202, v136, v132
    v_dot2_f32_bf16 v133, v202, v202, v133
    v_dot2_f32_bf16 v132, v203, v136, v132
    v_dot2_f32_bf16 v133, v203, v203, v133
    s_waitcnt lgkmcnt(0)
    v_dot2_f32_bf16 v132, v204, v136, v132
    v_dot2_f32_bf16 v133, v204, v204, v133
    v_dot2_f32_bf16 v132, v205, v136, v132
    v_dot2_f32_bf16 v133, v205, v205, v133
    v_dot2_f32_bf16 v132, v206, v136, v132
    v_dot2_f32_bf16 v133, v206, v206, v133
    v_dot2_f32_bf16 v132, v207, v136, v132
    v_dot2_f32_bf16 v133, v207, v207, v133
    v_mov_b32 v134, v14
    v_mov_b32 v135, v14
    s_mul_i32 s72, s70, 20480
    s_lshl_b32 s73, s71, 11
    s_add_u32 s72, s72, s73
    s_lshl_b32 s73, s6, 9
    s_add_u32 s72, s72, s73
    s_add_u32 s72, s72, 7143424
    v_add_f32_dpp v132, v132, v132 quad_perm:[1,0,3,2] row_mask:0xf bank_mask:0xf
    v_add_f32_dpp v133, v133, v133 quad_perm:[1,0,3,2] row_mask:0xf bank_mask:0xf
    s_mov_b32 exec_lo, 0x55555555
    s_mov_b32 exec_hi, 0x55555555
    buffer_store_dwordx4 v[132:135], v18, s[36:39], s72 offen sc1
    s_mov_b64 exec, -1
    s_lshl_b32 s72, s77, 16
    s_and_b32 s73, s77, 0xffff0000
    s_bitcmp1_b32 s75, 0
    s_cselect_b32 s77, s73, s72
    s_lshl_b32 s79, s71, 13
    s_lshl_b32 s72, s6, 11
    s_lshl_b32 s73, s70, 7
    s_add_u32 s72, s72, s73
    s_add_u32 s72, s72, s79
    s_add_u32 s72, s72, 7471104
    s_mov_b32 s11, s72
    s_waitcnt vmcnt(1)
    s_mov_b64 exec, 1
    buffer_store_dword v14, off, s[36:39], s11 sc1
    s_mov_b64 exec, -1
    s_lshl_b32 s7, s63, 10
    s_add_u32 s7, s7, s69
    v_min_u32 v10, 5, v1
    v_lshl_add_u32 v10, v10, 7, s7
    v_writelane_b32 v10, s66, 58
    v_writelane_b32 v10, s67, 59
    buffer_load_dword v11, v10, s[36:39], 0 offen sc1
    s_mul_i32 s72, s71, 262144
    s_lshl_b32 s73, s70, 10
    s_add_u32 s72, s72, s73
    s_lshl_b32 s73, s6, 8
    s_add_u32 s72, s72, s73
    s_add_u32 s72, s72, 36175872
    buffer_store_dwordx4 v[112:115], v19, s[36:39], s72 offen sc1
    s_add_u32 s72, s72, 65536
    buffer_store_dwordx4 v[116:119], v19, s[36:39], s72 offen sc1
    s_add_u32 s72, s72, 65536
    buffer_store_dwordx4 v[120:123], v19, s[36:39], s72 offen sc1
    s_add_u32 s72, s72, 65536
    buffer_store_dwordx4 v[124:127], v19, s[36:39], s72 offen sc1
    s_add_u32 s72, s72, 65536
    v_readfirstlane_b32 s72, v168
    v_readfirstlane_b32 s73, v169
    s_nop 0
    v_mov_b32 v164, s72
    v_mov_b32 v165, s73
    s_nop 0
    v_mov_b32_dpp v164, v160 wave_shl:1 row_mask:0xf bank_mask:0xf
    v_mov_b32_dpp v165, v161 wave_shl:1 row_mask:0xf bank_mask:0xf
    v_pk_mov_b32 v[32:33], v[160:161], v[160:161] op_sel:[0,1]
    v_alignbit_b32 v34, v161, v160, 16
    v_alignbit_b32 v35, v162, v161, 16
    ds_write_b128 v30, v[32:35] offset:32
    v_pk_mov_b32 v[36:37], v[160:161], v[162:163] op_sel:[1,0]
    v_alignbit_b32 v38, v162, v161, 16
    v_alignbit_b32 v39, v163, v162, 16
    ds_write_b128 v30, v[36:39] offset:4192
    v_pk_mov_b32 v[40:41], v[162:163], v[162:163] op_sel:[0,1]
    v_alignbit_b32 v42, v163, v162, 16
    v_alignbit_b32 v43, v164, v163, 16
    ds_write_b128 v30, v[40:43] offset:8352
    v_pk_mov_b32 v[44:45], v[162:163], v[164:165] op_sel:[1,0]
    v_alignbit_b32 v46, v164, v163, 16
    v_alignbit_b32 v47, v165, v164, 16
    ds_write_b128 v30, v[44:47] offset:12512
    v_readfirstlane_b32 s72, v176
    v_readfirstlane_b32 s73, v177
    s_nop 0
    v_mov_b32 v172, s72
    v_mov_b32 v173, s73
    s_nop 0
    v_mov_b32_dpp v172, v168 wave_shl:1 row_mask:0xf bank_mask:0xf
    v_mov_b32_dpp v173, v169 wave_shl:1 row_mask:0xf bank_mask:0xf
    v_pk_mov_b32 v[48:49], v[168:169], v[168:169] op_sel:[0,1]
    v_alignbit_b32 v50, v169, v168, 16
    v_alignbit_b32 v51, v170, v169, 16
    ds_write_b128 v30, v[48:51] offset:1056
    v_pk_mov_b32 v[52:53], v[168:169], v[170:171] op_sel:[1,0]
    v_alignbit_b32 v54, v170, v169, 16
    v_alignbit_b32 v55, v171, v170, 16
    ds_write_b128 v30, v[52:55] offset:5216
    v_pk_mov_b32 v[56:57], v[170:171], v[170:171] op_sel:[0,1]
    v_alignbit_b32 v58, v171, v170, 16
    v_alignbit_b32 v59, v172, v171, 16
    ds_write_b128 v30, v[56:59] offset:9376
    v_pk_mov_b32 v[60:61], v[170:171], v[172:173] op_sel:[1,0]
    v_alignbit_b32 v62, v172, v171, 16
    v_alignbit_b32 v63, v173, v172, 16
    ds_write_b128 v30, v[60:63] offset:13536
    v_readfirstlane_b32 s72, v184
    v_readfirstlane_b32 s73, v185
    s_nop 0
    v_mov_b32 v180, s72
    v_mov_b32 v181, s73
    s_nop 0
    v_mov_b32_dpp v180, v176 wave_shl:1 row_mask:0xf bank_mask:0xf
    v_mov_b32_dpp v181, v177 wave_shl:1 row_mask:0xf bank_mask:0xf
    v_pk_mov_b32 v[64:65], v[176:177], v[176:177] op_sel:[0,1]
    v_alignbit_b32 v66, v177, v176, 16
    v_alignbit_b32 v67, v178, v177, 16
    ds_write_b128 v30, v[64:67] offset:2080
    v_pk_mov_b32 v[68:69], v[176:177], v[178:179] op_sel:[1,0]
    v_alignbit_b32 v70, v178, v177, 16
    v_alignbit_b32 v71, v179, v178, 16
    ds_write_b128 v30, v[68:71] offset:6240
    v_pk_mov_b32 v[72:73], v[178:179], v[178:179] op_sel:[0,1]
    v_alignbit_b32 v74, v179, v178, 16
    v_alignbit_b32 v75, v180, v179, 16
    ds_write_b128 v30, v[72:75] offset:10400
    v_pk_mov_b32 v[76:77], v[178:179], v[180:181] op_sel:[1,0]
    v_alignbit_b32 v78, v180, v179, 16
    v_alignbit_b32 v79, v181, v180, 16
    ds_write_b128 v30, v[76:79] offset:14560
    v_mov_b32_dpp v188, v184 wave_shl:1 row_mask:0xf bank_mask:0xf
    v_mov_b32_dpp v189, v185 wave_shl:1 row_mask:0xf bank_mask:0xf
    v_pk_mov_b32 v[80:81], v[184:185], v[184:185] op_sel:[0,1]
    v_alignbit_b32 v82, v185, v184, 16
    v_alignbit_b32 v83, v186, v185, 16
    ds_write_b128 v30, v[80:83] offset:3104
    v_pk_mov_b32 v[84:85], v[184:185], v[186:187] op_sel:[1,0]
    v_alignbit_b32 v86, v186, v185, 16
    v_alignbit_b32 v87, v187, v186, 16
    ds_write_b128 v30, v[84:87] offset:7264
    v_pk_mov_b32 v[88:89], v[186:187], v[186:187] op_sel:[0,1]
    v_alignbit_b32 v90, v187, v186, 16
    v_alignbit_b32 v91, v188, v187, 16
    ds_write_b128 v30, v[88:91] offset:11424
    v_pk_mov_b32 v[92:93], v[186:187], v[188:189] op_sel:[1,0]
    v_alignbit_b32 v94, v188, v187, 16
    v_alignbit_b32 v95, v189, v188, 16
    ds_write_b128 v30, v[92:95] offset:15584
    v_readfirstlane_b32 s72, v32
    v_readfirstlane_b32 s73, v34
    v_mov_b32 v96, 0
    v_mov_b32 v97, 0
    v_mov_b32 v98, 0
    v_mov_b32 v99, 0
    s_mov_b32 exec_hi, 0
    ds_write_b128 v30, v[96:99] offset:16640
    s_mov_b64 exec, -1
    s_lshl_b32 s74, s72, 16
    v_mov_b32 v100, 0
    v_mov_b32 v101, 0
    v_mov_b32 v102, 0
    v_mov_b32 v103, 0
    v_writelane_b32 v103, s74, 5
    v_writelane_b32 v101, s72, 7
    v_writelane_b32 v102, s74, 7
    v_writelane_b32 v103, s73, 7
    v_lshrrev_b32 v31, 1, v1
    v_mul_u32_u24 v31, 4160, v31
    v_and_b32 v104, 1, v1
    v_lshl_add_u32 v31, v104, 4, v31
    v_add_u32 v31, s78, v31
    s_mov_b64 exec, 0xff
    ds_write_b128 v31, v[100:103]
    s_mov_b64 exec, -1
    s_lshl_b32 s72, s6, 7
    s_lshl_b32 s73, s70, 9
    s_add_u32 s72, s72, s73
    s_add_u32 s72, s72, s79
    s_add_u32 s72, s72, 7602176
    s_waitcnt vmcnt(0)
    s_mov_b64 exec, 1
    buffer_store_dword v14, off, s[36:39], s72 sc1
    s_mov_b64 exec, -1
    s_getreg_b32 s31, hwreg(HW_REG_XCC_ID, 0, 4)
    s_add_u32 s31, s31, s97
    s_add_u32 s31, s31, 1
    s_cmp_lg_u32 s6, 0
    s_cbranch_scc1 Lxid_1
    s_lshl_b32 s3, s4, 12
    s_lshl_b32 s7, s5, 7
    s_add_u32 s3, s3, s7
    s_add_u32 s3, s3, 6291456
    v_mov_b32 v5, s31
    s_mov_b64 exec, 1
    buffer_store_dword v5, off, s[36:39], s3 sc1
    s_mov_b64 exec, -1
Lxid_1:
    v_lshlrev_b32 v21, 3, v4
    v_sub_u32 v21, v3, v21
    v_add_u32 v21, 25, v21
    v_add_u32 v24, 0, v21
    v_bfe_u32 v25, v24, 1, 2
    v_mul_u32_u24 v25, 4160, v25
    v_lshrrev_b32 v26, 3, v24
    v_lshl_add_u32 v25, v26, 4, v25
    v_and_b32 v26, 1, v24
    v_lshl_add_u32 v25, v26, 3, v25
    v_add_u32 v22, s78, v25
    v_add_u32 v24, 4, v21
    v_bfe_u32 v25, v24, 1, 2
    v_mul_u32_u24 v25, 4160, v25
    v_lshrrev_b32 v26, 3, v24
    v_lshl_add_u32 v25, v26, 4, v25
    v_and_b32 v26, 1, v24
    v_lshl_add_u32 v25, v26, 3, v25
    v_add_u32 v23, s78, v25
    v_lshl_add_u32 v24, v3, 1, v4
    v_lshlrev_b32 v24, 4, v24
    s_add_u32 s72, s78, 16672
    v_add_u32 v24, s72, v24
    v_lshrrev_b32 v25, 1, v4
    v_lshl_add_u32 v25, v3, 1, v25
    v_lshlrev_b32 v25, 4, v25
    v_and_b32 v26, 1, v4
    v_lshlrev_b32 v26, 3, v26
    v_sub_u32 v25, v25, v26
    s_add_u32 s72, s78, 17160
    v_add_u32 v25, s72, v25
    v_lshlrev_b32 v26, 5, v3
    v_lshl_add_u32 v26, v4, 3, v26
    s_mul_i32 s72, s6, 2112
    s_add_u32 s72, s72, 143360
    v_add_u32 v26, s72, v26
    v_lshrrev_b32 v27, 2, v3
    v_mul_u32_u24 v27, 2112, v27
    v_and_b32 v28, 3, v1
    v_lshl_add_u32 v27, v28, 3, v27
    v_lshl_add_u32 v27, v4, 6, v27
    s_lshl_b32 s72, s6, 9
    s_add_u32 s72, s72, 143360
    v_add_u32 v27, s72, v27
    v_mul_u32_u24 v29, 40960, v4
    v_lshl_add_u32 v29, v3, 4, v29
    v_lshlrev_b32 v6, 9, v4
    v_lshl_add_u32 v6, v3, 4, v6
    v_add_u32 v7, 57344, v2
    v_add_u32 v8, 114688, v2
    v_lshrrev_b32 v9, 2, v3
    v_lshl_add_u32 v9, v9, 4, v3
    v_lshlrev_b32 v9, 2, v9
    v_lshlrev_b32 v10, 2, v3
    v_add_u32 v10, 64, v10
    v_and_b32 v228, 3, v1
    v_cmp_eq_u32 s[80:81], 1, v228
    v_cmp_eq_u32 s[82:83], 2, v228
    v_cmp_eq_u32 s[84:85], 3, v228
    v_cmp_gt_u32 s[86:87], 10, v3
    s_mul_i32 s3, s6, 5120
    s_add_u32 s3, s3, 143360
    v_lshrrev_b32 v229, 1, v4
    v_lshl_add_u32 v229, v229, 2, v3
    v_and_b32 v230, 15, v229
    v_lshlrev_b32 v230, 4, v230
    v_lshl_add_u32 v230, v4, 8, v230
    v_add_u32 v11, s3, v230
    v_add_u32 v229, 8, v229
    v_and_b32 v230, 15, v229
    v_lshlrev_b32 v230, 4, v230
    v_lshl_add_u32 v230, v4, 8, v230
    v_add_u32 v12, s3, v230
    v_min_u32 v229, 9, v3
    v_add_u32 v230, s6, v229
    v_lshl_add_u32 v230, v230, 2, v4
    v_and_b32 v230, 15, v230
    v_lshlrev_b32 v230, 4, v230
    v_lshl_add_u32 v230, v229, 9, v230
    v_add_u32 v13, 143360, v230
    v_lshlrev_b32 v0, 8, v4
    v_add_u32 v0, 99440, v0
    v_lshrrev_b32 v28, 1, v6
    v_min_u32 v20, 15, v1
    v_lshlrev_b32 v20, 7, v20
    s_bfe_u32 s72, s34, 0x20002
    s_lshl_b32 s72, s72, 11
    s_add_u32 s72, s72, s79
    s_add_u32 s72, s72, 7471104
    s_mov_b32 s96, 0
Lpoll_3:
    buffer_load_dword v21, v20, s[36:39], s72 offen sc1
    s_waitcnt vmcnt(0)
    v_cmp_ne_u32 vcc, v21, v14
    s_cbranch_vccz Lpd_2
    s_sleep 1
    s_add_u32 s96, s96, 1
    s_cmp_lt_u32 s96, 100000
    s_cbranch_scc1 Lpoll_3
Lpd_2:
    s_mul_i32 s72, s75, 4096
    s_add_u32 s72, s72, 33554432
    buffer_load_dwordx4 v[100:103], v2, s[36:39], s72 offen offset:0 sc1
    buffer_load_dwordx4 v[104:107], v2, s[36:39], s72 offen offset:1024 sc1
    buffer_load_dwordx4 v[108:111], v2, s[36:39], s72 offen offset:2048 sc1
    buffer_load_dwordx4 v[112:115], v2, s[36:39], s72 offen offset:3072 sc1
    s_lshl_b32 s101, s6, 12
    s_add_u32 s101, s101, 5242880
    s_lshl_b32 s72, s6, 11
    s_mul_i32 s74, s34, 16384
    s_add_u32 s72, s72, s74
    s_add_u32 s72, s72, 36175872
    s_add_u32 s73, s72, 8192
    v_and_b32 v20, 7, v1
    v_lshlrev_b32 v20, 7, v20
    v_and_b32 v19, 8, v1
    v_lshl_add_u32 v20, v19, 9, v20
    s_lshl_b32 s74, s6, 10
    s_add_u32 s79, s79, s74
    s_add_u32 s79, s79, 7602176
    s_waitcnt vmcnt(3)
    ds_write_b128 v30, v[100:103] offset:17152
    s_waitcnt vmcnt(2)
    ds_write_b128 v30, v[104:107] offset:18176
    s_waitcnt vmcnt(1)
    ds_write_b128 v30, v[108:111] offset:19200
    s_waitcnt vmcnt(0)
    ds_write_b128 v30, v[112:115] offset:20224
    s_waitcnt lgkmcnt(0)
    ds_read_b64 v[100:101], v22 offset:0
    ds_read_b64 v[102:103], v23 offset:0
    ds_read_b128 v[132:135], v24 offset:448
    ds_read_b64 v[104:105], v22 offset:512
    ds_read_b64 v[106:107], v23 offset:512
    ds_read_b128 v[136:139], v24 offset:960
    ds_read_b64 v[108:109], v22 offset:1024
    ds_read_b64 v[110:111], v23 offset:1024
    ds_read_b128 v[140:143], v24 offset:1472
    ds_read_b64 v[112:113], v22 offset:1536
    ds_read_b64 v[114:115], v23 offset:1536
    ds_read_b128 v[144:147], v24 offset:1984
    s_waitcnt lgkmcnt(9)
    v_mfma_f32_16x16x32_bf16 v[32:35], v[100:103], v[132:135], 0
    ds_read_b64 v[164:165], v22 offset:64
    ds_read_b64 v[166:167], v23 offset:64
    s_waitcnt lgkmcnt(9)
    v_mfma_f32_16x16x32_bf16 v[36:39], v[104:107], v[132:135], 0
    ds_read_b128 v[196:199], v24 offset:384
    ds_read_b64 v[168:169], v22 offset:576
    s_waitcnt lgkmcnt(10)
    v_mfma_f32_16x16x32_bf16 v[36:39], v[100:103], v[136:139], v[36:39]
    ds_read_b64 v[170:171], v23 offset:576
    ds_read_b128 v[200:203], v24 offset:896
    v_mfma_f32_16x16x32_bf16 v[40:43], v[104:107], v[136:139], 0
    ds_read_b64 v[172:173], v22 offset:1088
    ds_read_b64 v[174:175], v23 offset:1088
    s_waitcnt lgkmcnt(12)
    v_mfma_f32_16x16x32_bf16 v[40:43], v[108:111], v[132:135], v[40:43]
    ds_read_b128 v[204:207], v24 offset:1408
    ds_read_b64 v[176:177], v22 offset:1600
    v_mfma_f32_16x16x32_bf16 v[44:47], v[108:111], v[136:139], 0
    ds_read_b64 v[178:179], v23 offset:1600
    ds_read_b128 v[208:211], v24 offset:1920
    s_waitcnt lgkmcnt(15)
    v_mfma_f32_16x16x32_bf16 v[40:43], v[100:103], v[140:143], v[40:43]
    v_mfma_f32_16x16x32_bf16 v[44:47], v[104:107], v[140:143], v[44:47]
    s_waitcnt lgkmcnt(13)
    v_mfma_f32_16x16x32_bf16 v[44:47], v[112:115], v[132:135], v[44:47]
    s_waitcnt lgkmcnt(12)
    v_mfma_f32_16x16x32_bf16 v[44:47], v[100:103], v[144:147], v[44:47]
    s_waitcnt lgkmcnt(9)
    v_mfma_f32_16x16x32_bf16 v[32:35], v[164:167], v[196:199], v[32:35]
    ds_read_b64 v[100:101], v22 offset:128
    ds_read_b64 v[102:103], v23 offset:128
    s_waitcnt lgkmcnt(9)
    v_mfma_f32_16x16x32_bf16 v[36:39], v[168:171], v[196:199], v[36:39]
    ds_read_b128 v[132:135], v24 offset:320
    ds_read_b64 v[104:105], v22 offset:640
    s_waitcnt lgkmcnt(10)
    v_mfma_f32_16x16x32_bf16 v[36:39], v[164:167], v[200:203], v[36:39]
    ds_read_b64 v[106:107], v23 offset:640
    ds_read_b128 v[136:139], v24 offset:832
    v_mfma_f32_16x16x32_bf16 v[40:43], v[168:171], v[200:203], v[40:43]
    ds_read_b64 v[108:109], v22 offset:1152
    ds_read_b64 v[110:111], v23 offset:1152
    s_waitcnt lgkmcnt(12)
    v_mfma_f32_16x16x32_bf16 v[40:43], v[172:175], v[196:199], v[40:43]
    ds_read_b128 v[140:143], v24 offset:1344
    ds_read_b64 v[112:113], v22 offset:1664
    v_mfma_f32_16x16x32_bf16 v[44:47], v[172:175], v[200:203], v[44:47]
    ds_read_b64 v[114:115], v23 offset:1664
    ds_read_b128 v[144:147], v24 offset:1856
    s_waitcnt lgkmcnt(15)
    v_mfma_f32_16x16x32_bf16 v[40:43], v[164:167], v[204:207], v[40:43]
    v_mfma_f32_16x16x32_bf16 v[44:47], v[168:171], v[204:207], v[44:47]
    s_waitcnt lgkmcnt(13)
    v_mfma_f32_16x16x32_bf16 v[44:47], v[176:179], v[196:199], v[44:47]
    s_waitcnt lgkmcnt(12)
    v_mfma_f32_16x16x32_bf16 v[44:47], v[164:167], v[208:211], v[44:47]
    s_waitcnt lgkmcnt(9)
    v_mfma_f32_16x16x32_bf16 v[32:35], v[100:103], v[132:135], v[32:35]
    ds_read_b64 v[164:165], v22 offset:192
    ds_read_b64 v[166:167], v23 offset:192
    s_waitcnt lgkmcnt(9)
    v_mfma_f32_16x16x32_bf16 v[36:39], v[104:107], v[132:135], v[36:39]
    ds_read_b128 v[196:199], v24 offset:256
    ds_read_b64 v[168:169], v22 offset:704
    s_waitcnt lgkmcnt(10)
    v_mfma_f32_16x16x32_bf16 v[36:39], v[100:103], v[136:139], v[36:39]
    ds_read_b64 v[170:171], v23 offset:704
    ds_read_b128 v[200:203], v24 offset:768
    v_mfma_f32_16x16x32_bf16 v[40:43], v[104:107], v[136:139], v[40:43]
    ds_read_b64 v[172:173], v22 offset:1216
    ds_read_b64 v[174:175], v23 offset:1216
    s_waitcnt lgkmcnt(12)
    v_mfma_f32_16x16x32_bf16 v[40:43], v[108:111], v[132:135], v[40:43]
    ds_read_b128 v[204:207], v24 offset:1280
    ds_read_b64 v[176:177], v22 offset:1728
    v_mfma_f32_16x16x32_bf16 v[44:47], v[108:111], v[136:139], v[44:47]
    ds_read_b64 v[178:179], v23 offset:1728
    ds_read_b128 v[208:211], v24 offset:1792
    s_waitcnt lgkmcnt(15)
    v_mfma_f32_16x16x32_bf16 v[40:43], v[100:103], v[140:143], v[40:43]
    v_mfma_f32_16x16x32_bf16 v[44:47], v[104:107], v[140:143], v[44:47]
    s_waitcnt lgkmcnt(13)
    v_mfma_f32_16x16x32_bf16 v[44:47], v[112:115], v[132:135], v[44:47]
    s_waitcnt lgkmcnt(12)
    v_mfma_f32_16x16x32_bf16 v[44:47], v[100:103], v[144:147], v[44:47]
    s_waitcnt lgkmcnt(9)
    v_mfma_f32_16x16x32_bf16 v[32:35], v[164:167], v[196:199], v[32:35]
    ds_read_b64 v[100:101], v22 offset:256
    ds_read_b64 v[102:103], v23 offset:256
    s_waitcnt lgkmcnt(9)
    v_mfma_f32_16x16x32_bf16 v[36:39], v[168:171], v[196:199], v[36:39]
    ds_read_b128 v[132:135], v24 offset:192
    ds_read_b64 v[104:105], v22 offset:768
    s_waitcnt lgkmcnt(10)
    v_mfma_f32_16x16x32_bf16 v[36:39], v[164:167], v[200:203], v[36:39]
    ds_read_b64 v[106:107], v23 offset:768
    ds_read_b128 v[136:139], v24 offset:704
    v_mfma_f32_16x16x32_bf16 v[40:43], v[168:171], v[200:203], v[40:43]
    ds_read_b64 v[108:109], v22 offset:1280
    ds_read_b64 v[110:111], v23 offset:1280
    s_waitcnt lgkmcnt(12)
    v_mfma_f32_16x16x32_bf16 v[40:43], v[172:175], v[196:199], v[40:43]
    ds_read_b128 v[140:143], v24 offset:1216
    ds_read_b64 v[112:113], v22 offset:1792
    v_mfma_f32_16x16x32_bf16 v[44:47], v[172:175], v[200:203], v[44:47]
    ds_read_b64 v[114:115], v23 offset:1792
    ds_read_b128 v[144:147], v24 offset:1728
    s_waitcnt lgkmcnt(15)
    v_mfma_f32_16x16x32_bf16 v[40:43], v[164:167], v[204:207], v[40:43]
    v_mfma_f32_16x16x32_bf16 v[44:47], v[168:171], v[204:207], v[44:47]
    s_waitcnt lgkmcnt(13)
    v_mfma_f32_16x16x32_bf16 v[44:47], v[176:179], v[196:199], v[44:47]
    s_waitcnt lgkmcnt(12)
    v_mfma_f32_16x16x32_bf16 v[44:47], v[164:167], v[208:211], v[44:47]
    s_waitcnt lgkmcnt(9)
    v_mfma_f32_16x16x32_bf16 v[32:35], v[100:103], v[132:135], v[32:35]
    ds_read_b64 v[164:165], v22 offset:320
    ds_read_b64 v[166:167], v23 offset:320
    buffer_load_dword v21, v20, s[36:39], s79 offen sc1
    s_waitcnt lgkmcnt(9)
    v_mfma_f32_16x16x32_bf16 v[36:39], v[104:107], v[132:135], v[36:39]
    ds_read_b128 v[196:199], v24 offset:128
    ds_read_b64 v[168:169], v22 offset:832
    s_waitcnt lgkmcnt(10)
    v_mfma_f32_16x16x32_bf16 v[36:39], v[100:103], v[136:139], v[36:39]
    ds_read_b64 v[170:171], v23 offset:832
    ds_read_b128 v[200:203], v24 offset:640
    v_mfma_f32_16x16x32_bf16 v[40:43], v[104:107], v[136:139], v[40:43]
    ds_read_b64 v[172:173], v22 offset:1344
    ds_read_b64 v[174:175], v23 offset:1344
    s_waitcnt lgkmcnt(12)
    v_mfma_f32_16x16x32_bf16 v[40:43], v[108:111], v[132:135], v[40:43]
    ds_read_b128 v[204:207], v24 offset:1152
    ds_read_b64 v[176:177], v22 offset:1856
    v_mfma_f32_16x16x32_bf16 v[44:47], v[108:111], v[136:139], v[44:47]
    ds_read_b64 v[178:179], v23 offset:1856
    ds_read_b128 v[208:211], v24 offset:1664
    s_waitcnt lgkmcnt(15)
    v_mfma_f32_16x16x32_bf16 v[40:43], v[100:103], v[140:143], v[40:43]
    v_mfma_f32_16x16x32_bf16 v[44:47], v[104:107], v[140:143], v[44:47]
    s_waitcnt lgkmcnt(13)
    v_mfma_f32_16x16x32_bf16 v[44:47], v[112:115], v[132:135], v[44:47]
    s_waitcnt lgkmcnt(12)
    v_mfma_f32_16x16x32_bf16 v[44:47], v[100:103], v[144:147], v[44:47]
    s_waitcnt lgkmcnt(9)
    v_mfma_f32_16x16x32_bf16 v[32:35], v[164:167], v[196:199], v[32:35]
    ds_read_b64 v[100:101], v22 offset:384
    ds_read_b64 v[102:103], v23 offset:384
    s_waitcnt lgkmcnt(9)
    v_mfma_f32_16x16x32_bf16 v[36:39], v[168:171], v[196:199], v[36:39]
    ds_read_b128 v[132:135], v24 offset:64
    ds_read_b64 v[104:105], v22 offset:896
    s_waitcnt lgkmcnt(10)
    v_mfma_f32_16x16x32_bf16 v[36:39], v[164:167], v[200:203], v[36:39]
    ds_read_b64 v[106:107], v23 offset:896
    ds_read_b128 v[136:139], v24 offset:576
    v_mfma_f32_16x16x32_bf16 v[40:43], v[168:171], v[200:203], v[40:43]
    ds_read_b64 v[108:109], v22 offset:1408
    ds_read_b64 v[110:111], v23 offset:1408
    s_waitcnt lgkmcnt(12)
    v_mfma_f32_16x16x32_bf16 v[40:43], v[172:175], v[196:199], v[40:43]
    ds_read_b128 v[140:143], v24 offset:1088
    ds_read_b64 v[112:113], v22 offset:1920
    v_mfma_f32_16x16x32_bf16 v[44:47], v[172:175], v[200:203], v[44:47]
    ds_read_b64 v[114:115], v23 offset:1920
    ds_read_b128 v[144:147], v24 offset:1600
    s_waitcnt lgkmcnt(15)
    v_mfma_f32_16x16x32_bf16 v[40:43], v[164:167], v[204:207], v[40:43]
    v_mfma_f32_16x16x32_bf16 v[44:47], v[168:171], v[204:207], v[44:47]
    s_waitcnt lgkmcnt(13)
    v_mfma_f32_16x16x32_bf16 v[44:47], v[176:179], v[196:199], v[44:47]
    s_waitcnt lgkmcnt(12)
    v_mfma_f32_16x16x32_bf16 v[44:47], v[164:167], v[208:211], v[44:47]
    s_waitcnt lgkmcnt(9)
    v_mfma_f32_16x16x32_bf16 v[32:35], v[100:103], v[132:135], v[32:35]
    ds_read_b64 v[164:165], v22 offset:448
    ds_read_b64 v[166:167], v23 offset:448
    s_waitcnt lgkmcnt(9)
    v_mfma_f32_16x16x32_bf16 v[36:39], v[104:107], v[132:135], v[36:39]
    ds_read_b128 v[196:199], v24 offset:0
    ds_read_b64 v[168:169], v22 offset:960
    s_waitcnt lgkmcnt(10)
    v_mfma_f32_16x16x32_bf16 v[36:39], v[100:103], v[136:139], v[36:39]
    ds_read_b64 v[170:171], v23 offset:960
    ds_read_b128 v[200:203], v24 offset:512
    v_mfma_f32_16x16x32_bf16 v[40:43], v[104:107], v[136:139], v[40:43]
    ds_read_b64 v[172:173], v22 offset:1472
    ds_read_b64 v[174:175], v23 offset:1472
    s_waitcnt lgkmcnt(12)
    v_mfma_f32_16x16x32_bf16 v[40:43], v[108:111], v[132:135], v[40:43]
    ds_read_b128 v[204:207], v24 offset:1024
    ds_read_b64 v[176:177], v22 offset:1984
    v_mfma_f32_16x16x32_bf16 v[44:47], v[108:111], v[136:139], v[44:47]
    ds_read_b64 v[178:179], v23 offset:1984
    ds_read_b128 v[208:211], v24 offset:1536
    s_waitcnt vmcnt(0)
    v_cmp_ne_u32 vcc, v21, v14
    s_cbranch_vccz Lpd_4
    s_mov_b32 s96, 0
Lps_5x:
    buffer_load_dword v21, v20, s[36:39], s79 offen sc1
    s_waitcnt vmcnt(0)
    v_cmp_ne_u32 vcc, v21, v14
    s_cbranch_vccz Lpd_4
    s_sleep 1
    s_add_u32 s96, s96, 1
    s_cmp_lt_u32 s96, 100000
    s_cbranch_scc1 Lps_5x
Lpd_4:
    s_waitcnt lgkmcnt(15)
    v_mfma_f32_16x16x32_bf16 v[40:43], v[100:103], v[140:143], v[40:43]
    buffer_load_dwordx2 v[64:65], v28, s[36:39], s72 offen offset:0 sc1
    v_mfma_f32_16x16x32_bf16 v[44:47], v[104:107], v[140:143], v[44:47]
    buffer_load_dwordx2 v[66:67], v28, s[36:39], s72 offen offset:128 sc1
    s_waitcnt lgkmcnt(13)
    v_mfma_f32_16x16x32_bf16 v[44:47], v[112:115], v[132:135], v[44:47]
    buffer_load_dwordx2 v[68:69], v28, s[36:39], s72 offen offset:1024 sc1
    s_waitcnt lgkmcnt(12)
    v_mfma_f32_16x16x32_bf16 v[44:47], v[100:103], v[144:147], v[44:47]
    buffer_load_dwordx2 v[70:71], v28, s[36:39], s72 offen offset:1152 sc1
    s_waitcnt lgkmcnt(9)
    v_mfma_f32_16x16x32_bf16 v[32:35], v[164:167], v[196:199], v[32:35]
    buffer_load_dwordx4 v[80:83], v6, s[36:39], s101 offen offset:0 sc1
    s_waitcnt lgkmcnt(7)
    v_mfma_f32_16x16x32_bf16 v[36:39], v[168:171], v[196:199], v[36:39]
    buffer_load_dwordx4 v[84:87], v6, s[36:39], s101 offen offset:256 sc1
    s_waitcnt lgkmcnt(6)
    v_mfma_f32_16x16x32_bf16 v[36:39], v[164:167], v[200:203], v[36:39]
    buffer_load_dwordx4 v[88:91], v6, s[36:39], s101 offen offset:2048 sc1
    v_mfma_f32_16x16x32_bf16 v[40:43], v[168:171], v[200:203], v[40:43]
    buffer_load_dwordx4 v[92:95], v6, s[36:39], s101 offen offset:2304 sc1
    s_waitcnt lgkmcnt(4)
    v_mfma_f32_16x16x32_bf16 v[40:43], v[172:175], v[196:199], v[40:43]
    buffer_load_dwordx2 v[72:73], v28, s[36:39], s73 offen offset:0 sc1
    v_mfma_f32_16x16x32_bf16 v[44:47], v[172:175], v[200:203], v[44:47]
    buffer_load_dwordx2 v[74:75], v28, s[36:39], s73 offen offset:128 sc1
    s_waitcnt lgkmcnt(3)
    v_mfma_f32_16x16x32_bf16 v[40:43], v[164:167], v[204:207], v[40:43]
    buffer_load_dwordx2 v[76:77], v28, s[36:39], s73 offen offset:1024 sc1
    v_mfma_f32_16x16x32_bf16 v[44:47], v[168:171], v[204:207], v[44:47]
    buffer_load_dwordx2 v[78:79], v28, s[36:39], s73 offen offset:1152 sc1
    s_waitcnt lgkmcnt(1)
    v_mfma_f32_16x16x32_bf16 v[44:47], v[176:179], v[196:199], v[44:47]
    v_min_u32 v17, 1, v1
    s_waitcnt lgkmcnt(0)
    v_mfma_f32_16x16x32_bf16 v[44:47], v[164:167], v[208:211], v[44:47]
    v_max_u32 v17, 0, v17
    v_lshlrev_b32 v17, 9, v17
    s_mul_i32 s79, s61, 20
    s_add_u32 s79, s79, s6
    s_lshl_b32 s79, s79, 7
    s_add_u32 s79, s79, 6619136
    v_min_u32 v16, 4, v1
    v_max_u32 v16, 0, v16
    v_lshlrev_b32 v16, 9, v16
    s_mul_i32 s79, s61, 20
    s_add_u32 s79, s79, s6
    s_lshl_b32 s79, s79, 7
    s_add_u32 s79, s79, 6619136
    s_mul_i32 s8, s61, 143360
    s_add_u32 s8, s8, 8388608
    s_mul_i32 s9, s6, 7168
    s_add_u32 s8, s8, s9
    s_sub_u32 s9, 136192, s9
    buffer_load_dword v21, v17, s[36:39], s79 offen sc1
    ds_read_b64 v[48:49], v25 offset:0
    ds_read_b64 v[50:51], v25 offset:512
    ds_read_b64 v[52:53], v25 offset:1024
    ds_read_b64 v[54:55], v25 offset:1536
    s_mul_i32 s76, s6, 327680
    s_lshl_b32 s74, s34, 8
    s_add_u32 s76, s74, s76
    s_waitcnt lgkmcnt(3)
    v_lshlrev_b32 v59, 16, v48
    v_and_b32 v58, 0xffff0000, v48
    v_lshlrev_b32 v57, 16, v49
    v_and_b32 v56, 0xffff0000, v49
    v_fmac_f32 v32, s77, v56
    v_fmac_f32 v33, s77, v57
    v_fmac_f32 v34, s77, v58
    v_fmac_f32 v35, s77, v59
    v_cvt_pk_bf16_f32 v32, v32, v33
    v_cvt_pk_bf16_f32 v33, v34, v35
    ds_write_b64 v26, v[32:33] offset:0
    s_waitcnt lgkmcnt(3)
    v_lshlrev_b32 v59, 16, v50
    v_and_b32 v58, 0xffff0000, v50
    v_lshlrev_b32 v57, 16, v51
    v_and_b32 v56, 0xffff0000, v51
    v_fmac_f32 v36, s77, v56
    v_fmac_f32 v37, s77, v57
    v_fmac_f32 v38, s77, v58
    v_fmac_f32 v39, s77, v59
    v_cvt_pk_bf16_f32 v36, v36, v37
    v_cvt_pk_bf16_f32 v37, v38, v39
    ds_write_b64 v26, v[36:37] offset:512
    s_waitcnt lgkmcnt(3)
    v_lshlrev_b32 v59, 16, v52
    v_and_b32 v58, 0xffff0000, v52
    v_lshlrev_b32 v57, 16, v53
    v_and_b32 v56, 0xffff0000, v53
    v_fmac_f32 v40, s77, v56
    v_fmac_f32 v41, s77, v57
    v_fmac_f32 v42, s77, v58
    v_fmac_f32 v43, s77, v59
    v_cvt_pk_bf16_f32 v40, v40, v41
    v_cvt_pk_bf16_f32 v41, v42, v43
    ds_write_b64 v26, v[40:41] offset:1024
    s_waitcnt lgkmcnt(3)
    v_lshlrev_b32 v59, 16, v54
    v_and_b32 v58, 0xffff0000, v54
    v_lshlrev_b32 v57, 16, v55
    v_and_b32 v56, 0xffff0000, v55
    v_fmac_f32 v44, s77, v56
    v_fmac_f32 v45, s77, v57
    v_fmac_f32 v46, s77, v58
    v_fmac_f32 v47, s77, v59
    v_cvt_pk_bf16_f32 v44, v44, v45
    v_cvt_pk_bf16_f32 v45, v46, v47
    ds_write_b64 v26, v[44:45] offset:1536
    s_waitcnt lgkmcnt(0)
    s_barrier
    ds_read_b64_tr_b16 v[232:233], v27 offset:0
    ds_read_b64_tr_b16 v[234:235], v27 offset:32
    ds_read_b64_tr_b16 v[236:237], v27 offset:256
    ds_read_b64_tr_b16 v[238:239], v27 offset:288
    s_waitcnt vmcnt(8)
    v_cmp_ne_u32 vcc, v83, v14
    s_cbranch_vccz Lpd_6
    s_mov_b32 s96, 0
Lps_7x:
    buffer_load_dwordx4 v[80:83], v6, s[36:39], s101 offen offset:0 sc1
    s_waitcnt vmcnt(0)
    v_cmp_ne_u32 vcc, v83, v14
    s_cbranch_vccz Lpd_6
    s_sleep 1
    s_add_u32 s96, s96, 1
    s_cmp_lt_u32 s96, 100000
    s_cbranch_scc1 Lps_7x
Lpd_6:
    s_waitcnt vmcnt(7)
    v_cmp_ne_u32 vcc, v87, v14
    s_cbranch_vccz Lpd_8
    s_mov_b32 s96, 0
Lps_9x:
    buffer_load_dwordx4 v[84:87], v6, s[36:39], s101 offen offset:256 sc1
    s_waitcnt vmcnt(0)
    v_cmp_ne_u32 vcc, v87, v14
    s_cbranch_vccz Lpd_8
    s_sleep 1
    s_add_u32 s96, s96, 1
    s_cmp_lt_u32 s96, 100000
    s_cbranch_scc1 Lps_9x
Lpd_8:
    s_waitcnt vmcnt(6)
    v_cmp_ne_u32 vcc, v91, v14
    s_cbranch_vccz Lpd_10
    s_mov_b32 s96, 0
Lps_11x:
    buffer_load_dwordx4 v[88:91], v6, s[36:39], s101 offen offset:2048 sc1
    s_waitcnt vmcnt(0)
    v_cmp_ne_u32 vcc, v91, v14
    s_cbranch_vccz Lpd_10
    s_sleep 1
    s_add_u32 s96, s96, 1
    s_cmp_lt_u32 s96, 100000
    s_cbranch_scc1 Lps_11x
Lpd_10:
    s_waitcnt vmcnt(5)
    v_cmp_ne_u32 vcc, v95, v14
    s_cbranch_vccz Lpd_12
    s_mov_b32 s96, 0
Lps_13x:
    buffer_load_dwordx4 v[92:95], v6, s[36:39], s101 offen offset:2304 sc1
    s_waitcnt vmcnt(0)
    v_cmp_ne_u32 vcc, v95, v14
    s_cbranch_vccz Lpd_12
    s_sleep 1
    s_add_u32 s96, s96, 1
    s_cmp_lt_u32 s96, 100000
    s_cbranch_scc1 Lps_13x
Lpd_12:
    v_lshlrev_b32 v100, 16, v64
    v_and_b32 v101, 0xffff0000, v64
    v_lshlrev_b32 v102, 16, v65
    v_and_b32 v103, 0xffff0000, v65
    v_pk_add_f32 v[108:109], v[100:101], v[80:81] op_sel_hi:[1,0] neg_lo:[0,1] neg_hi:[0,1]
    v_pk_add_f32 v[110:111], v[102:103], v[80:81] op_sel_hi:[1,0] neg_lo:[0,1] neg_hi:[0,1]
    v_pk_mul_f32 v[108:109], v[108:109], v[80:81] op_sel:[0,1] op_sel_hi:[1,1]
    v_pk_mul_f32 v[110:111], v[110:111], v[80:81] op_sel:[0,1] op_sel_hi:[1,1]
    s_waitcnt lgkmcnt(3)
    v_lshlrev_b32 v104, 16, v232
    v_and_b32 v105, 0xffff0000, v232
    v_lshlrev_b32 v106, 16, v233
    v_and_b32 v107, 0xffff0000, v233
    v_pk_fma_f32 v[100:101], v[108:109], v[104:105], v[100:101]
    v_pk_fma_f32 v[102:103], v[110:111], v[106:107], v[102:103]
    v_cvt_pk_bf16_f32 v64, v100, v101
    v_cvt_pk_bf16_f32 v65, v102, v103
    v_lshlrev_b32 v100, 16, v66
    v_and_b32 v101, 0xffff0000, v66
    v_lshlrev_b32 v102, 16, v67
    v_and_b32 v103, 0xffff0000, v67
    v_pk_add_f32 v[108:109], v[100:101], v[84:85] op_sel_hi:[1,0] neg_lo:[0,1] neg_hi:[0,1]
    v_pk_add_f32 v[110:111], v[102:103], v[84:85] op_sel_hi:[1,0] neg_lo:[0,1] neg_hi:[0,1]
    v_pk_mul_f32 v[108:109], v[108:109], v[84:85] op_sel:[0,1] op_sel_hi:[1,1]
    v_pk_mul_f32 v[110:111], v[110:111], v[84:85] op_sel:[0,1] op_sel_hi:[1,1]
    s_waitcnt lgkmcnt(2)
    v_lshlrev_b32 v104, 16, v234
    v_and_b32 v105, 0xffff0000, v234
    v_lshlrev_b32 v106, 16, v235
    v_and_b32 v107, 0xffff0000, v235
    v_pk_fma_f32 v[100:101], v[108:109], v[104:105], v[100:101]
    v_pk_fma_f32 v[102:103], v[110:111], v[106:107], v[102:103]
    v_cvt_pk_bf16_f32 v66, v100, v101
    v_cvt_pk_bf16_f32 v67, v102, v103
    v_lshlrev_b32 v100, 16, v68
    v_and_b32 v101, 0xffff0000, v68
    v_lshlrev_b32 v102, 16, v69
    v_and_b32 v103, 0xffff0000, v69
    v_pk_add_f32 v[108:109], v[100:101], v[88:89] op_sel_hi:[1,0] neg_lo:[0,1] neg_hi:[0,1]
    v_pk_add_f32 v[110:111], v[102:103], v[88:89] op_sel_hi:[1,0] neg_lo:[0,1] neg_hi:[0,1]
    v_pk_mul_f32 v[108:109], v[108:109], v[88:89] op_sel:[0,1] op_sel_hi:[1,1]
    v_pk_mul_f32 v[110:111], v[110:111], v[88:89] op_sel:[0,1] op_sel_hi:[1,1]
    s_waitcnt lgkmcnt(1)
    v_lshlrev_b32 v104, 16, v236
    v_and_b32 v105, 0xffff0000, v236
    v_lshlrev_b32 v106, 16, v237
    v_and_b32 v107, 0xffff0000, v237
    v_pk_fma_f32 v[100:101], v[108:109], v[104:105], v[100:101]
    v_pk_fma_f32 v[102:103], v[110:111], v[106:107], v[102:103]
    v_cvt_pk_bf16_f32 v68, v100, v101
    v_cvt_pk_bf16_f32 v69, v102, v103
    v_lshlrev_b32 v100, 16, v70
    v_and_b32 v101, 0xffff0000, v70
    v_lshlrev_b32 v102, 16, v71
    v_and_b32 v103, 0xffff0000, v71
    v_pk_add_f32 v[108:109], v[100:101], v[92:93] op_sel_hi:[1,0] neg_lo:[0,1] neg_hi:[0,1]
    v_pk_add_f32 v[110:111], v[102:103], v[92:93] op_sel_hi:[1,0] neg_lo:[0,1] neg_hi:[0,1]
    v_pk_mul_f32 v[108:109], v[108:109], v[92:93] op_sel:[0,1] op_sel_hi:[1,1]
    v_pk_mul_f32 v[110:111], v[110:111], v[92:93] op_sel:[0,1] op_sel_hi:[1,1]
    s_waitcnt lgkmcnt(0)
    v_lshlrev_b32 v104, 16, v238
    v_and_b32 v105, 0xffff0000, v238
    v_lshlrev_b32 v106, 16, v239
    v_and_b32 v107, 0xffff0000, v239
    v_pk_fma_f32 v[100:101], v[108:109], v[104:105], v[100:101]
    v_pk_fma_f32 v[102:103], v[110:111], v[106:107], v[102:103]
    v_cvt_pk_bf16_f32 v70, v100, v101
    v_cvt_pk_bf16_f32 v71, v102, v103
    s_add_u32 s74, s76, 15728640
    buffer_store_dwordx4 v[64:67], v29, s[36:39], s74 offen sc1
    s_add_u32 s74, s76, 15892480
    buffer_store_dwordx4 v[68:71], v29, s[36:39], s74 offen sc1
    s_add_u32 s101, s101, 16384
    buffer_load_dwordx4 v[80:83], v6, s[36:39], s101 offen offset:0 sc1
    buffer_load_dwordx4 v[84:87], v6, s[36:39], s101 offen offset:256 sc1
    buffer_load_dwordx4 v[88:91], v6, s[36:39], s101 offen offset:2048 sc1
    buffer_load_dwordx4 v[92:95], v6, s[36:39], s101 offen offset:2304 sc1
    ds_read_b64 v[100:101], v22 offset:0
    ds_read_b64 v[102:103], v23 offset:0
    ds_read_b128 v[148:151], v24 offset:2496
    ds_read_b128 v[152:155], v24 offset:3008
    ds_read_b128 v[156:159], v24 offset:3520
    ds_read_b128 v[160:163], v24 offset:4032
    ds_read_b64 v[104:105], v22 offset:512
    ds_read_b64 v[106:107], v23 offset:512
    ds_read_b128 v[144:147], v24 offset:1984
    ds_read_b64 v[108:109], v22 offset:1024
    ds_read_b64 v[110:111], v23 offset:1024
    ds_read_b128 v[140:143], v24 offset:1472
    ds_read_b64 v[112:113], v22 offset:1536
    ds_read_b64 v[114:115], v23 offset:1536
    ds_read_b128 v[136:139], v24 offset:960
    ds_read_b64 v[116:117], v22 offset:2048
    ds_read_b64 v[118:119], v23 offset:2048
    ds_read_b128 v[132:135], v24 offset:448
    ds_read_b64 v[120:121], v22 offset:2560
    ds_read_b64 v[122:123], v23 offset:2560
    ds_read_b64 v[124:125], v22 offset:3072
    ds_read_b64 v[126:127], v23 offset:3072
    ds_read_b64 v[128:129], v22 offset:3584
    ds_read_b64 v[130:131], v23 offset:3584
    s_waitcnt lgkmcnt(15)
    v_mfma_f32_16x16x32_bf16 v[32:35], v[100:103], v[148:151], 0
    ds_read_b64 v[164:165], v22 offset:64
    v_min_u32 v62, 31, v1
    v_mfma_f32_16x16x32_bf16 v[36:39], v[100:103], v[152:155], 0
    ds_read_b64 v[166:167], v23 offset:64
    v_lshlrev_b32 v62, 7, v62
    v_mfma_f32_16x16x32_bf16 v[40:43], v[100:103], v[156:159], 0
    ds_read_b128 v[212:215], v24 offset:2432
    s_lshl_b32 s11, s4, 12
    v_mfma_f32_16x16x32_bf16 v[44:47], v[100:103], v[160:163], 0
    ds_read_b128 v[216:219], v24 offset:2944
    s_add_u32 s11, s11, 6291456
    v_mfma_f32_16x16x32_bf16 v[32:35], v[104:107], v[144:147], v[32:35]
    ds_read_b128 v[220:223], v24 offset:3456
    buffer_load_dword v60, v62, s[36:39], s11 offen sc1
    v_mfma_f32_16x16x32_bf16 v[36:39], v[104:107], v[148:151], v[36:39]
    ds_read_b128 v[224:227], v24 offset:3968
    s_lshl_b32 s7, s5, 2
    v_mfma_f32_16x16x32_bf16 v[40:43], v[104:107], v[152:155], v[40:43]
    ds_read_b64 v[168:169], v22 offset:576
    s_add_u32 s7, s7, s6
    v_mfma_f32_16x16x32_bf16 v[44:47], v[104:107], v[156:159], v[44:47]
    ds_read_b64 v[170:171], v23 offset:576
    s_mul_i32 s7, s7, 256
    s_waitcnt lgkmcnt(15)
    v_mfma_f32_16x16x32_bf16 v[32:35], v[108:111], v[140:143], v[32:35]
    ds_read_b128 v[208:211], v24 offset:1920
    v_lshl_add_u32 v96, v1, 7, s7
    v_mfma_f32_16x16x32_bf16 v[36:39], v[108:111], v[144:147], v[36:39]
    ds_read_b64 v[172:173], v22 offset:1088
    v_min_u32 v96, L_helper-L_g1c, v96
    v_mfma_f32_16x16x32_bf16 v[40:43], v[108:111], v[148:151], v[40:43]
    ds_read_b64 v[174:175], v23 offset:1088
    v_add_u32 v96, L_g1c-Lpf_14, v96
    v_mfma_f32_16x16x32_bf16 v[44:47], v[108:111], v[152:155], v[44:47]
    ds_read_b128 v[204:207], v24 offset:1408
    s_getpc_b64 s[12:13]
Lpf_14:
    s_mov_b64 exec, 3
    global_load_dword v5, v96, s[12:13]
    s_mov_b64 exec, -1
    v_mfma_f32_16x16x32_bf16 v[32:35], v[112:115], v[136:139], v[32:35]
    ds_read_b64 v[176:177], v22 offset:1600
    v_mfma_f32_16x16x32_bf16 v[36:39], v[112:115], v[140:143], v[36:39]
    ds_read_b64 v[178:179], v23 offset:1600
    v_mfma_f32_16x16x32_bf16 v[40:43], v[112:115], v[144:147], v[40:43]
    ds_read_b128 v[200:203], v24 offset:896
    v_mfma_f32_16x16x32_bf16 v[44:47], v[112:115], v[148:151], v[44:47]
    ds_read_b64 v[180:181], v22 offset:2112
    s_waitcnt lgkmcnt(15)
    v_mfma_f32_16x16x32_bf16 v[32:35], v[116:119], v[132:135], v[32:35]
    ds_read_b64 v[182:183], v23 offset:2112
    v_mfma_f32_16x16x32_bf16 v[36:39], v[116:119], v[136:139], v[36:39]
    ds_read_b128 v[196:199], v24 offset:384
    v_mfma_f32_16x16x32_bf16 v[40:43], v[116:119], v[140:143], v[40:43]
    ds_read_b64 v[184:185], v22 offset:2624
    v_mfma_f32_16x16x32_bf16 v[44:47], v[116:119], v[144:147], v[44:47]
    ds_read_b64 v[186:187], v23 offset:2624
    v_mfma_f32_16x16x32_bf16 v[36:39], v[120:123], v[132:135], v[36:39]
    ds_read_b64 v[188:189], v22 offset:3136
    v_mfma_f32_16x16x32_bf16 v[40:43], v[120:123], v[136:139], v[40:43]
    ds_read_b64 v[190:191], v23 offset:3136
    v_mfma_f32_16x16x32_bf16 v[44:47], v[120:123], v[140:143], v[44:47]
    ds_read_b64 v[192:193], v22 offset:3648
    v_mfma_f32_16x16x32_bf16 v[40:43], v[124:127], v[132:135], v[40:43]
    ds_read_b64 v[194:195], v23 offset:3648
    v_mfma_f32_16x16x32_bf16 v[44:47], v[124:127], v[136:139], v[44:47]
    v_mfma_f32_16x16x32_bf16 v[44:47], v[128:131], v[132:135], v[44:47]
    s_waitcnt lgkmcnt(15)
    v_mfma_f32_16x16x32_bf16 v[32:35], v[164:167], v[212:215], v[32:35]
    ds_read_b64 v[100:101], v22 offset:128
    v_mfma_f32_16x16x32_bf16 v[36:39], v[164:167], v[216:219], v[36:39]
    ds_read_b64 v[102:103], v23 offset:128
    v_mfma_f32_16x16x32_bf16 v[40:43], v[164:167], v[220:223], v[40:43]
    ds_read_b128 v[148:151], v24 offset:2368
    v_mfma_f32_16x16x32_bf16 v[44:47], v[164:167], v[224:227], v[44:47]
    ds_read_b128 v[152:155], v24 offset:2880
    v_mfma_f32_16x16x32_bf16 v[32:35], v[168:171], v[208:211], v[32:35]
    ds_read_b128 v[156:159], v24 offset:3392
    v_mfma_f32_16x16x32_bf16 v[36:39], v[168:171], v[212:215], v[36:39]
    ds_read_b128 v[160:163], v24 offset:3904
    v_mfma_f32_16x16x32_bf16 v[40:43], v[168:171], v[216:219], v[40:43]
    ds_read_b64 v[104:105], v22 offset:640
    v_mfma_f32_16x16x32_bf16 v[44:47], v[168:171], v[220:223], v[44:47]
    ds_read_b64 v[106:107], v23 offset:640
    s_waitcnt lgkmcnt(15)
    v_mfma_f32_16x16x32_bf16 v[32:35], v[172:175], v[204:207], v[32:35]
    ds_read_b128 v[144:147], v24 offset:1856
    v_mfma_f32_16x16x32_bf16 v[36:39], v[172:175], v[208:211], v[36:39]
    ds_read_b64 v[108:109], v22 offset:1152
    v_mfma_f32_16x16x32_bf16 v[40:43], v[172:175], v[212:215], v[40:43]
    ds_read_b64 v[110:111], v23 offset:1152
    v_mfma_f32_16x16x32_bf16 v[44:47], v[172:175], v[216:219], v[44:47]
    ds_read_b128 v[140:143], v24 offset:1344
    v_mfma_f32_16x16x32_bf16 v[32:35], v[176:179], v[200:203], v[32:35]
    ds_read_b64 v[112:113], v22 offset:1664
    v_mfma_f32_16x16x32_bf16 v[36:39], v[176:179], v[204:207], v[36:39]
    ds_read_b64 v[114:115], v23 offset:1664
    v_mfma_f32_16x16x32_bf16 v[40:43], v[176:179], v[208:211], v[40:43]
    ds_read_b128 v[136:139], v24 offset:832
    v_mfma_f32_16x16x32_bf16 v[44:47], v[176:179], v[212:215], v[44:47]
    ds_read_b64 v[116:117], v22 offset:2176
    s_waitcnt lgkmcnt(15)
    v_mfma_f32_16x16x32_bf16 v[32:35], v[180:183], v[196:199], v[32:35]
    ds_read_b64 v[118:119], v23 offset:2176
    v_mfma_f32_16x16x32_bf16 v[36:39], v[180:183], v[200:203], v[36:39]
    ds_read_b128 v[132:135], v24 offset:320
    v_mfma_f32_16x16x32_bf16 v[40:43], v[180:183], v[204:207], v[40:43]
    ds_read_b64 v[120:121], v22 offset:2688
    v_mfma_f32_16x16x32_bf16 v[44:47], v[180:183], v[208:211], v[44:47]
    ds_read_b64 v[122:123], v23 offset:2688
    v_mfma_f32_16x16x32_bf16 v[36:39], v[184:187], v[196:199], v[36:39]
    ds_read_b64 v[124:125], v22 offset:3200
    v_mfma_f32_16x16x32_bf16 v[40:43], v[184:187], v[200:203], v[40:43]
    ds_read_b64 v[126:127], v23 offset:3200
    v_mfma_f32_16x16x32_bf16 v[44:47], v[184:187], v[204:207], v[44:47]
    ds_read_b64 v[128:129], v22 offset:3712
    v_mfma_f32_16x16x32_bf16 v[40:43], v[188:191], v[196:199], v[40:43]
    ds_read_b64 v[130:131], v23 offset:3712
    v_mfma_f32_16x16x32_bf16 v[44:47], v[188:191], v[200:203], v[44:47]
    v_mfma_f32_16x16x32_bf16 v[44:47], v[192:195], v[196:199], v[44:47]
    s_waitcnt lgkmcnt(15)
    v_mfma_f32_16x16x32_bf16 v[32:35], v[100:103], v[148:151], v[32:35]
    ds_read_b64 v[164:165], v22 offset:192
    v_mfma_f32_16x16x32_bf16 v[36:39], v[100:103], v[152:155], v[36:39]
    ds_read_b64 v[166:167], v23 offset:192
    v_mfma_f32_16x16x32_bf16 v[40:43], v[100:103], v[156:159], v[40:43]
    ds_read_b128 v[212:215], v24 offset:2304
    v_mfma_f32_16x16x32_bf16 v[44:47], v[100:103], v[160:163], v[44:47]
    ds_read_b128 v[216:219], v24 offset:2816
    s_waitcnt vmcnt(6)
    s_mov_b64 exec, 1
    buffer_store_dword v14, off, s[36:39], s68 sc1
    s_mov_b64 exec, -1
    v_mfma_f32_16x16x32_bf16 v[32:35], v[104:107], v[144:147], v[32:35]
    ds_read_b128 v[220:223], v24 offset:3328
    s_add_u32 s74, s76, 18350080
    buffer_store_dwordx4 v[232:235], v29, s[36:39], s74 offen sc1
    v_mfma_f32_16x16x32_bf16 v[36:39], v[104:107], v[148:151], v[36:39]
    ds_read_b128 v[224:227], v24 offset:3840
    s_add_u32 s74, s76, 18513920
    buffer_store_dwordx4 v[236:239], v29, s[36:39], s74 offen sc1
    v_mfma_f32_16x16x32_bf16 v[40:43], v[104:107], v[152:155], v[40:43]
    ds_read_b64 v[168:169], v22 offset:704
    v_mfma_f32_16x16x32_bf16 v[44:47], v[104:107], v[156:159], v[44:47]
    ds_read_b64 v[170:171], v23 offset:704
    s_waitcnt lgkmcnt(15)
    v_mfma_f32_16x16x32_bf16 v[32:35], v[108:111], v[140:143], v[32:35]
    ds_read_b128 v[208:211], v24 offset:1792
    v_mfma_f32_16x16x32_bf16 v[36:39], v[108:111], v[144:147], v[36:39]
    ds_read_b64 v[172:173], v22 offset:1216
    v_mfma_f32_16x16x32_bf16 v[40:43], v[108:111], v[148:151], v[40:43]
    ds_read_b64 v[174:175], v23 offset:1216
    v_mfma_f32_16x16x32_bf16 v[44:47], v[108:111], v[152:155], v[44:47]
    ds_read_b128 v[204:207], v24 offset:1280
    v_mfma_f32_16x16x32_bf16 v[32:35], v[112:115], v[136:139], v[32:35]
    ds_read_b64 v[176:177], v22 offset:1728
    v_mfma_f32_16x16x32_bf16 v[36:39], v[112:115], v[140:143], v[36:39]
    ds_read_b64 v[178:179], v23 offset:1728
    v_mfma_f32_16x16x32_bf16 v[40:43], v[112:115], v[144:147], v[40:43]
    ds_read_b128 v[200:203], v24 offset:768
    v_mfma_f32_16x16x32_bf16 v[44:47], v[112:115], v[148:151], v[44:47]
    ds_read_b64 v[180:181], v22 offset:2240
    s_waitcnt lgkmcnt(15)
    v_mfma_f32_16x16x32_bf16 v[32:35], v[116:119], v[132:135], v[32:35]
    ds_read_b64 v[182:183], v23 offset:2240
    v_mfma_f32_16x16x32_bf16 v[36:39], v[116:119], v[136:139], v[36:39]
    ds_read_b128 v[196:199], v24 offset:256
    v_mfma_f32_16x16x32_bf16 v[40:43], v[116:119], v[140:143], v[40:43]
    ds_read_b64 v[184:185], v22 offset:2752
    v_mfma_f32_16x16x32_bf16 v[44:47], v[116:119], v[144:147], v[44:47]
    ds_read_b64 v[186:187], v23 offset:2752
    v_mfma_f32_16x16x32_bf16 v[36:39], v[120:123], v[132:135], v[36:39]
    ds_read_b64 v[188:189], v22 offset:3264
    v_mfma_f32_16x16x32_bf16 v[40:43], v[120:123], v[136:139], v[40:43]
    ds_read_b64 v[190:191], v23 offset:3264
    v_mfma_f32_16x16x32_bf16 v[44:47], v[120:123], v[140:143], v[44:47]
    ds_read_b64 v[192:193], v22 offset:3776
    v_mfma_f32_16x16x32_bf16 v[40:43], v[124:127], v[132:135], v[40:43]
    ds_read_b64 v[194:195], v23 offset:3776
    v_cmp_ne_u32 vcc, v21, v14
    s_cbranch_vccz Lpd_15
    s_mov_b32 s96, 0
Lps_16x:
    buffer_load_dword v21, v17, s[36:39], s79 offen sc1
    s_waitcnt vmcnt(0)
    v_cmp_ne_u32 vcc, v21, v14
    s_cbranch_vccz Lpd_15
    s_sleep 1
    s_add_u32 s96, s96, 1
    s_cmp_lt_u32 s96, 100000
    s_cbranch_scc1 Lps_16x
Lpd_15:
    v_mfma_f32_16x16x32_bf16 v[44:47], v[124:127], v[136:139], v[44:47]
    s_add_u32 s10, s8, 0
    s_add_u32 m0, s9, 0
    s_nop 0
    buffer_load_dwordx4 v2, s[36:39], s10 offen sc1 lds
    v_mfma_f32_16x16x32_bf16 v[44:47], v[128:131], v[132:135], v[44:47]
    s_waitcnt lgkmcnt(15)
    v_mfma_f32_16x16x32_bf16 v[32:35], v[164:167], v[212:215], v[32:35]
    ds_read_b64 v[100:101], v22 offset:256
    v_mfma_f32_16x16x32_bf16 v[36:39], v[164:167], v[216:219], v[36:39]
    ds_read_b64 v[102:103], v23 offset:256
    v_mfma_f32_16x16x32_bf16 v[40:43], v[164:167], v[220:223], v[40:43]
    ds_read_b128 v[148:151], v24 offset:2240
    v_mfma_f32_16x16x32_bf16 v[44:47], v[164:167], v[224:227], v[44:47]
    ds_read_b128 v[152:155], v24 offset:2752
    s_add_u32 s10, s8, 1024
    s_add_u32 m0, s9, 1024
    s_nop 0
    buffer_load_dwordx4 v2, s[36:39], s10 offen sc1 lds
    v_mfma_f32_16x16x32_bf16 v[32:35], v[168:171], v[208:211], v[32:35]
    ds_read_b128 v[156:159], v24 offset:3264
    v_mfma_f32_16x16x32_bf16 v[36:39], v[168:171], v[212:215], v[36:39]
    ds_read_b128 v[160:163], v24 offset:3776
    v_mfma_f32_16x16x32_bf16 v[40:43], v[168:171], v[216:219], v[40:43]
    ds_read_b64 v[104:105], v22 offset:768
    v_mfma_f32_16x16x32_bf16 v[44:47], v[168:171], v[220:223], v[44:47]
    ds_read_b64 v[106:107], v23 offset:768
    s_waitcnt vmcnt(6)
    v_subrev_u32 v61, s97, v60
    v_add_u32 v61, -1, v61
    v_cmp_lt_u32 vcc, 15, v61
    s_cbranch_vccnz Lxc_17
Lxd_18:
    v_cmp_ne_u32 vcc, s31, v60
    s_nop 0
    s_cmp_eq_u64 vcc, 0
    s_cselect_b32 s30, 1, 0
    s_waitcnt lgkmcnt(15)
    v_mfma_f32_16x16x32_bf16 v[32:35], v[172:175], v[204:207], v[32:35]
    ds_read_b128 v[144:147], v24 offset:1728
    s_add_u32 s10, s8, 2048
    s_add_u32 m0, s9, 2048
    s_nop 0
    buffer_load_dwordx4 v2, s[36:39], s10 offen sc1 lds
    v_mfma_f32_16x16x32_bf16 v[36:39], v[172:175], v[208:211], v[36:39]
    ds_read_b64 v[108:109], v22 offset:1280
    v_mfma_f32_16x16x32_bf16 v[40:43], v[172:175], v[212:215], v[40:43]
    ds_read_b64 v[110:111], v23 offset:1280
    v_mfma_f32_16x16x32_bf16 v[44:47], v[172:175], v[216:219], v[44:47]
    ds_read_b128 v[140:143], v24 offset:1216
    v_mfma_f32_16x16x32_bf16 v[32:35], v[176:179], v[200:203], v[32:35]
    ds_read_b64 v[112:113], v22 offset:1792
    v_mfma_f32_16x16x32_bf16 v[36:39], v[176:179], v[204:207], v[36:39]
    ds_read_b64 v[114:115], v23 offset:1792
    v_mfma_f32_16x16x32_bf16 v[40:43], v[176:179], v[208:211], v[40:43]
    ds_read_b128 v[136:139], v24 offset:704
    s_add_u32 s10, s8, 3072
    s_add_u32 m0, s9, 3072
    s_nop 0
    buffer_load_dwordx4 v2, s[36:39], s10 offen sc1 lds
    v_mfma_f32_16x16x32_bf16 v[44:47], v[176:179], v[212:215], v[44:47]
    ds_read_b64 v[116:117], v22 offset:2304
    s_waitcnt lgkmcnt(15)
    v_mfma_f32_16x16x32_bf16 v[32:35], v[180:183], v[196:199], v[32:35]
    ds_read_b64 v[118:119], v23 offset:2304
    v_mfma_f32_16x16x32_bf16 v[36:39], v[180:183], v[200:203], v[36:39]
    ds_read_b128 v[132:135], v24 offset:192
    v_mfma_f32_16x16x32_bf16 v[40:43], v[180:183], v[204:207], v[40:43]
    ds_read_b64 v[120:121], v22 offset:2816
    v_mfma_f32_16x16x32_bf16 v[44:47], v[180:183], v[208:211], v[44:47]
    ds_read_b64 v[122:123], v23 offset:2816
    s_add_u32 s10, s8, 4096
    s_add_u32 m0, s9, 4096
    s_nop 0
    buffer_load_dwordx4 v2, s[36:39], s10 offen sc1 lds
    v_mfma_f32_16x16x32_bf16 v[36:39], v[184:187], v[196:199], v[36:39]
    ds_read_b64 v[124:125], v22 offset:3328
    v_mfma_f32_16x16x32_bf16 v[40:43], v[184:187], v[200:203], v[40:43]
    ds_read_b64 v[126:127], v23 offset:3328
    v_mfma_f32_16x16x32_bf16 v[44:47], v[184:187], v[204:207], v[44:47]
    ds_read_b64 v[128:129], v22 offset:3840
    v_mfma_f32_16x16x32_bf16 v[40:43], v[188:191], v[196:199], v[40:43]
    ds_read_b64 v[130:131], v23 offset:3840
    v_mfma_f32_16x16x32_bf16 v[44:47], v[188:191], v[200:203], v[44:47]
    s_add_u32 s10, s8, 5120
    s_add_u32 m0, s9, 5120
    s_nop 0
    buffer_load_dwordx4 v2, s[36:39], s10 offen sc1 lds
    v_mfma_f32_16x16x32_bf16 v[44:47], v[192:195], v[196:199], v[44:47]
    s_waitcnt lgkmcnt(15)
    v_mfma_f32_16x16x32_bf16 v[32:35], v[100:103], v[148:151], v[32:35]
    ds_read_b64 v[164:165], v22 offset:320
    v_mfma_f32_16x16x32_bf16 v[36:39], v[100:103], v[152:155], v[36:39]
    ds_read_b64 v[166:167], v23 offset:320
    v_mfma_f32_16x16x32_bf16 v[40:43], v[100:103], v[156:159], v[40:43]
    ds_read_b128 v[212:215], v24 offset:2176
    v_mfma_f32_16x16x32_bf16 v[44:47], v[100:103], v[160:163], v[44:47]
    ds_read_b128 v[216:219], v24 offset:2688
    v_mfma_f32_16x16x32_bf16 v[32:35], v[104:107], v[144:147], v[32:35]
    ds_read_b128 v[220:223], v24 offset:3200
    s_add_u32 s10, s8, 6144
    s_add_u32 m0, s9, 6144
    s_nop 0
    buffer_load_dwordx4 v2, s[36:39], s10 offen sc1 lds
    v_mfma_f32_16x16x32_bf16 v[36:39], v[104:107], v[148:151], v[36:39]
    ds_read_b128 v[224:227], v24 offset:3712
    v_mfma_f32_16x16x32_bf16 v[40:43], v[104:107], v[152:155], v[40:43]
    ds_read_b64 v[168:169], v22 offset:832
    v_mfma_f32_16x16x32_bf16 v[44:47], v[104:107], v[156:159], v[44:47]
    ds_read_b64 v[170:171], v23 offset:832
    s_waitcnt lgkmcnt(15)
    v_mfma_f32_16x16x32_bf16 v[32:35], v[108:111], v[140:143], v[32:35]
    ds_read_b128 v[208:211], v24 offset:1664
    v_mfma_f32_16x16x32_bf16 v[36:39], v[108:111], v[144:147], v[36:39]
    ds_read_b64 v[172:173], v22 offset:1344
    s_add_u32 s10, s8, 28672
    s_sub_u32 m0, s9, 28672
    s_nop 0
    buffer_load_dwordx4 v2, s[36:39], s10 offen sc1 lds
    v_mfma_f32_16x16x32_bf16 v[40:43], v[108:111], v[148:151], v[40:43]
    ds_read_b64 v[174:175], v23 offset:1344
    v_mfma_f32_16x16x32_bf16 v[44:47], v[108:111], v[152:155], v[44:47]
    ds_read_b128 v[204:207], v24 offset:1152
    v_mfma_f32_16x16x32_bf16 v[32:35], v[112:115], v[136:139], v[32:35]
    ds_read_b64 v[176:177], v22 offset:1856
    v_mfma_f32_16x16x32_bf16 v[36:39], v[112:115], v[140:143], v[36:39]
    ds_read_b64 v[178:179], v23 offset:1856
    v_mfma_f32_16x16x32_bf16 v[40:43], v[112:115], v[144:147], v[40:43]
    ds_read_b128 v[200:203], v24 offset:640
    s_add_u32 s10, s8, 29696
    s_sub_u32 m0, s9, 27648
    s_nop 0
    buffer_load_dwordx4 v2, s[36:39], s10 offen sc1 lds
    v_mfma_f32_16x16x32_bf16 v[44:47], v[112:115], v[148:151], v[44:47]
    ds_read_b64 v[180:181], v22 offset:2368
    s_waitcnt lgkmcnt(15)
    v_mfma_f32_16x16x32_bf16 v[32:35], v[116:119], v[132:135], v[32:35]
    ds_read_b64 v[182:183], v23 offset:2368
    v_mfma_f32_16x16x32_bf16 v[36:39], v[116:119], v[136:139], v[36:39]
    ds_read_b128 v[196:199], v24 offset:128
    v_mfma_f32_16x16x32_bf16 v[40:43], v[116:119], v[140:143], v[40:43]
    ds_read_b64 v[184:185], v22 offset:2880
    v_mfma_f32_16x16x32_bf16 v[44:47], v[116:119], v[144:147], v[44:47]
    ds_read_b64 v[186:187], v23 offset:2880
    v_mfma_f32_16x16x32_bf16 v[36:39], v[120:123], v[132:135], v[36:39]
    ds_read_b64 v[188:189], v22 offset:3392
    s_add_u32 s10, s8, 30720
    s_sub_u32 m0, s9, 26624
    s_nop 0
    buffer_load_dwordx4 v2, s[36:39], s10 offen sc1 lds
    v_mfma_f32_16x16x32_bf16 v[40:43], v[120:123], v[136:139], v[40:43]
    ds_read_b64 v[190:191], v23 offset:3392
    v_mfma_f32_16x16x32_bf16 v[44:47], v[120:123], v[140:143], v[44:47]
    ds_read_b64 v[192:193], v22 offset:3904
    v_mfma_f32_16x16x32_bf16 v[40:43], v[124:127], v[132:135], v[40:43]
    ds_read_b64 v[194:195], v23 offset:3904
    v_mfma_f32_16x16x32_bf16 v[44:47], v[124:127], v[136:139], v[44:47]
    v_mfma_f32_16x16x32_bf16 v[44:47], v[128:131], v[132:135], v[44:47]
    s_add_u32 s10, s8, 31744
    s_sub_u32 m0, s9, 25600
    s_nop 0
    buffer_load_dwordx4 v2, s[36:39], s10 offen sc1 lds
    s_waitcnt lgkmcnt(15)
    v_mfma_f32_16x16x32_bf16 v[32:35], v[164:167], v[212:215], v[32:35]
    ds_read_b64 v[100:101], v22 offset:384
    v_mfma_f32_16x16x32_bf16 v[36:39], v[164:167], v[216:219], v[36:39]
    ds_read_b64 v[102:103], v23 offset:384
    v_mfma_f32_16x16x32_bf16 v[40:43], v[164:167], v[220:223], v[40:43]
    ds_read_b128 v[148:151], v24 offset:2112
    v_mfma_f32_16x16x32_bf16 v[44:47], v[164:167], v[224:227], v[44:47]
    ds_read_b128 v[152:155], v24 offset:2624
    v_mfma_f32_16x16x32_bf16 v[32:35], v[168:171], v[208:211], v[32:35]
    ds_read_b128 v[156:159], v24 offset:3136
    s_add_u32 s10, s8, 32768
    s_sub_u32 m0, s9, 24576
    s_nop 0
    buffer_load_dwordx4 v2, s[36:39], s10 offen sc1 lds
    v_mfma_f32_16x16x32_bf16 v[36:39], v[168:171], v[212:215], v[36:39]
    ds_read_b128 v[160:163], v24 offset:3648
    v_mfma_f32_16x16x32_bf16 v[40:43], v[168:171], v[216:219], v[40:43]
    ds_read_b64 v[104:105], v22 offset:896
    v_mfma_f32_16x16x32_bf16 v[44:47], v[168:171], v[220:223], v[44:47]
    ds_read_b64 v[106:107], v23 offset:896
    s_waitcnt lgkmcnt(15)
    v_mfma_f32_16x16x32_bf16 v[32:35], v[172:175], v[204:207], v[32:35]
    ds_read_b128 v[144:147], v24 offset:1600
    v_mfma_f32_16x16x32_bf16 v[36:39], v[172:175], v[208:211], v[36:39]
    ds_read_b64 v[108:109], v22 offset:1408
    v_mfma_f32_16x16x32_bf16 v[40:43], v[172:175], v[212:215], v[40:43]
    ds_read_b64 v[110:111], v23 offset:1408
    s_add_u32 s10, s8, 33792
    s_sub_u32 m0, s9, 23552
    s_nop 0
    buffer_load_dwordx4 v2, s[36:39], s10 offen sc1 lds
    v_mfma_f32_16x16x32_bf16 v[44:47], v[172:175], v[216:219], v[44:47]
    ds_read_b128 v[140:143], v24 offset:1088
    v_mfma_f32_16x16x32_bf16 v[32:35], v[176:179], v[200:203], v[32:35]
    ds_read_b64 v[112:113], v22 offset:1920
    v_mfma_f32_16x16x32_bf16 v[36:39], v[176:179], v[204:207], v[36:39]
    ds_read_b64 v[114:115], v23 offset:1920
    v_mfma_f32_16x16x32_bf16 v[40:43], v[176:179], v[208:211], v[40:43]
    ds_read_b128 v[136:139], v24 offset:576
    v_mfma_f32_16x16x32_bf16 v[44:47], v[176:179], v[212:215], v[44:47]
    ds_read_b64 v[116:117], v22 offset:2432
    s_add_u32 s10, s8, 34816
    s_sub_u32 m0, s9, 22528
    s_nop 0
    buffer_load_dwordx4 v2, s[36:39], s10 offen sc1 lds
    s_waitcnt lgkmcnt(15)
    v_mfma_f32_16x16x32_bf16 v[32:35], v[180:183], v[196:199], v[32:35]
    ds_read_b64 v[118:119], v23 offset:2432
    v_mfma_f32_16x16x32_bf16 v[36:39], v[180:183], v[200:203], v[36:39]
    ds_read_b128 v[132:135], v24 offset:64
    v_mfma_f32_16x16x32_bf16 v[40:43], v[180:183], v[204:207], v[40:43]
    ds_read_b64 v[120:121], v22 offset:2944
    v_mfma_f32_16x16x32_bf16 v[44:47], v[180:183], v[208:211], v[44:47]
    ds_read_b64 v[122:123], v23 offset:2944
    v_mfma_f32_16x16x32_bf16 v[36:39], v[184:187], v[196:199], v[36:39]
    ds_read_b64 v[124:125], v22 offset:3456
    v_mfma_f32_16x16x32_bf16 v[40:43], v[184:187], v[200:203], v[40:43]
    ds_read_b64 v[126:127], v23 offset:3456
    v_mfma_f32_16x16x32_bf16 v[44:47], v[184:187], v[204:207], v[44:47]
    ds_read_b64 v[128:129], v22 offset:3968
    v_mfma_f32_16x16x32_bf16 v[40:43], v[188:191], v[196:199], v[40:43]
    ds_read_b64 v[130:131], v23 offset:3968
    v_mfma_f32_16x16x32_bf16 v[44:47], v[188:191], v[200:203], v[44:47]
    v_mfma_f32_16x16x32_bf16 v[44:47], v[192:195], v[196:199], v[44:47]
    s_waitcnt lgkmcnt(15)
    v_mfma_f32_16x16x32_bf16 v[32:35], v[100:103], v[148:151], v[32:35]
    ds_read_b64 v[164:165], v22 offset:448
    v_mfma_f32_16x16x32_bf16 v[36:39], v[100:103], v[152:155], v[36:39]
    ds_read_b64 v[166:167], v23 offset:448
    v_mfma_f32_16x16x32_bf16 v[40:43], v[100:103], v[156:159], v[40:43]
    ds_read_b128 v[212:215], v24 offset:2048
    v_mfma_f32_16x16x32_bf16 v[44:47], v[100:103], v[160:163], v[44:47]
    ds_read_b128 v[216:219], v24 offset:2560
    v_mfma_f32_16x16x32_bf16 v[32:35], v[104:107], v[144:147], v[32:35]
    ds_read_b128 v[220:223], v24 offset:3072
    v_mfma_f32_16x16x32_bf16 v[36:39], v[104:107], v[148:151], v[36:39]
    ds_read_b128 v[224:227], v24 offset:3584
    v_mfma_f32_16x16x32_bf16 v[40:43], v[104:107], v[152:155], v[40:43]
    ds_read_b64 v[168:169], v22 offset:960
    v_mfma_f32_16x16x32_bf16 v[44:47], v[104:107], v[156:159], v[44:47]
    ds_read_b64 v[170:171], v23 offset:960
    s_waitcnt lgkmcnt(15)
    v_mfma_f32_16x16x32_bf16 v[32:35], v[108:111], v[140:143], v[32:35]
    ds_read_b128 v[208:211], v24 offset:1536
    v_mfma_f32_16x16x32_bf16 v[36:39], v[108:111], v[144:147], v[36:39]
    ds_read_b64 v[172:173], v22 offset:1472
    v_mfma_f32_16x16x32_bf16 v[40:43], v[108:111], v[148:151], v[40:43]
    ds_read_b64 v[174:175], v23 offset:1472
    v_mfma_f32_16x16x32_bf16 v[44:47], v[108:111], v[152:155], v[44:47]
    ds_read_b128 v[204:207], v24 offset:1024
    v_mfma_f32_16x16x32_bf16 v[32:35], v[112:115], v[136:139], v[32:35]
    ds_read_b64 v[176:177], v22 offset:1984
    v_mfma_f32_16x16x32_bf16 v[36:39], v[112:115], v[140:143], v[36:39]
    ds_read_b64 v[178:179], v23 offset:1984
    v_mfma_f32_16x16x32_bf16 v[40:43], v[112:115], v[144:147], v[40:43]
    ds_read_b128 v[200:203], v24 offset:512
    v_mfma_f32_16x16x32_bf16 v[44:47], v[112:115], v[148:151], v[44:47]
    ds_read_b64 v[180:181], v22 offset:2496
    s_waitcnt lgkmcnt(15)
    v_mfma_f32_16x16x32_bf16 v[32:35], v[116:119], v[132:135], v[32:35]
    ds_read_b64 v[182:183], v23 offset:2496
    v_mfma_f32_16x16x32_bf16 v[36:39], v[116:119], v[136:139], v[36:39]
    ds_read_b128 v[196:199], v24 offset:0
    v_mfma_f32_16x16x32_bf16 v[40:43], v[116:119], v[140:143], v[40:43]
    ds_read_b64 v[184:185], v22 offset:3008
    v_mfma_f32_16x16x32_bf16 v[44:47], v[116:119], v[144:147], v[44:47]
    ds_read_b64 v[186:187], v23 offset:3008
    v_mfma_f32_16x16x32_bf16 v[36:39], v[120:123], v[132:135], v[36:39]
    ds_read_b64 v[188:189], v22 offset:3520
    v_mfma_f32_16x16x32_bf16 v[40:43], v[120:123], v[136:139], v[40:43]
    ds_read_b64 v[190:191], v23 offset:3520
    v_mfma_f32_16x16x32_bf16 v[44:47], v[120:123], v[140:143], v[44:47]
    ds_read_b64 v[192:193], v22 offset:4032
    v_mfma_f32_16x16x32_bf16 v[40:43], v[124:127], v[132:135], v[40:43]
    ds_read_b64 v[194:195], v23 offset:4032
    v_mfma_f32_16x16x32_bf16 v[44:47], v[124:127], v[136:139], v[44:47]
    v_mfma_f32_16x16x32_bf16 v[44:47], v[128:131], v[132:135], v[44:47]
    s_waitcnt lgkmcnt(15)
    v_mfma_f32_16x16x32_bf16 v[32:35], v[164:167], v[212:215], v[32:35]
    v_mfma_f32_16x16x32_bf16 v[36:39], v[164:167], v[216:219], v[36:39]
    v_mfma_f32_16x16x32_bf16 v[40:43], v[164:167], v[220:223], v[40:43]
    v_mfma_f32_16x16x32_bf16 v[44:47], v[164:167], v[224:227], v[44:47]
    v_mfma_f32_16x16x32_bf16 v[32:35], v[168:171], v[208:211], v[32:35]
    v_mfma_f32_16x16x32_bf16 v[36:39], v[168:171], v[212:215], v[36:39]
    v_mfma_f32_16x16x32_bf16 v[40:43], v[168:171], v[216:219], v[40:43]
    v_mfma_f32_16x16x32_bf16 v[44:47], v[168:171], v[220:223], v[44:47]
    s_waitcnt lgkmcnt(12)
    v_mfma_f32_16x16x32_bf16 v[32:35], v[172:175], v[204:207], v[32:35]
    v_mfma_f32_16x16x32_bf16 v[36:39], v[172:175], v[208:211], v[36:39]
    v_mfma_f32_16x16x32_bf16 v[40:43], v[172:175], v[212:215], v[40:43]
    v_mfma_f32_16x16x32_bf16 v[44:47], v[172:175], v[216:219], v[44:47]
    s_waitcnt lgkmcnt(9)
    v_mfma_f32_16x16x32_bf16 v[32:35], v[176:179], v[200:203], v[32:35]
    v_mfma_f32_16x16x32_bf16 v[36:39], v[176:179], v[204:207], v[36:39]
    v_mfma_f32_16x16x32_bf16 v[40:43], v[176:179], v[208:211], v[40:43]
    v_mfma_f32_16x16x32_bf16 v[44:47], v[176:179], v[212:215], v[44:47]
    s_waitcnt lgkmcnt(6)
    v_mfma_f32_16x16x32_bf16 v[32:35], v[180:183], v[196:199], v[32:35]
    v_mfma_f32_16x16x32_bf16 v[36:39], v[180:183], v[200:203], v[36:39]
    v_mfma_f32_16x16x32_bf16 v[40:43], v[180:183], v[204:207], v[40:43]
    v_mfma_f32_16x16x32_bf16 v[44:47], v[180:183], v[208:211], v[44:47]
    s_waitcnt lgkmcnt(4)
    v_mfma_f32_16x16x32_bf16 v[36:39], v[184:187], v[196:199], v[36:39]
    v_mfma_f32_16x16x32_bf16 v[40:43], v[184:187], v[200:203], v[40:43]
    v_mfma_f32_16x16x32_bf16 v[44:47], v[184:187], v[204:207], v[44:47]
    buffer_load_dword v18, v16, s[36:39], s79 offen sc1
    s_waitcnt lgkmcnt(2)
    v_mfma_f32_16x16x32_bf16 v[40:43], v[188:191], v[196:199], v[40:43]
    v_mfma_f32_16x16x32_bf16 v[44:47], v[188:191], v[200:203], v[44:47]
    s_waitcnt lgkmcnt(0)
    v_mfma_f32_16x16x32_bf16 v[44:47], v[192:195], v[196:199], v[44:47]
    ds_read_b64 v[48:49], v25 offset:2048
    ds_read_b64 v[50:51], v25 offset:2560
    ds_read_b64 v[52:53], v25 offset:3072
    ds_read_b64 v[54:55], v25 offset:3584
    s_mul_i32 s76, s6, 327680
    s_lshl_b32 s74, s34, 8
    s_add_u32 s76, s74, s76
    s_waitcnt lgkmcnt(3)
    v_lshlrev_b32 v59, 16, v48
    v_and_b32 v58, 0xffff0000, v48
    v_lshlrev_b32 v57, 16, v49
    v_and_b32 v56, 0xffff0000, v49
    v_fmac_f32 v32, s77, v56
    v_fmac_f32 v33, s77, v57
    v_fmac_f32 v34, s77, v58
    v_fmac_f32 v35, s77, v59
    v_cvt_pk_bf16_f32 v32, v32, v33
    v_cvt_pk_bf16_f32 v33, v34, v35
    ds_write_b64 v26, v[32:33] offset:8448
    s_waitcnt lgkmcnt(3)
    v_lshlrev_b32 v59, 16, v50
    v_and_b32 v58, 0xffff0000, v50
    v_lshlrev_b32 v57, 16, v51
    v_and_b32 v56, 0xffff0000, v51
    v_fmac_f32 v36, s77, v56
    v_fmac_f32 v37, s77, v57
    v_fmac_f32 v38, s77, v58
    v_fmac_f32 v39, s77, v59
    v_cvt_pk_bf16_f32 v36, v36, v37
    v_cvt_pk_bf16_f32 v37, v38, v39
    ds_write_b64 v26, v[36:37] offset:8960
    s_waitcnt lgkmcnt(3)
    v_lshlrev_b32 v59, 16, v52
    v_and_b32 v58, 0xffff0000, v52
    v_lshlrev_b32 v57, 16, v53
    v_and_b32 v56, 0xffff0000, v53
    v_fmac_f32 v40, s77, v56
    v_fmac_f32 v41, s77, v57
    v_fmac_f32 v42, s77, v58
    v_fmac_f32 v43, s77, v59
    v_cvt_pk_bf16_f32 v40, v40, v41
    v_cvt_pk_bf16_f32 v41, v42, v43
    ds_write_b64 v26, v[40:41] offset:9472
    s_waitcnt lgkmcnt(3)
    v_lshlrev_b32 v59, 16, v54
    v_and_b32 v58, 0xffff0000, v54
    v_lshlrev_b32 v57, 16, v55
    v_and_b32 v56, 0xffff0000, v55
    v_fmac_f32 v44, s77, v56
    v_fmac_f32 v45, s77, v57
    v_fmac_f32 v46, s77, v58
    v_fmac_f32 v47, s77, v59
    v_cvt_pk_bf16_f32 v44, v44, v45
    v_cvt_pk_bf16_f32 v45, v46, v47
    ds_write_b64 v26, v[44:45] offset:9984
    s_waitcnt lgkmcnt(0)
    s_barrier
    ds_read_b64_tr_b16 v[240:241], v27 offset:8448
    ds_read_b64_tr_b16 v[242:243], v27 offset:8480
    ds_read_b64_tr_b16 v[244:245], v27 offset:8704
    ds_read_b64_tr_b16 v[246:247], v27 offset:8736
    v_min_u32 v19, 39, v1
    v_lshlrev_b32 v19, 7, v19
    buffer_load_dword v228, v19, s[36:39], s65 offen sc1
    v_cmp_ne_u32 vcc, v83, v14
    s_cbranch_vccz Lpd_19
    s_mov_b32 s96, 0
Lps_20x:
    buffer_load_dwordx4 v[80:83], v6, s[36:39], s101 offen offset:0 sc1
    s_waitcnt vmcnt(0)
    v_cmp_ne_u32 vcc, v83, v14
    s_cbranch_vccz Lpd_19
    s_sleep 1
    s_add_u32 s96, s96, 1
    s_cmp_lt_u32 s96, 100000
    s_cbranch_scc1 Lps_20x
Lpd_19:
    v_cmp_ne_u32 vcc, v87, v14
    s_cbranch_vccz Lpd_21
    s_mov_b32 s96, 0
Lps_22x:
    buffer_load_dwordx4 v[84:87], v6, s[36:39], s101 offen offset:256 sc1
    s_waitcnt vmcnt(0)
    v_cmp_ne_u32 vcc, v87, v14
    s_cbranch_vccz Lpd_21
    s_sleep 1
    s_add_u32 s96, s96, 1
    s_cmp_lt_u32 s96, 100000
    s_cbranch_scc1 Lps_22x
Lpd_21:
    v_cmp_ne_u32 vcc, v91, v14
    s_cbranch_vccz Lpd_23
    s_mov_b32 s96, 0
Lps_24x:
    buffer_load_dwordx4 v[88:91], v6, s[36:39], s101 offen offset:2048 sc1
    s_waitcnt vmcnt(0)
    v_cmp_ne_u32 vcc, v91, v14
    s_cbranch_vccz Lpd_23
    s_sleep 1
    s_add_u32 s96, s96, 1
    s_cmp_lt_u32 s96, 100000
    s_cbranch_scc1 Lps_24x
Lpd_23:
    v_cmp_ne_u32 vcc, v95, v14
    s_cbranch_vccz Lpd_25
    s_mov_b32 s96, 0
Lps_26x:
    buffer_load_dwordx4 v[92:95], v6, s[36:39], s101 offen offset:2304 sc1
    s_waitcnt vmcnt(0)
    v_cmp_ne_u32 vcc, v95, v14
    s_cbranch_vccz Lpd_25
    s_sleep 1
    s_add_u32 s96, s96, 1
    s_cmp_lt_u32 s96, 100000
    s_cbranch_scc1 Lps_26x
Lpd_25:
    v_lshlrev_b32 v100, 16, v72
    v_and_b32 v101, 0xffff0000, v72
    v_lshlrev_b32 v102, 16, v73
    v_and_b32 v103, 0xffff0000, v73
    v_pk_add_f32 v[108:109], v[100:101], v[80:81] op_sel_hi:[1,0] neg_lo:[0,1] neg_hi:[0,1]
    v_pk_add_f32 v[110:111], v[102:103], v[80:81] op_sel_hi:[1,0] neg_lo:[0,1] neg_hi:[0,1]
    v_pk_mul_f32 v[108:109], v[108:109], v[80:81] op_sel:[0,1] op_sel_hi:[1,1]
    v_pk_mul_f32 v[110:111], v[110:111], v[80:81] op_sel:[0,1] op_sel_hi:[1,1]
    s_waitcnt lgkmcnt(3)
    v_lshlrev_b32 v104, 16, v240
    v_and_b32 v105, 0xffff0000, v240
    v_lshlrev_b32 v106, 16, v241
    v_and_b32 v107, 0xffff0000, v241
    v_pk_fma_f32 v[100:101], v[108:109], v[104:105], v[100:101]
    v_pk_fma_f32 v[102:103], v[110:111], v[106:107], v[102:103]
    v_cvt_pk_bf16_f32 v72, v100, v101
    v_cvt_pk_bf16_f32 v73, v102, v103
    v_lshlrev_b32 v100, 16, v74
    v_and_b32 v101, 0xffff0000, v74
    v_lshlrev_b32 v102, 16, v75
    v_and_b32 v103, 0xffff0000, v75
    v_pk_add_f32 v[108:109], v[100:101], v[84:85] op_sel_hi:[1,0] neg_lo:[0,1] neg_hi:[0,1]
    v_pk_add_f32 v[110:111], v[102:103], v[84:85] op_sel_hi:[1,0] neg_lo:[0,1] neg_hi:[0,1]
    v_pk_mul_f32 v[108:109], v[108:109], v[84:85] op_sel:[0,1] op_sel_hi:[1,1]
    v_pk_mul_f32 v[110:111], v[110:111], v[84:85] op_sel:[0,1] op_sel_hi:[1,1]
    s_waitcnt lgkmcnt(2)
    v_lshlrev_b32 v104, 16, v242
    v_and_b32 v105, 0xffff0000, v242
    v_lshlrev_b32 v106, 16, v243
    v_and_b32 v107, 0xffff0000, v243
    v_pk_fma_f32 v[100:101], v[108:109], v[104:105], v[100:101]
    v_pk_fma_f32 v[102:103], v[110:111], v[106:107], v[102:103]
    v_cvt_pk_bf16_f32 v74, v100, v101
    v_cvt_pk_bf16_f32 v75, v102, v103
    v_lshlrev_b32 v100, 16, v76
    v_and_b32 v101, 0xffff0000, v76
    v_lshlrev_b32 v102, 16, v77
    v_and_b32 v103, 0xffff0000, v77
    v_pk_add_f32 v[108:109], v[100:101], v[88:89] op_sel_hi:[1,0] neg_lo:[0,1] neg_hi:[0,1]
    v_pk_add_f32 v[110:111], v[102:103], v[88:89] op_sel_hi:[1,0] neg_lo:[0,1] neg_hi:[0,1]
    v_pk_mul_f32 v[108:109], v[108:109], v[88:89] op_sel:[0,1] op_sel_hi:[1,1]
    v_pk_mul_f32 v[110:111], v[110:111], v[88:89] op_sel:[0,1] op_sel_hi:[1,1]
    s_waitcnt lgkmcnt(1)
    v_lshlrev_b32 v104, 16, v244
    v_and_b32 v105, 0xffff0000, v244
    v_lshlrev_b32 v106, 16, v245
    v_and_b32 v107, 0xffff0000, v245
    v_pk_fma_f32 v[100:101], v[108:109], v[104:105], v[100:101]
    v_pk_fma_f32 v[102:103], v[110:111], v[106:107], v[102:103]
    v_cvt_pk_bf16_f32 v76, v100, v101
    v_cvt_pk_bf16_f32 v77, v102, v103
    v_lshlrev_b32 v100, 16, v78
    v_and_b32 v101, 0xffff0000, v78
    v_lshlrev_b32 v102, 16, v79
    v_and_b32 v103, 0xffff0000, v79
    v_pk_add_f32 v[108:109], v[100:101], v[92:93] op_sel_hi:[1,0] neg_lo:[0,1] neg_hi:[0,1]
    v_pk_add_f32 v[110:111], v[102:103], v[92:93] op_sel_hi:[1,0] neg_lo:[0,1] neg_hi:[0,1]
    v_pk_mul_f32 v[108:109], v[108:109], v[92:93] op_sel:[0,1] op_sel_hi:[1,1]
    v_pk_mul_f32 v[110:111], v[110:111], v[92:93] op_sel:[0,1] op_sel_hi:[1,1]
    s_waitcnt lgkmcnt(0)
    v_lshlrev_b32 v104, 16, v246
    v_and_b32 v105, 0xffff0000, v246
    v_lshlrev_b32 v106, 16, v247
    v_and_b32 v107, 0xffff0000, v247
    v_pk_fma_f32 v[100:101], v[108:109], v[104:105], v[100:101]
    v_pk_fma_f32 v[102:103], v[110:111], v[106:107], v[102:103]
    v_cvt_pk_bf16_f32 v78, v100, v101
    v_cvt_pk_bf16_f32 v79, v102, v103
    s_add_u32 s74, s76, 17039360
    buffer_store_dwordx4 v[72:75], v29, s[36:39], s74 offen sc1
    s_add_u32 s74, s76, 17203200
    buffer_store_dwordx4 v[76:79], v29, s[36:39], s74 offen sc1
    s_add_u32 s74, s76, 19660800
    buffer_store_dwordx4 v[240:243], v29, s[36:39], s74 offen sc1
    s_add_u32 s74, s76, 19824640
    buffer_store_dwordx4 v[244:247], v29, s[36:39], s74 offen sc1
    s_waitcnt vmcnt(5)
    v_cmp_ne_u32 vcc, v18, v14
    s_cbranch_vccz Lpd_27
    s_mov_b32 s96, 0
Lps_28x:
    buffer_load_dword v18, v16, s[36:39], s79 offen sc1
    s_waitcnt vmcnt(0)
    v_cmp_ne_u32 vcc, v18, v14
    s_cbranch_vccz Lpd_27
    s_sleep 1
    s_add_u32 s96, s96, 1
    s_cmp_lt_u32 s96, 100000
    s_cbranch_scc1 Lps_28x
Lpd_27:
    s_waitcnt vmcnt(4)
    v_cmp_ne_u32 vcc, v228, v14
    s_cbranch_vccz Lpd_29
    s_waitcnt vmcnt(0)
    s_add_u32 s74, s68, 98304
    s_mov_b64 exec, 1
    buffer_store_dword v14, off, s[36:39], s74 sc1
    s_mov_b64 exec, -1
    s_mov_b32 s96, 0
Lps_30x:
    buffer_load_dword v228, v19, s[36:39], s65 offen sc1
    s_waitcnt vmcnt(0)
    v_cmp_ne_u32 vcc, v228, v14
    s_cbranch_vccz Lpd_29
    s_sleep 1
    s_add_u32 s96, s96, 1
    s_cmp_lt_u32 s96, 100000
    s_cbranch_scc1 Lps_30x
Lpd_29:
    s_barrier
    s_add_u32 s88, s90, 15728640
    buffer_load_dwordx4 v[140:143], v6, s[36:39], s88 offen offset:0 sc1
    buffer_load_dwordx4 v[144:147], v6, s[36:39], s88 offen offset:256 sc1
    buffer_load_dwordx4 v[148:151], v6, s[36:39], s88 offen offset:2048 sc1
    buffer_load_dwordx4 v[152:155], v6, s[36:39], s88 offen offset:2304 sc1
    s_add_u32 s88, s90, 15732736
    buffer_load_dwordx4 v[156:159], v6, s[36:39], s88 offen offset:0 sc1
    buffer_load_dwordx4 v[160:163], v6, s[36:39], s88 offen offset:256 sc1
    buffer_load_dwordx4 v[164:167], v6, s[36:39], s88 offen offset:2048 sc1
    buffer_load_dwordx4 v[168:171], v6, s[36:39], s88 offen offset:2304 sc1
    s_add_u32 s88, s90, 15736832
    buffer_load_dwordx4 v[172:175], v6, s[36:39], s88 offen offset:0 sc1
    buffer_load_dwordx4 v[176:179], v6, s[36:39], s88 offen offset:256 sc1
    buffer_load_dwordx4 v[180:183], v6, s[36:39], s88 offen offset:2048 sc1
    buffer_load_dwordx4 v[184:187], v6, s[36:39], s88 offen offset:2304 sc1
    s_add_u32 s88, s90, 15740928
    buffer_load_dwordx4 v[188:191], v6, s[36:39], s88 offen offset:0 sc1
    buffer_load_dwordx4 v[192:195], v6, s[36:39], s88 offen offset:256 sc1
    buffer_load_dwordx4 v[196:199], v6, s[36:39], s88 offen offset:2048 sc1
    buffer_load_dwordx4 v[200:203], v6, s[36:39], s88 offen offset:2304 sc1
L_g1c:
    ds_read_b128 v[112:115], v8 offset:21504
    ds_read_b128 v[116:119], v8 offset:22528
    ds_read_b128 v[120:123], v8 offset:23552
    ds_read_b128 v[124:127], v8 offset:24576
    ds_read_b128 v[128:131], v8 offset:25600
    ds_read_b128 v[132:135], v8 offset:26624
    ds_read_b128 v[136:139], v8 offset:27648
    s_waitcnt vmcnt(14)
    v_swap_b32 v142, v144
    v_swap_b32 v143, v145
    s_waitcnt lgkmcnt(5)
    s_nop 0
    v_mfma_f32_16x16x32_bf16 v[48:51], v[112:115], v[140:143], 0
    s_add_u32 s88, s90, 15745024
    buffer_load_dwordx4 v[204:207], v6, s[36:39], s88 offen offset:0 sc1
    s_add_u32 s74, s68, 98304
    s_mov_b64 exec, 1
    buffer_store_dword v14, off, s[36:39], s74 sc1
    s_mov_b64 exec, -1
    v_mfma_f32_16x16x32_bf16 v[76:79], v[112:115], v[144:147], 0
    ds_read_b128 v[112:115], v8 offset:14336
    s_add_u32 s10, s8, 57344
    s_sub_u32 m0, s9, 57344
    s_nop 0
    buffer_load_dwordx4 v2, s[36:39], s10 offen sc1 lds
    v_mfma_f32_16x16x32_bf16 v[52:55], v[116:119], v[140:143], 0
    buffer_load_dwordx4 v[208:211], v6, s[36:39], s88 offen offset:256 sc1
    v_mfma_f32_16x16x32_bf16 v[80:83], v[116:119], v[144:147], 0
    ds_read_b128 v[116:119], v8 offset:15360
    s_waitcnt lgkmcnt(5)
    v_mfma_f32_16x16x32_bf16 v[56:59], v[120:123], v[140:143], 0
    buffer_load_dwordx4 v[212:215], v6, s[36:39], s88 offen offset:2048 sc1
    v_mfma_f32_16x16x32_bf16 v[84:87], v[120:123], v[144:147], 0
    ds_read_b128 v[120:123], v8 offset:16384
    v_mfma_f32_16x16x32_bf16 v[60:63], v[124:127], v[140:143], 0
    buffer_load_dwordx4 v[216:219], v6, s[36:39], s88 offen offset:2304 sc1
    s_waitcnt vmcnt(18)
    v_mfma_f32_16x16x32_bf16 v[88:91], v[124:127], v[144:147], 0
    ds_read_b128 v[124:127], v8 offset:17408
    s_waitcnt lgkmcnt(5)
    v_mfma_f32_16x16x32_bf16 v[64:67], v[128:131], v[140:143], 0
    v_swap_b32 v150, v152
    s_add_u32 s10, s8, 58368
    s_sub_u32 m0, s9, 56320
    s_nop 0
    buffer_load_dwordx4 v2, s[36:39], s10 offen sc1 lds
    v_mfma_f32_16x16x32_bf16 v[92:95], v[128:131], v[144:147], 0
    ds_read_b128 v[128:131], v8 offset:18432
    v_mfma_f32_16x16x32_bf16 v[68:71], v[132:135], v[140:143], 0
    v_swap_b32 v151, v153
    v_mfma_f32_16x16x32_bf16 v[96:99], v[132:135], v[144:147], 0
    ds_read_b128 v[132:135], v8 offset:19456
    s_waitcnt lgkmcnt(6)
    v_mfma_f32_16x16x32_bf16 v[72:75], v[136:139], v[140:143], 0
    s_add_u32 s10, s8, 59392
    s_sub_u32 m0, s9, 55296
    s_nop 0
    buffer_load_dwordx4 v2, s[36:39], s10 offen sc1 lds
    v_mfma_f32_16x16x32_bf16 v[100:103], v[136:139], v[144:147], 0
    ds_read_b128 v[136:139], v8 offset:20480
    s_waitcnt lgkmcnt(5)
    v_mfma_f32_16x16x32_bf16 v[48:51], v[112:115], v[148:151], v[48:51]
    s_add_u32 s88, s90, 15749120
    buffer_load_dwordx4 v[220:223], v6, s[36:39], s88 offen offset:0 sc1
    v_mfma_f32_16x16x32_bf16 v[76:79], v[112:115], v[152:155], v[76:79]
    ds_read_b128 v[112:115], v8 offset:7168
    v_mfma_f32_16x16x32_bf16 v[52:55], v[116:119], v[148:151], v[52:55]
    buffer_load_dwordx4 v[224:227], v6, s[36:39], s88 offen offset:256 sc1
    s_add_u32 s10, s8, 60416
    s_sub_u32 m0, s9, 54272
    s_nop 0
    buffer_load_dwordx4 v2, s[36:39], s10 offen sc1 lds
    v_mfma_f32_16x16x32_bf16 v[80:83], v[116:119], v[152:155], v[80:83]
    ds_read_b128 v[116:119], v8 offset:8192
    s_waitcnt lgkmcnt(5)
    v_mfma_f32_16x16x32_bf16 v[56:59], v[120:123], v[148:151], v[56:59]
    buffer_load_dwordx4 v[140:143], v6, s[36:39], s88 offen offset:2048 sc1
    v_mfma_f32_16x16x32_bf16 v[84:87], v[120:123], v[152:155], v[84:87]
    ds_read_b128 v[120:123], v8 offset:9216
    v_mfma_f32_16x16x32_bf16 v[60:63], v[124:127], v[148:151], v[60:63]
    buffer_load_dwordx4 v[144:147], v6, s[36:39], s88 offen offset:2304 sc1
    s_waitcnt vmcnt(23)
    v_mfma_f32_16x16x32_bf16 v[88:91], v[124:127], v[152:155], v[88:91]
    ds_read_b128 v[124:127], v8 offset:10240
    s_waitcnt lgkmcnt(5)
    v_mfma_f32_16x16x32_bf16 v[64:67], v[128:131], v[148:151], v[64:67]
    v_swap_b32 v158, v160
    s_add_u32 s10, s8, 61440
    s_sub_u32 m0, s9, 53248
    s_nop 0
    buffer_load_dwordx4 v2, s[36:39], s10 offen sc1 lds
    v_mfma_f32_16x16x32_bf16 v[92:95], v[128:131], v[152:155], v[92:95]
    ds_read_b128 v[128:131], v8 offset:11264
    v_mfma_f32_16x16x32_bf16 v[68:71], v[132:135], v[148:151], v[68:71]
    v_swap_b32 v159, v161
    v_mfma_f32_16x16x32_bf16 v[96:99], v[132:135], v[152:155], v[96:99]
    ds_read_b128 v[132:135], v8 offset:12288
    s_waitcnt lgkmcnt(6)
    v_mfma_f32_16x16x32_bf16 v[72:75], v[136:139], v[148:151], v[72:75]
    v_mfma_f32_16x16x32_bf16 v[100:103], v[136:139], v[152:155], v[100:103]
    ds_read_b128 v[136:139], v8 offset:13312
    s_waitcnt lgkmcnt(5)
    v_mfma_f32_16x16x32_bf16 v[48:51], v[112:115], v[156:159], v[48:51]
    s_add_u32 s88, s90, 15753216
    buffer_load_dwordx4 v[148:151], v6, s[36:39], s88 offen offset:0 sc1
    s_add_u32 s10, s8, 62464
    s_sub_u32 m0, s9, 52224
    s_nop 0
    buffer_load_dwordx4 v2, s[36:39], s10 offen sc1 lds
    v_mfma_f32_16x16x32_bf16 v[76:79], v[112:115], v[160:163], v[76:79]
    ds_read_b128 v[112:115], v8 offset:0
    v_mfma_f32_16x16x32_bf16 v[52:55], v[116:119], v[156:159], v[52:55]
    buffer_load_dwordx4 v[152:155], v6, s[36:39], s88 offen offset:256 sc1
    v_mfma_f32_16x16x32_bf16 v[80:83], v[116:119], v[160:163], v[80:83]
    ds_read_b128 v[116:119], v8 offset:1024
    s_waitcnt lgkmcnt(5)
    v_mfma_f32_16x16x32_bf16 v[56:59], v[120:123], v[156:159], v[56:59]
    s_add_u32 s10, s8, 63488
    s_sub_u32 m0, s9, 51200
    s_nop 0
    buffer_load_dwordx4 v2, s[36:39], s10 offen sc1 lds
    v_mfma_f32_16x16x32_bf16 v[84:87], v[120:123], v[160:163], v[84:87]
    ds_read_b128 v[120:123], v8 offset:2048
    v_mfma_f32_16x16x32_bf16 v[60:63], v[124:127], v[156:159], v[60:63]
    s_waitcnt vmcnt(26)
    v_mfma_f32_16x16x32_bf16 v[88:91], v[124:127], v[160:163], v[88:91]
    ds_read_b128 v[124:127], v8 offset:3072
    s_waitcnt lgkmcnt(5)
    v_mfma_f32_16x16x32_bf16 v[64:67], v[128:131], v[156:159], v[64:67]
    v_swap_b32 v166, v168
    v_mfma_f32_16x16x32_bf16 v[92:95], v[128:131], v[160:163], v[92:95]
    ds_read_b128 v[128:131], v8 offset:4096
    v_mfma_f32_16x16x32_bf16 v[68:71], v[132:135], v[156:159], v[68:71]
    v_swap_b32 v167, v169
    s_add_u32 s10, s8, 86016
    s_sub_u32 m0, s9, 86016
    s_nop 0
    buffer_load_dwordx4 v2, s[36:39], s10 offen sc1 lds
    v_mfma_f32_16x16x32_bf16 v[96:99], v[132:135], v[160:163], v[96:99]
    ds_read_b128 v[132:135], v8 offset:5120
    s_waitcnt lgkmcnt(6)
    v_mfma_f32_16x16x32_bf16 v[72:75], v[136:139], v[156:159], v[72:75]
    v_mfma_f32_16x16x32_bf16 v[100:103], v[136:139], v[160:163], v[100:103]
    ds_read_b128 v[136:139], v8 offset:6144
    s_waitcnt lgkmcnt(5)
    v_mfma_f32_16x16x32_bf16 v[48:51], v[112:115], v[164:167], v[48:51]
    buffer_load_dwordx4 v[156:159], v6, s[36:39], s88 offen offset:2048 sc1
    s_add_u32 s10, s8, 87040
    s_sub_u32 m0, s9, 84992
    s_nop 0
    buffer_load_dwordx4 v2, s[36:39], s10 offen sc1 lds
    v_mfma_f32_16x16x32_bf16 v[76:79], v[112:115], v[168:171], v[76:79]
    ds_read_b128 v[112:115], v7 offset:50176
    v_mfma_f32_16x16x32_bf16 v[52:55], v[116:119], v[164:167], v[52:55]
    buffer_load_dwordx4 v[160:163], v6, s[36:39], s88 offen offset:2304 sc1
    v_mfma_f32_16x16x32_bf16 v[80:83], v[116:119], v[168:171], v[80:83]
    ds_read_b128 v[116:119], v7 offset:51200
    s_waitcnt lgkmcnt(5)
    v_mfma_f32_16x16x32_bf16 v[56:59], v[120:123], v[164:167], v[56:59]
    v_mfma_f32_16x16x32_bf16 v[84:87], v[120:123], v[168:171], v[84:87]
    ds_read_b128 v[120:123], v7 offset:52224
    v_mfma_f32_16x16x32_bf16 v[60:63], v[124:127], v[164:167], v[60:63]
    s_waitcnt vmcnt(28)
    s_add_u32 s10, s8, 88064
    s_sub_u32 m0, s9, 83968
    s_nop 0
    buffer_load_dwordx4 v2, s[36:39], s10 offen sc1 lds
    v_mfma_f32_16x16x32_bf16 v[88:91], v[124:127], v[168:171], v[88:91]
    ds_read_b128 v[124:127], v7 offset:53248
    s_waitcnt lgkmcnt(5)
    v_mfma_f32_16x16x32_bf16 v[64:67], v[128:131], v[164:167], v[64:67]
    v_swap_b32 v174, v176
    v_mfma_f32_16x16x32_bf16 v[92:95], v[128:131], v[168:171], v[92:95]
    ds_read_b128 v[128:131], v7 offset:54272
    v_mfma_f32_16x16x32_bf16 v[68:71], v[132:135], v[164:167], v[68:71]
    v_swap_b32 v175, v177
    v_mfma_f32_16x16x32_bf16 v[96:99], v[132:135], v[168:171], v[96:99]
    ds_read_b128 v[132:135], v7 offset:55296
    s_waitcnt lgkmcnt(6)
    v_mfma_f32_16x16x32_bf16 v[72:75], v[136:139], v[164:167], v[72:75]
    s_add_u32 s10, s8, 89088
    s_sub_u32 m0, s9, 82944
    s_nop 0
    buffer_load_dwordx4 v2, s[36:39], s10 offen sc1 lds
    v_mfma_f32_16x16x32_bf16 v[100:103], v[136:139], v[168:171], v[100:103]
    ds_read_b128 v[136:139], v7 offset:56320
    s_waitcnt lgkmcnt(5)
    v_mfma_f32_16x16x32_bf16 v[48:51], v[112:115], v[172:175], v[48:51]
    s_add_u32 s88, s90, 15757312
    buffer_load_dwordx4 v[164:167], v6, s[36:39], s88 offen offset:0 sc1
    v_mfma_f32_16x16x32_bf16 v[76:79], v[112:115], v[176:179], v[76:79]
    ds_read_b128 v[112:115], v7 offset:43008
    v_mfma_f32_16x16x32_bf16 v[52:55], v[116:119], v[172:175], v[52:55]
    buffer_load_dwordx4 v[168:171], v6, s[36:39], s88 offen offset:256 sc1
    s_add_u32 s10, s8, 90112
    s_sub_u32 m0, s9, 81920
    s_nop 0
    buffer_load_dwordx4 v2, s[36:39], s10 offen sc1 lds
    v_mfma_f32_16x16x32_bf16 v[80:83], v[116:119], v[176:179], v[80:83]
    ds_read_b128 v[116:119], v7 offset:44032
    s_waitcnt lgkmcnt(5)
    v_mfma_f32_16x16x32_bf16 v[56:59], v[120:123], v[172:175], v[56:59]
    s_lshr_b32 s79, s63, 2
    s_lshl_b32 s79, s79, 12
    v_mfma_f32_16x16x32_bf16 v[84:87], v[120:123], v[176:179], v[84:87]
    ds_read_b128 v[120:123], v7 offset:45056
    s_lshl_b32 s71, s6, 10
    v_mfma_f32_16x16x32_bf16 v[60:63], v[124:127], v[172:175], v[60:63]
    s_waitcnt vmcnt(31)
    s_add_u32 s79, s79, s71
    v_mfma_f32_16x16x32_bf16 v[88:91], v[124:127], v[176:179], v[88:91]
    ds_read_b128 v[124:127], v7 offset:46080
    s_waitcnt lgkmcnt(5)
    v_mfma_f32_16x16x32_bf16 v[64:67], v[128:131], v[172:175], v[64:67]
    v_swap_b32 v182, v184
    v_min_u32 v23, 7, v1
    v_mfma_f32_16x16x32_bf16 v[92:95], v[128:131], v[176:179], v[92:95]
    ds_read_b128 v[128:131], v7 offset:47104
    v_lshlrev_b32 v23, 7, v23
    v_mfma_f32_16x16x32_bf16 v[68:71], v[132:135], v[172:175], v[68:71]
    v_swap_b32 v183, v185
    s_add_u32 s79, s79, 6569984
    v_mfma_f32_16x16x32_bf16 v[96:99], v[132:135], v[176:179], v[96:99]
    ds_read_b128 v[132:135], v7 offset:48128
    s_waitcnt lgkmcnt(6)
    v_mfma_f32_16x16x32_bf16 v[72:75], v[136:139], v[172:175], v[72:75]
    buffer_load_dword v22, v23, s[36:39], s79 offen sc1
    v_mfma_f32_16x16x32_bf16 v[100:103], v[136:139], v[176:179], v[100:103]
    ds_read_b128 v[136:139], v7 offset:49152
    s_waitcnt lgkmcnt(5)
    v_mfma_f32_16x16x32_bf16 v[48:51], v[112:115], v[180:183], v[48:51]
    buffer_load_dwordx4 v[172:175], v6, s[36:39], s88 offen offset:2048 sc1
    s_add_u32 s10, s8, 91136
    s_sub_u32 m0, s9, 80896
    s_nop 0
    buffer_load_dwordx4 v2, s[36:39], s10 offen sc1 lds
    v_mfma_f32_16x16x32_bf16 v[76:79], v[112:115], v[184:187], v[76:79]
    ds_read_b128 v[112:115], v7 offset:35840
    s_add_u32 s10, s8, 92160
    s_sub_u32 m0, s9, 79872
    s_nop 0
    buffer_load_dwordx4 v2, s[36:39], s10 offen sc1 lds
    v_mfma_f32_16x16x32_bf16 v[52:55], v[116:119], v[180:183], v[52:55]
    buffer_load_dwordx4 v[176:179], v6, s[36:39], s88 offen offset:2304 sc1
    v_mfma_f32_16x16x32_bf16 v[80:83], v[116:119], v[184:187], v[80:83]
    ds_read_b128 v[116:119], v7 offset:36864
    s_waitcnt lgkmcnt(5)
    v_mfma_f32_16x16x32_bf16 v[56:59], v[120:123], v[180:183], v[56:59]
    s_add_u32 s10, s8, 114688
    s_sub_u32 m0, s9, 114688
    s_nop 0
    buffer_load_dwordx4 v2, s[36:39], s10 offen sc1 lds
    v_mfma_f32_16x16x32_bf16 v[84:87], v[120:123], v[184:187], v[84:87]
    ds_read_b128 v[120:123], v7 offset:37888
    v_mfma_f32_16x16x32_bf16 v[60:63], v[124:127], v[180:183], v[60:63]
    s_waitcnt vmcnt(35)
    v_mfma_f32_16x16x32_bf16 v[88:91], v[124:127], v[184:187], v[88:91]
    ds_read_b128 v[124:127], v7 offset:38912
    s_waitcnt lgkmcnt(5)
    v_mfma_f32_16x16x32_bf16 v[64:67], v[128:131], v[180:183], v[64:67]
    v_swap_b32 v190, v192
    v_mfma_f32_16x16x32_bf16 v[92:95], v[128:131], v[184:187], v[92:95]
    ds_read_b128 v[128:131], v7 offset:39936
    v_mfma_f32_16x16x32_bf16 v[68:71], v[132:135], v[180:183], v[68:71]
    v_swap_b32 v191, v193
    s_add_u32 s10, s8, 115712
    s_sub_u32 m0, s9, 113664
    s_nop 0
    buffer_load_dwordx4 v2, s[36:39], s10 offen sc1 lds
    v_mfma_f32_16x16x32_bf16 v[96:99], v[132:135], v[184:187], v[96:99]
    ds_read_b128 v[132:135], v7 offset:40960
    s_waitcnt lgkmcnt(6)
    v_mfma_f32_16x16x32_bf16 v[72:75], v[136:139], v[180:183], v[72:75]
    v_mfma_f32_16x16x32_bf16 v[100:103], v[136:139], v[184:187], v[100:103]
    ds_read_b128 v[136:139], v7 offset:41984
    s_waitcnt lgkmcnt(5)
    v_mfma_f32_16x16x32_bf16 v[48:51], v[112:115], v[188:191], v[48:51]
    s_add_u32 s88, s90, 15761408
    buffer_load_dwordx4 v[180:183], v6, s[36:39], s88 offen offset:0 sc1
    s_add_u32 s10, s8, 116736
    s_sub_u32 m0, s9, 112640
    s_nop 0
    buffer_load_dwordx4 v2, s[36:39], s10 offen sc1 lds
    v_mfma_f32_16x16x32_bf16 v[76:79], v[112:115], v[192:195], v[76:79]
    ds_read_b128 v[112:115], v7 offset:28672
    v_mfma_f32_16x16x32_bf16 v[52:55], v[116:119], v[188:191], v[52:55]
    buffer_load_dwordx4 v[184:187], v6, s[36:39], s88 offen offset:256 sc1
    v_mfma_f32_16x16x32_bf16 v[80:83], v[116:119], v[192:195], v[80:83]
    ds_read_b128 v[116:119], v7 offset:29696
    s_waitcnt lgkmcnt(5)
    v_mfma_f32_16x16x32_bf16 v[56:59], v[120:123], v[188:191], v[56:59]
    v_mfma_f32_16x16x32_bf16 v[84:87], v[120:123], v[192:195], v[84:87]
    ds_read_b128 v[120:123], v7 offset:30720
    v_mfma_f32_16x16x32_bf16 v[60:63], v[124:127], v[188:191], v[60:63]
    s_waitcnt vmcnt(37)
    s_waitcnt vmcnt(19)
    s_barrier
    v_mfma_f32_16x16x32_bf16 v[88:91], v[124:127], v[192:195], v[88:91]
    ds_read_b128 v[124:127], v7 offset:31744
    s_waitcnt lgkmcnt(5)
    v_mfma_f32_16x16x32_bf16 v[64:67], v[128:131], v[188:191], v[64:67]
    v_swap_b32 v198, v200
    s_add_u32 s10, s8, 117760
    s_sub_u32 m0, s9, 111616
    s_nop 0
    buffer_load_dwordx4 v2, s[36:39], s10 offen sc1 lds
    v_mfma_f32_16x16x32_bf16 v[92:95], v[128:131], v[192:195], v[92:95]
    ds_read_b128 v[128:131], v7 offset:32768
    v_mfma_f32_16x16x32_bf16 v[68:71], v[132:135], v[188:191], v[68:71]
    v_swap_b32 v199, v201
    v_mfma_f32_16x16x32_bf16 v[96:99], v[132:135], v[192:195], v[96:99]
    ds_read_b128 v[132:135], v7 offset:33792
    s_waitcnt lgkmcnt(6)
    v_mfma_f32_16x16x32_bf16 v[72:75], v[136:139], v[188:191], v[72:75]
    s_add_u32 s10, s8, 118784
    s_sub_u32 m0, s9, 110592
    s_nop 0
    buffer_load_dwordx4 v2, s[36:39], s10 offen sc1 lds
    v_mfma_f32_16x16x32_bf16 v[100:103], v[136:139], v[192:195], v[100:103]
    ds_read_b128 v[136:139], v7 offset:34816
    s_waitcnt lgkmcnt(5)
    v_mfma_f32_16x16x32_bf16 v[48:51], v[112:115], v[196:199], v[48:51]
    buffer_load_dwordx4 v[188:191], v6, s[36:39], s88 offen offset:2048 sc1
    v_mfma_f32_16x16x32_bf16 v[76:79], v[112:115], v[200:203], v[76:79]
    ds_read_b128 v[112:115], v7 offset:21504
    v_mfma_f32_16x16x32_bf16 v[52:55], v[116:119], v[196:199], v[52:55]
    buffer_load_dwordx4 v[192:195], v6, s[36:39], s88 offen offset:2304 sc1
    s_add_u32 s10, s8, 119808
    s_sub_u32 m0, s9, 109568
    s_nop 0
    buffer_load_dwordx4 v2, s[36:39], s10 offen sc1 lds
    v_mfma_f32_16x16x32_bf16 v[80:83], v[116:119], v[200:203], v[80:83]
    ds_read_b128 v[116:119], v7 offset:22528
    s_waitcnt lgkmcnt(5)
    v_mfma_f32_16x16x32_bf16 v[56:59], v[120:123], v[196:199], v[56:59]
    v_mfma_f32_16x16x32_bf16 v[84:87], v[120:123], v[200:203], v[84:87]
    ds_read_b128 v[120:123], v7 offset:23552
    v_mfma_f32_16x16x32_bf16 v[60:63], v[124:127], v[196:199], v[60:63]
    v_mfma_f32_16x16x32_bf16 v[88:91], v[124:127], v[200:203], v[88:91]
    ds_read_b128 v[124:127], v7 offset:24576
    s_waitcnt lgkmcnt(5)
    v_mfma_f32_16x16x32_bf16 v[64:67], v[128:131], v[196:199], v[64:67]
    v_swap_b32 v206, v208
    s_add_u32 s10, s8, 120832
    s_sub_u32 m0, s9, 108544
    s_nop 0
    buffer_load_dwordx4 v2, s[36:39], s10 offen sc1 lds
    v_mfma_f32_16x16x32_bf16 v[92:95], v[128:131], v[200:203], v[92:95]
    ds_read_b128 v[128:131], v7 offset:25600
    v_mfma_f32_16x16x32_bf16 v[68:71], v[132:135], v[196:199], v[68:71]
    v_swap_b32 v207, v209
    v_mfma_f32_16x16x32_bf16 v[96:99], v[132:135], v[200:203], v[96:99]
    ds_read_b128 v[132:135], v7 offset:26624
    s_waitcnt lgkmcnt(6)
    v_mfma_f32_16x16x32_bf16 v[72:75], v[136:139], v[196:199], v[72:75]
    v_mfma_f32_16x16x32_bf16 v[100:103], v[136:139], v[200:203], v[100:103]
    ds_read_b128 v[136:139], v7 offset:27648
    s_waitcnt lgkmcnt(5)
    v_mfma_f32_16x16x32_bf16 v[48:51], v[112:115], v[204:207], v[48:51]
    s_add_u32 s88, s90, 15765504
    buffer_load_dwordx4 v[196:199], v6, s[36:39], s88 offen offset:0 sc1
    v_mfma_f32_16x16x32_bf16 v[76:79], v[112:115], v[208:211], v[76:79]
    ds_read_b128 v[112:115], v7 offset:14336
    v_mfma_f32_16x16x32_bf16 v[52:55], v[116:119], v[204:207], v[52:55]
    buffer_load_dwordx4 v[200:203], v6, s[36:39], s88 offen offset:256 sc1
    v_mfma_f32_16x16x32_bf16 v[80:83], v[116:119], v[208:211], v[80:83]
    ds_read_b128 v[116:119], v7 offset:15360
    s_waitcnt lgkmcnt(5)
    v_mfma_f32_16x16x32_bf16 v[56:59], v[120:123], v[204:207], v[56:59]
    v_mfma_f32_16x16x32_bf16 v[84:87], v[120:123], v[208:211], v[84:87]
    ds_read_b128 v[120:123], v7 offset:16384
    v_mfma_f32_16x16x32_bf16 v[60:63], v[124:127], v[204:207], v[60:63]
    v_mfma_f32_16x16x32_bf16 v[88:91], v[124:127], v[208:211], v[88:91]
    ds_read_b128 v[124:127], v7 offset:17408
    s_waitcnt lgkmcnt(5)
    v_mfma_f32_16x16x32_bf16 v[64:67], v[128:131], v[204:207], v[64:67]
    v_swap_b32 v214, v216
    v_mfma_f32_16x16x32_bf16 v[92:95], v[128:131], v[208:211], v[92:95]
    ds_read_b128 v[128:131], v7 offset:18432
    v_mfma_f32_16x16x32_bf16 v[68:71], v[132:135], v[204:207], v[68:71]
    v_swap_b32 v215, v217
    s_lshl_b32 s70, s61, 7
    v_mfma_f32_16x16x32_bf16 v[96:99], v[132:135], v[208:211], v[96:99]
    ds_read_b128 v[132:135], v7 offset:19456
    s_waitcnt lgkmcnt(6)
    v_mfma_f32_16x16x32_bf16 v[72:75], v[136:139], v[204:207], v[72:75]
    v_min_u32 v21, 0, v1
    v_lshlrev_b32 v21, 7, v21
    v_mfma_f32_16x16x32_bf16 v[100:103], v[136:139], v[208:211], v[100:103]
    ds_read_b128 v[136:139], v7 offset:20480
    s_waitcnt lgkmcnt(5)
    v_mfma_f32_16x16x32_bf16 v[48:51], v[112:115], v[212:215], v[48:51]
    buffer_load_dwordx4 v[204:207], v6, s[36:39], s88 offen offset:2048 sc1
    s_add_u32 s70, s70, 6586368
    v_mfma_f32_16x16x32_bf16 v[76:79], v[112:115], v[216:219], v[76:79]
    ds_read_b128 v[112:115], v7 offset:7168
    buffer_load_dword v20, v21, s[36:39], s70 offen sc1
    v_mfma_f32_16x16x32_bf16 v[52:55], v[116:119], v[212:215], v[52:55]
    buffer_load_dwordx4 v[208:211], v6, s[36:39], s88 offen offset:2304 sc1
    v_mfma_f32_16x16x32_bf16 v[80:83], v[116:119], v[216:219], v[80:83]
    ds_read_b128 v[116:119], v7 offset:8192
    s_waitcnt lgkmcnt(5)
    v_mfma_f32_16x16x32_bf16 v[56:59], v[120:123], v[212:215], v[56:59]
    v_mfma_f32_16x16x32_bf16 v[84:87], v[120:123], v[216:219], v[84:87]
    ds_read_b128 v[120:123], v7 offset:9216
    v_mfma_f32_16x16x32_bf16 v[60:63], v[124:127], v[212:215], v[60:63]
    v_mfma_f32_16x16x32_bf16 v[88:91], v[124:127], v[216:219], v[88:91]
    ds_read_b128 v[124:127], v7 offset:10240
    s_waitcnt lgkmcnt(5)
    v_mfma_f32_16x16x32_bf16 v[64:67], v[128:131], v[212:215], v[64:67]
    v_swap_b32 v222, v224
    v_mfma_f32_16x16x32_bf16 v[92:95], v[128:131], v[216:219], v[92:95]
    ds_read_b128 v[128:131], v7 offset:11264
    v_mfma_f32_16x16x32_bf16 v[68:71], v[132:135], v[212:215], v[68:71]
    v_swap_b32 v223, v225
    v_mfma_f32_16x16x32_bf16 v[96:99], v[132:135], v[216:219], v[96:99]
    ds_read_b128 v[132:135], v7 offset:12288
    s_waitcnt lgkmcnt(6)
    v_mfma_f32_16x16x32_bf16 v[72:75], v[136:139], v[212:215], v[72:75]
    v_min_u32 v231, 39, v1
    v_lshlrev_b32 v231, 7, v231
    v_mfma_f32_16x16x32_bf16 v[100:103], v[136:139], v[216:219], v[100:103]
    ds_read_b128 v[136:139], v7 offset:13312
    s_waitcnt lgkmcnt(5)
    v_mfma_f32_16x16x32_bf16 v[48:51], v[112:115], v[220:223], v[48:51]
    s_add_u32 s75, s65, 98304
    buffer_load_dword v228, v231, s[36:39], s75 offen sc1
    v_mfma_f32_16x16x32_bf16 v[76:79], v[112:115], v[224:227], v[76:79]
    ds_read_b128 v[112:115], v7 offset:0
    v_mfma_f32_16x16x32_bf16 v[52:55], v[116:119], v[220:223], v[52:55]
    s_waitcnt vmcnt(21)
    v_cmp_ne_u32 vcc, v22, v14
    s_cbranch_vccz Lpd_31
    s_mov_b32 s96, 0
Lps_32x:
    buffer_load_dword v22, v23, s[36:39], s79 offen sc1
    s_waitcnt vmcnt(0)
    v_cmp_ne_u32 vcc, v22, v14
    s_cbranch_vccz Lpd_31
    s_sleep 1
    s_add_u32 s96, s96, 1
    s_cmp_lt_u32 s96, 100000
    s_cbranch_scc1 Lps_32x
Lpd_31:
    v_mfma_f32_16x16x32_bf16 v[80:83], v[116:119], v[224:227], v[80:83]
    ds_read_b128 v[116:119], v7 offset:1024
    s_waitcnt lgkmcnt(5)
    v_mfma_f32_16x16x32_bf16 v[56:59], v[120:123], v[220:223], v[56:59]
    s_add_u32 s93, s92, 13107200
    buffer_load_dwordx4 a[0:3], v2, s[36:39], s93 offen offset:0 sc1
    v_mfma_f32_16x16x32_bf16 v[84:87], v[120:123], v[224:227], v[84:87]
    ds_read_b128 v[120:123], v7 offset:2048
    buffer_load_dwordx4 a[4:7], v2, s[36:39], s93 offen offset:1024 sc1
    v_mfma_f32_16x16x32_bf16 v[60:63], v[124:127], v[220:223], v[60:63]
    s_waitcnt vmcnt(20)
    s_barrier
    v_mfma_f32_16x16x32_bf16 v[88:91], v[124:127], v[224:227], v[88:91]
    ds_read_b128 v[124:127], v7 offset:3072
    s_waitcnt lgkmcnt(5)
    v_mfma_f32_16x16x32_bf16 v[64:67], v[128:131], v[220:223], v[64:67]
    v_swap_b32 v142, v144
    v_mfma_f32_16x16x32_bf16 v[92:95], v[128:131], v[224:227], v[92:95]
    ds_read_b128 v[128:131], v7 offset:4096
    v_mfma_f32_16x16x32_bf16 v[68:71], v[132:135], v[220:223], v[68:71]
    v_swap_b32 v143, v145
    v_mfma_f32_16x16x32_bf16 v[96:99], v[132:135], v[224:227], v[96:99]
    ds_read_b128 v[132:135], v7 offset:5120
    s_waitcnt lgkmcnt(6)
    v_mfma_f32_16x16x32_bf16 v[72:75], v[136:139], v[220:223], v[72:75]
    buffer_load_dwordx4 a[8:11], v2, s[36:39], s93 offen offset:2048 sc1
    v_mfma_f32_16x16x32_bf16 v[100:103], v[136:139], v[224:227], v[100:103]
    ds_read_b128 v[136:139], v7 offset:6144
    s_waitcnt lgkmcnt(5)
    v_mfma_f32_16x16x32_bf16 v[48:51], v[112:115], v[140:143], v[48:51]
    v_mfma_f32_16x16x32_bf16 v[76:79], v[112:115], v[144:147], v[76:79]
    ds_read_b128 v[112:115], v2 offset:50176
    v_mfma_f32_16x16x32_bf16 v[52:55], v[116:119], v[140:143], v[52:55]
    buffer_load_dwordx4 a[12:15], v2, s[36:39], s93 offen offset:3072 sc1
    v_mfma_f32_16x16x32_bf16 v[80:83], v[116:119], v[144:147], v[80:83]
    ds_read_b128 v[116:119], v2 offset:51200
    s_waitcnt lgkmcnt(5)
    v_mfma_f32_16x16x32_bf16 v[56:59], v[120:123], v[140:143], v[56:59]
    v_mfma_f32_16x16x32_bf16 v[84:87], v[120:123], v[144:147], v[84:87]
    ds_read_b128 v[120:123], v2 offset:52224
    v_mfma_f32_16x16x32_bf16 v[60:63], v[124:127], v[140:143], v[60:63]
    v_mfma_f32_16x16x32_bf16 v[88:91], v[124:127], v[144:147], v[88:91]
    ds_read_b128 v[124:127], v2 offset:53248
    s_waitcnt lgkmcnt(5)
    v_mfma_f32_16x16x32_bf16 v[64:67], v[128:131], v[140:143], v[64:67]
    v_swap_b32 v150, v152
    v_mfma_f32_16x16x32_bf16 v[92:95], v[128:131], v[144:147], v[92:95]
    ds_read_b128 v[128:131], v2 offset:54272
    v_mfma_f32_16x16x32_bf16 v[68:71], v[132:135], v[140:143], v[68:71]
    v_swap_b32 v151, v153
    s_add_u32 s93, s92, 13111296
    v_mfma_f32_16x16x32_bf16 v[96:99], v[132:135], v[144:147], v[96:99]
    ds_read_b128 v[132:135], v2 offset:55296
    s_waitcnt lgkmcnt(6)
    v_mfma_f32_16x16x32_bf16 v[72:75], v[136:139], v[140:143], v[72:75]
    buffer_load_dwordx4 a[16:19], v2, s[36:39], s93 offen offset:0 sc1
    v_mfma_f32_16x16x32_bf16 v[100:103], v[136:139], v[144:147], v[100:103]
    ds_read_b128 v[136:139], v2 offset:56320
    s_waitcnt lgkmcnt(5)
    v_mfma_f32_16x16x32_bf16 v[48:51], v[112:115], v[148:151], v[48:51]
    buffer_load_dwordx4 a[20:23], v2, s[36:39], s93 offen offset:1024 sc1
    v_mfma_f32_16x16x32_bf16 v[76:79], v[112:115], v[152:155], v[76:79]
    ds_read_b128 v[112:115], v2 offset:43008
    v_mfma_f32_16x16x32_bf16 v[52:55], v[116:119], v[148:151], v[52:55]
    v_mfma_f32_16x16x32_bf16 v[80:83], v[116:119], v[152:155], v[80:83]
    ds_read_b128 v[116:119], v2 offset:44032
    s_waitcnt lgkmcnt(5)
    v_mfma_f32_16x16x32_bf16 v[56:59], v[120:123], v[148:151], v[56:59]
    v_mfma_f32_16x16x32_bf16 v[84:87], v[120:123], v[152:155], v[84:87]
    ds_read_b128 v[120:123], v2 offset:45056
    v_mfma_f32_16x16x32_bf16 v[60:63], v[124:127], v[148:151], v[60:63]
    v_mfma_f32_16x16x32_bf16 v[88:91], v[124:127], v[152:155], v[88:91]
    ds_read_b128 v[124:127], v2 offset:46080
    s_waitcnt lgkmcnt(5)
    v_mfma_f32_16x16x32_bf16 v[64:67], v[128:131], v[148:151], v[64:67]
    v_swap_b32 v158, v160
    buffer_load_dwordx4 a[24:27], v2, s[36:39], s93 offen offset:2048 sc1
    v_mfma_f32_16x16x32_bf16 v[92:95], v[128:131], v[152:155], v[92:95]
    ds_read_b128 v[128:131], v2 offset:47104
    v_mfma_f32_16x16x32_bf16 v[68:71], v[132:135], v[148:151], v[68:71]
    v_swap_b32 v159, v161
    v_mfma_f32_16x16x32_bf16 v[96:99], v[132:135], v[152:155], v[96:99]
    ds_read_b128 v[132:135], v2 offset:48128
    s_waitcnt lgkmcnt(6)
    v_mfma_f32_16x16x32_bf16 v[72:75], v[136:139], v[148:151], v[72:75]
    v_mfma_f32_16x16x32_bf16 v[100:103], v[136:139], v[152:155], v[100:103]
    ds_read_b128 v[136:139], v2 offset:49152
    s_waitcnt lgkmcnt(5)
    v_mfma_f32_16x16x32_bf16 v[48:51], v[112:115], v[156:159], v[48:51]
    buffer_load_dwordx4 a[28:31], v2, s[36:39], s93 offen offset:3072 sc1
    v_mfma_f32_16x16x32_bf16 v[76:79], v[112:115], v[160:163], v[76:79]
    ds_read_b128 v[112:115], v2 offset:35840
    v_mfma_f32_16x16x32_bf16 v[52:55], v[116:119], v[156:159], v[52:55]
    v_mfma_f32_16x16x32_bf16 v[80:83], v[116:119], v[160:163], v[80:83]
    ds_read_b128 v[116:119], v2 offset:36864
    s_waitcnt lgkmcnt(5)
    v_mfma_f32_16x16x32_bf16 v[56:59], v[120:123], v[156:159], v[56:59]
    v_mfma_f32_16x16x32_bf16 v[84:87], v[120:123], v[160:163], v[84:87]
    ds_read_b128 v[120:123], v2 offset:37888
    v_mfma_f32_16x16x32_bf16 v[60:63], v[124:127], v[156:159], v[60:63]
    s_add_u32 s93, s92, 13115392
    v_mfma_f32_16x16x32_bf16 v[88:91], v[124:127], v[160:163], v[88:91]
    ds_read_b128 v[124:127], v2 offset:38912
    s_waitcnt lgkmcnt(5)
    v_mfma_f32_16x16x32_bf16 v[64:67], v[128:131], v[156:159], v[64:67]
    v_swap_b32 v166, v168
    buffer_load_dwordx4 a[32:35], v2, s[36:39], s93 offen offset:0 sc1
    v_mfma_f32_16x16x32_bf16 v[92:95], v[128:131], v[160:163], v[92:95]
    ds_read_b128 v[128:131], v2 offset:39936
    v_mfma_f32_16x16x32_bf16 v[68:71], v[132:135], v[156:159], v[68:71]
    v_swap_b32 v167, v169
    v_mfma_f32_16x16x32_bf16 v[96:99], v[132:135], v[160:163], v[96:99]
    ds_read_b128 v[132:135], v2 offset:40960
    s_waitcnt lgkmcnt(6)
    v_mfma_f32_16x16x32_bf16 v[72:75], v[136:139], v[156:159], v[72:75]
    buffer_load_dwordx4 a[36:39], v2, s[36:39], s93 offen offset:1024 sc1
    v_mfma_f32_16x16x32_bf16 v[100:103], v[136:139], v[160:163], v[100:103]
    ds_read_b128 v[136:139], v2 offset:41984
    s_waitcnt lgkmcnt(5)
    v_mfma_f32_16x16x32_bf16 v[48:51], v[112:115], v[164:167], v[48:51]
    s_waitcnt vmcnt(12)
    v_cmp_ne_u32 vcc, v20, v14
    s_cbranch_vccz Lpd_33
    s_mov_b32 s96, 0
Lps_34x:
    buffer_load_dword v20, v21, s[36:39], s70 offen sc1
    s_waitcnt vmcnt(0)
    v_cmp_ne_u32 vcc, v20, v14
    s_cbranch_vccz Lpd_33
    s_sleep 1
    s_add_u32 s96, s96, 1
    s_cmp_lt_u32 s96, 100000
    s_cbranch_scc1 Lps_34x
Lpd_33:
    s_lshl_b32 s70, s61, 9
    s_add_u32 s70, s70, 5373952
    buffer_load_dwordx4 v[32:35], v2, s[36:39], s70 offen sc1
    v_lshrrev_b32 v36, 2, v1
    v_mfma_f32_16x16x32_bf16 v[76:79], v[112:115], v[168:171], v[76:79]
    ds_read_b128 v[112:115], v2 offset:28672
    v_mul_u32_u24 v36, 7168, v36
    v_mfma_f32_16x16x32_bf16 v[52:55], v[116:119], v[164:167], v[52:55]
    v_and_b32 v37, 3, v1
    v_mfma_f32_16x16x32_bf16 v[80:83], v[116:119], v[168:171], v[80:83]
    ds_read_b128 v[116:119], v2 offset:29696
    s_waitcnt lgkmcnt(5)
    v_mfma_f32_16x16x32_bf16 v[56:59], v[120:123], v[164:167], v[56:59]
    s_waitcnt vmcnt(11)
    v_cmp_ne_u32 vcc, v228, v14
    s_cbranch_vccz Lpd_35
    s_mov_b32 s96, 0
Lps_36x:
    buffer_load_dword v228, v231, s[36:39], s75 offen sc1
    s_waitcnt vmcnt(0)
    v_cmp_ne_u32 vcc, v228, v14
    s_cbranch_vccz Lpd_35
    s_sleep 1
    s_add_u32 s96, s96, 1
    s_cmp_lt_u32 s96, 100000
    s_cbranch_scc1 Lps_36x
Lpd_35:
    v_lshlrev_b32 v37, 8, v37
    v_mfma_f32_16x16x32_bf16 v[84:87], v[120:123], v[168:171], v[84:87]
    ds_read_b128 v[120:123], v2 offset:30720
    v_sub_u32 v36, v37, v36
    v_mfma_f32_16x16x32_bf16 v[60:63], v[124:127], v[164:167], v[60:63]
    s_barrier
    v_mfma_f32_16x16x32_bf16 v[88:91], v[124:127], v[168:171], v[88:91]
    ds_read_b128 v[124:127], v2 offset:31744
    s_waitcnt lgkmcnt(5)
    v_mfma_f32_16x16x32_bf16 v[64:67], v[128:131], v[164:167], v[64:67]
    v_swap_b32 v174, v176
    s_mul_i32 s76, s62, 40960
    v_mfma_f32_16x16x32_bf16 v[92:95], v[128:131], v[168:171], v[92:95]
    ds_read_b128 v[128:131], v2 offset:32768
    s_mul_i32 s77, s63, 5120
    v_mfma_f32_16x16x32_bf16 v[68:71], v[132:135], v[164:167], v[68:71]
    v_swap_b32 v175, v177
    s_add_u32 s76, s76, s77
    v_mfma_f32_16x16x32_bf16 v[96:99], v[132:135], v[168:171], v[96:99]
    ds_read_b128 v[132:135], v2 offset:33792
    s_waitcnt lgkmcnt(6)
    v_mfma_f32_16x16x32_bf16 v[72:75], v[136:139], v[164:167], v[72:75]
    s_and_b32 s77, s6, 1
    v_add_u32 v36, 142448, v36
    v_mfma_f32_16x16x32_bf16 v[100:103], v[136:139], v[168:171], v[100:103]
    ds_read_b128 v[136:139], v2 offset:34816
    s_waitcnt lgkmcnt(5)
    v_mfma_f32_16x16x32_bf16 v[48:51], v[112:115], v[172:175], v[48:51]
    s_add_u32 s88, s90, 17039360
    buffer_load_dwordx4 v[212:215], v6, s[36:39], s88 offen offset:0 sc1
    s_mul_i32 s77, s77, 2621440
    v_mfma_f32_16x16x32_bf16 v[76:79], v[112:115], v[176:179], v[76:79]
    ds_read_b128 v[112:115], v2 offset:21504
    s_add_u32 s76, s76, s77
    v_mfma_f32_16x16x32_bf16 v[52:55], v[116:119], v[172:175], v[52:55]
    buffer_load_dwordx4 v[216:219], v6, s[36:39], s88 offen offset:256 sc1
    s_lshr_b32 s77, s6, 1
    v_mfma_f32_16x16x32_bf16 v[80:83], v[116:119], v[176:179], v[80:83]
    ds_read_b128 v[116:119], v2 offset:22528
    s_waitcnt lgkmcnt(5)
    v_mfma_f32_16x16x32_bf16 v[56:59], v[120:123], v[172:175], v[56:59]
    buffer_load_dwordx4 v[220:223], v6, s[36:39], s88 offen offset:2048 sc1
    s_mul_i32 s77, s77, 1310720
    v_mfma_f32_16x16x32_bf16 v[84:87], v[120:123], v[176:179], v[84:87]
    ds_read_b128 v[120:123], v2 offset:23552
    s_add_u32 s76, s76, s77
    v_mfma_f32_16x16x32_bf16 v[60:63], v[124:127], v[172:175], v[60:63]
    buffer_load_dwordx4 v[224:227], v6, s[36:39], s88 offen offset:2304 sc1
    v_mfma_f32_16x16x32_bf16 v[88:91], v[124:127], v[176:179], v[88:91]
    ds_read_b128 v[124:127], v2 offset:24576
    s_waitcnt lgkmcnt(5)
    v_mfma_f32_16x16x32_bf16 v[64:67], v[128:131], v[172:175], v[64:67]
    v_swap_b32 v182, v184
    s_add_u32 s76, s76, 15728640
    v_mfma_f32_16x16x32_bf16 v[92:95], v[128:131], v[176:179], v[92:95]
    ds_read_b128 v[128:131], v2 offset:25600
    s_mul_i32 s77, s6, 5120
    v_mfma_f32_16x16x32_bf16 v[68:71], v[132:135], v[172:175], v[68:71]
    v_swap_b32 v183, v185
    v_lshlrev_b32 v229, 1, v4
    v_mfma_f32_16x16x32_bf16 v[96:99], v[132:135], v[176:179], v[96:99]
    ds_read_b128 v[132:135], v2 offset:26624
    s_waitcnt lgkmcnt(6)
    v_mfma_f32_16x16x32_bf16 v[72:75], v[136:139], v[172:175], v[72:75]
    v_and_b32 v229, 4, v229
    buffer_load_dwordx4 a[40:43], v2, s[36:39], s93 offen offset:2048 sc1
    v_mfma_f32_16x16x32_bf16 v[100:103], v[136:139], v[176:179], v[100:103]
    ds_read_b128 v[136:139], v2 offset:27648
    s_waitcnt lgkmcnt(5)
    v_mfma_f32_16x16x32_bf16 v[48:51], v[112:115], v[180:183], v[48:51]
    s_add_u32 s88, s90, 17043456
    buffer_load_dwordx4 v[140:143], v6, s[36:39], s88 offen offset:0 sc1
    v_sub_u32 v229, v3, v229
    v_mfma_f32_16x16x32_bf16 v[76:79], v[112:115], v[184:187], v[76:79]
    ds_read_b128 v[112:115], v2 offset:14336
    v_and_b32 v229, 15, v229
    v_mfma_f32_16x16x32_bf16 v[52:55], v[116:119], v[180:183], v[52:55]
    buffer_load_dwordx4 v[144:147], v6, s[36:39], s88 offen offset:256 sc1
    v_lshlrev_b32 v229, 4, v229
    v_mfma_f32_16x16x32_bf16 v[80:83], v[116:119], v[184:187], v[80:83]
    ds_read_b128 v[116:119], v2 offset:15360
    s_waitcnt lgkmcnt(5)
    v_mfma_f32_16x16x32_bf16 v[56:59], v[120:123], v[180:183], v[56:59]
    buffer_load_dwordx4 v[148:151], v6, s[36:39], s88 offen offset:2048 sc1
    v_lshl_add_u32 v229, v4, 8, v229
    v_mfma_f32_16x16x32_bf16 v[84:87], v[120:123], v[184:187], v[84:87]
    ds_read_b128 v[120:123], v2 offset:16384
    v_xor_b32 v230, 0x80, v229
    v_mfma_f32_16x16x32_bf16 v[60:63], v[124:127], v[180:183], v[60:63]
    buffer_load_dwordx4 v[152:155], v6, s[36:39], s88 offen offset:2304 sc1
    v_mfma_f32_16x16x32_bf16 v[88:91], v[124:127], v[184:187], v[88:91]
    ds_read_b128 v[124:127], v2 offset:17408
    s_waitcnt lgkmcnt(5)
    v_mfma_f32_16x16x32_bf16 v[64:67], v[128:131], v[180:183], v[64:67]
    v_swap_b32 v190, v192
    s_add_u32 s78, s76, 0
    s_add_u32 m0, s77, 143360
    s_nop 0
    buffer_load_dwordx4 v229, s[36:39], s78 offen sc1 lds
    v_mfma_f32_16x16x32_bf16 v[92:95], v[128:131], v[184:187], v[92:95]
    ds_read_b128 v[128:131], v2 offset:18432
    s_add_u32 s78, s76, 1024
    s_add_u32 m0, s77, 144384
    s_nop 0
    buffer_load_dwordx4 v230, s[36:39], s78 offen sc1 lds
    v_mfma_f32_16x16x32_bf16 v[68:71], v[132:135], v[180:183], v[68:71]
    v_swap_b32 v191, v193
    s_add_u32 s78, s76, 2048
    s_add_u32 m0, s77, 145408
    s_nop 0
    buffer_load_dwordx4 v229, s[36:39], s78 offen sc1 lds
    v_mfma_f32_16x16x32_bf16 v[96:99], v[132:135], v[184:187], v[96:99]
    ds_read_b128 v[132:135], v2 offset:19456
    s_waitcnt lgkmcnt(6)
    v_mfma_f32_16x16x32_bf16 v[72:75], v[136:139], v[180:183], v[72:75]
    s_add_u32 s78, s76, 3072
    s_add_u32 m0, s77, 146432
    s_nop 0
    buffer_load_dwordx4 v230, s[36:39], s78 offen sc1 lds
    buffer_load_dwordx4 a[44:47], v2, s[36:39], s93 offen offset:3072 sc1
    v_mfma_f32_16x16x32_bf16 v[100:103], v[136:139], v[184:187], v[100:103]
    ds_read_b128 v[136:139], v2 offset:20480
    s_waitcnt lgkmcnt(5)
    v_mfma_f32_16x16x32_bf16 v[48:51], v[112:115], v[188:191], v[48:51]
    s_add_u32 s88, s90, 17047552
    buffer_load_dwordx4 v[156:159], v6, s[36:39], s88 offen offset:0 sc1
    s_add_u32 s78, s76, 4096
    s_add_u32 m0, s77, 147456
    s_nop 0
    buffer_load_dwordx4 v229, s[36:39], s78 offen sc1 lds
    v_mfma_f32_16x16x32_bf16 v[76:79], v[112:115], v[192:195], v[76:79]
    ds_read_b128 v[112:115], v2 offset:7168
    s_add_u32 s93, s92, 13119488
    v_mfma_f32_16x16x32_bf16 v[52:55], v[116:119], v[188:191], v[52:55]
    buffer_load_dwordx4 v[160:163], v6, s[36:39], s88 offen offset:256 sc1
    buffer_load_dwordx4 a[48:51], v2, s[36:39], s93 offen offset:0 sc1
    v_mfma_f32_16x16x32_bf16 v[80:83], v[116:119], v[192:195], v[80:83]
    ds_read_b128 v[116:119], v2 offset:8192
    s_waitcnt lgkmcnt(5)
    v_mfma_f32_16x16x32_bf16 v[56:59], v[120:123], v[188:191], v[56:59]
    buffer_load_dwordx4 v[164:167], v6, s[36:39], s88 offen offset:2048 sc1
    buffer_load_dwordx4 a[52:55], v2, s[36:39], s93 offen offset:1024 sc1
    v_mfma_f32_16x16x32_bf16 v[84:87], v[120:123], v[192:195], v[84:87]
    ds_read_b128 v[120:123], v2 offset:9216
    buffer_load_dwordx4 a[56:59], v2, s[36:39], s93 offen offset:2048 sc1
    v_mfma_f32_16x16x32_bf16 v[60:63], v[124:127], v[188:191], v[60:63]
    buffer_load_dwordx4 v[168:171], v6, s[36:39], s88 offen offset:2304 sc1
    v_mfma_f32_16x16x32_bf16 v[88:91], v[124:127], v[192:195], v[88:91]
    ds_read_b128 v[124:127], v2 offset:10240
    s_waitcnt lgkmcnt(5)
    v_mfma_f32_16x16x32_bf16 v[64:67], v[128:131], v[188:191], v[64:67]
    v_swap_b32 v198, v200
    buffer_load_dwordx4 a[60:63], v2, s[36:39], s93 offen offset:3072 sc1
    v_mfma_f32_16x16x32_bf16 v[92:95], v[128:131], v[192:195], v[92:95]
    ds_read_b128 v[128:131], v2 offset:11264
    s_add_u32 s93, s92, 13123584
    v_mfma_f32_16x16x32_bf16 v[68:71], v[132:135], v[188:191], v[68:71]
    v_swap_b32 v199, v201
    buffer_load_dwordx4 a[64:67], v2, s[36:39], s93 offen offset:0 sc1
    v_mfma_f32_16x16x32_bf16 v[96:99], v[132:135], v[192:195], v[96:99]
    ds_read_b128 v[132:135], v2 offset:12288
    s_waitcnt lgkmcnt(6)
    v_mfma_f32_16x16x32_bf16 v[72:75], v[136:139], v[188:191], v[72:75]
    buffer_load_dwordx4 a[68:71], v2, s[36:39], s93 offen offset:1024 sc1
    buffer_load_dwordx4 a[72:75], v2, s[36:39], s93 offen offset:2048 sc1
    v_mfma_f32_16x16x32_bf16 v[100:103], v[136:139], v[192:195], v[100:103]
    ds_read_b128 v[136:139], v2 offset:13312
    s_waitcnt lgkmcnt(0)
    v_mfma_f32_16x16x32_bf16 v[72:75], v[136:139], v[196:199], v[72:75]
    s_add_u32 s88, s90, 17051648
    buffer_load_dwordx4 v[172:175], v6, s[36:39], s88 offen offset:0 sc1
    v_mfma_f32_16x16x32_bf16 v[100:103], v[136:139], v[200:203], v[100:103]
    ds_read_b128 v[136:139], v2 offset:6144
    v_mfma_f32_16x16x32_bf16 v[48:51], v[112:115], v[196:199], v[48:51]
    buffer_load_dwordx4 v[176:179], v6, s[36:39], s88 offen offset:256 sc1
    buffer_load_dwordx4 a[76:79], v2, s[36:39], s93 offen offset:3072 sc1
    v_mfma_f32_16x16x32_bf16 v[76:79], v[112:115], v[200:203], v[76:79]
    ds_read_b128 v[112:115], v2 offset:0
    v_mfma_f32_16x16x32_bf16 v[52:55], v[116:119], v[196:199], v[52:55]
    buffer_load_dwordx4 v[180:183], v6, s[36:39], s88 offen offset:2048 sc1
    v_mfma_f32_16x16x32_bf16 v[80:83], v[116:119], v[200:203], v[80:83]
    ds_read_b128 v[116:119], v2 offset:1024
    v_mfma_f32_16x16x32_bf16 v[56:59], v[120:123], v[196:199], v[56:59]
    buffer_load_dwordx4 v[184:187], v6, s[36:39], s88 offen offset:2304 sc1
    v_mfma_f32_16x16x32_bf16 v[84:87], v[120:123], v[200:203], v[84:87]
    ds_read_b128 v[120:123], v2 offset:2048
    v_mfma_f32_16x16x32_bf16 v[60:63], v[124:127], v[196:199], v[60:63]
    v_swap_b32 v206, v208
    v_mfma_f32_16x16x32_bf16 v[88:91], v[124:127], v[200:203], v[88:91]
    ds_read_b128 v[124:127], v2 offset:3072
    v_mfma_f32_16x16x32_bf16 v[64:67], v[128:131], v[196:199], v[64:67]
    v_swap_b32 v207, v209
    s_waitcnt vmcnt(31)
    s_mov_b32 exec_lo, 0x0fffffff
    s_mov_b32 exec_hi, 0
    ds_write_b128 v36, v[32:35]
    s_mov_b64 exec, -1
    v_mfma_f32_16x16x32_bf16 v[92:95], v[128:131], v[200:203], v[92:95]
    ds_read_b128 v[128:131], v2 offset:4096
    v_mfma_f32_16x16x32_bf16 v[68:71], v[132:135], v[196:199], v[68:71]
    v_mfma_f32_16x16x32_bf16 v[96:99], v[132:135], v[200:203], v[96:99]
    ds_read_b128 v[132:135], v2 offset:5120
    s_waitcnt lgkmcnt(6)
    v_mfma_f32_16x16x32_bf16 v[72:75], v[136:139], v[204:207], v[72:75]
    s_add_u32 s88, s90, 17055744
    buffer_load_dwordx4 v[188:191], v6, s[36:39], s88 offen offset:0 sc1
    v_mfma_f32_16x16x32_bf16 v[100:103], v[136:139], v[208:211], v[100:103]
    ds_read_b128 v[136:139], v0 offset:0
    v_mfma_f32_16x16x32_bf16 v[48:51], v[112:115], v[204:207], v[48:51]
    buffer_load_dwordx4 v[192:195], v6, s[36:39], s88 offen offset:256 sc1
    v_mfma_f32_16x16x32_bf16 v[76:79], v[112:115], v[208:211], v[76:79]
    ds_read_b128 v[112:115], v0 offset:43008
    s_waitcnt lgkmcnt(6)
    v_mfma_f32_16x16x32_bf16 v[52:55], v[116:119], v[204:207], v[52:55]
    buffer_load_dwordx4 v[196:199], v6, s[36:39], s88 offen offset:2048 sc1
    v_mfma_f32_16x16x32_bf16 v[80:83], v[116:119], v[208:211], v[80:83]
    ds_read_b128 v[116:119], v0 offset:35840
    v_mfma_f32_16x16x32_bf16 v[56:59], v[120:123], v[204:207], v[56:59]
    ds_bpermute_b32 v104, v10, v74
    ds_bpermute_b32 v106, v10, v102
    v_mfma_f32_16x16x32_bf16 v[84:87], v[120:123], v[208:211], v[84:87]
    ds_read_b128 v[120:123], v0 offset:28672
    s_waitcnt lgkmcnt(7)
    v_mfma_f32_16x16x32_bf16 v[60:63], v[124:127], v[204:207], v[60:63]
    v_mfma_f32_16x16x32_bf16 v[88:91], v[124:127], v[208:211], v[88:91]
    ds_read_b128 v[124:127], v0 offset:21504
    v_mfma_f32_16x16x32_bf16 v[64:67], v[128:131], v[204:207], v[64:67]
    v_mfma_f32_16x16x32_bf16 v[92:95], v[128:131], v[208:211], v[92:95]
    ds_read_b128 v[128:131], v0 offset:14336
    s_waitcnt lgkmcnt(8)
    v_mfma_f32_16x16x32_bf16 v[68:71], v[132:135], v[204:207], v[68:71]
    s_waitcnt lgkmcnt(3)
    v_mul_f32 v104, 0x3acccccd, v104
    v_mfma_f32_16x16x32_bf16 v[96:99], v[132:135], v[208:211], v[96:99]
    ds_read_b128 v[132:135], v0 offset:7168
    v_mul_f32 v106, 0x3acccccd, v106
    v_cvt_pk_bf16_f32 v104, v104, v104
    v_cvt_pk_bf16_f32 v106, v106, v106
    v_lshlrev_b32 v104, 16, v104
    v_lshlrev_b32 v106, 16, v106
    s_add_u32 s72, s95, 33554432
    buffer_load_dwordx4 v[200:203], v6, s[36:39], s88 offen offset:2304 sc1
    s_add_u32 s88, s90, 17059840
    buffer_load_dwordx4 v[204:207], v6, s[36:39], s88 offen offset:0 sc1
    buffer_load_dwordx4 v[208:211], v6, s[36:39], s88 offen offset:256 sc1
    v_pk_fma_f32 v[72:73], v[136:137], v[104:105], v[72:73] op_sel_hi:[1,0,1] neg_lo:[0,1,0] neg_hi:[0,1,0]
    v_pk_fma_f32 v[74:75], v[138:139], v[104:105], v[74:75] op_sel_hi:[1,0,1] neg_lo:[0,1,0] neg_hi:[0,1,0]
    v_pk_fma_f32 v[48:49], v[112:113], v[104:105], v[48:49] op_sel_hi:[1,0,1] neg_lo:[0,1,0] neg_hi:[0,1,0]
    v_pk_fma_f32 v[50:51], v[114:115], v[104:105], v[50:51] op_sel_hi:[1,0,1] neg_lo:[0,1,0] neg_hi:[0,1,0]
    v_pk_fma_f32 v[52:53], v[116:117], v[104:105], v[52:53] op_sel_hi:[1,0,1] neg_lo:[0,1,0] neg_hi:[0,1,0]
    v_pk_fma_f32 v[54:55], v[118:119], v[104:105], v[54:55] op_sel_hi:[1,0,1] neg_lo:[0,1,0] neg_hi:[0,1,0]
    s_waitcnt lgkmcnt(3)
    v_pk_fma_f32 v[56:57], v[120:121], v[104:105], v[56:57] op_sel_hi:[1,0,1] neg_lo:[0,1,0] neg_hi:[0,1,0]
    v_pk_fma_f32 v[58:59], v[122:123], v[104:105], v[58:59] op_sel_hi:[1,0,1] neg_lo:[0,1,0] neg_hi:[0,1,0]
    s_waitcnt lgkmcnt(2)
    v_pk_fma_f32 v[60:61], v[124:125], v[104:105], v[60:61] op_sel_hi:[1,0,1] neg_lo:[0,1,0] neg_hi:[0,1,0]
    v_pk_fma_f32 v[62:63], v[126:127], v[104:105], v[62:63] op_sel_hi:[1,0,1] neg_lo:[0,1,0] neg_hi:[0,1,0]
    s_waitcnt lgkmcnt(1)
    v_pk_fma_f32 v[64:65], v[128:129], v[104:105], v[64:65] op_sel_hi:[1,0,1] neg_lo:[0,1,0] neg_hi:[0,1,0]
    v_pk_fma_f32 v[66:67], v[130:131], v[104:105], v[66:67] op_sel_hi:[1,0,1] neg_lo:[0,1,0] neg_hi:[0,1,0]
    s_waitcnt lgkmcnt(0)
    v_pk_fma_f32 v[68:69], v[132:133], v[104:105], v[68:69] op_sel_hi:[1,0,1] neg_lo:[0,1,0] neg_hi:[0,1,0]
    v_pk_fma_f32 v[70:71], v[134:135], v[104:105], v[70:71] op_sel_hi:[1,0,1] neg_lo:[0,1,0] neg_hi:[0,1,0]
    v_permlane32_swap_b32 v72, v74
    v_permlane32_swap_b32 v73, v75
    v_pk_mul_f32 v[48:49], v[48:49], v[60:61]
    v_pk_mul_f32 v[50:51], v[50:51], v[62:63]
    v_pk_mul_f32 v[52:53], v[52:53], v[64:65]
    v_pk_mul_f32 v[54:55], v[54:55], v[66:67]
    v_pk_mul_f32 v[56:57], v[56:57], v[68:69]
    v_pk_mul_f32 v[58:59], v[58:59], v[70:71]
    v_pk_mul_f32 v[60:61], v[72:73], v[74:75]
    v_cvt_pk_bf16_f32 v72, v56, v57
    v_cvt_pk_bf16_f32 v73, v58, v59
    v_mov_b32 v71, 0
    v_cvt_pk_bf16_f32 v64, v48, v49
    v_cvt_pk_bf16_f32 v65, v50, v51
    v_cvt_pk_bf16_f32 v66, v52, v53
    v_cvt_pk_bf16_f32 v67, v54, v55
    v_permlane16_swap_b32 v72, v73
    v_cvt_pk_bf16_f32 v68, v56, v57
    v_cvt_pk_bf16_f32 v69, v58, v59
    v_cvt_pk_bf16_f32 v70, v60, v61
    v_permlane32_swap_b32 v73, v71
    s_cmp_eq_u32 s30, 0
    s_cbranch_scc1 Lg_37
    buffer_store_dwordx4 v[64:67], v2, s[36:39], s72 offen
    s_mov_b32 exec_hi, 0xffff
    buffer_store_dwordx4 v[68:71], v2, s[36:39], s72 offen offset:1024
    s_mov_b64 exec, -1
Lgb_38:
    s_add_u32 s72, s72, 57344
    v_pk_fma_f32 v[100:101], v[136:137], v[106:107], v[100:101] op_sel_hi:[1,0,1] neg_lo:[0,1,0] neg_hi:[0,1,0]
    v_pk_fma_f32 v[102:103], v[138:139], v[106:107], v[102:103] op_sel_hi:[1,0,1] neg_lo:[0,1,0] neg_hi:[0,1,0]
    v_pk_fma_f32 v[76:77], v[112:113], v[106:107], v[76:77] op_sel_hi:[1,0,1] neg_lo:[0,1,0] neg_hi:[0,1,0]
    v_pk_fma_f32 v[78:79], v[114:115], v[106:107], v[78:79] op_sel_hi:[1,0,1] neg_lo:[0,1,0] neg_hi:[0,1,0]
    v_pk_fma_f32 v[80:81], v[116:117], v[106:107], v[80:81] op_sel_hi:[1,0,1] neg_lo:[0,1,0] neg_hi:[0,1,0]
    v_pk_fma_f32 v[82:83], v[118:119], v[106:107], v[82:83] op_sel_hi:[1,0,1] neg_lo:[0,1,0] neg_hi:[0,1,0]
    v_pk_fma_f32 v[84:85], v[120:121], v[106:107], v[84:85] op_sel_hi:[1,0,1] neg_lo:[0,1,0] neg_hi:[0,1,0]
    v_pk_fma_f32 v[86:87], v[122:123], v[106:107], v[86:87] op_sel_hi:[1,0,1] neg_lo:[0,1,0] neg_hi:[0,1,0]
    v_pk_fma_f32 v[88:89], v[124:125], v[106:107], v[88:89] op_sel_hi:[1,0,1] neg_lo:[0,1,0] neg_hi:[0,1,0]
    v_pk_fma_f32 v[90:91], v[126:127], v[106:107], v[90:91] op_sel_hi:[1,0,1] neg_lo:[0,1,0] neg_hi:[0,1,0]
    v_pk_fma_f32 v[92:93], v[128:129], v[106:107], v[92:93] op_sel_hi:[1,0,1] neg_lo:[0,1,0] neg_hi:[0,1,0]
    v_pk_fma_f32 v[94:95], v[130:131], v[106:107], v[94:95] op_sel_hi:[1,0,1] neg_lo:[0,1,0] neg_hi:[0,1,0]
    v_pk_fma_f32 v[96:97], v[132:133], v[106:107], v[96:97] op_sel_hi:[1,0,1] neg_lo:[0,1,0] neg_hi:[0,1,0]
    v_pk_fma_f32 v[98:99], v[134:135], v[106:107], v[98:99] op_sel_hi:[1,0,1] neg_lo:[0,1,0] neg_hi:[0,1,0]
    v_permlane32_swap_b32 v100, v102
    v_permlane32_swap_b32 v101, v103
    v_pk_mul_f32 v[76:77], v[76:77], v[88:89]
    v_pk_mul_f32 v[78:79], v[78:79], v[90:91]
    v_pk_mul_f32 v[80:81], v[80:81], v[92:93]
    v_pk_mul_f32 v[82:83], v[82:83], v[94:95]
    v_pk_mul_f32 v[84:85], v[84:85], v[96:97]
    v_pk_mul_f32 v[86:87], v[86:87], v[98:99]
    v_pk_mul_f32 v[88:89], v[100:101], v[102:103]
    v_cvt_pk_bf16_f32 v100, v84, v85
    v_cvt_pk_bf16_f32 v101, v86, v87
    v_mov_b32 v99, 0
    v_cvt_pk_bf16_f32 v92, v76, v77
    v_cvt_pk_bf16_f32 v93, v78, v79
    v_cvt_pk_bf16_f32 v94, v80, v81
    v_cvt_pk_bf16_f32 v95, v82, v83
    v_permlane16_swap_b32 v100, v101
    v_cvt_pk_bf16_f32 v96, v84, v85
    v_cvt_pk_bf16_f32 v97, v86, v87
    v_cvt_pk_bf16_f32 v98, v88, v89
    v_permlane32_swap_b32 v101, v99
    s_cmp_eq_u32 s30, 0
    s_cbranch_scc1 Lg_39
    buffer_store_dwordx4 v[92:95], v2, s[36:39], s72 offen
    s_mov_b32 exec_hi, 0xffff
    buffer_store_dwordx4 v[96:99], v2, s[36:39], s72 offen offset:1024
    s_mov_b64 exec, -1
Lgb_40:
    ds_read_b128 v[112:115], v8 offset:21504
    ds_read_b128 v[116:119], v8 offset:22528
    ds_read_b128 v[120:123], v8 offset:23552
    ds_read_b128 v[124:127], v8 offset:24576
    ds_read_b128 v[128:131], v8 offset:25600
    ds_read_b128 v[132:135], v8 offset:26624
    ds_read_b128 v[136:139], v8 offset:27648
    s_waitcnt vmcnt(39)
    v_swap_b32 v214, v216
    v_swap_b32 v215, v217
    s_waitcnt lgkmcnt(5)
    s_nop 0
    v_mfma_f32_16x16x32_bf16 v[48:51], v[112:115], v[212:215], 0
    v_mfma_f32_16x16x32_bf16 v[76:79], v[112:115], v[216:219], 0
    ds_read_b128 v[112:115], v8 offset:14336
    v_mfma_f32_16x16x32_bf16 v[52:55], v[116:119], v[212:215], 0
    s_add_u32 s93, s92, 13127680
    s_waitcnt vmcnt(25)
    s_barrier
    v_mfma_f32_16x16x32_bf16 v[80:83], v[116:119], v[216:219], 0
    ds_read_b128 v[116:119], v8 offset:15360
    s_waitcnt lgkmcnt(5)
    v_mfma_f32_16x16x32_bf16 v[56:59], v[120:123], v[212:215], 0
    buffer_load_dwordx4 a[80:83], v2, s[36:39], s93 offen offset:0 sc1
    ds_read_b128 v[16:19], v13 offset:0
    v_mfma_f32_16x16x32_bf16 v[84:87], v[120:123], v[216:219], 0
    ds_read_b128 v[120:123], v8 offset:16384
    s_lshl_b32 s7, s5, 2
    v_mfma_f32_16x16x32_bf16 v[60:63], v[124:127], v[212:215], 0
    s_add_u32 s7, s7, s6
    v_mfma_f32_16x16x32_bf16 v[88:91], v[124:127], v[216:219], 0
    ds_read_b128 v[124:127], v8 offset:17408
    s_waitcnt lgkmcnt(6)
    v_mfma_f32_16x16x32_bf16 v[64:67], v[128:131], v[212:215], 0
    v_swap_b32 v222, v224
    s_mul_i32 s7, s7, 384
    v_mfma_f32_16x16x32_bf16 v[92:95], v[128:131], v[216:219], 0
    ds_read_b128 v[128:131], v8 offset:18432
    v_lshl_add_u32 v105, v1, 7, s7
    v_mfma_f32_16x16x32_bf16 v[68:71], v[132:135], v[212:215], 0
    v_swap_b32 v223, v225
    v_min_u32 v105, L_last-L_join, v105
    v_mfma_f32_16x16x32_bf16 v[96:99], v[132:135], v[216:219], 0
    ds_read_b128 v[132:135], v8 offset:19456
    s_waitcnt lgkmcnt(7)
    v_mfma_f32_16x16x32_bf16 v[72:75], v[136:139], v[212:215], 0
    v_add_u32 v105, L_join-Lpf_41, v105
    s_getpc_b64 s[12:13]
Lpf_41:
    s_mov_b64 exec, 7
    global_load_dword v5, v105, s[12:13]
    s_mov_b64 exec, -1
    v_mfma_f32_16x16x32_bf16 v[100:103], v[136:139], v[216:219], 0
    ds_read_b128 v[136:139], v8 offset:20480
    s_waitcnt lgkmcnt(6)
    v_mfma_f32_16x16x32_bf16 v[48:51], v[112:115], v[220:223], v[48:51]
    buffer_load_dwordx4 v[212:215], v6, s[36:39], s88 offen offset:2048 sc1
    buffer_load_dwordx4 a[84:87], v2, s[36:39], s93 offen offset:1024 sc1
    v_mfma_f32_16x16x32_bf16 v[76:79], v[112:115], v[224:227], v[76:79]
    ds_read_b128 v[112:115], v8 offset:7168
    buffer_load_dwordx4 a[88:91], v2, s[36:39], s93 offen offset:2048 sc1
    v_mfma_f32_16x16x32_bf16 v[52:55], v[116:119], v[220:223], v[52:55]
    buffer_load_dwordx4 v[216:219], v6, s[36:39], s88 offen offset:2304 sc1
    buffer_load_dwordx4 a[92:95], v2, s[36:39], s93 offen offset:3072 sc1
    v_mfma_f32_16x16x32_bf16 v[80:83], v[116:119], v[224:227], v[80:83]
    ds_read_b128 v[116:119], v8 offset:8192
    s_waitcnt lgkmcnt(5)
    v_mfma_f32_16x16x32_bf16 v[56:59], v[120:123], v[220:223], v[56:59]
    ds_read_b128 v[20:23], v13 offset:256
    v_mfma_f32_16x16x32_bf16 v[84:87], v[120:123], v[224:227], v[84:87]
    ds_read_b128 v[120:123], v8 offset:9216
    v_mfma_f32_16x16x32_bf16 v[60:63], v[124:127], v[220:223], v[60:63]
    s_add_u32 s93, s92, 13131776
    v_mfma_f32_16x16x32_bf16 v[88:91], v[124:127], v[224:227], v[88:91]
    ds_read_b128 v[124:127], v8 offset:10240
    s_waitcnt lgkmcnt(6)
    v_mfma_f32_16x16x32_bf16 v[64:67], v[128:131], v[220:223], v[64:67]
    v_swap_b32 v142, v144
    buffer_load_dwordx4 a[96:99], v2, s[36:39], s93 offen offset:0 sc1
    v_mfma_f32_16x16x32_bf16 v[92:95], v[128:131], v[224:227], v[92:95]
    ds_read_b128 v[128:131], v8 offset:11264
    ds_read_b128 v[32:35], v13 offset:5120
    v_mfma_f32_16x16x32_bf16 v[68:71], v[132:135], v[220:223], v[68:71]
    v_swap_b32 v143, v145
    v_mfma_f32_16x16x32_bf16 v[96:99], v[132:135], v[224:227], v[96:99]
    ds_read_b128 v[132:135], v8 offset:12288
    s_waitcnt lgkmcnt(8)
    v_mfma_f32_16x16x32_bf16 v[72:75], v[136:139], v[220:223], v[72:75]
    buffer_load_dwordx4 a[100:103], v2, s[36:39], s93 offen offset:1024 sc1
    ds_read_b128 v[36:39], v13 offset:5376
    v_mfma_f32_16x16x32_bf16 v[100:103], v[136:139], v[224:227], v[100:103]
    ds_read_b128 v[136:139], v8 offset:13312
    s_waitcnt lgkmcnt(8)
    v_mfma_f32_16x16x32_bf16 v[48:51], v[112:115], v[140:143], v[48:51]
    s_add_u32 s88, s90, 17063936
    buffer_load_dwordx4 v[220:223], v6, s[36:39], s88 offen offset:0 sc1
    buffer_load_dwordx4 a[104:107], v2, s[36:39], s93 offen offset:2048 sc1
    v_mfma_f32_16x16x32_bf16 v[76:79], v[112:115], v[144:147], v[76:79]
    ds_read_b128 v[112:115], v8 offset:0
    v_mfma_f32_16x16x32_bf16 v[52:55], v[116:119], v[140:143], v[52:55]
    buffer_load_dwordx4 v[224:227], v6, s[36:39], s88 offen offset:256 sc1
    ds_read_b128 v[24:27], v13 offset:10240
    v_mfma_f32_16x16x32_bf16 v[80:83], v[116:119], v[144:147], v[80:83]
    ds_read_b128 v[116:119], v8 offset:1024
    s_waitcnt lgkmcnt(8)
    v_mfma_f32_16x16x32_bf16 v[56:59], v[120:123], v[140:143], v[56:59]
    v_mfma_f32_16x16x32_bf16 v[84:87], v[120:123], v[144:147], v[84:87]
    ds_read_b128 v[120:123], v8 offset:2048
    v_mfma_f32_16x16x32_bf16 v[60:63], v[124:127], v[140:143], v[60:63]
    buffer_load_dwordx4 a[108:111], v2, s[36:39], s93 offen offset:3072 sc1
    v_mfma_f32_16x16x32_bf16 v[88:91], v[124:127], v[144:147], v[88:91]
    ds_read_b128 v[124:127], v8 offset:3072
    s_waitcnt lgkmcnt(7)
    v_mfma_f32_16x16x32_bf16 v[64:67], v[128:131], v[140:143], v[64:67]
    v_swap_b32 v150, v152
    ds_read_b128 v[28:31], v13 offset:10496
    v_mfma_f32_16x16x32_bf16 v[92:95], v[128:131], v[144:147], v[92:95]
    ds_read_b128 v[128:131], v8 offset:4096
    v_mfma_f32_16x16x32_bf16 v[68:71], v[132:135], v[140:143], v[68:71]
    v_swap_b32 v151, v153
    s_add_u32 s93, s92, 13135872
    v_mfma_f32_16x16x32_bf16 v[96:99], v[132:135], v[144:147], v[96:99]
    ds_read_b128 v[132:135], v8 offset:5120
    s_waitcnt lgkmcnt(8)
    v_mfma_f32_16x16x32_bf16 v[72:75], v[136:139], v[140:143], v[72:75]
    buffer_load_dwordx4 a[112:115], v2, s[36:39], s93 offen offset:0 sc1
    ds_read_b128 v[40:43], v13 offset:15360
    v_mfma_f32_16x16x32_bf16 v[100:103], v[136:139], v[144:147], v[100:103]
    ds_read_b128 v[136:139], v8 offset:6144
    s_waitcnt lgkmcnt(7)
    v_mfma_f32_16x16x32_bf16 v[48:51], v[112:115], v[148:151], v[48:51]
    buffer_load_dwordx4 v[140:143], v6, s[36:39], s88 offen offset:2048 sc1
    buffer_load_dwordx4 a[116:119], v2, s[36:39], s93 offen offset:1024 sc1
    v_mfma_f32_16x16x32_bf16 v[76:79], v[112:115], v[152:155], v[76:79]
    ds_read_b128 v[112:115], v7 offset:50176
    v_mfma_f32_16x16x32_bf16 v[52:55], v[116:119], v[148:151], v[52:55]
    buffer_load_dwordx4 v[144:147], v6, s[36:39], s88 offen offset:2304 sc1
    ds_read_b128 v[44:47], v13 offset:15616
    v_mfma_f32_16x16x32_bf16 v[80:83], v[116:119], v[152:155], v[80:83]
    ds_read_b128 v[116:119], v7 offset:51200
    s_waitcnt lgkmcnt(8)
    v_mfma_f32_16x16x32_bf16 v[56:59], v[120:123], v[148:151], v[56:59]
    v_mfma_f32_16x16x32_bf16 v[84:87], v[120:123], v[152:155], v[84:87]
    ds_read_b128 v[120:123], v7 offset:52224
    v_mfma_f32_16x16x32_bf16 v[60:63], v[124:127], v[148:151], v[60:63]
    s_waitcnt vmcnt(41)
    buffer_load_dwordx4 a[120:123], v2, s[36:39], s93 offen offset:2048 sc1
    v_mfma_f32_16x16x32_bf16 v[88:91], v[124:127], v[152:155], v[88:91]
    ds_read_b128 v[124:127], v7 offset:53248
    s_waitcnt lgkmcnt(7)
    v_mfma_f32_16x16x32_bf16 v[64:67], v[128:131], v[148:151], v[64:67]
    v_swap_b32 v158, v160
    s_add_u32 s73, s66, 0
    v_mfma_f32_16x16x32_bf16 v[92:95], v[128:131], v[152:155], v[92:95]
    ds_read_b128 v[128:131], v7 offset:54272
    s_waitcnt vmcnt(18)
    v_mfma_f32_16x16x32_bf16 v[68:71], v[132:135], v[148:151], v[68:71]
    v_swap_b32 v159, v161
    s_cmp_eq_u32 s30, 0
    s_cbranch_scc1 Lg_50
    s_mov_b64 exec, 1
    buffer_store_dword v14, off, s[36:39], s73
    s_mov_b64 exec, -1
Lgb_51:
    v_mfma_f32_16x16x32_bf16 v[96:99], v[132:135], v[152:155], v[96:99]
    ds_read_b128 v[132:135], v7 offset:55296
    s_waitcnt lgkmcnt(7)
    v_mfma_f32_16x16x32_bf16 v[72:75], v[136:139], v[148:151], v[72:75]
    buffer_load_dwordx4 a[124:127], v2, s[36:39], s93 offen offset:3072 sc1
    v_mfma_f32_16x16x32_bf16 v[100:103], v[136:139], v[152:155], v[100:103]
    ds_read_b128 v[136:139], v7 offset:56320
    s_waitcnt lgkmcnt(5)
    v_mfma_f32_16x16x32_bf16 v[48:51], v[112:115], v[156:159], v[48:51]
    s_add_u32 s88, s90, 17068032
    buffer_load_dwordx4 v[148:151], v6, s[36:39], s88 offen offset:0 sc1
    s_add_u32 s93, s92, 13139968
    v_mfma_f32_16x16x32_bf16 v[76:79], v[112:115], v[160:163], v[76:79]
    ds_read_b128 v[112:115], v7 offset:43008
    buffer_load_dwordx4 a[128:131], v2, s[36:39], s93 offen offset:0 sc1
    v_mfma_f32_16x16x32_bf16 v[52:55], v[116:119], v[156:159], v[52:55]
    buffer_load_dwordx4 v[152:155], v6, s[36:39], s88 offen offset:256 sc1
    v_mfma_f32_16x16x32_bf16 v[80:83], v[116:119], v[160:163], v[80:83]
    ds_read_b128 v[116:119], v7 offset:44032
    s_waitcnt lgkmcnt(5)
    v_mfma_f32_16x16x32_bf16 v[56:59], v[120:123], v[156:159], v[56:59]
    buffer_load_dwordx4 a[132:135], v2, s[36:39], s93 offen offset:1024 sc1
    v_mfma_f32_16x16x32_bf16 v[84:87], v[120:123], v[160:163], v[84:87]
    ds_read_b128 v[120:123], v7 offset:45056
    v_swap_b32 v18, v20
    v_mfma_f32_16x16x32_bf16 v[60:63], v[124:127], v[156:159], v[60:63]
    v_swap_b32 v19, v21
    v_mfma_f32_16x16x32_bf16 v[88:91], v[124:127], v[160:163], v[88:91]
    ds_read_b128 v[124:127], v7 offset:46080
    s_waitcnt lgkmcnt(5)
    v_mfma_f32_16x16x32_bf16 v[64:67], v[128:131], v[156:159], v[64:67]
    v_swap_b32 v166, v168
    v_swap_b32 v26, v28
    v_mfma_f32_16x16x32_bf16 v[92:95], v[128:131], v[160:163], v[92:95]
    ds_read_b128 v[128:131], v7 offset:47104
    v_swap_b32 v27, v29
    v_mfma_f32_16x16x32_bf16 v[68:71], v[132:135], v[156:159], v[68:71]
    v_swap_b32 v167, v169
    buffer_load_dwordx4 a[136:139], v2, s[36:39], s93 offen offset:2048 sc1
    v_mfma_f32_16x16x32_bf16 v[96:99], v[132:135], v[160:163], v[96:99]
    ds_read_b128 v[132:135], v7 offset:48128
    s_waitcnt lgkmcnt(6)
    v_mfma_f32_16x16x32_bf16 v[72:75], v[136:139], v[156:159], v[72:75]
    v_swap_b32 v34, v36
    v_swap_b32 v35, v37
    v_mfma_f32_16x16x32_bf16 v[100:103], v[136:139], v[160:163], v[100:103]
    ds_read_b128 v[136:139], v7 offset:49152
    s_waitcnt lgkmcnt(5)
    v_mfma_f32_16x16x32_bf16 v[48:51], v[112:115], v[164:167], v[48:51]
    buffer_load_dwordx4 v[156:159], v6, s[36:39], s88 offen offset:2048 sc1
    buffer_load_dwordx4 a[140:143], v2, s[36:39], s93 offen offset:3072 sc1
    v_mfma_f32_16x16x32_bf16 v[76:79], v[112:115], v[168:171], v[76:79]
    ds_read_b128 v[112:115], v7 offset:35840
    v_swap_b32 v42, v44
    v_mfma_f32_16x16x32_bf16 v[52:55], v[116:119], v[164:167], v[52:55]
    buffer_load_dwordx4 v[160:163], v6, s[36:39], s88 offen offset:2304 sc1
    v_swap_b32 v43, v45
    v_mfma_f32_16x16x32_bf16 v[80:83], v[116:119], v[168:171], v[80:83]
    ds_read_b128 v[116:119], v7 offset:36864
    s_waitcnt lgkmcnt(5)
    v_mfma_f32_16x16x32_bf16 v[56:59], v[120:123], v[164:167], v[56:59]
    s_add_u32 s93, s92, 13144064
    v_mov_b32 v9, 0x3f803f80
    v_mfma_f32_16x16x32_bf16 v[84:87], v[120:123], v[168:171], v[84:87]
    ds_read_b128 v[120:123], v7 offset:37888
    buffer_load_dwordx4 a[144:147], v2, s[36:39], s93 offen offset:0 sc1
    v_mfma_f32_16x16x32_bf16 v[60:63], v[124:127], v[164:167], v[60:63]
    v_mov_b32 v110, v14
    v_mfma_f32_16x16x32_bf16 v[88:91], v[124:127], v[168:171], v[88:91]
    ds_read_b128 v[124:127], v7 offset:38912
    s_waitcnt lgkmcnt(5)
    v_mfma_f32_16x16x32_bf16 v[64:67], v[128:131], v[164:167], v[64:67]
    v_swap_b32 v174, v176
    v_mov_b32 v111, v14
    v_mfma_f32_16x16x32_bf16 v[92:95], v[128:131], v[168:171], v[92:95]
    ds_read_b128 v[128:131], v7 offset:39936
    v_lshlrev_b32 v229, 4, v4
    v_mfma_f32_16x16x32_bf16 v[68:71], v[132:135], v[164:167], v[68:71]
    v_swap_b32 v175, v177
    buffer_load_dwordx4 a[148:151], v2, s[36:39], s93 offen offset:1024 sc1
    v_mfma_f32_16x16x32_bf16 v[96:99], v[132:135], v[168:171], v[96:99]
    ds_read_b128 v[132:135], v7 offset:40960
    s_waitcnt lgkmcnt(6)
    v_mfma_f32_16x16x32_bf16 v[72:75], v[136:139], v[164:167], v[72:75]
    s_lshl_b32 s78, s63, 10
    s_add_u32 s78, s78, s69
    v_mfma_f32_16x16x32_bf16 v[100:103], v[136:139], v[168:171], v[100:103]
    ds_read_b128 v[136:139], v7 offset:41984
    s_waitcnt lgkmcnt(5)
    v_mfma_f32_16x16x32_bf16 v[48:51], v[112:115], v[172:175], v[48:51]
    s_add_u32 s88, s90, 17072128
    buffer_load_dwordx4 v[164:167], v6, s[36:39], s88 offen offset:0 sc1
    buffer_load_dwordx4 a[152:155], v2, s[36:39], s93 offen offset:2048 sc1
    v_mfma_f32_16x16x32_bf16 v[76:79], v[112:115], v[176:179], v[76:79]
    ds_read_b128 v[112:115], v7 offset:28672
    v_dot2_f32_bf16 v108, v16, v9, 0
    v_mfma_f32_16x16x32_bf16 v[52:55], v[116:119], v[172:175], v[52:55]
    buffer_load_dwordx4 v[168:171], v6, s[36:39], s88 offen offset:256 sc1
    v_dot2_f32_bf16 v109, v16, v16, 0
    v_mfma_f32_16x16x32_bf16 v[80:83], v[116:119], v[176:179], v[80:83]
    ds_read_b128 v[116:119], v7 offset:29696
    s_waitcnt lgkmcnt(5)
    v_mfma_f32_16x16x32_bf16 v[56:59], v[120:123], v[172:175], v[56:59]
    buffer_load_dwordx4 a[156:159], v2, s[36:39], s93 offen offset:3072 sc1
    v_dot2_f32_bf16 v108, v17, v9, v108
    v_mfma_f32_16x16x32_bf16 v[84:87], v[120:123], v[176:179], v[84:87]
    ds_read_b128 v[120:123], v7 offset:30720
    v_dot2_f32_bf16 v109, v17, v17, v109
    v_mfma_f32_16x16x32_bf16 v[60:63], v[124:127], v[172:175], v[60:63]
    v_dot2_f32_bf16 v108, v18, v9, v108
    v_mfma_f32_16x16x32_bf16 v[88:91], v[124:127], v[176:179], v[88:91]
    ds_read_b128 v[124:127], v7 offset:31744
    s_waitcnt lgkmcnt(5)
    v_mfma_f32_16x16x32_bf16 v[64:67], v[128:131], v[172:175], v[64:67]
    v_swap_b32 v182, v184
    v_dot2_f32_bf16 v109, v18, v18, v109
    v_mfma_f32_16x16x32_bf16 v[92:95], v[128:131], v[176:179], v[92:95]
    ds_read_b128 v[128:131], v7 offset:32768
    v_dot2_f32_bf16 v108, v19, v9, v108
    v_mfma_f32_16x16x32_bf16 v[68:71], v[132:135], v[172:175], v[68:71]
    v_swap_b32 v183, v185
    s_add_u32 s93, s92, 13148160
    v_mfma_f32_16x16x32_bf16 v[96:99], v[132:135], v[176:179], v[96:99]
    ds_read_b128 v[132:135], v7 offset:33792
    s_waitcnt lgkmcnt(6)
    v_mfma_f32_16x16x32_bf16 v[72:75], v[136:139], v[172:175], v[72:75]
    buffer_load_dwordx4 a[160:163], v2, s[36:39], s93 offen offset:0 sc1
    v_dot2_f32_bf16 v109, v19, v19, v109
    v_mfma_f32_16x16x32_bf16 v[100:103], v[136:139], v[176:179], v[100:103]
    ds_read_b128 v[136:139], v7 offset:34816
    s_waitcnt lgkmcnt(5)
    v_mfma_f32_16x16x32_bf16 v[48:51], v[112:115], v[180:183], v[48:51]
    buffer_load_dwordx4 v[172:175], v6, s[36:39], s88 offen offset:2048 sc1
    buffer_load_dwordx4 a[164:167], v2, s[36:39], s93 offen offset:1024 sc1
    v_mfma_f32_16x16x32_bf16 v[76:79], v[112:115], v[184:187], v[76:79]
    ds_read_b128 v[112:115], v7 offset:21504
    s_nop 1
    v_mfma_f32_16x16x32_bf16 v[52:55], v[116:119], v[180:183], v[52:55]
    buffer_load_dwordx4 v[176:179], v6, s[36:39], s88 offen offset:2304 sc1
    v_cndmask_b32 v108, 0, v108, s[86:87]
    v_mfma_f32_16x16x32_bf16 v[80:83], v[116:119], v[184:187], v[80:83]
    ds_read_b128 v[116:119], v7 offset:22528
    s_waitcnt lgkmcnt(5)
    v_mfma_f32_16x16x32_bf16 v[56:59], v[120:123], v[180:183], v[56:59]
    buffer_load_dwordx4 a[168:171], v2, s[36:39], s93 offen offset:2048 sc1
    v_cndmask_b32 v109, 0, v109, s[86:87]
    v_mfma_f32_16x16x32_bf16 v[84:87], v[120:123], v[184:187], v[84:87]
    ds_read_b128 v[120:123], v7 offset:23552
    v_add_f32_dpp v108, v108, v108 row_ror:8 row_mask:0xf bank_mask:0xf
    v_mfma_f32_16x16x32_bf16 v[60:63], v[124:127], v[180:183], v[60:63]
    v_add_f32_dpp v109, v109, v109 row_ror:8 row_mask:0xf bank_mask:0xf
    v_mfma_f32_16x16x32_bf16 v[88:91], v[124:127], v[184:187], v[88:91]
    ds_read_b128 v[124:127], v7 offset:24576
    s_waitcnt lgkmcnt(5)
    v_mfma_f32_16x16x32_bf16 v[64:67], v[128:131], v[180:183], v[64:67]
    v_swap_b32 v190, v192
    buffer_load_dwordx4 a[172:175], v2, s[36:39], s93 offen offset:3072 sc1
    v_mfma_f32_16x16x32_bf16 v[92:95], v[128:131], v[184:187], v[92:95]
    ds_read_b128 v[128:131], v7 offset:25600
    v_add_f32_dpp v108, v108, v108 row_ror:4 row_mask:0xf bank_mask:0xf
    v_mfma_f32_16x16x32_bf16 v[68:71], v[132:135], v[180:183], v[68:71]
    v_swap_b32 v191, v193
    v_add_f32_dpp v109, v109, v109 row_ror:4 row_mask:0xf bank_mask:0xf
    v_mfma_f32_16x16x32_bf16 v[96:99], v[132:135], v[184:187], v[96:99]
    ds_read_b128 v[132:135], v7 offset:26624
    s_waitcnt lgkmcnt(6)
    v_mfma_f32_16x16x32_bf16 v[72:75], v[136:139], v[180:183], v[72:75]
    v_add_f32_dpp v108, v108, v108 row_ror:2 row_mask:0xf bank_mask:0xf
    v_add_f32_dpp v109, v109, v109 row_ror:2 row_mask:0xf bank_mask:0xf
    v_mfma_f32_16x16x32_bf16 v[100:103], v[136:139], v[184:187], v[100:103]
    ds_read_b128 v[136:139], v7 offset:27648
    s_waitcnt lgkmcnt(5)
    v_mfma_f32_16x16x32_bf16 v[48:51], v[112:115], v[188:191], v[48:51]
    s_add_u32 s88, s90, 17076224
    buffer_load_dwordx4 v[180:183], v6, s[36:39], s88 offen offset:0 sc1
    s_add_u32 s93, s92, 13152256
    v_mfma_f32_16x16x32_bf16 v[76:79], v[112:115], v[192:195], v[76:79]
    ds_read_b128 v[112:115], v7 offset:14336
    buffer_load_dwordx4 a[176:179], v2, s[36:39], s93 offen offset:0 sc1
    v_mfma_f32_16x16x32_bf16 v[52:55], v[116:119], v[188:191], v[52:55]
    buffer_load_dwordx4 v[184:187], v6, s[36:39], s88 offen offset:256 sc1
    v_add_f32_dpp v108, v108, v108 row_ror:1 row_mask:0xf bank_mask:0xf
    v_mfma_f32_16x16x32_bf16 v[80:83], v[116:119], v[192:195], v[80:83]
    ds_read_b128 v[116:119], v7 offset:15360
    s_waitcnt lgkmcnt(5)
    v_mfma_f32_16x16x32_bf16 v[56:59], v[120:123], v[188:191], v[56:59]
    buffer_load_dwordx4 a[180:183], v2, s[36:39], s93 offen offset:1024 sc1
    v_add_f32_dpp v109, v109, v109 row_ror:1 row_mask:0xf bank_mask:0xf
    v_mfma_f32_16x16x32_bf16 v[84:87], v[120:123], v[192:195], v[84:87]
    ds_read_b128 v[120:123], v7 offset:16384
    s_cmp_eq_u32 s30, 0
    s_cbranch_scc1 Lg_42
    s_add_u32 s74, s78, 256
    s_mov_b32 exec_lo, 0x00010001
    s_mov_b32 exec_hi, 0x00010001
    buffer_store_dwordx4 v[108:111], v229, s[36:39], s74 offen
    s_mov_b64 exec, -1
Lgb_43:
    v_mfma_f32_16x16x32_bf16 v[60:63], v[124:127], v[188:191], v[60:63]
    v_dot2_f32_bf16 v108, v20, v9, 0
    v_mfma_f32_16x16x32_bf16 v[88:91], v[124:127], v[192:195], v[88:91]
    ds_read_b128 v[124:127], v7 offset:17408
    s_waitcnt lgkmcnt(5)
    v_mfma_f32_16x16x32_bf16 v[64:67], v[128:131], v[188:191], v[64:67]
    v_swap_b32 v198, v200
    buffer_load_dwordx4 a[184:187], v2, s[36:39], s93 offen offset:2048 sc1
    v_mfma_f32_16x16x32_bf16 v[92:95], v[128:131], v[192:195], v[92:95]
    ds_read_b128 v[128:131], v7 offset:18432
    v_dot2_f32_bf16 v109, v20, v20, 0
    v_mfma_f32_16x16x32_bf16 v[68:71], v[132:135], v[188:191], v[68:71]
    v_swap_b32 v199, v201
    v_min_u32 v231, 7, v1
    v_mfma_f32_16x16x32_bf16 v[96:99], v[132:135], v[192:195], v[96:99]
    ds_read_b128 v[132:135], v7 offset:19456
    s_waitcnt lgkmcnt(6)
    v_mfma_f32_16x16x32_bf16 v[72:75], v[136:139], v[188:191], v[72:75]
    v_lshlrev_b32 v231, 7, v231
    v_dot2_f32_bf16 v108, v21, v9, v108
    v_mfma_f32_16x16x32_bf16 v[100:103], v[136:139], v[192:195], v[100:103]
    ds_read_b128 v[136:139], v7 offset:20480
    s_waitcnt lgkmcnt(5)
    v_mfma_f32_16x16x32_bf16 v[48:51], v[112:115], v[196:199], v[48:51]
    buffer_load_dwordx4 v[188:191], v6, s[36:39], s88 offen offset:2048 sc1
    s_add_u32 s75, s64, 0
    v_mfma_f32_16x16x32_bf16 v[76:79], v[112:115], v[200:203], v[76:79]
    ds_read_b128 v[112:115], v7 offset:7168
    buffer_load_dword v228, v231, s[36:39], s75 offen sc1
    v_mfma_f32_16x16x32_bf16 v[52:55], v[116:119], v[196:199], v[52:55]
    buffer_load_dwordx4 v[192:195], v6, s[36:39], s88 offen offset:2304 sc1
    v_mfma_f32_16x16x32_bf16 v[80:83], v[116:119], v[200:203], v[80:83]
    ds_read_b128 v[116:119], v7 offset:8192
    s_waitcnt lgkmcnt(5)
    v_mfma_f32_16x16x32_bf16 v[56:59], v[120:123], v[196:199], v[56:59]
    buffer_load_dwordx4 a[188:191], v2, s[36:39], s93 offen offset:3072 sc1
    v_dot2_f32_bf16 v109, v21, v21, v109
    v_mfma_f32_16x16x32_bf16 v[84:87], v[120:123], v[200:203], v[84:87]
    ds_read_b128 v[120:123], v7 offset:9216
    s_add_u32 s93, s92, 13156352
    v_mfma_f32_16x16x32_bf16 v[60:63], v[124:127], v[196:199], v[60:63]
    buffer_load_dwordx4 a[192:195], v2, s[36:39], s93 offen offset:0 sc1
    v_mfma_f32_16x16x32_bf16 v[88:91], v[124:127], v[200:203], v[88:91]
    ds_read_b128 v[124:127], v7 offset:10240
    s_waitcnt lgkmcnt(5)
    v_mfma_f32_16x16x32_bf16 v[64:67], v[128:131], v[196:199], v[64:67]
    v_swap_b32 v206, v208
    buffer_load_dwordx4 a[196:199], v2, s[36:39], s93 offen offset:1024 sc1
    v_mfma_f32_16x16x32_bf16 v[92:95], v[128:131], v[200:203], v[92:95]
    ds_read_b128 v[128:131], v7 offset:11264
    v_dot2_f32_bf16 v108, v22, v9, v108
    v_mfma_f32_16x16x32_bf16 v[68:71], v[132:135], v[196:199], v[68:71]
    v_swap_b32 v207, v209
    v_dot2_f32_bf16 v109, v22, v22, v109
    v_mfma_f32_16x16x32_bf16 v[96:99], v[132:135], v[200:203], v[96:99]
    ds_read_b128 v[132:135], v7 offset:12288
    s_waitcnt lgkmcnt(6)
    v_mfma_f32_16x16x32_bf16 v[72:75], v[136:139], v[196:199], v[72:75]
    v_dot2_f32_bf16 v108, v23, v9, v108
    v_dot2_f32_bf16 v109, v23, v23, v109
    v_mfma_f32_16x16x32_bf16 v[100:103], v[136:139], v[200:203], v[100:103]
    ds_read_b128 v[136:139], v7 offset:13312
    s_waitcnt lgkmcnt(5)
    v_mfma_f32_16x16x32_bf16 v[48:51], v[112:115], v[204:207], v[48:51]
    buffer_load_dwordx4 a[200:203], v2, s[36:39], s93 offen offset:2048 sc1
    s_nop 1
    v_mfma_f32_16x16x32_bf16 v[76:79], v[112:115], v[208:211], v[76:79]
    ds_read_b128 v[112:115], v7 offset:0
    v_cndmask_b32 v108, 0, v108, s[86:87]
    v_mfma_f32_16x16x32_bf16 v[52:55], v[116:119], v[204:207], v[52:55]
    buffer_load_dwordx4 a[204:207], v2, s[36:39], s93 offen offset:3072 sc1
    v_cndmask_b32 v109, 0, v109, s[86:87]
    v_mfma_f32_16x16x32_bf16 v[80:83], v[116:119], v[208:211], v[80:83]
    ds_read_b128 v[116:119], v7 offset:1024
    s_waitcnt lgkmcnt(5)
    v_mfma_f32_16x16x32_bf16 v[56:59], v[120:123], v[204:207], v[56:59]
    v_add_f32_dpp v108, v108, v108 row_ror:8 row_mask:0xf bank_mask:0xf
    v_add_f32_dpp v109, v109, v109 row_ror:8 row_mask:0xf bank_mask:0xf
    v_mfma_f32_16x16x32_bf16 v[84:87], v[120:123], v[208:211], v[84:87]
    ds_read_b128 v[120:123], v7 offset:2048
    v_add_f32_dpp v108, v108, v108 row_ror:4 row_mask:0xf bank_mask:0xf
    v_mfma_f32_16x16x32_bf16 v[60:63], v[124:127], v[204:207], v[60:63]
    s_waitcnt vmcnt(48)
    v_add_f32_dpp v109, v109, v109 row_ror:4 row_mask:0xf bank_mask:0xf
    v_mfma_f32_16x16x32_bf16 v[88:91], v[124:127], v[208:211], v[88:91]
    ds_read_b128 v[124:127], v7 offset:3072
    s_waitcnt lgkmcnt(5)
    v_mfma_f32_16x16x32_bf16 v[64:67], v[128:131], v[204:207], v[64:67]
    v_swap_b32 v214, v216
    s_add_u32 s93, s92, 13160448
    v_mfma_f32_16x16x32_bf16 v[92:95], v[128:131], v[208:211], v[92:95]
    ds_read_b128 v[128:131], v7 offset:4096
    buffer_load_dwordx4 a[208:211], v2, s[36:39], s93 offen offset:0 sc1
    v_mfma_f32_16x16x32_bf16 v[68:71], v[132:135], v[204:207], v[68:71]
    v_swap_b32 v215, v217
    v_add_f32_dpp v108, v108, v108 row_ror:2 row_mask:0xf bank_mask:0xf
    v_mfma_f32_16x16x32_bf16 v[96:99], v[132:135], v[208:211], v[96:99]
    ds_read_b128 v[132:135], v7 offset:5120
    s_waitcnt lgkmcnt(6)
    v_mfma_f32_16x16x32_bf16 v[72:75], v[136:139], v[204:207], v[72:75]
    buffer_load_dwordx4 a[212:215], v2, s[36:39], s93 offen offset:1024 sc1
    v_add_f32_dpp v109, v109, v109 row_ror:2 row_mask:0xf bank_mask:0xf
    v_mfma_f32_16x16x32_bf16 v[100:103], v[136:139], v[208:211], v[100:103]
    ds_read_b128 v[136:139], v7 offset:6144
    s_waitcnt lgkmcnt(5)
    v_mfma_f32_16x16x32_bf16 v[48:51], v[112:115], v[212:215], v[48:51]
    v_add_f32_dpp v108, v108, v108 row_ror:1 row_mask:0xf bank_mask:0xf
    v_add_f32_dpp v109, v109, v109 row_ror:1 row_mask:0xf bank_mask:0xf
    v_mfma_f32_16x16x32_bf16 v[76:79], v[112:115], v[216:219], v[76:79]
    ds_read_b128 v[112:115], v2 offset:50176
    s_cmp_eq_u32 s30, 0
    s_cbranch_scc1 Lg_44
    s_add_u32 s74, s78, 320
    s_mov_b32 exec_lo, 0x00010001
    s_mov_b32 exec_hi, 0x00010001
    buffer_store_dwordx4 v[108:111], v229, s[36:39], s74 offen
    s_mov_b64 exec, -1
Lgb_45:
    v_mfma_f32_16x16x32_bf16 v[52:55], v[116:119], v[212:215], v[52:55]
    buffer_load_dwordx4 a[216:219], v2, s[36:39], s93 offen offset:2048 sc1
    v_dot2_f32_bf16 v108, v24, v9, 0
    v_mfma_f32_16x16x32_bf16 v[80:83], v[116:119], v[216:219], v[80:83]
    ds_read_b128 v[116:119], v2 offset:51200
    s_waitcnt lgkmcnt(5)
    v_mfma_f32_16x16x32_bf16 v[56:59], v[120:123], v[212:215], v[56:59]
    v_dot2_f32_bf16 v109, v24, v24, 0
    v_dot2_f32_bf16 v108, v25, v9, v108
    v_mfma_f32_16x16x32_bf16 v[84:87], v[120:123], v[216:219], v[84:87]
    ds_read_b128 v[120:123], v2 offset:52224
    v_dot2_f32_bf16 v109, v25, v25, v109
    v_mfma_f32_16x16x32_bf16 v[60:63], v[124:127], v[212:215], v[60:63]
    s_waitcnt vmcnt(46)
    s_waitcnt vmcnt(10)
    v_cmp_ne_u32 vcc, v228, v14
    s_cbranch_vccz Lpd_52
    s_mov_b32 s96, 0
Lps_53x:
    buffer_load_dword v228, v231, s[36:39], s75 offen sc1
    s_waitcnt vmcnt(0)
    v_cmp_ne_u32 vcc, v228, v14
    s_cbranch_vccz Lpd_52
    s_sleep 1
    s_add_u32 s96, s96, 1
    s_cmp_lt_u32 s96, 100000
    s_cbranch_scc1 Lps_53x
Lpd_52:
    v_mfma_f32_16x16x32_bf16 v[88:91], v[124:127], v[216:219], v[88:91]
    ds_read_b128 v[124:127], v2 offset:53248
    s_waitcnt lgkmcnt(5)
    v_mfma_f32_16x16x32_bf16 v[64:67], v[128:131], v[212:215], v[64:67]
    v_swap_b32 v222, v224
    buffer_load_dwordx4 a[220:223], v2, s[36:39], s93 offen offset:3072 sc1
    v_mfma_f32_16x16x32_bf16 v[92:95], v[128:131], v[216:219], v[92:95]
    ds_read_b128 v[128:131], v2 offset:54272
    v_dot2_f32_bf16 v108, v26, v9, v108
    v_mfma_f32_16x16x32_bf16 v[68:71], v[132:135], v[212:215], v[68:71]
    v_swap_b32 v223, v225
    v_dot2_f32_bf16 v109, v26, v26, v109
    v_mfma_f32_16x16x32_bf16 v[96:99], v[132:135], v[216:219], v[96:99]
    ds_read_b128 v[132:135], v2 offset:55296
    s_waitcnt lgkmcnt(6)
    v_mfma_f32_16x16x32_bf16 v[72:75], v[136:139], v[212:215], v[72:75]
    s_add_u32 s93, s92, 13164544
    v_dot2_f32_bf16 v108, v27, v9, v108
    v_mfma_f32_16x16x32_bf16 v[100:103], v[136:139], v[216:219], v[100:103]
    ds_read_b128 v[136:139], v2 offset:56320
    s_waitcnt lgkmcnt(5)
    v_mfma_f32_16x16x32_bf16 v[48:51], v[112:115], v[220:223], v[48:51]
    s_add_u32 s88, s91, 33554432
    buffer_load_dwordx4 v[196:199], v2, s[36:39], s88 offen offset:0 sc1
    buffer_load_dwordx4 a[224:227], v2, s[36:39], s93 offen offset:0 sc1
    v_mfma_f32_16x16x32_bf16 v[76:79], v[112:115], v[224:227], v[76:79]
    ds_read_b128 v[112:115], v2 offset:43008
    v_dot2_f32_bf16 v109, v27, v27, v109
    v_mfma_f32_16x16x32_bf16 v[52:55], v[116:119], v[220:223], v[52:55]
    buffer_load_dwordx4 v[200:203], v2, s[36:39], s88 offen offset:1024 sc1
    buffer_load_dwordx4 a[228:231], v2, s[36:39], s93 offen offset:1024 sc1
    v_mfma_f32_16x16x32_bf16 v[80:83], v[116:119], v[224:227], v[80:83]
    ds_read_b128 v[116:119], v2 offset:44032
    s_waitcnt lgkmcnt(5)
    v_mfma_f32_16x16x32_bf16 v[56:59], v[120:123], v[220:223], v[56:59]
    buffer_load_dwordx4 v[204:207], v2, s[36:39], s88 offen offset:2048 sc1
    s_nop 1
    v_mfma_f32_16x16x32_bf16 v[84:87], v[120:123], v[224:227], v[84:87]
    ds_read_b128 v[120:123], v2 offset:45056
    v_cndmask_b32 v108, 0, v108, s[86:87]
    v_mfma_f32_16x16x32_bf16 v[60:63], v[124:127], v[220:223], v[60:63]
    buffer_load_dwordx4 v[208:211], v2, s[36:39], s88 offen offset:3072 sc1
    v_mfma_f32_16x16x32_bf16 v[88:91], v[124:127], v[224:227], v[88:91]
    ds_read_b128 v[124:127], v2 offset:46080
    s_waitcnt lgkmcnt(5)
    v_mfma_f32_16x16x32_bf16 v[64:67], v[128:131], v[220:223], v[64:67]
    v_swap_b32 v142, v144
    buffer_load_dwordx4 a[232:235], v2, s[36:39], s93 offen offset:2048 sc1
    v_mfma_f32_16x16x32_bf16 v[92:95], v[128:131], v[224:227], v[92:95]
    ds_read_b128 v[128:131], v2 offset:47104
    v_cndmask_b32 v109, 0, v109, s[86:87]
    v_mfma_f32_16x16x32_bf16 v[68:71], v[132:135], v[220:223], v[68:71]
    v_swap_b32 v143, v145
    v_add_f32_dpp v108, v108, v108 row_ror:8 row_mask:0xf bank_mask:0xf
    v_mfma_f32_16x16x32_bf16 v[96:99], v[132:135], v[224:227], v[96:99]
    ds_read_b128 v[132:135], v2 offset:48128
    s_waitcnt lgkmcnt(6)
    v_mfma_f32_16x16x32_bf16 v[72:75], v[136:139], v[220:223], v[72:75]
    buffer_load_dwordx4 a[236:239], v2, s[36:39], s93 offen offset:3072 sc1
    v_add_f32_dpp v109, v109, v109 row_ror:8 row_mask:0xf bank_mask:0xf
    v_mfma_f32_16x16x32_bf16 v[100:103], v[136:139], v[224:227], v[100:103]
    ds_read_b128 v[136:139], v2 offset:49152
    s_waitcnt lgkmcnt(5)
    v_mfma_f32_16x16x32_bf16 v[48:51], v[112:115], v[140:143], v[48:51]
    s_add_u32 s88, s91, 33558528
    buffer_load_dwordx4 v[212:215], v2, s[36:39], s88 offen offset:0 sc1
    v_add_f32_dpp v108, v108, v108 row_ror:4 row_mask:0xf bank_mask:0xf
    v_mfma_f32_16x16x32_bf16 v[76:79], v[112:115], v[144:147], v[76:79]
    ds_read_b128 v[112:115], v2 offset:35840
    v_add_f32_dpp v109, v109, v109 row_ror:4 row_mask:0xf bank_mask:0xf
    v_mfma_f32_16x16x32_bf16 v[52:55], v[116:119], v[140:143], v[52:55]
    buffer_load_dwordx4 v[216:219], v2, s[36:39], s88 offen offset:1024 sc1
    s_add_u32 s93, s92, 13168640
    v_mfma_f32_16x16x32_bf16 v[80:83], v[116:119], v[144:147], v[80:83]
    ds_read_b128 v[116:119], v2 offset:36864
    s_waitcnt lgkmcnt(5)
    v_mfma_f32_16x16x32_bf16 v[56:59], v[120:123], v[140:143], v[56:59]
    buffer_load_dwordx4 v[220:223], v2, s[36:39], s88 offen offset:2048 sc1
    buffer_load_dwordx4 a[240:243], v2, s[36:39], s93 offen offset:0 sc1
    v_mfma_f32_16x16x32_bf16 v[84:87], v[120:123], v[144:147], v[84:87]
    ds_read_b128 v[120:123], v2 offset:37888
    v_add_f32_dpp v108, v108, v108 row_ror:2 row_mask:0xf bank_mask:0xf
    v_mfma_f32_16x16x32_bf16 v[60:63], v[124:127], v[140:143], v[60:63]
    buffer_load_dwordx4 v[224:227], v2, s[36:39], s88 offen offset:3072 sc1
    v_mfma_f32_16x16x32_bf16 v[88:91], v[124:127], v[144:147], v[88:91]
    ds_read_b128 v[124:127], v2 offset:38912
    s_waitcnt lgkmcnt(5)
    v_mfma_f32_16x16x32_bf16 v[64:67], v[128:131], v[140:143], v[64:67]
    v_swap_b32 v150, v152
    buffer_load_dwordx4 a[244:247], v2, s[36:39], s93 offen offset:1024 sc1
    v_mfma_f32_16x16x32_bf16 v[92:95], v[128:131], v[144:147], v[92:95]
    ds_read_b128 v[128:131], v2 offset:39936
    v_add_f32_dpp v109, v109, v109 row_ror:2 row_mask:0xf bank_mask:0xf
    v_mfma_f32_16x16x32_bf16 v[68:71], v[132:135], v[140:143], v[68:71]
    v_swap_b32 v151, v153
    v_add_f32_dpp v108, v108, v108 row_ror:1 row_mask:0xf bank_mask:0xf
    v_mfma_f32_16x16x32_bf16 v[96:99], v[132:135], v[144:147], v[96:99]
    ds_read_b128 v[132:135], v2 offset:40960
    s_waitcnt lgkmcnt(6)
    v_mfma_f32_16x16x32_bf16 v[72:75], v[136:139], v[140:143], v[72:75]
    buffer_load_dwordx4 a[248:251], v2, s[36:39], s93 offen offset:2048 sc1
    v_add_f32_dpp v109, v109, v109 row_ror:1 row_mask:0xf bank_mask:0xf
    v_mfma_f32_16x16x32_bf16 v[100:103], v[136:139], v[144:147], v[100:103]
    ds_read_b128 v[136:139], v2 offset:41984
    s_waitcnt lgkmcnt(5)
    v_mfma_f32_16x16x32_bf16 v[48:51], v[112:115], v[148:151], v[48:51]
    s_add_u32 s88, s91, 33562624
    buffer_load_dwordx4 v[140:143], v2, s[36:39], s88 offen offset:0 sc1
    buffer_load_dwordx4 a[252:255], v2, s[36:39], s93 offen offset:3072 sc1
    v_mfma_f32_16x16x32_bf16 v[76:79], v[112:115], v[152:155], v[76:79]
    ds_read_b128 v[112:115], v2 offset:28672
    s_cmp_eq_u32 s30, 0
    s_cbranch_scc1 Lg_46
    s_add_u32 s74, s78, 384
    s_mov_b32 exec_lo, 0x00010001
    s_mov_b32 exec_hi, 0x00010001
    buffer_store_dwordx4 v[108:111], v229, s[36:39], s74 offen
    s_mov_b64 exec, -1
Lgb_47:
    v_mfma_f32_16x16x32_bf16 v[52:55], v[116:119], v[148:151], v[52:55]
    buffer_load_dwordx4 v[144:147], v2, s[36:39], s88 offen offset:1024 sc1
    v_dot2_f32_bf16 v108, v28, v9, 0
    v_mfma_f32_16x16x32_bf16 v[80:83], v[116:119], v[152:155], v[80:83]
    ds_read_b128 v[116:119], v2 offset:29696
    s_waitcnt lgkmcnt(5)
    v_mfma_f32_16x16x32_bf16 v[56:59], v[120:123], v[148:151], v[56:59]
    v_dot2_f32_bf16 v109, v28, v28, 0
    v_dot2_f32_bf16 v108, v29, v9, v108
    v_mfma_f32_16x16x32_bf16 v[84:87], v[120:123], v[152:155], v[84:87]
    ds_read_b128 v[120:123], v2 offset:30720
    v_dot2_f32_bf16 v109, v29, v29, v109
    v_mfma_f32_16x16x32_bf16 v[60:63], v[124:127], v[148:151], v[60:63]
    s_add_u32 s93, s92, 13172736
    v_mfma_f32_16x16x32_bf16 v[88:91], v[124:127], v[152:155], v[88:91]
    ds_read_b128 v[124:127], v2 offset:31744
    s_waitcnt lgkmcnt(5)
    v_mfma_f32_16x16x32_bf16 v[64:67], v[128:131], v[148:151], v[64:67]
    v_swap_b32 v158, v160
    buffer_load_dwordx4 v[232:235], v2, s[36:39], s93 offen offset:0 sc1
    v_mfma_f32_16x16x32_bf16 v[92:95], v[128:131], v[152:155], v[92:95]
    ds_read_b128 v[128:131], v2 offset:32768
    v_dot2_f32_bf16 v108, v30, v9, v108
    v_mfma_f32_16x16x32_bf16 v[68:71], v[132:135], v[148:151], v[68:71]
    v_swap_b32 v159, v161
    v_dot2_f32_bf16 v109, v30, v30, v109
    v_mfma_f32_16x16x32_bf16 v[96:99], v[132:135], v[152:155], v[96:99]
    ds_read_b128 v[132:135], v2 offset:33792
    s_waitcnt lgkmcnt(6)
    v_mfma_f32_16x16x32_bf16 v[72:75], v[136:139], v[148:151], v[72:75]
    buffer_load_dwordx4 v[236:239], v2, s[36:39], s93 offen offset:1024 sc1
    v_dot2_f32_bf16 v108, v31, v9, v108
    v_mfma_f32_16x16x32_bf16 v[100:103], v[136:139], v[152:155], v[100:103]
    ds_read_b128 v[136:139], v2 offset:34816
    s_waitcnt lgkmcnt(5)
    v_mfma_f32_16x16x32_bf16 v[48:51], v[112:115], v[156:159], v[48:51]
    buffer_load_dwordx4 v[148:151], v2, s[36:39], s88 offen offset:2048 sc1
    buffer_load_dwordx4 v[240:243], v2, s[36:39], s93 offen offset:2048 sc1
    v_mfma_f32_16x16x32_bf16 v[76:79], v[112:115], v[160:163], v[76:79]
    ds_read_b128 v[112:115], v2 offset:21504
    v_dot2_f32_bf16 v109, v31, v31, v109
    v_mfma_f32_16x16x32_bf16 v[52:55], v[116:119], v[156:159], v[52:55]
    buffer_load_dwordx4 v[152:155], v2, s[36:39], s88 offen offset:3072 sc1
    s_nop 1
    v_mfma_f32_16x16x32_bf16 v[80:83], v[116:119], v[160:163], v[80:83]
    ds_read_b128 v[116:119], v2 offset:22528
    s_waitcnt lgkmcnt(5)
    v_mfma_f32_16x16x32_bf16 v[56:59], v[120:123], v[156:159], v[56:59]
    v_cndmask_b32 v108, 0, v108, s[86:87]
    v_cndmask_b32 v109, 0, v109, s[86:87]
    v_mfma_f32_16x16x32_bf16 v[84:87], v[120:123], v[160:163], v[84:87]
    ds_read_b128 v[120:123], v2 offset:23552
    v_add_f32_dpp v108, v108, v108 row_ror:8 row_mask:0xf bank_mask:0xf
    v_mfma_f32_16x16x32_bf16 v[60:63], v[124:127], v[156:159], v[60:63]
    buffer_load_dwordx4 v[244:247], v2, s[36:39], s93 offen offset:3072 sc1
    v_mfma_f32_16x16x32_bf16 v[88:91], v[124:127], v[160:163], v[88:91]
    ds_read_b128 v[124:127], v2 offset:24576
    s_waitcnt lgkmcnt(5)
    v_mfma_f32_16x16x32_bf16 v[64:67], v[128:131], v[156:159], v[64:67]
    v_swap_b32 v166, v168
    v_add_f32_dpp v109, v109, v109 row_ror:8 row_mask:0xf bank_mask:0xf
    v_mfma_f32_16x16x32_bf16 v[92:95], v[128:131], v[160:163], v[92:95]
    ds_read_b128 v[128:131], v2 offset:25600
    v_add_f32_dpp v108, v108, v108 row_ror:4 row_mask:0xf bank_mask:0xf
    v_mfma_f32_16x16x32_bf16 v[68:71], v[132:135], v[156:159], v[68:71]
    v_swap_b32 v167, v169
    s_add_u32 s93, s92, 13176832
    v_mfma_f32_16x16x32_bf16 v[96:99], v[132:135], v[160:163], v[96:99]
    ds_read_b128 v[132:135], v2 offset:26624
    s_waitcnt lgkmcnt(6)
    v_mfma_f32_16x16x32_bf16 v[72:75], v[136:139], v[156:159], v[72:75]
    buffer_load_dwordx4 v[248:251], v2, s[36:39], s93 offen offset:0 sc1
    v_add_f32_dpp v109, v109, v109 row_ror:4 row_mask:0xf bank_mask:0xf
    v_mfma_f32_16x16x32_bf16 v[100:103], v[136:139], v[160:163], v[100:103]
    ds_read_b128 v[136:139], v2 offset:27648
    s_waitcnt lgkmcnt(5)
    v_mfma_f32_16x16x32_bf16 v[48:51], v[112:115], v[164:167], v[48:51]
    s_add_u32 s88, s91, 33566720
    buffer_load_dwordx4 v[156:159], v2, s[36:39], s88 offen offset:0 sc1
    buffer_load_dwordx4 v[252:255], v2, s[36:39], s93 offen offset:1024 sc1
    v_mfma_f32_16x16x32_bf16 v[76:79], v[112:115], v[168:171], v[76:79]
    ds_read_b128 v[112:115], v2 offset:14336
    v_add_f32_dpp v108, v108, v108 row_ror:2 row_mask:0xf bank_mask:0xf
    v_mfma_f32_16x16x32_bf16 v[52:55], v[116:119], v[164:167], v[52:55]
    buffer_load_dwordx4 v[160:163], v2, s[36:39], s88 offen offset:1024 sc1
    v_add_f32_dpp v109, v109, v109 row_ror:2 row_mask:0xf bank_mask:0xf
    v_mfma_f32_16x16x32_bf16 v[80:83], v[116:119], v[168:171], v[80:83]
    ds_read_b128 v[116:119], v2 offset:15360
    s_waitcnt lgkmcnt(5)
    v_mfma_f32_16x16x32_bf16 v[56:59], v[120:123], v[164:167], v[56:59]
    v_add_f32_dpp v108, v108, v108 row_ror:1 row_mask:0xf bank_mask:0xf
    v_add_f32_dpp v109, v109, v109 row_ror:1 row_mask:0xf bank_mask:0xf
    v_mfma_f32_16x16x32_bf16 v[84:87], v[120:123], v[168:171], v[84:87]
    ds_read_b128 v[120:123], v2 offset:16384
    s_cmp_eq_u32 s30, 0
    s_cbranch_scc1 Lg_48
    s_add_u32 s74, s78, 448
    s_mov_b32 exec_lo, 0x00010001
    s_mov_b32 exec_hi, 0x00010001
    buffer_store_dwordx4 v[108:111], v229, s[36:39], s74 offen
    s_mov_b64 exec, -1
Lgb_49:
    v_mfma_f32_16x16x32_bf16 v[60:63], v[124:127], v[164:167], v[60:63]
    v_mfma_f32_16x16x32_bf16 v[88:91], v[124:127], v[168:171], v[88:91]
    ds_read_b128 v[124:127], v2 offset:17408
    s_waitcnt lgkmcnt(5)
    v_mfma_f32_16x16x32_bf16 v[64:67], v[128:131], v[164:167], v[64:67]
    v_swap_b32 v174, v176
    v_mfma_f32_16x16x32_bf16 v[92:95], v[128:131], v[168:171], v[92:95]
    ds_read_b128 v[128:131], v2 offset:18432
    v_mfma_f32_16x16x32_bf16 v[68:71], v[132:135], v[164:167], v[68:71]
    v_swap_b32 v175, v177
    v_mfma_f32_16x16x32_bf16 v[96:99], v[132:135], v[168:171], v[96:99]
    ds_read_b128 v[132:135], v2 offset:19456
    s_waitcnt lgkmcnt(6)
    v_mfma_f32_16x16x32_bf16 v[72:75], v[136:139], v[164:167], v[72:75]
    v_mfma_f32_16x16x32_bf16 v[100:103], v[136:139], v[168:171], v[100:103]
    ds_read_b128 v[136:139], v2 offset:20480
    s_waitcnt lgkmcnt(5)
    v_mfma_f32_16x16x32_bf16 v[48:51], v[112:115], v[172:175], v[48:51]
    s_add_u32 s88, s91, 33611776
    buffer_load_dwordx4 v[164:167], v2, s[36:39], s88 offen offset:0 sc1
    v_mfma_f32_16x16x32_bf16 v[76:79], v[112:115], v[176:179], v[76:79]
    ds_read_b128 v[112:115], v2 offset:7168
    v_mfma_f32_16x16x32_bf16 v[52:55], v[116:119], v[172:175], v[52:55]
    buffer_load_dwordx4 v[168:171], v2, s[36:39], s88 offen offset:1024 sc1
    v_mfma_f32_16x16x32_bf16 v[80:83], v[116:119], v[176:179], v[80:83]
    ds_read_b128 v[116:119], v2 offset:8192
    s_waitcnt lgkmcnt(5)
    v_mfma_f32_16x16x32_bf16 v[56:59], v[120:123], v[172:175], v[56:59]
    v_mfma_f32_16x16x32_bf16 v[84:87], v[120:123], v[176:179], v[84:87]
    ds_read_b128 v[120:123], v2 offset:9216
    v_mfma_f32_16x16x32_bf16 v[60:63], v[124:127], v[172:175], v[60:63]
    v_mfma_f32_16x16x32_bf16 v[88:91], v[124:127], v[176:179], v[88:91]
    ds_read_b128 v[124:127], v2 offset:10240
    s_waitcnt lgkmcnt(5)
    v_mfma_f32_16x16x32_bf16 v[64:67], v[128:131], v[172:175], v[64:67]
    v_swap_b32 v182, v184
    v_mfma_f32_16x16x32_bf16 v[92:95], v[128:131], v[176:179], v[92:95]
    ds_read_b128 v[128:131], v2 offset:11264
    v_mfma_f32_16x16x32_bf16 v[68:71], v[132:135], v[172:175], v[68:71]
    v_swap_b32 v183, v185
    v_mfma_f32_16x16x32_bf16 v[96:99], v[132:135], v[176:179], v[96:99]
    ds_read_b128 v[132:135], v2 offset:12288
    s_waitcnt lgkmcnt(6)
    v_mfma_f32_16x16x32_bf16 v[72:75], v[136:139], v[172:175], v[72:75]
    v_mfma_f32_16x16x32_bf16 v[100:103], v[136:139], v[176:179], v[100:103]
    ds_read_b128 v[136:139], v2 offset:13312
    s_waitcnt lgkmcnt(0)
    v_mfma_f32_16x16x32_bf16 v[72:75], v[136:139], v[180:183], v[72:75]
    buffer_load_dwordx4 v[172:175], v2, s[36:39], s88 offen offset:2048 sc1
    v_mfma_f32_16x16x32_bf16 v[100:103], v[136:139], v[184:187], v[100:103]
    ds_read_b128 v[136:139], v2 offset:6144
    v_mfma_f32_16x16x32_bf16 v[48:51], v[112:115], v[180:183], v[48:51]
    buffer_load_dwordx4 v[176:179], v2, s[36:39], s88 offen offset:3072 sc1
    v_mfma_f32_16x16x32_bf16 v[76:79], v[112:115], v[184:187], v[76:79]
    ds_read_b128 v[112:115], v2 offset:0
    v_mfma_f32_16x16x32_bf16 v[52:55], v[116:119], v[180:183], v[52:55]
    v_and_b32 v105, 7, v1
    v_lshlrev_b32 v105, 10, v105
    v_mfma_f32_16x16x32_bf16 v[80:83], v[116:119], v[184:187], v[80:83]
    ds_read_b128 v[116:119], v2 offset:1024
    v_lshl_add_u32 v105, v4, 4, v105
    v_mfma_f32_16x16x32_bf16 v[56:59], v[120:123], v[180:183], v[56:59]
    s_waitcnt vmcnt(44)
    v_and_b32 v107, 8, v1
    v_mfma_f32_16x16x32_bf16 v[84:87], v[120:123], v[184:187], v[84:87]
    ds_read_b128 v[120:123], v2 offset:2048
    v_mfma_f32_16x16x32_bf16 v[60:63], v[124:127], v[180:183], v[60:63]
    v_swap_b32 v190, v192
    v_lshl_add_u32 v105, v107, 3, v105
    v_mfma_f32_16x16x32_bf16 v[88:91], v[124:127], v[184:187], v[88:91]
    ds_read_b128 v[124:127], v2 offset:3072
    s_add_u32 s79, s69, 256
    v_mfma_f32_16x16x32_bf16 v[64:67], v[128:131], v[180:183], v[64:67]
    v_swap_b32 v191, v193
    buffer_load_dwordx4 v[108:111], v105, s[36:39], s79 offen offset:0 sc1
    v_mfma_f32_16x16x32_bf16 v[92:95], v[128:131], v[184:187], v[92:95]
    ds_read_b128 v[128:131], v2 offset:4096
    v_mfma_f32_16x16x32_bf16 v[68:71], v[132:135], v[180:183], v[68:71]
    buffer_load_dwordx4 v[228:231], v105, s[36:39], s79 offen offset:128 sc1
    v_mfma_f32_16x16x32_bf16 v[96:99], v[132:135], v[184:187], v[96:99]
    ds_read_b128 v[132:135], v2 offset:5120
    s_waitcnt lgkmcnt(5)
    v_mfma_f32_16x16x32_bf16 v[72:75], v[136:139], v[188:191], v[72:75]
    s_add_u32 s88, s91, 33615872
    buffer_load_dwordx4 v[180:183], v2, s[36:39], s88 offen offset:0 sc1
    v_mfma_f32_16x16x32_bf16 v[100:103], v[136:139], v[192:195], v[100:103]
    ds_read_b128 v[136:139], v0 offset:0
    v_mfma_f32_16x16x32_bf16 v[48:51], v[112:115], v[188:191], v[48:51]
    buffer_load_dwordx4 v[184:187], v2, s[36:39], s88 offen offset:1024 sc1
    v_mfma_f32_16x16x32_bf16 v[76:79], v[112:115], v[192:195], v[76:79]
    ds_read_b128 v[112:115], v0 offset:43008
    s_waitcnt lgkmcnt(5)
    v_mfma_f32_16x16x32_bf16 v[52:55], v[116:119], v[188:191], v[52:55]
    v_mfma_f32_16x16x32_bf16 v[80:83], v[116:119], v[192:195], v[80:83]
    ds_read_b128 v[116:119], v0 offset:35840
    v_mfma_f32_16x16x32_bf16 v[56:59], v[120:123], v[188:191], v[56:59]
    ds_bpermute_b32 v104, v10, v74
    ds_bpermute_b32 v106, v10, v102
    v_mfma_f32_16x16x32_bf16 v[84:87], v[120:123], v[192:195], v[84:87]
    ds_read_b128 v[120:123], v0 offset:28672
    s_waitcnt lgkmcnt(7)
    v_mfma_f32_16x16x32_bf16 v[60:63], v[124:127], v[188:191], v[60:63]
    v_mfma_f32_16x16x32_bf16 v[88:91], v[124:127], v[192:195], v[88:91]
    ds_read_b128 v[124:127], v0 offset:21504
    v_mfma_f32_16x16x32_bf16 v[64:67], v[128:131], v[188:191], v[64:67]
    v_mfma_f32_16x16x32_bf16 v[92:95], v[128:131], v[192:195], v[92:95]
    ds_read_b128 v[128:131], v0 offset:14336
    s_waitcnt lgkmcnt(8)
    v_mfma_f32_16x16x32_bf16 v[68:71], v[132:135], v[188:191], v[68:71]
    s_waitcnt lgkmcnt(3)
    v_mul_f32 v104, 0x3acccccd, v104
    v_mfma_f32_16x16x32_bf16 v[96:99], v[132:135], v[192:195], v[96:99]
    ds_read_b128 v[132:135], v0 offset:7168
    v_mul_f32 v106, 0x3acccccd, v106
    v_cvt_pk_bf16_f32 v104, v104, v104
    v_cvt_pk_bf16_f32 v106, v106, v106
    v_lshlrev_b32 v104, 16, v104
    v_lshlrev_b32 v106, 16, v106
    s_add_u32 s72, s95, 23592960
    buffer_load_dwordx4 v[188:191], v2, s[36:39], s88 offen offset:2048 sc1
    buffer_load_dwordx4 v[192:195], v2, s[36:39], s88 offen offset:3072 sc1
    v_pk_fma_f32 v[72:73], v[136:137], v[104:105], v[72:73] op_sel_hi:[1,0,1] neg_lo:[0,1,0] neg_hi:[0,1,0]
    v_pk_fma_f32 v[74:75], v[138:139], v[104:105], v[74:75] op_sel_hi:[1,0,1] neg_lo:[0,1,0] neg_hi:[0,1,0]
    v_pk_fma_f32 v[48:49], v[112:113], v[104:105], v[48:49] op_sel_hi:[1,0,1] neg_lo:[0,1,0] neg_hi:[0,1,0]
    v_pk_fma_f32 v[50:51], v[114:115], v[104:105], v[50:51] op_sel_hi:[1,0,1] neg_lo:[0,1,0] neg_hi:[0,1,0]
    v_pk_fma_f32 v[52:53], v[116:117], v[104:105], v[52:53] op_sel_hi:[1,0,1] neg_lo:[0,1,0] neg_hi:[0,1,0]
    v_pk_fma_f32 v[54:55], v[118:119], v[104:105], v[54:55] op_sel_hi:[1,0,1] neg_lo:[0,1,0] neg_hi:[0,1,0]
    s_waitcnt lgkmcnt(3)
    v_pk_fma_f32 v[56:57], v[120:121], v[104:105], v[56:57] op_sel_hi:[1,0,1] neg_lo:[0,1,0] neg_hi:[0,1,0]
    v_pk_fma_f32 v[58:59], v[122:123], v[104:105], v[58:59] op_sel_hi:[1,0,1] neg_lo:[0,1,0] neg_hi:[0,1,0]
    s_waitcnt lgkmcnt(2)
    v_pk_fma_f32 v[60:61], v[124:125], v[104:105], v[60:61] op_sel_hi:[1,0,1] neg_lo:[0,1,0] neg_hi:[0,1,0]
    v_pk_fma_f32 v[62:63], v[126:127], v[104:105], v[62:63] op_sel_hi:[1,0,1] neg_lo:[0,1,0] neg_hi:[0,1,0]
    s_waitcnt lgkmcnt(1)
    v_pk_fma_f32 v[64:65], v[128:129], v[104:105], v[64:65] op_sel_hi:[1,0,1] neg_lo:[0,1,0] neg_hi:[0,1,0]
    v_pk_fma_f32 v[66:67], v[130:131], v[104:105], v[66:67] op_sel_hi:[1,0,1] neg_lo:[0,1,0] neg_hi:[0,1,0]
    s_waitcnt lgkmcnt(0)
    v_pk_fma_f32 v[68:69], v[132:133], v[104:105], v[68:69] op_sel_hi:[1,0,1] neg_lo:[0,1,0] neg_hi:[0,1,0]
    v_pk_fma_f32 v[70:71], v[134:135], v[104:105], v[70:71] op_sel_hi:[1,0,1] neg_lo:[0,1,0] neg_hi:[0,1,0]
    v_permlane32_swap_b32 v72, v74
    v_permlane32_swap_b32 v73, v75
    v_pk_mul_f32 v[48:49], v[48:49], v[60:61]
    v_pk_mul_f32 v[50:51], v[50:51], v[62:63]
    v_pk_mul_f32 v[52:53], v[52:53], v[64:65]
    v_pk_mul_f32 v[54:55], v[54:55], v[66:67]
    v_pk_mul_f32 v[56:57], v[56:57], v[68:69]
    v_pk_mul_f32 v[58:59], v[58:59], v[70:71]
    v_pk_mul_f32 v[60:61], v[72:73], v[74:75]
    v_cvt_pk_bf16_f32 v72, v56, v57
    v_cvt_pk_bf16_f32 v73, v58, v59
    v_mov_b32 v71, 0
    v_cvt_pk_bf16_f32 v64, v48, v49
    v_cvt_pk_bf16_f32 v65, v50, v51
    v_cvt_pk_bf16_f32 v66, v52, v53
    v_cvt_pk_bf16_f32 v67, v54, v55
    v_permlane16_swap_b32 v72, v73
    v_cvt_pk_bf16_f32 v68, v56, v57
    v_cvt_pk_bf16_f32 v69, v58, v59
    v_cvt_pk_bf16_f32 v70, v60, v61
    v_permlane32_swap_b32 v73, v71
    buffer_store_dwordx4 v[64:67], v2, s[36:39], s72 offen sc1
    s_mov_b32 exec_hi, 0xffff
    buffer_store_dwordx4 v[68:71], v2, s[36:39], s72 offen offset:1024 sc1
    s_mov_b64 exec, -1
    s_add_u32 s72, s72, 57344
    v_pk_fma_f32 v[100:101], v[136:137], v[106:107], v[100:101] op_sel_hi:[1,0,1] neg_lo:[0,1,0] neg_hi:[0,1,0]
    v_pk_fma_f32 v[102:103], v[138:139], v[106:107], v[102:103] op_sel_hi:[1,0,1] neg_lo:[0,1,0] neg_hi:[0,1,0]
    v_pk_fma_f32 v[76:77], v[112:113], v[106:107], v[76:77] op_sel_hi:[1,0,1] neg_lo:[0,1,0] neg_hi:[0,1,0]
    v_pk_fma_f32 v[78:79], v[114:115], v[106:107], v[78:79] op_sel_hi:[1,0,1] neg_lo:[0,1,0] neg_hi:[0,1,0]
    v_pk_fma_f32 v[80:81], v[116:117], v[106:107], v[80:81] op_sel_hi:[1,0,1] neg_lo:[0,1,0] neg_hi:[0,1,0]
    v_pk_fma_f32 v[82:83], v[118:119], v[106:107], v[82:83] op_sel_hi:[1,0,1] neg_lo:[0,1,0] neg_hi:[0,1,0]
    v_pk_fma_f32 v[84:85], v[120:121], v[106:107], v[84:85] op_sel_hi:[1,0,1] neg_lo:[0,1,0] neg_hi:[0,1,0]
    v_pk_fma_f32 v[86:87], v[122:123], v[106:107], v[86:87] op_sel_hi:[1,0,1] neg_lo:[0,1,0] neg_hi:[0,1,0]
    v_pk_fma_f32 v[88:89], v[124:125], v[106:107], v[88:89] op_sel_hi:[1,0,1] neg_lo:[0,1,0] neg_hi:[0,1,0]
    v_pk_fma_f32 v[90:91], v[126:127], v[106:107], v[90:91] op_sel_hi:[1,0,1] neg_lo:[0,1,0] neg_hi:[0,1,0]
    v_pk_fma_f32 v[92:93], v[128:129], v[106:107], v[92:93] op_sel_hi:[1,0,1] neg_lo:[0,1,0] neg_hi:[0,1,0]
    v_pk_fma_f32 v[94:95], v[130:131], v[106:107], v[94:95] op_sel_hi:[1,0,1] neg_lo:[0,1,0] neg_hi:[0,1,0]
    v_pk_fma_f32 v[96:97], v[132:133], v[106:107], v[96:97] op_sel_hi:[1,0,1] neg_lo:[0,1,0] neg_hi:[0,1,0]
    v_pk_fma_f32 v[98:99], v[134:135], v[106:107], v[98:99] op_sel_hi:[1,0,1] neg_lo:[0,1,0] neg_hi:[0,1,0]
    v_permlane32_swap_b32 v100, v102
    v_permlane32_swap_b32 v101, v103
    v_pk_mul_f32 v[76:77], v[76:77], v[88:89]
    v_pk_mul_f32 v[78:79], v[78:79], v[90:91]
    v_pk_mul_f32 v[80:81], v[80:81], v[92:93]
    v_pk_mul_f32 v[82:83], v[82:83], v[94:95]
    v_pk_mul_f32 v[84:85], v[84:85], v[96:97]
    v_pk_mul_f32 v[86:87], v[86:87], v[98:99]
    v_pk_mul_f32 v[88:89], v[100:101], v[102:103]
    v_cvt_pk_bf16_f32 v100, v84, v85
    v_cvt_pk_bf16_f32 v101, v86, v87
    v_mov_b32 v99, 0
    v_cvt_pk_bf16_f32 v92, v76, v77
    v_cvt_pk_bf16_f32 v93, v78, v79
    v_cvt_pk_bf16_f32 v94, v80, v81
    v_cvt_pk_bf16_f32 v95, v82, v83
    v_permlane16_swap_b32 v100, v101
    v_cvt_pk_bf16_f32 v96, v84, v85
    v_cvt_pk_bf16_f32 v97, v86, v87
    v_cvt_pk_bf16_f32 v98, v88, v89
    v_permlane32_swap_b32 v101, v99
    buffer_store_dwordx4 v[92:95], v2, s[36:39], s72 offen sc1
    s_mov_b32 exec_hi, 0xffff
    buffer_store_dwordx4 v[96:99], v2, s[36:39], s72 offen offset:1024 sc1
    s_mov_b64 exec, -1
    s_waitcnt vmcnt(16)
    s_waitcnt vmcnt(14)
    s_branch L_join
L_helper:
    s_sub_u32 s70, s2, 160
    v_bfe_u32 v20, v1, 2, 2
    v_and_b32 v21, 3, v1
    s_cmp_lt_u32 s70, 32
    s_cbranch_scc1 L_hv0
    s_cmp_lt_u32 s70, 64
    s_cbranch_scc1 L_hv3
    s_cmp_lt_u32 s70, 80
    s_cbranch_scc1 L_hv1
    s_branch L_hv2
L_hv0:
    s_add_u32 s77, s70, 0
    s_and_b32 s76, s77, 7
    s_lshr_b32 s77, s77, 3
    v_mul_u32_u24 v25, 37, v1
    v_lshrrev_b32 v25, 8, v25
    v_lshrrev_b32 v26, 2, v25
    v_mul_u32_u24 v26, 3024, v26
    v_lshlrev_b32 v25, 2, v25
    v_sub_u32 v25, v2, v25
    s_mul_i32 s74, s76, 432
    v_add3_u32 v25, v25, v26, s74
    s_lshl_b32 s74, s77, 5
    s_lshl_b32 s75, s6, 3
    s_add_u32 s74, s74, s75
    s_mul_i32 s74, s74, 3456
    s_mul_i32 s75, s75, 448
    s_mov_b32 exec_hi, 0xffffff
    s_mov_b32 s7, 6602752
    s_waitcnt lgkmcnt(0)
    s_load_dword s97, s[32:33], s7
    s_mov_b32 s48, s22
    s_mov_b32 s49, s23
    s_mov_b32 s50, 2211840
    s_mov_b32 s51, 0x20000
    s_mov_b32 s52, s24
    s_mov_b32 s53, s25
    s_mov_b32 s54, 2211840
    s_mov_b32 s55, 0x20000
    s_add_u32 m0, s75, 0
    s_nop 0
    buffer_load_dwordx4 v25, s[48:51], s74 offen nt lds
    s_add_u32 m0, s75, 14336
    s_nop 0
    buffer_load_dwordx4 v25, s[52:55], s74 offen nt lds
    s_add_u32 s74, s74, 6912
    s_add_u32 m0, s75, 896
    s_nop 0
    buffer_load_dwordx4 v25, s[48:51], s74 offen nt lds
    s_add_u32 m0, s75, 15232
    s_nop 0
    buffer_load_dwordx4 v25, s[52:55], s74 offen nt lds
    s_add_u32 s74, s74, 6912
    s_add_u32 m0, s75, 1792
    s_nop 0
    buffer_load_dwordx4 v25, s[48:51], s74 offen nt lds
    s_add_u32 m0, s75, 16128
    s_nop 0
    buffer_load_dwordx4 v25, s[52:55], s74 offen nt lds
    s_add_u32 s74, s74, 6912
    s_add_u32 m0, s75, 2688
    s_nop 0
    buffer_load_dwordx4 v25, s[48:51], s74 offen nt lds
    s_add_u32 m0, s75, 17024
    s_nop 0
    buffer_load_dwordx4 v25, s[52:55], s74 offen nt lds
    s_add_u32 s74, s74, 6912
    s_mov_b64 exec, -1
    s_add_u32 s79, s70, 96
    s_and_b32 s78, s79, 7
    s_lshr_b32 s79, s79, 3
    v_mul_u32_u24 v25, 37, v1
    v_lshrrev_b32 v25, 8, v25
    v_lshrrev_b32 v26, 2, v25
    v_mul_u32_u24 v26, 3024, v26
    v_lshlrev_b32 v25, 2, v25
    v_sub_u32 v25, v2, v25
    s_mul_i32 s74, s78, 432
    v_add3_u32 v25, v25, v26, s74
    s_lshl_b32 s74, s79, 5
    s_lshl_b32 s75, s6, 3
    s_add_u32 s74, s74, s75
    s_mul_i32 s74, s74, 3456
    s_mul_i32 s75, s75, 448
    s_mov_b32 exec_hi, 0xffffff
    s_add_u32 m0, s75, 28672
    s_nop 0
    buffer_load_dwordx4 v25, s[48:51], s74 offen nt lds
    s_add_u32 m0, s75, 43008
    s_nop 0
    buffer_load_dwordx4 v25, s[52:55], s74 offen nt lds
    s_add_u32 s74, s74, 6912
    s_add_u32 m0, s75, 29568
    s_nop 0
    buffer_load_dwordx4 v25, s[48:51], s74 offen nt lds
    s_add_u32 m0, s75, 43904
    s_nop 0
    buffer_load_dwordx4 v25, s[52:55], s74 offen nt lds
    s_add_u32 s74, s74, 6912
    s_add_u32 m0, s75, 30464
    s_nop 0
    buffer_load_dwordx4 v25, s[48:51], s74 offen nt lds
    s_add_u32 m0, s75, 44800
    s_nop 0
    buffer_load_dwordx4 v25, s[52:55], s74 offen nt lds
    s_add_u32 s74, s74, 6912
    s_add_u32 m0, s75, 31360
    s_nop 0
    buffer_load_dwordx4 v25, s[48:51], s74 offen nt lds
    s_add_u32 m0, s75, 45696
    s_nop 0
    buffer_load_dwordx4 v25, s[52:55], s74 offen nt lds
    s_add_u32 s74, s74, 6912
    s_mov_b64 exec, -1
    s_mov_b32 s36, s32
    s_mov_b32 s37, s33
    s_mov_b32 s38, 268435456
    s_mov_b32 s39, 0x20000
    s_mov_b32 s44, s28
    s_mov_b32 s45, s29
    s_mov_b32 s46, 2621440
    s_mov_b32 s47, 0x20000
    s_lshl_b32 s3, s60, 2
    s_add_u32 s3, s3, s6
    s_mul_i32 s90, s3, 40960
    s_mul_i32 s95, s3, 114688
    s_mul_i32 s7, s61, 1792
    s_add_u32 s95, s95, s7
    s_lshl_b32 s3, s3, 12
    s_add_u32 s35, s3, 6029312
    s_lshl_b32 s7, s61, 7
    s_add_u32 s3, s3, s7
    s_add_u32 s66, s3, 5505024
    s_lshl_b32 s3, s62, 12
    s_lshl_b32 s7, s6, 10
    s_add_u32 s7, s7, s3
    s_add_u32 s64, s7, 5505024
    s_lshl_b32 s7, s63, 9
    s_add_u32 s3, s3, s7
    s_lshl_b32 s7, s6, 7
    s_add_u32 s3, s3, s7
    s_add_u32 s67, s3, 6029312
    s_lshl_b32 s3, s34, 7
    s_mul_i32 s7, s6, 24576
    s_add_u32 s3, s3, s7
    s_add_u32 s68, s3, 7733248
    s_lshr_b32 s3, s60, 1
    s_mul_i32 s3, s3, 24576
    s_mul_i32 s7, s6, 5120
    s_add_u32 s3, s3, s7
    s_add_u32 s65, s3, 7733248
    s_lshl_b32 s3, s62, 15
    s_lshl_b32 s7, s6, 13
    s_add_u32 s3, s3, s7
    s_add_u32 s69, s3, 20971520
    s_mul_i32 s91, s62, 114688
    s_mul_i32 s7, s6, 14336
    s_add_u32 s91, s91, s7
    s_mul_i32 s92, s63, 286720
    s_mul_i32 s7, s6, 71680
    s_add_u32 s92, s92, s7
    s_lshl_b32 s7, s63, 10
    s_add_u32 s7, s7, s69
    v_min_u32 v10, 5, v1
    v_lshl_add_u32 v10, v10, 7, s7
    v_writelane_b32 v10, s66, 58
    v_writelane_b32 v10, s67, 59
    buffer_load_dword v11, v10, s[36:39], 0 offen sc1
    v_lshl_add_u32 v43, v4, 3, v20
    v_mul_u32_u24 v43, 448, v43
    s_mul_i32 s74, s6, 112
    v_add_u32 v43, s74, v43
    v_lshl_add_u32 v40, v21, 4, v43
    v_lshl_add_u32 v41, v21, 3, v43
    v_and_b32 v42, 1, v21
    v_lshl_add_u32 v42, v42, 3, v43
    v_lshrrev_b32 v43, 1, v21
    v_mul_u32_u24 v43, 14336, v43
    v_add_u32 v42, v42, v43
    v_and_b32 v43, 6, v1
    v_cmp_ne_u32 vcc, 6, v43
    s_nop 1
    v_cndmask_b32 v44, 0, -1, vcc
    v_cmp_eq_u32 vcc, 6, v3
    v_mov_b32 v43, 0x3f803f80
    s_nop 0
    v_cndmask_b32 v45, 0, v43, vcc
    s_waitcnt lgkmcnt(0)
    s_add_u32 s97, s97, 0x9e3779b1
    v_mov_b32 v14, s97
    s_lshl_b32 s74, s76, 2
    s_add_u32 s74, s74, s6
    s_mul_i32 s74, s74, 143360
    s_mul_i32 s75, s77, 7168
    s_add_u32 s74, s74, s75
    s_add_u32 s74, s74, 8388608
    s_waitcnt vmcnt(9)
    s_barrier
    ds_read_b64_tr_b16 v[128:129], v40 offset:0
    ds_read_b64_tr_b16 v[130:131], v40 offset:1792
    ds_read_b64_tr_b16 v[132:133], v40 offset:8
    ds_read_b64_tr_b16 v[134:135], v40 offset:1800
    ds_read_b64_tr_b16 v[136:137], v41 offset:64
    ds_read_b64_tr_b16 v[138:139], v41 offset:1856
    ds_read_b64_tr_b16 v[140:141], v40 offset:14336
    ds_read_b64_tr_b16 v[142:143], v40 offset:16128
    ds_read_b64_tr_b16 v[144:145], v40 offset:14344
    ds_read_b64_tr_b16 v[146:147], v40 offset:16136
    ds_read_b64_tr_b16 v[148:149], v41 offset:14400
    ds_read_b64_tr_b16 v[150:151], v41 offset:16192
    ds_read_b64_tr_b16 v[152:153], v42 offset:96
    ds_read_b64_tr_b16 v[154:155], v42 offset:1888
    s_waitcnt lgkmcnt(12)
    buffer_store_dwordx4 v[128:131], v2, s[36:39], s74 offen offset:0 sc1
    s_waitcnt lgkmcnt(10)
    buffer_store_dwordx4 v[132:135], v2, s[36:39], s74 offen offset:1024 sc1
    s_waitcnt lgkmcnt(8)
    buffer_store_dwordx4 v[136:139], v2, s[36:39], s74 offen offset:2048 sc1
    s_waitcnt lgkmcnt(6)
    buffer_store_dwordx4 v[140:143], v2, s[36:39], s74 offen offset:3072 sc1
    s_waitcnt lgkmcnt(4)
    s_add_u32 s74, s74, 4096
    buffer_store_dwordx4 v[144:147], v2, s[36:39], s74 offen offset:0 sc1
    s_waitcnt lgkmcnt(2)
    buffer_store_dwordx4 v[148:151], v2, s[36:39], s74 offen offset:1024 sc1
    s_waitcnt lgkmcnt(0)
    v_and_or_b32 v152, v152, v44, v45
    v_and_or_b32 v153, v153, v44, v45
    v_and_or_b32 v154, v154, v44, v45
    v_and_or_b32 v155, v155, v44, v45
    buffer_store_dwordx4 v[152:155], v2, s[36:39], s74 offen offset:2048 sc1
    s_getreg_b32 s31, hwreg(HW_REG_XCC_ID, 0, 4)
    s_add_u32 s31, s31, s97
    s_add_u32 s31, s31, 1
    s_cmp_lg_u32 s6, 0
    s_cbranch_scc1 Lxid_54
    s_lshl_b32 s3, s4, 12
    s_lshl_b32 s7, s5, 7
    s_add_u32 s3, s3, s7
    s_add_u32 s3, s3, 6291456
    v_mov_b32 v5, s31
    s_mov_b64 exec, 1
    buffer_store_dword v5, off, s[36:39], s3 sc1
    s_mov_b64 exec, -1
Lxid_54:
    s_lshl_b32 s74, s78, 2
    s_add_u32 s74, s74, s6
    s_mul_i32 s74, s74, 143360
    s_mul_i32 s75, s79, 7168
    s_add_u32 s74, s74, s75
    s_add_u32 s74, s74, 8388608
    s_waitcnt vmcnt(8)
    s_barrier
    ds_read_b64_tr_b16 v[160:161], v40 offset:28672
    ds_read_b64_tr_b16 v[162:163], v40 offset:30464
    ds_read_b64_tr_b16 v[164:165], v40 offset:28680
    ds_read_b64_tr_b16 v[166:167], v40 offset:30472
    ds_read_b64_tr_b16 v[168:169], v41 offset:28736
    ds_read_b64_tr_b16 v[170:171], v41 offset:30528
    ds_read_b64_tr_b16 v[172:173], v40 offset:43008
    ds_read_b64_tr_b16 v[174:175], v40 offset:44800
    ds_read_b64_tr_b16 v[176:177], v40 offset:43016
    ds_read_b64_tr_b16 v[178:179], v40 offset:44808
    ds_read_b64_tr_b16 v[180:181], v41 offset:43072
    ds_read_b64_tr_b16 v[182:183], v41 offset:44864
    ds_read_b64_tr_b16 v[184:185], v42 offset:28768
    ds_read_b64_tr_b16 v[186:187], v42 offset:30560
    s_waitcnt lgkmcnt(12)
    buffer_store_dwordx4 v[160:163], v2, s[36:39], s74 offen offset:0 sc1
    s_waitcnt lgkmcnt(10)
    buffer_store_dwordx4 v[164:167], v2, s[36:39], s74 offen offset:1024 sc1
    s_waitcnt lgkmcnt(8)
    buffer_store_dwordx4 v[168:171], v2, s[36:39], s74 offen offset:2048 sc1
    s_waitcnt lgkmcnt(6)
    buffer_store_dwordx4 v[172:175], v2, s[36:39], s74 offen offset:3072 sc1
    s_waitcnt lgkmcnt(4)
    s_add_u32 s74, s74, 4096
    buffer_store_dwordx4 v[176:179], v2, s[36:39], s74 offen offset:0 sc1
    s_waitcnt lgkmcnt(2)
    buffer_store_dwordx4 v[180:183], v2, s[36:39], s74 offen offset:1024 sc1
    s_waitcnt lgkmcnt(0)
    v_and_or_b32 v184, v184, v44, v45
    v_and_or_b32 v185, v185, v44, v45
    v_and_or_b32 v186, v186, v44, v45
    v_and_or_b32 v187, v187, v44, v45
    buffer_store_dwordx4 v[184:187], v2, s[36:39], s74 offen offset:2048 sc1
    s_lshl_b32 s74, s76, 2
    s_add_u32 s74, s74, s6
    s_mul_i32 s74, s74, 20
    s_add_u32 s74, s74, s77
    s_lshl_b32 s74, s74, 7
    s_add_u32 s74, s74, 6619136
    s_waitcnt vmcnt(7)
    s_mov_b64 exec, 1
    buffer_store_dword v14, off, s[36:39], s74 sc1
    s_mov_b64 exec, -1
    s_lshl_b32 s74, s78, 2
    s_add_u32 s74, s74, s6
    s_mul_i32 s74, s74, 20
    s_add_u32 s74, s74, s79
    s_lshl_b32 s74, s74, 7
    s_add_u32 s74, s74, 6619136
    s_waitcnt vmcnt(1)
    s_mov_b64 exec, 1
    buffer_store_dword v14, off, s[36:39], s74 sc1
    s_mov_b64 exec, -1
    s_branch L_hdone
L_hv3:
    s_add_u32 s77, s70, 0
    s_and_b32 s76, s77, 7
    s_lshr_b32 s77, s77, 3
    v_mul_u32_u24 v25, 37, v1
    v_lshrrev_b32 v25, 8, v25
    v_lshrrev_b32 v26, 2, v25
    v_mul_u32_u24 v26, 3024, v26
    v_lshlrev_b32 v25, 2, v25
    v_sub_u32 v25, v2, v25
    s_mul_i32 s74, s76, 432
    v_add3_u32 v25, v25, v26, s74
    s_lshl_b32 s74, s77, 5
    s_lshl_b32 s75, s6, 3
    s_add_u32 s74, s74, s75
    s_mul_i32 s74, s74, 3456
    s_mul_i32 s75, s75, 448
    s_mov_b32 exec_hi, 0xffffff
    s_mov_b32 s7, 6602752
    s_waitcnt lgkmcnt(0)
    s_load_dword s97, s[32:33], s7
    s_mov_b32 s48, s22
    s_mov_b32 s49, s23
    s_mov_b32 s50, 2211840
    s_mov_b32 s51, 0x20000
    s_mov_b32 s52, s24
    s_mov_b32 s53, s25
    s_mov_b32 s54, 2211840
    s_mov_b32 s55, 0x20000
    s_add_u32 m0, s75, 0
    s_nop 0
    buffer_load_dwordx4 v25, s[48:51], s74 offen nt lds
    s_add_u32 m0, s75, 14336
    s_nop 0
    buffer_load_dwordx4 v25, s[52:55], s74 offen nt lds
    s_add_u32 s74, s74, 6912
    s_add_u32 m0, s75, 896
    s_nop 0
    buffer_load_dwordx4 v25, s[48:51], s74 offen nt lds
    s_add_u32 m0, s75, 15232
    s_nop 0
    buffer_load_dwordx4 v25, s[52:55], s74 offen nt lds
    s_add_u32 s74, s74, 6912
    s_add_u32 m0, s75, 1792
    s_nop 0
    buffer_load_dwordx4 v25, s[48:51], s74 offen nt lds
    s_add_u32 m0, s75, 16128
    s_nop 0
    buffer_load_dwordx4 v25, s[52:55], s74 offen nt lds
    s_add_u32 s74, s74, 6912
    s_add_u32 m0, s75, 2688
    s_nop 0
    buffer_load_dwordx4 v25, s[48:51], s74 offen nt lds
    s_add_u32 m0, s75, 17024
    s_nop 0
    buffer_load_dwordx4 v25, s[52:55], s74 offen nt lds
    s_add_u32 s74, s74, 6912
    s_mov_b64 exec, -1
    s_add_u32 s79, s70, 96
    s_and_b32 s78, s79, 7
    s_lshr_b32 s79, s79, 3
    v_mul_u32_u24 v25, 37, v1
    v_lshrrev_b32 v25, 8, v25
    v_lshrrev_b32 v26, 2, v25
    v_mul_u32_u24 v26, 3024, v26
    v_lshlrev_b32 v25, 2, v25
    v_sub_u32 v25, v2, v25
    s_mul_i32 s74, s78, 432
    v_add3_u32 v25, v25, v26, s74
    s_lshl_b32 s74, s79, 5
    s_lshl_b32 s75, s6, 3
    s_add_u32 s74, s74, s75
    s_mul_i32 s74, s74, 3456
    s_mul_i32 s75, s75, 448
    s_mov_b32 exec_hi, 0xffffff
    s_add_u32 m0, s75, 28672
    s_nop 0
    buffer_load_dwordx4 v25, s[48:51], s74 offen nt lds
    s_add_u32 m0, s75, 43008
    s_nop 0
    buffer_load_dwordx4 v25, s[52:55], s74 offen nt lds
    s_add_u32 s74, s74, 6912
    s_add_u32 m0, s75, 29568
    s_nop 0
    buffer_load_dwordx4 v25, s[48:51], s74 offen nt lds
    s_add_u32 m0, s75, 43904
    s_nop 0
    buffer_load_dwordx4 v25, s[52:55], s74 offen nt lds
    s_add_u32 s74, s74, 6912
    s_add_u32 m0, s75, 30464
    s_nop 0
    buffer_load_dwordx4 v25, s[48:51], s74 offen nt lds
    s_add_u32 m0, s75, 44800
    s_nop 0
    buffer_load_dwordx4 v25, s[52:55], s74 offen nt lds
    s_add_u32 s74, s74, 6912
    s_add_u32 m0, s75, 31360
    s_nop 0
    buffer_load_dwordx4 v25, s[48:51], s74 offen nt lds
    s_add_u32 m0, s75, 45696
    s_nop 0
    buffer_load_dwordx4 v25, s[52:55], s74 offen nt lds
    s_add_u32 s74, s74, 6912
    s_mov_b64 exec, -1
    s_mov_b32 s36, s32
    s_mov_b32 s37, s33
    s_mov_b32 s38, 268435456
    s_mov_b32 s39, 0x20000
    s_mov_b32 s44, s28
    s_mov_b32 s45, s29
    s_mov_b32 s46, 2621440
    s_mov_b32 s47, 0x20000
    s_lshl_b32 s3, s60, 2
    s_add_u32 s3, s3, s6
    s_mul_i32 s90, s3, 40960
    s_mul_i32 s95, s3, 114688
    s_mul_i32 s7, s61, 1792
    s_add_u32 s95, s95, s7
    s_lshl_b32 s3, s3, 12
    s_add_u32 s35, s3, 6029312
    s_lshl_b32 s7, s61, 7
    s_add_u32 s3, s3, s7
    s_add_u32 s66, s3, 5505024
    s_lshl_b32 s3, s62, 12
    s_lshl_b32 s7, s6, 10
    s_add_u32 s7, s7, s3
    s_add_u32 s64, s7, 5505024
    s_lshl_b32 s7, s63, 9
    s_add_u32 s3, s3, s7
    s_lshl_b32 s7, s6, 7
    s_add_u32 s3, s3, s7
    s_add_u32 s67, s3, 6029312
    s_lshl_b32 s3, s34, 7
    s_mul_i32 s7, s6, 24576
    s_add_u32 s3, s3, s7
    s_add_u32 s68, s3, 7733248
    s_lshr_b32 s3, s60, 1
    s_mul_i32 s3, s3, 24576
    s_mul_i32 s7, s6, 5120
    s_add_u32 s3, s3, s7
    s_add_u32 s65, s3, 7733248
    s_lshl_b32 s3, s62, 15
    s_lshl_b32 s7, s6, 13
    s_add_u32 s3, s3, s7
    s_add_u32 s69, s3, 20971520
    s_mul_i32 s91, s62, 114688
    s_mul_i32 s7, s6, 14336
    s_add_u32 s91, s91, s7
    s_mul_i32 s92, s63, 286720
    s_mul_i32 s7, s6, 71680
    s_add_u32 s92, s92, s7
    s_lshl_b32 s7, s63, 10
    s_add_u32 s7, s7, s69
    v_min_u32 v10, 5, v1
    v_lshl_add_u32 v10, v10, 7, s7
    v_writelane_b32 v10, s66, 58
    v_writelane_b32 v10, s67, 59
    buffer_load_dword v11, v10, s[36:39], 0 offen sc1
    v_lshl_add_u32 v43, v4, 3, v20
    v_mul_u32_u24 v43, 448, v43
    s_mul_i32 s74, s6, 112
    v_add_u32 v43, s74, v43
    v_lshl_add_u32 v40, v21, 4, v43
    v_lshl_add_u32 v41, v21, 3, v43
    v_and_b32 v42, 1, v21
    v_lshl_add_u32 v42, v42, 3, v43
    v_lshrrev_b32 v43, 1, v21
    v_mul_u32_u24 v43, 14336, v43
    v_add_u32 v42, v42, v43
    v_and_b32 v43, 6, v1
    v_cmp_ne_u32 vcc, 6, v43
    s_nop 1
    v_cndmask_b32 v44, 0, -1, vcc
    v_cmp_eq_u32 vcc, 6, v3
    v_mov_b32 v43, 0x3f803f80
    s_nop 0
    v_cndmask_b32 v45, 0, v43, vcc
    s_waitcnt lgkmcnt(0)
    s_add_u32 s97, s97, 0x9e3779b1
    v_mov_b32 v14, s97
    s_lshl_b32 s74, s76, 2
    s_add_u32 s74, s74, s6
    s_mul_i32 s74, s74, 143360
    s_mul_i32 s75, s77, 7168
    s_add_u32 s74, s74, s75
    s_add_u32 s74, s74, 8388608
    s_waitcnt vmcnt(9)
    s_barrier
    ds_read_b64_tr_b16 v[128:129], v40 offset:0
    ds_read_b64_tr_b16 v[130:131], v40 offset:1792
    ds_read_b64_tr_b16 v[132:133], v40 offset:8
    ds_read_b64_tr_b16 v[134:135], v40 offset:1800
    ds_read_b64_tr_b16 v[136:137], v41 offset:64
    ds_read_b64_tr_b16 v[138:139], v41 offset:1856
    ds_read_b64_tr_b16 v[140:141], v40 offset:14336
    ds_read_b64_tr_b16 v[142:143], v40 offset:16128
    ds_read_b64_tr_b16 v[144:145], v40 offset:14344
    ds_read_b64_tr_b16 v[146:147], v40 offset:16136
    ds_read_b64_tr_b16 v[148:149], v41 offset:14400
    ds_read_b64_tr_b16 v[150:151], v41 offset:16192
    ds_read_b64_tr_b16 v[152:153], v42 offset:96
    ds_read_b64_tr_b16 v[154:155], v42 offset:1888
    s_waitcnt lgkmcnt(12)
    buffer_store_dwordx4 v[128:131], v2, s[36:39], s74 offen offset:0 sc1
    s_waitcnt lgkmcnt(10)
    buffer_store_dwordx4 v[132:135], v2, s[36:39], s74 offen offset:1024 sc1
    s_waitcnt lgkmcnt(8)
    buffer_store_dwordx4 v[136:139], v2, s[36:39], s74 offen offset:2048 sc1
    s_waitcnt lgkmcnt(6)
    buffer_store_dwordx4 v[140:143], v2, s[36:39], s74 offen offset:3072 sc1
    s_waitcnt lgkmcnt(4)
    s_add_u32 s74, s74, 4096
    buffer_store_dwordx4 v[144:147], v2, s[36:39], s74 offen offset:0 sc1
    s_waitcnt lgkmcnt(2)
    buffer_store_dwordx4 v[148:151], v2, s[36:39], s74 offen offset:1024 sc1
    s_waitcnt lgkmcnt(0)
    v_and_or_b32 v152, v152, v44, v45
    v_and_or_b32 v153, v153, v44, v45
    v_and_or_b32 v154, v154, v44, v45
    v_and_or_b32 v155, v155, v44, v45
    buffer_store_dwordx4 v[152:155], v2, s[36:39], s74 offen offset:2048 sc1
    s_getreg_b32 s31, hwreg(HW_REG_XCC_ID, 0, 4)
    s_add_u32 s31, s31, s97
    s_add_u32 s31, s31, 1
    s_cmp_lg_u32 s6, 0
    s_cbranch_scc1 Lxid_55
    s_lshl_b32 s3, s4, 12
    s_lshl_b32 s7, s5, 7
    s_add_u32 s3, s3, s7
    s_add_u32 s3, s3, 6291456
    v_mov_b32 v5, s31
    s_mov_b64 exec, 1
    buffer_store_dword v5, off, s[36:39], s3 sc1
    s_mov_b64 exec, -1
Lxid_55:
    s_lshl_b32 s74, s78, 2
    s_add_u32 s74, s74, s6
    s_mul_i32 s74, s74, 143360
    s_mul_i32 s75, s79, 7168
    s_add_u32 s74, s74, s75
    s_add_u32 s74, s74, 8388608
    s_waitcnt vmcnt(8)
    s_barrier
    ds_read_b64_tr_b16 v[160:161], v40 offset:28672
    ds_read_b64_tr_b16 v[162:163], v40 offset:30464
    ds_read_b64_tr_b16 v[164:165], v40 offset:28680
    ds_read_b64_tr_b16 v[166:167], v40 offset:30472
    ds_read_b64_tr_b16 v[168:169], v41 offset:28736
    ds_read_b64_tr_b16 v[170:171], v41 offset:30528
    ds_read_b64_tr_b16 v[172:173], v40 offset:43008
    ds_read_b64_tr_b16 v[174:175], v40 offset:44800
    ds_read_b64_tr_b16 v[176:177], v40 offset:43016
    ds_read_b64_tr_b16 v[178:179], v40 offset:44808
    ds_read_b64_tr_b16 v[180:181], v41 offset:43072
    ds_read_b64_tr_b16 v[182:183], v41 offset:44864
    ds_read_b64_tr_b16 v[184:185], v42 offset:28768
    ds_read_b64_tr_b16 v[186:187], v42 offset:30560
    s_waitcnt lgkmcnt(12)
    buffer_store_dwordx4 v[160:163], v2, s[36:39], s74 offen offset:0 sc1
    s_waitcnt lgkmcnt(10)
    buffer_store_dwordx4 v[164:167], v2, s[36:39], s74 offen offset:1024 sc1
    s_waitcnt lgkmcnt(8)
    buffer_store_dwordx4 v[168:171], v2, s[36:39], s74 offen offset:2048 sc1
    s_waitcnt lgkmcnt(6)
    buffer_store_dwordx4 v[172:175], v2, s[36:39], s74 offen offset:3072 sc1
    s_waitcnt lgkmcnt(4)
    s_add_u32 s74, s74, 4096
    buffer_store_dwordx4 v[176:179], v2, s[36:39], s74 offen offset:0 sc1
    s_waitcnt lgkmcnt(2)
    buffer_store_dwordx4 v[180:183], v2, s[36:39], s74 offen offset:1024 sc1
    s_waitcnt lgkmcnt(0)
    v_and_or_b32 v184, v184, v44, v45
    v_and_or_b32 v185, v185, v44, v45
    v_and_or_b32 v186, v186, v44, v45
    v_and_or_b32 v187, v187, v44, v45
    buffer_store_dwordx4 v[184:187], v2, s[36:39], s74 offen offset:2048 sc1
    s_mov_b32 s40, s26
    s_mov_b32 s41, s27
    s_mov_b32 s42, 2211840
    s_mov_b32 s43, 0x20000
    s_mul_i32 s20, s70, 1
    s_add_i32 s20, s20, -32
    s_lshr_b32 s21, s20, 1
    s_and_b32 s20, s20, 1
    s_mul_i32 s74, s21, 69120
    s_mul_i32 s75, s20, 640
    s_add_u32 s74, s74, s75
    s_mov_b32 s72, 1639
    s_lshl_b32 s75, s6, 10
    v_mov_b32 v32, 0
    v_mov_b32 v33, 0
    v_mov_b32 v34, 0
    v_mov_b32 v35, 0
    v_add_u32 v36, 102400, v2
    ds_write_b128 v36, v[32:35]
    v_add_u32 v30, 0, v0
    v_min_u32 v30, 2159, v30
    v_mul_u32_u24 v31, s72, v30
    v_lshrrev_b32 v31, 16, v31
    v_mul_u32_u24 v31, 640, v31
    v_lshl_add_u32 v30, v30, 4, v31
    s_add_u32 m0, s75, 65536
    s_nop 0
    buffer_load_dwordx4 v30, s[40:43], s74 offen nt lds
    v_add_u32 v30, 256, v0
    v_min_u32 v30, 2159, v30
    v_mul_u32_u24 v31, s72, v30
    v_lshrrev_b32 v31, 16, v31
    v_mul_u32_u24 v31, 640, v31
    v_lshl_add_u32 v30, v30, 4, v31
    s_add_u32 m0, s75, 69632
    s_nop 0
    buffer_load_dwordx4 v30, s[40:43], s74 offen nt lds
    v_add_u32 v30, 512, v0
    v_min_u32 v30, 2159, v30
    v_mul_u32_u24 v31, s72, v30
    v_lshrrev_b32 v31, 16, v31
    v_mul_u32_u24 v31, 640, v31
    v_lshl_add_u32 v30, v30, 4, v31
    s_add_u32 m0, s75, 73728
    s_nop 0
    buffer_load_dwordx4 v30, s[40:43], s74 offen nt lds
    v_add_u32 v30, 768, v0
    v_min_u32 v30, 2159, v30
    v_mul_u32_u24 v31, s72, v30
    v_lshrrev_b32 v31, 16, v31
    v_mul_u32_u24 v31, 640, v31
    v_lshl_add_u32 v30, v30, 4, v31
    s_add_u32 m0, s75, 77824
    s_nop 0
    buffer_load_dwordx4 v30, s[40:43], s74 offen nt lds
    v_add_u32 v30, 1024, v0
    v_min_u32 v30, 2159, v30
    v_mul_u32_u24 v31, s72, v30
    v_lshrrev_b32 v31, 16, v31
    v_mul_u32_u24 v31, 640, v31
    v_lshl_add_u32 v30, v30, 4, v31
    s_add_u32 m0, s75, 81920
    s_nop 0
    buffer_load_dwordx4 v30, s[40:43], s74 offen nt lds
    v_add_u32 v30, 1280, v0
    v_min_u32 v30, 2159, v30
    v_mul_u32_u24 v31, s72, v30
    v_lshrrev_b32 v31, 16, v31
    v_mul_u32_u24 v31, 640, v31
    v_lshl_add_u32 v30, v30, 4, v31
    s_add_u32 m0, s75, 86016
    s_nop 0
    buffer_load_dwordx4 v30, s[40:43], s74 offen nt lds
    v_add_u32 v30, 1536, v0
    v_min_u32 v30, 2159, v30
    v_mul_u32_u24 v31, s72, v30
    v_lshrrev_b32 v31, 16, v31
    v_mul_u32_u24 v31, 640, v31
    v_lshl_add_u32 v30, v30, 4, v31
    s_add_u32 m0, s75, 90112
    s_nop 0
    buffer_load_dwordx4 v30, s[40:43], s74 offen nt lds
    v_add_u32 v30, 1792, v0
    v_min_u32 v30, 2159, v30
    v_mul_u32_u24 v31, s72, v30
    v_lshrrev_b32 v31, 16, v31
    v_mul_u32_u24 v31, 640, v31
    v_lshl_add_u32 v30, v30, 4, v31
    s_add_u32 m0, s75, 94208
    s_nop 0
    buffer_load_dwordx4 v30, s[40:43], s74 offen nt lds
    v_add_u32 v30, 2048, v0
    v_min_u32 v30, 2159, v30
    v_mul_u32_u24 v31, s72, v30
    v_lshrrev_b32 v31, 16, v31
    v_mul_u32_u24 v31, 640, v31
    v_lshl_add_u32 v30, v30, 4, v31
    s_add_u32 m0, s75, 98304
    s_nop 0
    buffer_load_dwordx4 v30, s[40:43], s74 offen nt lds
    s_lshl_b32 s74, s76, 2
    s_add_u32 s74, s74, s6
    s_mul_i32 s74, s74, 20
    s_add_u32 s74, s74, s77
    s_lshl_b32 s74, s74, 7
    s_add_u32 s74, s74, 6619136
    s_waitcnt vmcnt(16)
    s_mov_b64 exec, 1
    buffer_store_dword v14, off, s[36:39], s74 sc1
    s_mov_b64 exec, -1
    s_lshl_b32 s74, s78, 2
    s_add_u32 s74, s74, s6
    s_mul_i32 s74, s74, 20
    s_add_u32 s74, s74, s79
    s_lshl_b32 s74, s74, 7
    s_add_u32 s74, s74, 6619136
    s_waitcnt vmcnt(10)
    s_mov_b64 exec, 1
    buffer_store_dword v14, off, s[36:39], s74 sc1
    s_mov_b64 exec, -1
    v_lshl_add_u32 v24, v4, 3, v20
    v_mul_u32_u24 v24, 640, v24
    v_lshl_add_u32 v25, v4, 2, v20
    v_add_u32 v25, 32, v25
    v_mul_u32_u24 v25, 640, v25
    v_lshlrev_b32 v26, 3, v4
    v_mov_b32 v27, 0x30323430
    v_mov_b32 v28, 0x2c002e2c
    v_lshrrev_b32 v27, v26, v27
    v_lshrrev_b32 v28, v26, v28
    v_and_b32 v27, 0xff, v27
    v_and_b32 v28, 0xff, v28
    v_cmp_gt_u32 vcc, 2, v20
    s_nop 1
    v_cndmask_b32 v26, v28, v27, vcc
    v_and_b32 v27, 1, v20
    v_add_u32 v27, v26, v27
    v_mul_u32_u24 v27, 640, v27
    v_cmp_eq_u32 vcc, 0, v26
    v_mov_b32 v28, 36864
    s_nop 0
    v_cndmask_b32 v26, v27, v28, vcc
    s_mul_i32 s75, s6, 160
    s_add_u32 s75, s75, 65536
    v_lshl_add_u32 v27, v21, 3, s75
    v_add_u32 v24, v24, v27
    v_add_u32 v25, v25, v27
    v_add_u32 v26, v26, v27
    s_mul_i32 s75, s21, 7
    v_add_u32 v30, s75, v4
    v_add_u32 v30, 0, v30
    v_lshrrev_b32 v31, 2, v30
    v_mul_u32_u24 v31, 5120, v31
    v_and_b32 v30, 3, v30
    v_lshl_add_u32 v31, v30, 8, v31
    v_lshl_add_u32 v28, v3, 4, v31
    v_add_u32 v30, s75, v4
    v_add_u32 v30, 4, v30
    v_lshrrev_b32 v31, 2, v30
    v_mul_u32_u24 v31, 5120, v31
    v_and_b32 v30, 3, v30
    v_lshl_add_u32 v31, v30, 8, v31
    v_lshl_add_u32 v29, v3, 4, v31
    s_lshl_b32 s74, s20, 2
    s_add_u32 s74, s74, s6
    s_mul_i32 s74, s74, 286720
    s_add_u32 s74, s74, 13107200
    s_add_u32 s75, s74, 4096
    s_waitcnt vmcnt(2) lgkmcnt(0)
    s_barrier
    ds_read_b64_tr_b16 v[212:213], v24 offset:0
    ds_read_b64_tr_b16 v[214:215], v24 offset:2560
    ds_read_b64_tr_b16 v[216:217], v24 offset:32
    ds_read_b64_tr_b16 v[218:219], v24 offset:2592
    ds_read_b64_tr_b16 v[220:221], v24 offset:64
    ds_read_b64_tr_b16 v[222:223], v24 offset:2624
    ds_read_b64_tr_b16 v[224:225], v24 offset:96
    ds_read_b64_tr_b16 v[226:227], v24 offset:2656
    ds_read_b64_tr_b16 v[228:229], v24 offset:128
    ds_read_b64_tr_b16 v[230:231], v24 offset:2688
    ds_read_b64_tr_b16 v[232:233], v25 offset:0
    ds_read_b64_tr_b16 v[234:235], v26 offset:0
    ds_read_b64_tr_b16 v[236:237], v25 offset:32
    ds_read_b64_tr_b16 v[238:239], v26 offset:32
    ds_read_b64_tr_b16 v[240:241], v25 offset:64
    ds_read_b64_tr_b16 v[242:243], v26 offset:64
    ds_read_b64_tr_b16 v[244:245], v25 offset:96
    ds_read_b64_tr_b16 v[246:247], v26 offset:96
    ds_read_b64_tr_b16 v[248:249], v25 offset:128
    ds_read_b64_tr_b16 v[250:251], v26 offset:128
    s_waitcnt lgkmcnt(15)
    buffer_store_dwordx4 v[212:215], v28, s[36:39], s74 offen offset:0 sc1
    buffer_store_dwordx4 v[216:219], v28, s[36:39], s74 offen offset:1024 sc1
    s_waitcnt lgkmcnt(14)
    buffer_store_dwordx4 v[220:223], v28, s[36:39], s74 offen offset:2048 sc1
    s_waitcnt lgkmcnt(12)
    buffer_store_dwordx4 v[224:227], v28, s[36:39], s74 offen offset:3072 sc1
    s_waitcnt lgkmcnt(10)
    buffer_store_dwordx4 v[228:231], v28, s[36:39], s75 offen offset:0 sc1
    s_waitcnt lgkmcnt(0)
    s_mov_b32 exec_hi, 0xffff
    buffer_store_dwordx4 v[232:235], v29, s[36:39], s74 offen offset:0 sc1
    buffer_store_dwordx4 v[236:239], v29, s[36:39], s74 offen offset:1024 sc1
    buffer_store_dwordx4 v[240:243], v29, s[36:39], s74 offen offset:2048 sc1
    buffer_store_dwordx4 v[244:247], v29, s[36:39], s74 offen offset:3072 sc1
    buffer_store_dwordx4 v[248:251], v29, s[36:39], s75 offen offset:0 sc1
    s_mov_b64 exec, -1
    s_lshl_b32 s74, s20, 12
    s_lshl_b32 s75, s21, 7
    s_add_u32 s74, s74, s75
    s_add_u32 s74, s74, 6569984
    s_waitcnt vmcnt(0)
    s_barrier
    s_cmp_lg_u32 s6, 0
    s_cbranch_scc1 Lsig_56
    s_mov_b64 exec, 1
    buffer_store_dword v14, off, s[36:39], s74 sc1
    s_mov_b64 exec, -1
Lsig_56:
    s_branch L_hdone
L_hv1:
    s_add_u32 s77, s70, 0
    s_and_b32 s76, s77, 7
    s_lshr_b32 s77, s77, 3
    v_mul_u32_u24 v25, 37, v1
    v_lshrrev_b32 v25, 8, v25
    v_lshrrev_b32 v26, 2, v25
    v_mul_u32_u24 v26, 3024, v26
    v_lshlrev_b32 v25, 2, v25
    v_sub_u32 v25, v2, v25
    s_mul_i32 s74, s76, 432
    v_add3_u32 v25, v25, v26, s74
    s_lshl_b32 s74, s77, 5
    s_lshl_b32 s75, s6, 3
    s_add_u32 s74, s74, s75
    s_mul_i32 s74, s74, 3456
    s_mul_i32 s75, s75, 448
    s_mov_b32 exec_hi, 0xffffff
    s_mov_b32 s7, 6602752
    s_waitcnt lgkmcnt(0)
    s_load_dword s97, s[32:33], s7
    s_mov_b32 s48, s22
    s_mov_b32 s49, s23
    s_mov_b32 s50, 2211840
    s_mov_b32 s51, 0x20000
    s_mov_b32 s52, s24
    s_mov_b32 s53, s25
    s_mov_b32 s54, 2211840
    s_mov_b32 s55, 0x20000
    s_add_u32 m0, s75, 0
    s_nop 0
    buffer_load_dwordx4 v25, s[48:51], s74 offen nt lds
    s_add_u32 m0, s75, 14336
    s_nop 0
    buffer_load_dwordx4 v25, s[52:55], s74 offen nt lds
    s_add_u32 s74, s74, 6912
    s_add_u32 m0, s75, 896
    s_nop 0
    buffer_load_dwordx4 v25, s[48:51], s74 offen nt lds
    s_add_u32 m0, s75, 15232
    s_nop 0
    buffer_load_dwordx4 v25, s[52:55], s74 offen nt lds
    s_add_u32 s74, s74, 6912
    s_add_u32 m0, s75, 1792
    s_nop 0
    buffer_load_dwordx4 v25, s[48:51], s74 offen nt lds
    s_add_u32 m0, s75, 16128
    s_nop 0
    buffer_load_dwordx4 v25, s[52:55], s74 offen nt lds
    s_add_u32 s74, s74, 6912
    s_add_u32 m0, s75, 2688
    s_nop 0
    buffer_load_dwordx4 v25, s[48:51], s74 offen nt lds
    s_add_u32 m0, s75, 17024
    s_nop 0
    buffer_load_dwordx4 v25, s[52:55], s74 offen nt lds
    s_add_u32 s74, s74, 6912
    s_mov_b64 exec, -1
    s_mov_b32 s36, s32
    s_mov_b32 s37, s33
    s_mov_b32 s38, 268435456
    s_mov_b32 s39, 0x20000
    s_mov_b32 s44, s28
    s_mov_b32 s45, s29
    s_mov_b32 s46, 2621440
    s_mov_b32 s47, 0x20000
    s_lshl_b32 s3, s60, 2
    s_add_u32 s3, s3, s6
    s_mul_i32 s90, s3, 40960
    s_mul_i32 s95, s3, 114688
    s_mul_i32 s7, s61, 1792
    s_add_u32 s95, s95, s7
    s_lshl_b32 s3, s3, 12
    s_add_u32 s35, s3, 6029312
    s_lshl_b32 s7, s61, 7
    s_add_u32 s3, s3, s7
    s_add_u32 s66, s3, 5505024
    s_lshl_b32 s3, s62, 12
    s_lshl_b32 s7, s6, 10
    s_add_u32 s7, s7, s3
    s_add_u32 s64, s7, 5505024
    s_lshl_b32 s7, s63, 9
    s_add_u32 s3, s3, s7
    s_lshl_b32 s7, s6, 7
    s_add_u32 s3, s3, s7
    s_add_u32 s67, s3, 6029312
    s_lshl_b32 s3, s34, 7
    s_mul_i32 s7, s6, 24576
    s_add_u32 s3, s3, s7
    s_add_u32 s68, s3, 7733248
    s_lshr_b32 s3, s60, 1
    s_mul_i32 s3, s3, 24576
    s_mul_i32 s7, s6, 5120
    s_add_u32 s3, s3, s7
    s_add_u32 s65, s3, 7733248
    s_lshl_b32 s3, s62, 15
    s_lshl_b32 s7, s6, 13
    s_add_u32 s3, s3, s7
    s_add_u32 s69, s3, 20971520
    s_mul_i32 s91, s62, 114688
    s_mul_i32 s7, s6, 14336
    s_add_u32 s91, s91, s7
    s_mul_i32 s92, s63, 286720
    s_mul_i32 s7, s6, 71680
    s_add_u32 s92, s92, s7
    s_lshl_b32 s7, s63, 10
    s_add_u32 s7, s7, s69
    v_min_u32 v10, 5, v1
    v_lshl_add_u32 v10, v10, 7, s7
    v_writelane_b32 v10, s66, 58
    v_writelane_b32 v10, s67, 59
    buffer_load_dword v11, v10, s[36:39], 0 offen sc1
    v_lshl_add_u32 v43, v4, 3, v20
    v_mul_u32_u24 v43, 448, v43
    s_mul_i32 s74, s6, 112
    v_add_u32 v43, s74, v43
    v_lshl_add_u32 v40, v21, 4, v43
    v_lshl_add_u32 v41, v21, 3, v43
    v_and_b32 v42, 1, v21
    v_lshl_add_u32 v42, v42, 3, v43
    v_lshrrev_b32 v43, 1, v21
    v_mul_u32_u24 v43, 14336, v43
    v_add_u32 v42, v42, v43
    v_and_b32 v43, 6, v1
    v_cmp_ne_u32 vcc, 6, v43
    s_nop 1
    v_cndmask_b32 v44, 0, -1, vcc
    v_cmp_eq_u32 vcc, 6, v3
    v_mov_b32 v43, 0x3f803f80
    s_nop 0
    v_cndmask_b32 v45, 0, v43, vcc
    s_waitcnt lgkmcnt(0)
    s_add_u32 s97, s97, 0x9e3779b1
    v_mov_b32 v14, s97
    s_lshl_b32 s74, s76, 2
    s_add_u32 s74, s74, s6
    s_mul_i32 s74, s74, 143360
    s_mul_i32 s75, s77, 7168
    s_add_u32 s74, s74, s75
    s_add_u32 s74, s74, 8388608
    s_waitcnt vmcnt(1)
    s_barrier
    ds_read_b64_tr_b16 v[128:129], v40 offset:0
    ds_read_b64_tr_b16 v[130:131], v40 offset:1792
    ds_read_b64_tr_b16 v[132:133], v40 offset:8
    ds_read_b64_tr_b16 v[134:135], v40 offset:1800
    ds_read_b64_tr_b16 v[136:137], v41 offset:64
    ds_read_b64_tr_b16 v[138:139], v41 offset:1856
    ds_read_b64_tr_b16 v[140:141], v40 offset:14336
    ds_read_b64_tr_b16 v[142:143], v40 offset:16128
    ds_read_b64_tr_b16 v[144:145], v40 offset:14344
    ds_read_b64_tr_b16 v[146:147], v40 offset:16136
    ds_read_b64_tr_b16 v[148:149], v41 offset:14400
    ds_read_b64_tr_b16 v[150:151], v41 offset:16192
    ds_read_b64_tr_b16 v[152:153], v42 offset:96
    ds_read_b64_tr_b16 v[154:155], v42 offset:1888
    s_waitcnt lgkmcnt(12)
    buffer_store_dwordx4 v[128:131], v2, s[36:39], s74 offen offset:0 sc1
    s_waitcnt lgkmcnt(10)
    buffer_store_dwordx4 v[132:135], v2, s[36:39], s74 offen offset:1024 sc1
    s_waitcnt lgkmcnt(8)
    buffer_store_dwordx4 v[136:139], v2, s[36:39], s74 offen offset:2048 sc1
    s_waitcnt lgkmcnt(6)
    buffer_store_dwordx4 v[140:143], v2, s[36:39], s74 offen offset:3072 sc1
    s_waitcnt lgkmcnt(4)
    s_add_u32 s74, s74, 4096
    buffer_store_dwordx4 v[144:147], v2, s[36:39], s74 offen offset:0 sc1
    s_waitcnt lgkmcnt(2)
    buffer_store_dwordx4 v[148:151], v2, s[36:39], s74 offen offset:1024 sc1
    s_waitcnt lgkmcnt(0)
    v_and_or_b32 v152, v152, v44, v45
    v_and_or_b32 v153, v153, v44, v45
    v_and_or_b32 v154, v154, v44, v45
    v_and_or_b32 v155, v155, v44, v45
    buffer_store_dwordx4 v[152:155], v2, s[36:39], s74 offen offset:2048 sc1
    s_getreg_b32 s31, hwreg(HW_REG_XCC_ID, 0, 4)
    s_add_u32 s31, s31, s97
    s_add_u32 s31, s31, 1
    s_cmp_lg_u32 s6, 0
    s_cbranch_scc1 Lxid_57
    s_lshl_b32 s3, s4, 12
    s_lshl_b32 s7, s5, 7
    s_add_u32 s3, s3, s7
    s_add_u32 s3, s3, 6291456
    v_mov_b32 v5, s31
    s_mov_b64 exec, 1
    buffer_store_dword v5, off, s[36:39], s3 sc1
    s_mov_b64 exec, -1
Lxid_57:
    s_mov_b32 s40, s26
    s_mov_b32 s41, s27
    s_mov_b32 s42, 2211840
    s_mov_b32 s43, 0x20000
    s_mul_i32 s78, s70, 2
    s_add_i32 s78, s78, -96
    s_lshr_b32 s79, s78, 1
    s_and_b32 s78, s78, 1
    s_mul_i32 s74, s79, 69120
    s_mul_i32 s75, s78, 640
    s_add_u32 s74, s74, s75
    s_mov_b32 s72, 1639
    s_lshl_b32 s75, s6, 10
    v_mov_b32 v32, 0
    v_mov_b32 v33, 0
    v_mov_b32 v34, 0
    v_mov_b32 v35, 0
    v_add_u32 v36, 69632, v2
    ds_write_b128 v36, v[32:35]
    v_add_u32 v30, 0, v0
    v_min_u32 v30, 2159, v30
    v_mul_u32_u24 v31, s72, v30
    v_lshrrev_b32 v31, 16, v31
    v_mul_u32_u24 v31, 640, v31
    v_lshl_add_u32 v30, v30, 4, v31
    s_add_u32 m0, s75, 32768
    s_nop 0
    buffer_load_dwordx4 v30, s[40:43], s74 offen nt lds
    v_add_u32 v30, 256, v0
    v_min_u32 v30, 2159, v30
    v_mul_u32_u24 v31, s72, v30
    v_lshrrev_b32 v31, 16, v31
    v_mul_u32_u24 v31, 640, v31
    v_lshl_add_u32 v30, v30, 4, v31
    s_add_u32 m0, s75, 36864
    s_nop 0
    buffer_load_dwordx4 v30, s[40:43], s74 offen nt lds
    v_add_u32 v30, 512, v0
    v_min_u32 v30, 2159, v30
    v_mul_u32_u24 v31, s72, v30
    v_lshrrev_b32 v31, 16, v31
    v_mul_u32_u24 v31, 640, v31
    v_lshl_add_u32 v30, v30, 4, v31
    s_add_u32 m0, s75, 40960
    s_nop 0
    buffer_load_dwordx4 v30, s[40:43], s74 offen nt lds
    v_add_u32 v30, 768, v0
    v_min_u32 v30, 2159, v30
    v_mul_u32_u24 v31, s72, v30
    v_lshrrev_b32 v31, 16, v31
    v_mul_u32_u24 v31, 640, v31
    v_lshl_add_u32 v30, v30, 4, v31
    s_add_u32 m0, s75, 45056
    s_nop 0
    buffer_load_dwordx4 v30, s[40:43], s74 offen nt lds
    v_add_u32 v30, 1024, v0
    v_min_u32 v30, 2159, v30
    v_mul_u32_u24 v31, s72, v30
    v_lshrrev_b32 v31, 16, v31
    v_mul_u32_u24 v31, 640, v31
    v_lshl_add_u32 v30, v30, 4, v31
    s_add_u32 m0, s75, 49152
    s_nop 0
    buffer_load_dwordx4 v30, s[40:43], s74 offen nt lds
    v_add_u32 v30, 1280, v0
    v_min_u32 v30, 2159, v30
    v_mul_u32_u24 v31, s72, v30
    v_lshrrev_b32 v31, 16, v31
    v_mul_u32_u24 v31, 640, v31
    v_lshl_add_u32 v30, v30, 4, v31
    s_add_u32 m0, s75, 53248
    s_nop 0
    buffer_load_dwordx4 v30, s[40:43], s74 offen nt lds
    v_add_u32 v30, 1536, v0
    v_min_u32 v30, 2159, v30
    v_mul_u32_u24 v31, s72, v30
    v_lshrrev_b32 v31, 16, v31
    v_mul_u32_u24 v31, 640, v31
    v_lshl_add_u32 v30, v30, 4, v31
    s_add_u32 m0, s75, 57344
    s_nop 0
    buffer_load_dwordx4 v30, s[40:43], s74 offen nt lds
    v_add_u32 v30, 1792, v0
    v_min_u32 v30, 2159, v30
    v_mul_u32_u24 v31, s72, v30
    v_lshrrev_b32 v31, 16, v31
    v_mul_u32_u24 v31, 640, v31
    v_lshl_add_u32 v30, v30, 4, v31
    s_add_u32 m0, s75, 61440
    s_nop 0
    buffer_load_dwordx4 v30, s[40:43], s74 offen nt lds
    v_add_u32 v30, 2048, v0
    v_min_u32 v30, 2159, v30
    v_mul_u32_u24 v31, s72, v30
    v_lshrrev_b32 v31, 16, v31
    v_mul_u32_u24 v31, 640, v31
    v_lshl_add_u32 v30, v30, 4, v31
    s_add_u32 m0, s75, 65536
    s_nop 0
    buffer_load_dwordx4 v30, s[40:43], s74 offen nt lds
    s_mov_b32 s40, s26
    s_mov_b32 s41, s27
    s_mov_b32 s42, 2211840
    s_mov_b32 s43, 0x20000
    s_mul_i32 s20, s70, 2
    s_add_i32 s20, s20, -95
    s_lshr_b32 s21, s20, 1
    s_and_b32 s20, s20, 1
    s_mul_i32 s74, s21, 69120
    s_mul_i32 s75, s20, 640
    s_add_u32 s74, s74, s75
    s_mov_b32 s72, 1639
    s_lshl_b32 s75, s6, 10
    v_mov_b32 v32, 0
    v_mov_b32 v33, 0
    v_mov_b32 v34, 0
    v_mov_b32 v35, 0
    v_add_u32 v36, 107520, v2
    ds_write_b128 v36, v[32:35]
    v_add_u32 v30, 0, v0
    v_min_u32 v30, 2159, v30
    v_mul_u32_u24 v31, s72, v30
    v_lshrrev_b32 v31, 16, v31
    v_mul_u32_u24 v31, 640, v31
    v_lshl_add_u32 v30, v30, 4, v31
    s_add_u32 m0, s75, 70656
    s_nop 0
    buffer_load_dwordx4 v30, s[40:43], s74 offen nt lds
    v_add_u32 v30, 256, v0
    v_min_u32 v30, 2159, v30
    v_mul_u32_u24 v31, s72, v30
    v_lshrrev_b32 v31, 16, v31
    v_mul_u32_u24 v31, 640, v31
    v_lshl_add_u32 v30, v30, 4, v31
    s_add_u32 m0, s75, 74752
    s_nop 0
    buffer_load_dwordx4 v30, s[40:43], s74 offen nt lds
    v_add_u32 v30, 512, v0
    v_min_u32 v30, 2159, v30
    v_mul_u32_u24 v31, s72, v30
    v_lshrrev_b32 v31, 16, v31
    v_mul_u32_u24 v31, 640, v31
    v_lshl_add_u32 v30, v30, 4, v31
    s_add_u32 m0, s75, 78848
    s_nop 0
    buffer_load_dwordx4 v30, s[40:43], s74 offen nt lds
    v_add_u32 v30, 768, v0
    v_min_u32 v30, 2159, v30
    v_mul_u32_u24 v31, s72, v30
    v_lshrrev_b32 v31, 16, v31
    v_mul_u32_u24 v31, 640, v31
    v_lshl_add_u32 v30, v30, 4, v31
    s_add_u32 m0, s75, 82944
    s_nop 0
    buffer_load_dwordx4 v30, s[40:43], s74 offen nt lds
    v_add_u32 v30, 1024, v0
    v_min_u32 v30, 2159, v30
    v_mul_u32_u24 v31, s72, v30
    v_lshrrev_b32 v31, 16, v31
    v_mul_u32_u24 v31, 640, v31
    v_lshl_add_u32 v30, v30, 4, v31
    s_add_u32 m0, s75, 87040
    s_nop 0
    buffer_load_dwordx4 v30, s[40:43], s74 offen nt lds
    v_add_u32 v30, 1280, v0
    v_min_u32 v30, 2159, v30
    v_mul_u32_u24 v31, s72, v30
    v_lshrrev_b32 v31, 16, v31
    v_mul_u32_u24 v31, 640, v31
    v_lshl_add_u32 v30, v30, 4, v31
    s_add_u32 m0, s75, 91136
    s_nop 0
    buffer_load_dwordx4 v30, s[40:43], s74 offen nt lds
    v_add_u32 v30, 1536, v0
    v_min_u32 v30, 2159, v30
    v_mul_u32_u24 v31, s72, v30
    v_lshrrev_b32 v31, 16, v31
    v_mul_u32_u24 v31, 640, v31
    v_lshl_add_u32 v30, v30, 4, v31
    s_add_u32 m0, s75, 95232
    s_nop 0
    buffer_load_dwordx4 v30, s[40:43], s74 offen nt lds
    v_add_u32 v30, 1792, v0
    v_min_u32 v30, 2159, v30
    v_mul_u32_u24 v31, s72, v30
    v_lshrrev_b32 v31, 16, v31
    v_mul_u32_u24 v31, 640, v31
    v_lshl_add_u32 v30, v30, 4, v31
    s_add_u32 m0, s75, 99328
    s_nop 0
    buffer_load_dwordx4 v30, s[40:43], s74 offen nt lds
    v_add_u32 v30, 2048, v0
    v_min_u32 v30, 2159, v30
    v_mul_u32_u24 v31, s72, v30
    v_lshrrev_b32 v31, 16, v31
    v_mul_u32_u24 v31, 640, v31
    v_lshl_add_u32 v30, v30, 4, v31
    s_add_u32 m0, s75, 103424
    s_nop 0
    buffer_load_dwordx4 v30, s[40:43], s74 offen nt lds
    s_lshl_b32 s74, s76, 2
    s_add_u32 s74, s74, s6
    s_mul_i32 s74, s74, 20
    s_add_u32 s74, s74, s77
    s_lshl_b32 s74, s74, 7
    s_add_u32 s74, s74, 6619136
    s_waitcnt vmcnt(18)
    s_mov_b64 exec, 1
    buffer_store_dword v14, off, s[36:39], s74 sc1
    s_mov_b64 exec, -1
    v_lshl_add_u32 v24, v4, 3, v20
    v_mul_u32_u24 v24, 640, v24
    v_lshl_add_u32 v25, v4, 2, v20
    v_add_u32 v25, 32, v25
    v_mul_u32_u24 v25, 640, v25
    v_lshlrev_b32 v26, 3, v4
    v_mov_b32 v27, 0x30323430
    v_mov_b32 v28, 0x2c002e2c
    v_lshrrev_b32 v27, v26, v27
    v_lshrrev_b32 v28, v26, v28
    v_and_b32 v27, 0xff, v27
    v_and_b32 v28, 0xff, v28
    v_cmp_gt_u32 vcc, 2, v20
    s_nop 1
    v_cndmask_b32 v26, v28, v27, vcc
    v_and_b32 v27, 1, v20
    v_add_u32 v27, v26, v27
    v_mul_u32_u24 v27, 640, v27
    v_cmp_eq_u32 vcc, 0, v26
    v_mov_b32 v28, 36864
    s_nop 0
    v_cndmask_b32 v26, v27, v28, vcc
    s_mul_i32 s75, s6, 160
    s_add_u32 s75, s75, 32768
    v_lshl_add_u32 v27, v21, 3, s75
    v_add_u32 v24, v24, v27
    v_add_u32 v25, v25, v27
    v_add_u32 v26, v26, v27
    s_mul_i32 s75, s79, 7
    v_add_u32 v30, s75, v4
    v_add_u32 v30, 0, v30
    v_lshrrev_b32 v31, 2, v30
    v_mul_u32_u24 v31, 5120, v31
    v_and_b32 v30, 3, v30
    v_lshl_add_u32 v31, v30, 8, v31
    v_lshl_add_u32 v28, v3, 4, v31
    v_add_u32 v30, s75, v4
    v_add_u32 v30, 4, v30
    v_lshrrev_b32 v31, 2, v30
    v_mul_u32_u24 v31, 5120, v31
    v_and_b32 v30, 3, v30
    v_lshl_add_u32 v31, v30, 8, v31
    v_lshl_add_u32 v29, v3, 4, v31
    s_lshl_b32 s74, s78, 2
    s_add_u32 s74, s74, s6
    s_mul_i32 s74, s74, 286720
    s_add_u32 s74, s74, 13107200
    s_add_u32 s75, s74, 4096
    s_waitcnt vmcnt(10) lgkmcnt(0)
    s_barrier
    ds_read_b64_tr_b16 v[168:169], v24 offset:0
    ds_read_b64_tr_b16 v[170:171], v24 offset:2560
    ds_read_b64_tr_b16 v[172:173], v24 offset:32
    ds_read_b64_tr_b16 v[174:175], v24 offset:2592
    ds_read_b64_tr_b16 v[176:177], v24 offset:64
    ds_read_b64_tr_b16 v[178:179], v24 offset:2624
    ds_read_b64_tr_b16 v[180:181], v24 offset:96
    ds_read_b64_tr_b16 v[182:183], v24 offset:2656
    ds_read_b64_tr_b16 v[184:185], v24 offset:128
    ds_read_b64_tr_b16 v[186:187], v24 offset:2688
    ds_read_b64_tr_b16 v[188:189], v25 offset:0
    ds_read_b64_tr_b16 v[190:191], v26 offset:0
    ds_read_b64_tr_b16 v[192:193], v25 offset:32
    ds_read_b64_tr_b16 v[194:195], v26 offset:32
    ds_read_b64_tr_b16 v[196:197], v25 offset:64
    ds_read_b64_tr_b16 v[198:199], v26 offset:64
    ds_read_b64_tr_b16 v[200:201], v25 offset:96
    ds_read_b64_tr_b16 v[202:203], v26 offset:96
    ds_read_b64_tr_b16 v[204:205], v25 offset:128
    ds_read_b64_tr_b16 v[206:207], v26 offset:128
    s_waitcnt lgkmcnt(15)
    buffer_store_dwordx4 v[168:171], v28, s[36:39], s74 offen offset:0 sc1
    buffer_store_dwordx4 v[172:175], v28, s[36:39], s74 offen offset:1024 sc1
    s_waitcnt lgkmcnt(14)
    buffer_store_dwordx4 v[176:179], v28, s[36:39], s74 offen offset:2048 sc1
    s_waitcnt lgkmcnt(12)
    buffer_store_dwordx4 v[180:183], v28, s[36:39], s74 offen offset:3072 sc1
    s_waitcnt lgkmcnt(10)
    buffer_store_dwordx4 v[184:187], v28, s[36:39], s75 offen offset:0 sc1
    s_waitcnt lgkmcnt(0)
    s_mov_b32 exec_hi, 0xffff
    buffer_store_dwordx4 v[188:191], v29, s[36:39], s74 offen offset:0 sc1
    buffer_store_dwordx4 v[192:195], v29, s[36:39], s74 offen offset:1024 sc1
    buffer_store_dwordx4 v[196:199], v29, s[36:39], s74 offen offset:2048 sc1
    buffer_store_dwordx4 v[200:203], v29, s[36:39], s74 offen offset:3072 sc1
    buffer_store_dwordx4 v[204:207], v29, s[36:39], s75 offen offset:0 sc1
    s_mov_b64 exec, -1
    v_lshl_add_u32 v24, v4, 3, v20
    v_mul_u32_u24 v24, 640, v24
    v_lshl_add_u32 v25, v4, 2, v20
    v_add_u32 v25, 32, v25
    v_mul_u32_u24 v25, 640, v25
    v_lshlrev_b32 v26, 3, v4
    v_mov_b32 v27, 0x30323430
    v_mov_b32 v28, 0x2c002e2c
    v_lshrrev_b32 v27, v26, v27
    v_lshrrev_b32 v28, v26, v28
    v_and_b32 v27, 0xff, v27
    v_and_b32 v28, 0xff, v28
    v_cmp_gt_u32 vcc, 2, v20
    s_nop 1
    v_cndmask_b32 v26, v28, v27, vcc
    v_and_b32 v27, 1, v20
    v_add_u32 v27, v26, v27
    v_mul_u32_u24 v27, 640, v27
    v_cmp_eq_u32 vcc, 0, v26
    v_mov_b32 v28, 36864
    s_nop 0
    v_cndmask_b32 v26, v27, v28, vcc
    s_mul_i32 s75, s6, 160
    s_add_u32 s75, s75, 70656
    v_lshl_add_u32 v27, v21, 3, s75
    v_add_u32 v24, v24, v27
    v_add_u32 v25, v25, v27
    v_add_u32 v26, v26, v27
    s_mul_i32 s75, s21, 7
    v_add_u32 v30, s75, v4
    v_add_u32 v30, 0, v30
    v_lshrrev_b32 v31, 2, v30
    v_mul_u32_u24 v31, 5120, v31
    v_and_b32 v30, 3, v30
    v_lshl_add_u32 v31, v30, 8, v31
    v_lshl_add_u32 v28, v3, 4, v31
    v_add_u32 v30, s75, v4
    v_add_u32 v30, 4, v30
    v_lshrrev_b32 v31, 2, v30
    v_mul_u32_u24 v31, 5120, v31
    v_and_b32 v30, 3, v30
    v_lshl_add_u32 v31, v30, 8, v31
    v_lshl_add_u32 v29, v3, 4, v31
    s_lshl_b32 s74, s20, 2
    s_add_u32 s74, s74, s6
    s_mul_i32 s74, s74, 286720
    s_add_u32 s74, s74, 13107200
    s_add_u32 s75, s74, 4096
    s_waitcnt vmcnt(11) lgkmcnt(0)
    s_barrier
    ds_read_b64_tr_b16 v[212:213], v24 offset:0
    ds_read_b64_tr_b16 v[214:215], v24 offset:2560
    ds_read_b64_tr_b16 v[216:217], v24 offset:32
    ds_read_b64_tr_b16 v[218:219], v24 offset:2592
    ds_read_b64_tr_b16 v[220:221], v24 offset:64
    ds_read_b64_tr_b16 v[222:223], v24 offset:2624
    ds_read_b64_tr_b16 v[224:225], v24 offset:96
    ds_read_b64_tr_b16 v[226:227], v24 offset:2656
    ds_read_b64_tr_b16 v[228:229], v24 offset:128
    ds_read_b64_tr_b16 v[230:231], v24 offset:2688
    ds_read_b64_tr_b16 v[232:233], v25 offset:0
    ds_read_b64_tr_b16 v[234:235], v26 offset:0
    ds_read_b64_tr_b16 v[236:237], v25 offset:32
    ds_read_b64_tr_b16 v[238:239], v26 offset:32
    ds_read_b64_tr_b16 v[240:241], v25 offset:64
    ds_read_b64_tr_b16 v[242:243], v26 offset:64
    ds_read_b64_tr_b16 v[244:245], v25 offset:96
    ds_read_b64_tr_b16 v[246:247], v26 offset:96
    ds_read_b64_tr_b16 v[248:249], v25 offset:128
    ds_read_b64_tr_b16 v[250:251], v26 offset:128
    s_waitcnt lgkmcnt(15)
    buffer_store_dwordx4 v[212:215], v28, s[36:39], s74 offen offset:0 sc1
    buffer_store_dwordx4 v[216:219], v28, s[36:39], s74 offen offset:1024 sc1
    s_waitcnt lgkmcnt(14)
    buffer_store_dwordx4 v[220:223], v28, s[36:39], s74 offen offset:2048 sc1
    s_waitcnt lgkmcnt(12)
    buffer_store_dwordx4 v[224:227], v28, s[36:39], s74 offen offset:3072 sc1
    s_waitcnt lgkmcnt(10)
    buffer_store_dwordx4 v[228:231], v28, s[36:39], s75 offen offset:0 sc1
    s_waitcnt lgkmcnt(0)
    s_mov_b32 exec_hi, 0xffff
    buffer_store_dwordx4 v[232:235], v29, s[36:39], s74 offen offset:0 sc1
    buffer_store_dwordx4 v[236:239], v29, s[36:39], s74 offen offset:1024 sc1
    buffer_store_dwordx4 v[240:243], v29, s[36:39], s74 offen offset:2048 sc1
    buffer_store_dwordx4 v[244:247], v29, s[36:39], s74 offen offset:3072 sc1
    buffer_store_dwordx4 v[248:251], v29, s[36:39], s75 offen offset:0 sc1
    s_mov_b64 exec, -1
    s_lshl_b32 s74, s78, 12
    s_lshl_b32 s75, s79, 7
    s_add_u32 s74, s74, s75
    s_add_u32 s74, s74, 6569984
    s_waitcnt vmcnt(10)
    s_barrier
    s_cmp_lg_u32 s6, 0
    s_cbranch_scc1 Lsig_58
    s_mov_b64 exec, 1
    buffer_store_dword v14, off, s[36:39], s74 sc1
    s_mov_b64 exec, -1
Lsig_58:
    s_lshl_b32 s74, s20, 12
    s_lshl_b32 s75, s21, 7
    s_add_u32 s74, s74, s75
    s_add_u32 s74, s74, 6569984
    s_waitcnt vmcnt(0)
    s_barrier
    s_cmp_lg_u32 s6, 0
    s_cbranch_scc1 Lsig_59
    s_mov_b64 exec, 1
    buffer_store_dword v14, off, s[36:39], s74 sc1
    s_mov_b64 exec, -1
Lsig_59:
    s_branch L_hdone
L_hv2:
    s_add_u32 s77, s70, 0
    s_and_b32 s76, s77, 7
    s_lshr_b32 s77, s77, 3
    v_mul_u32_u24 v25, 37, v1
    v_lshrrev_b32 v25, 8, v25
    v_lshrrev_b32 v26, 2, v25
    v_mul_u32_u24 v26, 3024, v26
    v_lshlrev_b32 v25, 2, v25
    v_sub_u32 v25, v2, v25
    s_mul_i32 s74, s76, 432
    v_add3_u32 v25, v25, v26, s74
    s_lshl_b32 s74, s77, 5
    s_lshl_b32 s75, s6, 3
    s_add_u32 s74, s74, s75
    s_mul_i32 s74, s74, 3456
    s_mul_i32 s75, s75, 448
    s_mov_b32 exec_hi, 0xffffff
    s_mov_b32 s7, 6602752
    s_waitcnt lgkmcnt(0)
    s_load_dword s97, s[32:33], s7
    s_mov_b32 s48, s22
    s_mov_b32 s49, s23
    s_mov_b32 s50, 2211840
    s_mov_b32 s51, 0x20000
    s_mov_b32 s52, s24
    s_mov_b32 s53, s25
    s_mov_b32 s54, 2211840
    s_mov_b32 s55, 0x20000
    s_add_u32 m0, s75, 0
    s_nop 0
    buffer_load_dwordx4 v25, s[48:51], s74 offen nt lds
    s_add_u32 m0, s75, 14336
    s_nop 0
    buffer_load_dwordx4 v25, s[52:55], s74 offen nt lds
    s_add_u32 s74, s74, 6912
    s_add_u32 m0, s75, 896
    s_nop 0
    buffer_load_dwordx4 v25, s[48:51], s74 offen nt lds
    s_add_u32 m0, s75, 15232
    s_nop 0
    buffer_load_dwordx4 v25, s[52:55], s74 offen nt lds
    s_add_u32 s74, s74, 6912
    s_add_u32 m0, s75, 1792
    s_nop 0
    buffer_load_dwordx4 v25, s[48:51], s74 offen nt lds
    s_add_u32 m0, s75, 16128
    s_nop 0
    buffer_load_dwordx4 v25, s[52:55], s74 offen nt lds
    s_add_u32 s74, s74, 6912
    s_add_u32 m0, s75, 2688
    s_nop 0
    buffer_load_dwordx4 v25, s[48:51], s74 offen nt lds
    s_add_u32 m0, s75, 17024
    s_nop 0
    buffer_load_dwordx4 v25, s[52:55], s74 offen nt lds
    s_add_u32 s74, s74, 6912
    s_mov_b64 exec, -1
    s_mov_b32 s36, s32
    s_mov_b32 s37, s33
    s_mov_b32 s38, 268435456
    s_mov_b32 s39, 0x20000
    s_mov_b32 s44, s28
    s_mov_b32 s45, s29
    s_mov_b32 s46, 2621440
    s_mov_b32 s47, 0x20000
    s_lshl_b32 s3, s60, 2
    s_add_u32 s3, s3, s6
    s_mul_i32 s90, s3, 40960
    s_mul_i32 s95, s3, 114688
    s_mul_i32 s7, s61, 1792
    s_add_u32 s95, s95, s7
    s_lshl_b32 s3, s3, 12
    s_add_u32 s35, s3, 6029312
    s_lshl_b32 s7, s61, 7
    s_add_u32 s3, s3, s7
    s_add_u32 s66, s3, 5505024
    s_lshl_b32 s3, s62, 12
    s_lshl_b32 s7, s6, 10
    s_add_u32 s7, s7, s3
    s_add_u32 s64, s7, 5505024
    s_lshl_b32 s7, s63, 9
    s_add_u32 s3, s3, s7
    s_lshl_b32 s7, s6, 7
    s_add_u32 s3, s3, s7
    s_add_u32 s67, s3, 6029312
    s_lshl_b32 s3, s34, 7
    s_mul_i32 s7, s6, 24576
    s_add_u32 s3, s3, s7
    s_add_u32 s68, s3, 7733248
    s_lshr_b32 s3, s60, 1
    s_mul_i32 s3, s3, 24576
    s_mul_i32 s7, s6, 5120
    s_add_u32 s3, s3, s7
    s_add_u32 s65, s3, 7733248
    s_lshl_b32 s3, s62, 15
    s_lshl_b32 s7, s6, 13
    s_add_u32 s3, s3, s7
    s_add_u32 s69, s3, 20971520
    s_mul_i32 s91, s62, 114688
    s_mul_i32 s7, s6, 14336
    s_add_u32 s91, s91, s7
    s_mul_i32 s92, s63, 286720
    s_mul_i32 s7, s6, 71680
    s_add_u32 s92, s92, s7
    s_lshl_b32 s7, s63, 10
    s_add_u32 s7, s7, s69
    v_min_u32 v10, 5, v1
    v_lshl_add_u32 v10, v10, 7, s7
    v_writelane_b32 v10, s66, 58
    v_writelane_b32 v10, s67, 59
    buffer_load_dword v11, v10, s[36:39], 0 offen sc1
    v_lshl_add_u32 v43, v4, 3, v20
    v_mul_u32_u24 v43, 448, v43
    s_mul_i32 s74, s6, 112
    v_add_u32 v43, s74, v43
    v_lshl_add_u32 v40, v21, 4, v43
    v_lshl_add_u32 v41, v21, 3, v43
    v_and_b32 v42, 1, v21
    v_lshl_add_u32 v42, v42, 3, v43
    v_lshrrev_b32 v43, 1, v21
    v_mul_u32_u24 v43, 14336, v43
    v_add_u32 v42, v42, v43
    v_and_b32 v43, 6, v1
    v_cmp_ne_u32 vcc, 6, v43
    s_nop 1
    v_cndmask_b32 v44, 0, -1, vcc
    v_cmp_eq_u32 vcc, 6, v3
    v_mov_b32 v43, 0x3f803f80
    s_nop 0
    v_cndmask_b32 v45, 0, v43, vcc
    s_waitcnt lgkmcnt(0)
    s_add_u32 s97, s97, 0x9e3779b1
    v_mov_b32 v14, s97
    s_lshl_b32 s74, s76, 2
    s_add_u32 s74, s74, s6
    s_mul_i32 s74, s74, 143360
    s_mul_i32 s75, s77, 7168
    s_add_u32 s74, s74, s75
    s_add_u32 s74, s74, 8388608
    s_waitcnt vmcnt(1)
    s_barrier
    ds_read_b64_tr_b16 v[128:129], v40 offset:0
    ds_read_b64_tr_b16 v[130:131], v40 offset:1792
    ds_read_b64_tr_b16 v[132:133], v40 offset:8
    ds_read_b64_tr_b16 v[134:135], v40 offset:1800
    ds_read_b64_tr_b16 v[136:137], v41 offset:64
    ds_read_b64_tr_b16 v[138:139], v41 offset:1856
    ds_read_b64_tr_b16 v[140:141], v40 offset:14336
    ds_read_b64_tr_b16 v[142:143], v40 offset:16128
    ds_read_b64_tr_b16 v[144:145], v40 offset:14344
    ds_read_b64_tr_b16 v[146:147], v40 offset:16136
    ds_read_b64_tr_b16 v[148:149], v41 offset:14400
    ds_read_b64_tr_b16 v[150:151], v41 offset:16192
    ds_read_b64_tr_b16 v[152:153], v42 offset:96
    ds_read_b64_tr_b16 v[154:155], v42 offset:1888
    s_waitcnt lgkmcnt(12)
    buffer_store_dwordx4 v[128:131], v2, s[36:39], s74 offen offset:0 sc1
    s_waitcnt lgkmcnt(10)
    buffer_store_dwordx4 v[132:135], v2, s[36:39], s74 offen offset:1024 sc1
    s_waitcnt lgkmcnt(8)
    buffer_store_dwordx4 v[136:139], v2, s[36:39], s74 offen offset:2048 sc1
    s_waitcnt lgkmcnt(6)
    buffer_store_dwordx4 v[140:143], v2, s[36:39], s74 offen offset:3072 sc1
    s_waitcnt lgkmcnt(4)
    s_add_u32 s74, s74, 4096
    buffer_store_dwordx4 v[144:147], v2, s[36:39], s74 offen offset:0 sc1
    s_waitcnt lgkmcnt(2)
    buffer_store_dwordx4 v[148:151], v2, s[36:39], s74 offen offset:1024 sc1
    s_waitcnt lgkmcnt(0)
    v_and_or_b32 v152, v152, v44, v45
    v_and_or_b32 v153, v153, v44, v45
    v_and_or_b32 v154, v154, v44, v45
    v_and_or_b32 v155, v155, v44, v45
    buffer_store_dwordx4 v[152:155], v2, s[36:39], s74 offen offset:2048 sc1
    s_getreg_b32 s31, hwreg(HW_REG_XCC_ID, 0, 4)
    s_add_u32 s31, s31, s97
    s_add_u32 s31, s31, 1
    s_cmp_lg_u32 s6, 0
    s_cbranch_scc1 Lxid_60
    s_lshl_b32 s3, s4, 12
    s_lshl_b32 s7, s5, 7
    s_add_u32 s3, s3, s7
    s_add_u32 s3, s3, 6291456
    v_mov_b32 v5, s31
    s_mov_b64 exec, 1
    buffer_store_dword v5, off, s[36:39], s3 sc1
    s_mov_b64 exec, -1
Lxid_60:
    s_lshl_b32 s74, s76, 2
    s_add_u32 s74, s74, s6
    s_mul_i32 s74, s74, 20
    s_add_u32 s74, s74, s77
    s_lshl_b32 s74, s74, 7
    s_add_u32 s74, s74, 6619136
    s_waitcnt vmcnt(0)
    s_mov_b64 exec, 1
    buffer_store_dword v14, off, s[36:39], s74 sc1
    s_mov_b64 exec, -1
    s_cmp_ge_u32 s6, 2
    s_cbranch_scc1 Lrs_61
    s_sub_u32 s71, s70, 80
    s_mul_i32 s73, s71, 20480
    s_lshl_b32 s74, s6, 10
    s_add_u32 s73, s73, s74
    s_add_u32 s73, s73, 7143424
    s_lshl_b32 s71, s71, 11
    s_add_u32 s71, s71, s74
    s_add_u32 s71, s71, 5242880
    s_mov_b32 s96, 0
Lrp_62:
    s_add_u32 s74, s73, 0
    buffer_load_dwordx4 v[48:51], v2, s[36:39], s74 offen offset:0 sc1
    buffer_load_dwordx4 v[52:55], v2, s[36:39], s74 offen offset:2048 sc1
    s_add_u32 s74, s73, 4096
    buffer_load_dwordx4 v[56:59], v2, s[36:39], s74 offen offset:0 sc1
    buffer_load_dwordx4 v[60:63], v2, s[36:39], s74 offen offset:2048 sc1
    s_add_u32 s74, s73, 8192
    buffer_load_dwordx4 v[64:67], v2, s[36:39], s74 offen offset:0 sc1
    buffer_load_dwordx4 v[68:71], v2, s[36:39], s74 offen offset:2048 sc1
    s_add_u32 s74, s73, 12288
    buffer_load_dwordx4 v[72:75], v2, s[36:39], s74 offen offset:0 sc1
    buffer_load_dwordx4 v[76:79], v2, s[36:39], s74 offen offset:2048 sc1
    s_add_u32 s74, s73, 16384
    buffer_load_dwordx4 v[80:83], v2, s[36:39], s74 offen offset:0 sc1
    buffer_load_dwordx4 v[84:87], v2, s[36:39], s74 offen offset:2048 sc1
    s_waitcnt vmcnt(0)
    v_xor_b32 v51, v14, v51
    v_xor_b32 v55, v14, v55
    v_xor_b32 v59, v14, v59
    v_xor_b32 v63, v14, v63
    v_xor_b32 v67, v14, v67
    v_xor_b32 v71, v14, v71
    v_xor_b32 v75, v14, v75
    v_xor_b32 v79, v14, v79
    v_xor_b32 v83, v14, v83
    v_xor_b32 v87, v14, v87
    v_or_b32 v51, v51, v55
    v_or_b32 v51, v51, v59
    v_or_b32 v51, v51, v63
    v_or_b32 v51, v51, v67
    v_or_b32 v51, v51, v71
    v_or_b32 v51, v51, v75
    v_or_b32 v51, v51, v79
    v_or_b32 v51, v51, v83
    v_or_b32 v51, v51, v87
    v_cmp_ne_u32 vcc, 0, v51
    s_cbranch_vccz Lrd_63
    s_sleep 1
    s_add_u32 s96, s96, 1
    s_cmp_lt_u32 s96, 100000
    s_cbranch_scc1 Lrp_62
Lrd_63:
    v_pk_add_f32 v[48:49], v[48:49], v[52:53]
    v_pk_add_f32 v[48:49], v[48:49], v[56:57]
    v_pk_add_f32 v[48:49], v[48:49], v[60:61]
    v_pk_add_f32 v[48:49], v[48:49], v[64:65]
    v_pk_add_f32 v[48:49], v[48:49], v[68:69]
    v_pk_add_f32 v[48:49], v[48:49], v[72:73]
    v_pk_add_f32 v[48:49], v[48:49], v[76:77]
    v_pk_add_f32 v[48:49], v[48:49], v[80:81]
    v_pk_add_f32 v[48:49], v[48:49], v[84:85]
    v_mul_f32 v48, 0x3acccccd, v48
    v_mul_f32 v49, 0x3acccccd, v49
    v_fma_f32 v49, -v48, v48, v49
    v_max_f32 v49, 0, v49
    v_cvt_pk_bf16_f32 v48, v48, v48
    v_lshlrev_b32 v48, 16, v48
    v_cvt_pk_bf16_f32 v49, v49, v49
    v_lshlrev_b32 v49, 16, v49
    v_add_f32 v49, 0x3727c5ac, v49
    v_cvt_pk_bf16_f32 v49, v49, v49
    v_lshlrev_b32 v49, 16, v49
    v_sqrt_f32 v49, v49
    s_nop 0
    v_cvt_pk_bf16_f32 v49, v49, v49
    v_lshlrev_b32 v49, 16, v49
    v_rcp_f32 v49, v49
    v_mov_b32 v50, v14
    v_mov_b32 v51, v14
    buffer_store_dwordx4 v[48:51], v2, s[36:39], s71 offen sc1
Lrs_61:
L_hdone:
    s_waitcnt vmcnt(0)
    v_lshlrev_b32 v6, 9, v4
    v_lshl_add_u32 v6, v3, 4, v6
    v_add_u32 v7, 57344, v2
    v_add_u32 v8, 114688, v2
    v_lshrrev_b32 v9, 2, v3
    v_lshl_add_u32 v9, v9, 4, v3
    v_lshlrev_b32 v9, 2, v9
    v_lshlrev_b32 v10, 2, v3
    v_add_u32 v10, 64, v10
    v_and_b32 v228, 3, v1
    v_cmp_eq_u32 s[80:81], 1, v228
    v_cmp_eq_u32 s[82:83], 2, v228
    v_cmp_eq_u32 s[84:85], 3, v228
    v_cmp_gt_u32 s[86:87], 10, v3
    s_mul_i32 s3, s6, 5120
    s_add_u32 s3, s3, 143360
    v_lshrrev_b32 v229, 1, v4
    v_lshl_add_u32 v229, v229, 2, v3
    v_and_b32 v230, 15, v229
    v_lshlrev_b32 v230, 4, v230
    v_lshl_add_u32 v230, v4, 8, v230
    v_add_u32 v11, s3, v230
    v_add_u32 v229, 8, v229
    v_and_b32 v230, 15, v229
    v_lshlrev_b32 v230, 4, v230
    v_lshl_add_u32 v230, v4, 8, v230
    v_add_u32 v12, s3, v230
    v_min_u32 v229, 9, v3
    v_add_u32 v230, s6, v229
    v_lshl_add_u32 v230, v230, 2, v4
    v_and_b32 v230, 15, v230
    v_lshlrev_b32 v230, 4, v230
    v_lshl_add_u32 v230, v229, 9, v230
    v_add_u32 v13, 143360, v230
    v_lshlrev_b32 v0, 8, v4
    v_add_u32 v0, 99440, v0
    s_barrier
    s_mul_i32 s8, s61, 143360
    s_add_u32 s8, s8, 8388608
    s_mul_i32 s9, s6, 7168
    s_add_u32 s8, s8, s9
    s_sub_u32 s9, 136192, s9
    v_min_u32 v17, 1, v1
    v_max_u32 v17, 0, v17
    v_lshlrev_b32 v17, 9, v17
    s_mul_i32 s79, s61, 20
    s_add_u32 s79, s79, s6
    s_lshl_b32 s79, s79, 7
    s_add_u32 s79, s79, 6619136
    s_mov_b32 s96, 0
Lpoll_66:
    buffer_load_dword v21, v17, s[36:39], s79 offen sc1
    s_waitcnt vmcnt(0)
    v_cmp_ne_u32 vcc, v21, v14
    s_cbranch_vccz Lpd_65
    s_sleep 2
    s_add_u32 s96, s96, 1
    s_cmp_lt_u32 s96, 100000
    s_cbranch_scc1 Lpoll_66
Lpd_65:
    s_add_u32 s10, s8, 0
    s_add_u32 m0, s9, 0
    s_nop 0
    buffer_load_dwordx4 v2, s[36:39], s10 offen sc1 lds
    s_add_u32 s10, s8, 1024
    s_add_u32 m0, s9, 1024
    s_nop 0
    buffer_load_dwordx4 v2, s[36:39], s10 offen sc1 lds
    s_add_u32 s10, s8, 2048
    s_add_u32 m0, s9, 2048
    s_nop 0
    buffer_load_dwordx4 v2, s[36:39], s10 offen sc1 lds
    s_add_u32 s10, s8, 3072
    s_add_u32 m0, s9, 3072
    s_nop 0
    buffer_load_dwordx4 v2, s[36:39], s10 offen sc1 lds
    s_add_u32 s10, s8, 4096
    s_add_u32 m0, s9, 4096
    s_nop 0
    buffer_load_dwordx4 v2, s[36:39], s10 offen sc1 lds
    s_add_u32 s10, s8, 5120
    s_add_u32 m0, s9, 5120
    s_nop 0
    buffer_load_dwordx4 v2, s[36:39], s10 offen sc1 lds
    s_add_u32 s10, s8, 6144
    s_add_u32 m0, s9, 6144
    s_nop 0
    buffer_load_dwordx4 v2, s[36:39], s10 offen sc1 lds
    s_add_u32 s10, s8, 28672
    s_sub_u32 m0, s9, 28672
    s_nop 0
    buffer_load_dwordx4 v2, s[36:39], s10 offen sc1 lds
    s_add_u32 s10, s8, 29696
    s_sub_u32 m0, s9, 27648
    s_nop 0
    buffer_load_dwordx4 v2, s[36:39], s10 offen sc1 lds
    s_add_u32 s10, s8, 30720
    s_sub_u32 m0, s9, 26624
    s_nop 0
    buffer_load_dwordx4 v2, s[36:39], s10 offen sc1 lds
    s_add_u32 s10, s8, 31744
    s_sub_u32 m0, s9, 25600
    s_nop 0
    buffer_load_dwordx4 v2, s[36:39], s10 offen sc1 lds
    s_add_u32 s10, s8, 32768
    s_sub_u32 m0, s9, 24576
    s_nop 0
    buffer_load_dwordx4 v2, s[36:39], s10 offen sc1 lds
    s_add_u32 s10, s8, 33792
    s_sub_u32 m0, s9, 23552
    s_nop 0
    buffer_load_dwordx4 v2, s[36:39], s10 offen sc1 lds
    s_add_u32 s10, s8, 34816
    s_sub_u32 m0, s9, 22528
    s_nop 0
    buffer_load_dwordx4 v2, s[36:39], s10 offen sc1 lds
Lp1_64:
    v_min_u32 v17, 4, v1
    v_max_u32 v17, 2, v17
    v_lshlrev_b32 v17, 9, v17
    s_mul_i32 s79, s61, 20
    s_add_u32 s79, s79, s6
    s_lshl_b32 s79, s79, 7
    s_add_u32 s79, s79, 6619136
    buffer_load_dword v21, v17, s[36:39], s79 offen sc1
    s_waitcnt vmcnt(0)
    v_cmp_ne_u32 vcc, v21, v14
    s_cbranch_vccz Lpd_67
    s_mov_b32 s96, 0
Lps_68x:
    buffer_load_dword v21, v17, s[36:39], s79 offen sc1
    s_waitcnt vmcnt(0)
    v_cmp_ne_u32 vcc, v21, v14
    s_cbranch_vccz Lpd_67
    s_sleep 2
    s_add_u32 s96, s96, 1
    s_cmp_lt_u32 s96, 100000
    s_cbranch_scc1 Lps_68x
Lpd_67:
    s_add_u32 s10, s8, 57344
    s_sub_u32 m0, s9, 57344
    s_nop 0
    buffer_load_dwordx4 v2, s[36:39], s10 offen sc1 lds
    s_add_u32 s10, s8, 58368
    s_sub_u32 m0, s9, 56320
    s_nop 0
    buffer_load_dwordx4 v2, s[36:39], s10 offen sc1 lds
    s_add_u32 s10, s8, 59392
    s_sub_u32 m0, s9, 55296
    s_nop 0
    buffer_load_dwordx4 v2, s[36:39], s10 offen sc1 lds
    s_add_u32 s10, s8, 60416
    s_sub_u32 m0, s9, 54272
    s_nop 0
    buffer_load_dwordx4 v2, s[36:39], s10 offen sc1 lds
    s_add_u32 s10, s8, 61440
    s_sub_u32 m0, s9, 53248
    s_nop 0
    buffer_load_dwordx4 v2, s[36:39], s10 offen sc1 lds
    s_add_u32 s10, s8, 62464
    s_sub_u32 m0, s9, 52224
    s_nop 0
    buffer_load_dwordx4 v2, s[36:39], s10 offen sc1 lds
    s_add_u32 s10, s8, 63488
    s_sub_u32 m0, s9, 51200
    s_nop 0
    buffer_load_dwordx4 v2, s[36:39], s10 offen sc1 lds
    s_add_u32 s10, s8, 86016
    s_sub_u32 m0, s9, 86016
    s_nop 0
    buffer_load_dwordx4 v2, s[36:39], s10 offen sc1 lds
    s_add_u32 s10, s8, 87040
    s_sub_u32 m0, s9, 84992
    s_nop 0
    buffer_load_dwordx4 v2, s[36:39], s10 offen sc1 lds
    s_add_u32 s10, s8, 88064
    s_sub_u32 m0, s9, 83968
    s_nop 0
    buffer_load_dwordx4 v2, s[36:39], s10 offen sc1 lds
    s_add_u32 s10, s8, 89088
    s_sub_u32 m0, s9, 82944
    s_nop 0
    buffer_load_dwordx4 v2, s[36:39], s10 offen sc1 lds
    s_add_u32 s10, s8, 90112
    s_sub_u32 m0, s9, 81920
    s_nop 0
    buffer_load_dwordx4 v2, s[36:39], s10 offen sc1 lds
    s_add_u32 s10, s8, 91136
    s_sub_u32 m0, s9, 80896
    s_nop 0
    buffer_load_dwordx4 v2, s[36:39], s10 offen sc1 lds
    s_add_u32 s10, s8, 92160
    s_sub_u32 m0, s9, 79872
    s_nop 0
    buffer_load_dwordx4 v2, s[36:39], s10 offen sc1 lds
    s_add_u32 s10, s8, 114688
    s_sub_u32 m0, s9, 114688
    s_nop 0
    buffer_load_dwordx4 v2, s[36:39], s10 offen sc1 lds
    s_add_u32 s10, s8, 115712
    s_sub_u32 m0, s9, 113664
    s_nop 0
    buffer_load_dwordx4 v2, s[36:39], s10 offen sc1 lds
    s_add_u32 s10, s8, 116736
    s_sub_u32 m0, s9, 112640
    s_nop 0
    buffer_load_dwordx4 v2, s[36:39], s10 offen sc1 lds
    s_add_u32 s10, s8, 117760
    s_sub_u32 m0, s9, 111616
    s_nop 0
    buffer_load_dwordx4 v2, s[36:39], s10 offen sc1 lds
    s_add_u32 s10, s8, 118784
    s_sub_u32 m0, s9, 110592
    s_nop 0
    buffer_load_dwordx4 v2, s[36:39], s10 offen sc1 lds
    s_add_u32 s10, s8, 119808
    s_sub_u32 m0, s9, 109568
    s_nop 0
    buffer_load_dwordx4 v2, s[36:39], s10 offen sc1 lds
    s_add_u32 s10, s8, 120832
    s_sub_u32 m0, s9, 108544
    s_nop 0
    buffer_load_dwordx4 v2, s[36:39], s10 offen sc1 lds
    s_cmp_ge_u32 s5, 24
    s_cbranch_scc1 L_nocs
    s_mul_i32 s72, s6, 35840
    v_add_u32 v20, s72, v2
    v_mov_b32 v24, 0x3f803f80
    v_mov_b32 v25, 0x3f803f80
    v_mov_b32 v26, 0x3f803f80
    v_mov_b32 v27, 0x3f803f80
    s_waitcnt vmcnt(0) lgkmcnt(0)
    s_barrier
    ds_read_b128 v[64:67], v20 offset:0
    ds_read_b128 v[68:71], v20 offset:1024
    ds_read_b128 v[72:75], v20 offset:2048
    ds_read_b128 v[76:79], v20 offset:3072
    ds_read_b128 v[80:83], v20 offset:4096
    ds_read_b128 v[84:87], v20 offset:5120
    ds_read_b128 v[88:91], v20 offset:6144
    s_waitcnt lgkmcnt(6)
    v_mfma_f32_16x16x32_bf16 v[32:35], v[64:67], v[24:27], 0
    s_waitcnt lgkmcnt(5)
    v_mfma_f32_16x16x32_bf16 v[36:39], v[68:71], v[24:27], 0
    s_waitcnt lgkmcnt(4)
    v_mfma_f32_16x16x32_bf16 v[40:43], v[72:75], v[24:27], 0
    s_waitcnt lgkmcnt(3)
    v_mfma_f32_16x16x32_bf16 v[44:47], v[76:79], v[24:27], 0
    s_waitcnt lgkmcnt(2)
    v_mfma_f32_16x16x32_bf16 v[48:51], v[80:83], v[24:27], 0
    s_waitcnt lgkmcnt(1)
    v_mfma_f32_16x16x32_bf16 v[52:55], v[84:87], v[24:27], 0
    s_waitcnt lgkmcnt(0)
    v_mfma_f32_16x16x32_bf16 v[56:59], v[88:91], v[24:27], 0
    ds_read_b128 v[64:67], v20 offset:7168
    ds_read_b128 v[68:71], v20 offset:8192
    ds_read_b128 v[72:75], v20 offset:9216
    ds_read_b128 v[76:79], v20 offset:10240
    ds_read_b128 v[80:83], v20 offset:11264
    ds_read_b128 v[84:87], v20 offset:12288
    ds_read_b128 v[88:91], v20 offset:13312
    s_waitcnt lgkmcnt(6)
    v_mfma_f32_16x16x32_bf16 v[32:35], v[64:67], v[24:27], v[32:35]
    s_waitcnt lgkmcnt(5)
    v_mfma_f32_16x16x32_bf16 v[36:39], v[68:71], v[24:27], v[36:39]
    s_waitcnt lgkmcnt(4)
    v_mfma_f32_16x16x32_bf16 v[40:43], v[72:75], v[24:27], v[40:43]
    s_waitcnt lgkmcnt(3)
    v_mfma_f32_16x16x32_bf16 v[44:47], v[76:79], v[24:27], v[44:47]
    s_waitcnt lgkmcnt(2)
    v_mfma_f32_16x16x32_bf16 v[48:51], v[80:83], v[24:27], v[48:51]
    s_waitcnt lgkmcnt(1)
    v_mfma_f32_16x16x32_bf16 v[52:55], v[84:87], v[24:27], v[52:55]
    s_waitcnt lgkmcnt(0)
    v_mfma_f32_16x16x32_bf16 v[56:59], v[88:91], v[24:27], v[56:59]
    ds_read_b128 v[64:67], v20 offset:14336
    ds_read_b128 v[68:71], v20 offset:15360
    ds_read_b128 v[72:75], v20 offset:16384
    ds_read_b128 v[76:79], v20 offset:17408
    ds_read_b128 v[80:83], v20 offset:18432
    ds_read_b128 v[84:87], v20 offset:19456
    ds_read_b128 v[88:91], v20 offset:20480
    s_waitcnt lgkmcnt(6)
    v_mfma_f32_16x16x32_bf16 v[32:35], v[64:67], v[24:27], v[32:35]
    s_waitcnt lgkmcnt(5)
    v_mfma_f32_16x16x32_bf16 v[36:39], v[68:71], v[24:27], v[36:39]
    s_waitcnt lgkmcnt(4)
    v_mfma_f32_16x16x32_bf16 v[40:43], v[72:75], v[24:27], v[40:43]
    s_waitcnt lgkmcnt(3)
    v_mfma_f32_16x16x32_bf16 v[44:47], v[76:79], v[24:27], v[44:47]
    s_waitcnt lgkmcnt(2)
    v_mfma_f32_16x16x32_bf16 v[48:51], v[80:83], v[24:27], v[48:51]
    s_waitcnt lgkmcnt(1)
    v_mfma_f32_16x16x32_bf16 v[52:55], v[84:87], v[24:27], v[52:55]
    s_waitcnt lgkmcnt(0)
    v_mfma_f32_16x16x32_bf16 v[56:59], v[88:91], v[24:27], v[56:59]
    ds_read_b128 v[64:67], v20 offset:21504
    ds_read_b128 v[68:71], v20 offset:22528
    ds_read_b128 v[72:75], v20 offset:23552
    ds_read_b128 v[76:79], v20 offset:24576
    ds_read_b128 v[80:83], v20 offset:25600
    ds_read_b128 v[84:87], v20 offset:26624
    ds_read_b128 v[88:91], v20 offset:27648
    s_waitcnt lgkmcnt(6)
    v_mfma_f32_16x16x32_bf16 v[32:35], v[64:67], v[24:27], v[32:35]
    s_waitcnt lgkmcnt(5)
    v_mfma_f32_16x16x32_bf16 v[36:39], v[68:71], v[24:27], v[36:39]
    s_waitcnt lgkmcnt(4)
    v_mfma_f32_16x16x32_bf16 v[40:43], v[72:75], v[24:27], v[40:43]
    s_waitcnt lgkmcnt(3)
    v_mfma_f32_16x16x32_bf16 v[44:47], v[76:79], v[24:27], v[44:47]
    s_waitcnt lgkmcnt(2)
    v_mfma_f32_16x16x32_bf16 v[48:51], v[80:83], v[24:27], v[48:51]
    s_waitcnt lgkmcnt(1)
    v_mfma_f32_16x16x32_bf16 v[52:55], v[84:87], v[24:27], v[52:55]
    s_waitcnt lgkmcnt(0)
    v_mfma_f32_16x16x32_bf16 v[56:59], v[88:91], v[24:27], v[56:59]
    ds_read_b128 v[64:67], v20 offset:28672
    ds_read_b128 v[68:71], v20 offset:29696
    ds_read_b128 v[72:75], v20 offset:30720
    ds_read_b128 v[76:79], v20 offset:31744
    ds_read_b128 v[80:83], v20 offset:32768
    ds_read_b128 v[84:87], v20 offset:33792
    ds_read_b128 v[88:91], v20 offset:34816
    s_waitcnt lgkmcnt(6)
    v_mfma_f32_16x16x32_bf16 v[32:35], v[64:67], v[24:27], v[32:35]
    s_waitcnt lgkmcnt(5)
    v_mfma_f32_16x16x32_bf16 v[36:39], v[68:71], v[24:27], v[36:39]
    s_waitcnt lgkmcnt(4)
    v_mfma_f32_16x16x32_bf16 v[40:43], v[72:75], v[24:27], v[40:43]
    s_waitcnt lgkmcnt(3)
    v_mfma_f32_16x16x32_bf16 v[44:47], v[76:79], v[24:27], v[44:47]
    s_waitcnt lgkmcnt(2)
    v_mfma_f32_16x16x32_bf16 v[48:51], v[80:83], v[24:27], v[48:51]
    s_waitcnt lgkmcnt(1)
    v_mfma_f32_16x16x32_bf16 v[52:55], v[84:87], v[24:27], v[52:55]
    s_waitcnt lgkmcnt(0)
    v_mfma_f32_16x16x32_bf16 v[56:59], v[88:91], v[24:27], v[56:59]
    s_lshl_b32 s72, s6, 9
    s_add_u32 s72, s72, 143360
    v_lshl_add_u32 v21, v4, 4, s72
    s_mov_b32 exec_lo, 0x00010001
    s_mov_b32 exec_hi, 0x00010001
    ds_write_b128 v21, v[32:35] offset:0
    ds_write_b128 v21, v[36:39] offset:64
    ds_write_b128 v21, v[40:43] offset:128
    ds_write_b128 v21, v[44:47] offset:192
    ds_write_b128 v21, v[48:51] offset:256
    ds_write_b128 v21, v[52:55] offset:320
    ds_write_b128 v21, v[56:59] offset:384
    s_mov_b64 exec, -1
    s_waitcnt lgkmcnt(0)
    s_barrier
    v_lshlrev_b32 v21, 3, v1
    v_add_u32 v22, 143360, v21
    ds_read_b64 v[32:33], v22 offset:0
    ds_read_b64 v[34:35], v22 offset:512
    ds_read_b64 v[36:37], v22 offset:1024
    ds_read_b64 v[38:39], v22 offset:1536
    s_waitcnt lgkmcnt(0)
    v_pk_add_f32 v[32:33], v[32:33], v[34:35]
    v_pk_add_f32 v[36:37], v[36:37], v[38:39]
    v_pk_add_f32 v[32:33], v[32:33], v[36:37]
    s_lshl_b32 s72, s61, 9
    s_add_u32 s72, s72, 5373952
    buffer_store_dwordx2 v[32:33], v21, s[36:39], s72 offen sc1
    s_lshl_b32 s72, s61, 7
    s_add_u32 s72, s72, 6586368
    s_waitcnt vmcnt(0)
    s_barrier
    s_cmp_lg_u32 s6, 0
    s_cbranch_scc1 Lsig_69
    s_mov_b64 exec, 1
    buffer_store_dword v14, off, s[36:39], s72 sc1
    s_mov_b64 exec, -1
Lsig_69:
L_nocs:
    v_min_u32 v19, 7, v1
    v_lshlrev_b32 v19, 7, v19
    s_lshr_b32 s70, s63, 2
    s_lshl_b32 s70, s70, 12
    s_lshl_b32 s71, s6, 10
    s_add_u32 s70, s70, s71
    s_add_u32 s70, s70, 6569984
    s_add_u32 s72, s2, s6
    s_cmp_lg_u32 s72, 258
    s_cbranch_scc1 L_noep
    v_lshlrev_b32 v104, 7, v1
    s_mov_b32 s96, 0
Lep_70:
    s_mov_b32 s72, 6291456
    buffer_load_dword v108, v104, s[36:39], s72 offen sc1
    s_mov_b32 s72, 6299648
    buffer_load_dword v109, v104, s[36:39], s72 offen sc1
    s_mov_b32 s72, 6307840
    buffer_load_dword v110, v104, s[36:39], s72 offen sc1
    s_mov_b32 s72, 6316032
    buffer_load_dword v111, v104, s[36:39], s72 offen sc1
    s_waitcnt vmcnt(0)
    v_subrev_u32 v108, s97, v108
    v_add_u32 v108, -1, v108
    v_subrev_u32 v109, s97, v109
    v_add_u32 v109, -1, v109
    v_subrev_u32 v110, s97, v110
    v_add_u32 v110, -1, v110
    v_subrev_u32 v111, s97, v111
    v_add_u32 v111, -1, v111
    v_max3_u32 v108, v108, v109, v110
    v_max_u32 v108, v108, v111
    v_cmp_lt_u32 vcc, 15, v108
    s_cbranch_vccz Lepd_71
    s_add_u32 s96, s96, 1
    s_cmp_lt_u32 s96, 100000
    s_cbranch_scc1 Lep_70
Lepd_71:
    s_mov_b32 s72, 6602752
    s_mov_b64 exec, 1
    buffer_store_dword v14, off, s[36:39], s72 sc1
    s_mov_b64 exec, -1
L_noep:
    s_sub_u32 s70, s5, 20
    s_lshl_b32 s7, s70, 2
    s_add_u32 s7, s7, s6
    s_mul_i32 s7, s7, 384
    v_lshl_add_u32 v40, v1, 7, s7
    v_min_u32 v40, L_join-L_g1h, v40
    v_add_u32 v40, L_g1h-Lpf_72, v40
    s_getpc_b64 s[12:13]
Lpf_72:
    s_mov_b64 exec, 7
    global_load_dword v5, v40, s[12:13]
    s_mov_b64 exec, -1
    v_min_u32 v46, 31, v1
    v_lshlrev_b32 v46, 7, v46
    s_lshl_b32 s11, s4, 12
    s_add_u32 s11, s11, 6291456
    buffer_load_dword v44, v46, s[36:39], s11 offen sc1
    v_min_u32 v20, 39, v1
    v_lshlrev_b32 v20, 7, v20
    s_mov_b32 s96, 0
Lpoll_74:
    buffer_load_dword v228, v20, s[36:39], s65 offen sc1
    s_waitcnt vmcnt(0)
    v_cmp_ne_u32 vcc, v228, v14
    s_cbranch_vccz Lpd_73
    s_sleep 2
    s_add_u32 s96, s96, 1
    s_cmp_lt_u32 s96, 100000
    s_cbranch_scc1 Lpoll_74
Lpd_73:
    v_subrev_u32 v45, s97, v44
    v_add_u32 v45, -1, v45
    v_cmp_lt_u32 vcc, 15, v45
    s_cbranch_vccnz Lxc_75
Lxd_76:
    v_cmp_ne_u32 vcc, s31, v44
    s_nop 0
    s_cmp_eq_u64 vcc, 0
    s_cselect_b32 s30, 1, 0
    s_barrier
    s_add_u32 s88, s90, 15728640
    buffer_load_dwordx4 v[140:143], v6, s[36:39], s88 offen offset:0 sc1
    buffer_load_dwordx4 v[144:147], v6, s[36:39], s88 offen offset:256 sc1
    buffer_load_dwordx4 v[148:151], v6, s[36:39], s88 offen offset:2048 sc1
    buffer_load_dwordx4 v[152:155], v6, s[36:39], s88 offen offset:2304 sc1
    s_add_u32 s88, s90, 15732736
    buffer_load_dwordx4 v[156:159], v6, s[36:39], s88 offen offset:0 sc1
    buffer_load_dwordx4 v[160:163], v6, s[36:39], s88 offen offset:256 sc1
    buffer_load_dwordx4 v[164:167], v6, s[36:39], s88 offen offset:2048 sc1
    buffer_load_dwordx4 v[168:171], v6, s[36:39], s88 offen offset:2304 sc1
    s_add_u32 s88, s90, 15736832
    buffer_load_dwordx4 v[172:175], v6, s[36:39], s88 offen offset:0 sc1
    buffer_load_dwordx4 v[176:179], v6, s[36:39], s88 offen offset:256 sc1
    buffer_load_dwordx4 v[180:183], v6, s[36:39], s88 offen offset:2048 sc1
    buffer_load_dwordx4 v[184:187], v6, s[36:39], s88 offen offset:2304 sc1
    s_add_u32 s88, s90, 15740928
    buffer_load_dwordx4 v[188:191], v6, s[36:39], s88 offen offset:0 sc1
    buffer_load_dwordx4 v[192:195], v6, s[36:39], s88 offen offset:256 sc1
    buffer_load_dwordx4 v[196:199], v6, s[36:39], s88 offen offset:2048 sc1
    buffer_load_dwordx4 v[200:203], v6, s[36:39], s88 offen offset:2304 sc1
L_g1h:
    ds_read_b128 v[112:115], v8 offset:21504
    ds_read_b128 v[116:119], v8 offset:22528
    ds_read_b128 v[120:123], v8 offset:23552
    ds_read_b128 v[124:127], v8 offset:24576
    ds_read_b128 v[128:131], v8 offset:25600
    ds_read_b128 v[132:135], v8 offset:26624
    ds_read_b128 v[136:139], v8 offset:27648
    s_waitcnt vmcnt(14)
    v_swap_b32 v142, v144
    v_swap_b32 v143, v145
    s_waitcnt lgkmcnt(5)
    s_nop 0
    v_mfma_f32_16x16x32_bf16 v[48:51], v[112:115], v[140:143], 0
    s_add_u32 s88, s90, 15745024
    buffer_load_dwordx4 v[204:207], v6, s[36:39], s88 offen offset:0 sc1
    v_mfma_f32_16x16x32_bf16 v[76:79], v[112:115], v[144:147], 0
    ds_read_b128 v[112:115], v8 offset:14336
    v_mfma_f32_16x16x32_bf16 v[52:55], v[116:119], v[140:143], 0
    buffer_load_dwordx4 v[208:211], v6, s[36:39], s88 offen offset:256 sc1
    v_mfma_f32_16x16x32_bf16 v[80:83], v[116:119], v[144:147], 0
    ds_read_b128 v[116:119], v8 offset:15360
    s_waitcnt lgkmcnt(5)
    v_mfma_f32_16x16x32_bf16 v[56:59], v[120:123], v[140:143], 0
    buffer_load_dwordx4 v[212:215], v6, s[36:39], s88 offen offset:2048 sc1
    v_mfma_f32_16x16x32_bf16 v[84:87], v[120:123], v[144:147], 0
    ds_read_b128 v[120:123], v8 offset:16384
    v_mfma_f32_16x16x32_bf16 v[60:63], v[124:127], v[140:143], 0
    buffer_load_dwordx4 v[216:219], v6, s[36:39], s88 offen offset:2304 sc1
    s_waitcnt vmcnt(16)
    v_mfma_f32_16x16x32_bf16 v[88:91], v[124:127], v[144:147], 0
    ds_read_b128 v[124:127], v8 offset:17408
    s_waitcnt lgkmcnt(5)
    v_mfma_f32_16x16x32_bf16 v[64:67], v[128:131], v[140:143], 0
    v_swap_b32 v150, v152
    v_mfma_f32_16x16x32_bf16 v[92:95], v[128:131], v[144:147], 0
    ds_read_b128 v[128:131], v8 offset:18432
    v_mfma_f32_16x16x32_bf16 v[68:71], v[132:135], v[140:143], 0
    v_swap_b32 v151, v153
    v_mfma_f32_16x16x32_bf16 v[96:99], v[132:135], v[144:147], 0
    ds_read_b128 v[132:135], v8 offset:19456
    s_waitcnt lgkmcnt(6)
    v_mfma_f32_16x16x32_bf16 v[72:75], v[136:139], v[140:143], 0
    v_mfma_f32_16x16x32_bf16 v[100:103], v[136:139], v[144:147], 0
    ds_read_b128 v[136:139], v8 offset:20480
    s_waitcnt lgkmcnt(5)
    v_mfma_f32_16x16x32_bf16 v[48:51], v[112:115], v[148:151], v[48:51]
    s_add_u32 s88, s90, 15749120
    buffer_load_dwordx4 v[220:223], v6, s[36:39], s88 offen offset:0 sc1
    v_mfma_f32_16x16x32_bf16 v[76:79], v[112:115], v[152:155], v[76:79]
    ds_read_b128 v[112:115], v8 offset:7168
    v_mfma_f32_16x16x32_bf16 v[52:55], v[116:119], v[148:151], v[52:55]
    buffer_load_dwordx4 v[224:227], v6, s[36:39], s88 offen offset:256 sc1
    v_mfma_f32_16x16x32_bf16 v[80:83], v[116:119], v[152:155], v[80:83]
    ds_read_b128 v[116:119], v8 offset:8192
    s_waitcnt lgkmcnt(5)
    v_mfma_f32_16x16x32_bf16 v[56:59], v[120:123], v[148:151], v[56:59]
    buffer_load_dwordx4 v[140:143], v6, s[36:39], s88 offen offset:2048 sc1
    v_mfma_f32_16x16x32_bf16 v[84:87], v[120:123], v[152:155], v[84:87]
    ds_read_b128 v[120:123], v8 offset:9216
    v_mfma_f32_16x16x32_bf16 v[60:63], v[124:127], v[148:151], v[60:63]
    buffer_load_dwordx4 v[144:147], v6, s[36:39], s88 offen offset:2304 sc1
    s_waitcnt vmcnt(18)
    v_mfma_f32_16x16x32_bf16 v[88:91], v[124:127], v[152:155], v[88:91]
    ds_read_b128 v[124:127], v8 offset:10240
    s_waitcnt lgkmcnt(5)
    v_mfma_f32_16x16x32_bf16 v[64:67], v[128:131], v[148:151], v[64:67]
    v_swap_b32 v158, v160
    v_mfma_f32_16x16x32_bf16 v[92:95], v[128:131], v[152:155], v[92:95]
    ds_read_b128 v[128:131], v8 offset:11264
    v_mfma_f32_16x16x32_bf16 v[68:71], v[132:135], v[148:151], v[68:71]
    v_swap_b32 v159, v161
    v_mfma_f32_16x16x32_bf16 v[96:99], v[132:135], v[152:155], v[96:99]
    ds_read_b128 v[132:135], v8 offset:12288
    s_waitcnt lgkmcnt(6)
    v_mfma_f32_16x16x32_bf16 v[72:75], v[136:139], v[148:151], v[72:75]
    s_lshr_b32 s79, s63, 2
    s_lshl_b32 s79, s79, 12
    v_mfma_f32_16x16x32_bf16 v[100:103], v[136:139], v[152:155], v[100:103]
    ds_read_b128 v[136:139], v8 offset:13312
    s_waitcnt lgkmcnt(5)
    v_mfma_f32_16x16x32_bf16 v[48:51], v[112:115], v[156:159], v[48:51]
    s_add_u32 s88, s90, 15753216
    buffer_load_dwordx4 v[148:151], v6, s[36:39], s88 offen offset:0 sc1
    s_lshl_b32 s71, s6, 10
    v_mfma_f32_16x16x32_bf16 v[76:79], v[112:115], v[160:163], v[76:79]
    ds_read_b128 v[112:115], v8 offset:0
    s_add_u32 s79, s79, s71
    v_mfma_f32_16x16x32_bf16 v[52:55], v[116:119], v[156:159], v[52:55]
    buffer_load_dwordx4 v[152:155], v6, s[36:39], s88 offen offset:256 sc1
    v_min_u32 v23, 7, v1
    v_mfma_f32_16x16x32_bf16 v[80:83], v[116:119], v[160:163], v[80:83]
    ds_read_b128 v[116:119], v8 offset:1024
    s_waitcnt lgkmcnt(5)
    v_mfma_f32_16x16x32_bf16 v[56:59], v[120:123], v[156:159], v[56:59]
    v_lshlrev_b32 v23, 7, v23
    s_add_u32 s79, s79, 6569984
    v_mfma_f32_16x16x32_bf16 v[84:87], v[120:123], v[160:163], v[84:87]
    ds_read_b128 v[120:123], v8 offset:2048
    buffer_load_dword v22, v23, s[36:39], s79 offen sc1
    v_mfma_f32_16x16x32_bf16 v[60:63], v[124:127], v[156:159], v[60:63]
    s_waitcnt vmcnt(19)
    v_mfma_f32_16x16x32_bf16 v[88:91], v[124:127], v[160:163], v[88:91]
    ds_read_b128 v[124:127], v8 offset:3072
    s_waitcnt lgkmcnt(5)
    v_mfma_f32_16x16x32_bf16 v[64:67], v[128:131], v[156:159], v[64:67]
    v_swap_b32 v166, v168
    v_mfma_f32_16x16x32_bf16 v[92:95], v[128:131], v[160:163], v[92:95]
    ds_read_b128 v[128:131], v8 offset:4096
    v_mfma_f32_16x16x32_bf16 v[68:71], v[132:135], v[156:159], v[68:71]
    v_swap_b32 v167, v169
    v_mfma_f32_16x16x32_bf16 v[96:99], v[132:135], v[160:163], v[96:99]
    ds_read_b128 v[132:135], v8 offset:5120
    s_waitcnt lgkmcnt(6)
    v_mfma_f32_16x16x32_bf16 v[72:75], v[136:139], v[156:159], v[72:75]
    v_mfma_f32_16x16x32_bf16 v[100:103], v[136:139], v[160:163], v[100:103]
    ds_read_b128 v[136:139], v8 offset:6144
    s_waitcnt lgkmcnt(5)
    v_mfma_f32_16x16x32_bf16 v[48:51], v[112:115], v[164:167], v[48:51]
    buffer_load_dwordx4 v[156:159], v6, s[36:39], s88 offen offset:2048 sc1
    v_mfma_f32_16x16x32_bf16 v[76:79], v[112:115], v[168:171], v[76:79]
    ds_read_b128 v[112:115], v7 offset:50176
    v_mfma_f32_16x16x32_bf16 v[52:55], v[116:119], v[164:167], v[52:55]
    buffer_load_dwordx4 v[160:163], v6, s[36:39], s88 offen offset:2304 sc1
    v_mfma_f32_16x16x32_bf16 v[80:83], v[116:119], v[168:171], v[80:83]
    ds_read_b128 v[116:119], v7 offset:51200
    s_waitcnt lgkmcnt(5)
    v_mfma_f32_16x16x32_bf16 v[56:59], v[120:123], v[164:167], v[56:59]
    v_mfma_f32_16x16x32_bf16 v[84:87], v[120:123], v[168:171], v[84:87]
    ds_read_b128 v[120:123], v7 offset:52224
    v_mfma_f32_16x16x32_bf16 v[60:63], v[124:127], v[164:167], v[60:63]
    s_waitcnt vmcnt(19)
    v_mfma_f32_16x16x32_bf16 v[88:91], v[124:127], v[168:171], v[88:91]
    ds_read_b128 v[124:127], v7 offset:53248
    s_waitcnt lgkmcnt(5)
    v_mfma_f32_16x16x32_bf16 v[64:67], v[128:131], v[164:167], v[64:67]
    v_swap_b32 v174, v176
    v_mfma_f32_16x16x32_bf16 v[92:95], v[128:131], v[168:171], v[92:95]
    ds_read_b128 v[128:131], v7 offset:54272
    v_mfma_f32_16x16x32_bf16 v[68:71], v[132:135], v[164:167], v[68:71]
    v_swap_b32 v175, v177
    v_mfma_f32_16x16x32_bf16 v[96:99], v[132:135], v[168:171], v[96:99]
    ds_read_b128 v[132:135], v7 offset:55296
    s_waitcnt lgkmcnt(6)
    v_mfma_f32_16x16x32_bf16 v[72:75], v[136:139], v[164:167], v[72:75]
    v_mfma_f32_16x16x32_bf16 v[100:103], v[136:139], v[168:171], v[100:103]
    ds_read_b128 v[136:139], v7 offset:56320
    s_waitcnt lgkmcnt(5)
    v_mfma_f32_16x16x32_bf16 v[48:51], v[112:115], v[172:175], v[48:51]
    s_add_u32 s88, s90, 15757312
    buffer_load_dwordx4 v[164:167], v6, s[36:39], s88 offen offset:0 sc1
    v_mfma_f32_16x16x32_bf16 v[76:79], v[112:115], v[176:179], v[76:79]
    ds_read_b128 v[112:115], v7 offset:43008
    v_mfma_f32_16x16x32_bf16 v[52:55], v[116:119], v[172:175], v[52:55]
    buffer_load_dwordx4 v[168:171], v6, s[36:39], s88 offen offset:256 sc1
    v_mfma_f32_16x16x32_bf16 v[80:83], v[116:119], v[176:179], v[80:83]
    ds_read_b128 v[116:119], v7 offset:44032
    s_waitcnt lgkmcnt(5)
    v_mfma_f32_16x16x32_bf16 v[56:59], v[120:123], v[172:175], v[56:59]
    v_mfma_f32_16x16x32_bf16 v[84:87], v[120:123], v[176:179], v[84:87]
    ds_read_b128 v[120:123], v7 offset:45056
    v_mfma_f32_16x16x32_bf16 v[60:63], v[124:127], v[172:175], v[60:63]
    s_waitcnt vmcnt(19)
    v_mfma_f32_16x16x32_bf16 v[88:91], v[124:127], v[176:179], v[88:91]
    ds_read_b128 v[124:127], v7 offset:46080
    s_waitcnt lgkmcnt(5)
    v_mfma_f32_16x16x32_bf16 v[64:67], v[128:131], v[172:175], v[64:67]
    v_swap_b32 v182, v184
    v_mfma_f32_16x16x32_bf16 v[92:95], v[128:131], v[176:179], v[92:95]
    ds_read_b128 v[128:131], v7 offset:47104
    v_mfma_f32_16x16x32_bf16 v[68:71], v[132:135], v[172:175], v[68:71]
    v_swap_b32 v183, v185
    v_mfma_f32_16x16x32_bf16 v[96:99], v[132:135], v[176:179], v[96:99]
    ds_read_b128 v[132:135], v7 offset:48128
    s_waitcnt lgkmcnt(6)
    v_mfma_f32_16x16x32_bf16 v[72:75], v[136:139], v[172:175], v[72:75]
    v_mfma_f32_16x16x32_bf16 v[100:103], v[136:139], v[176:179], v[100:103]
    ds_read_b128 v[136:139], v7 offset:49152
    s_waitcnt lgkmcnt(5)
    v_mfma_f32_16x16x32_bf16 v[48:51], v[112:115], v[180:183], v[48:51]
    buffer_load_dwordx4 v[172:175], v6, s[36:39], s88 offen offset:2048 sc1
    v_mfma_f32_16x16x32_bf16 v[76:79], v[112:115], v[184:187], v[76:79]
    ds_read_b128 v[112:115], v7 offset:35840
    v_mfma_f32_16x16x32_bf16 v[52:55], v[116:119], v[180:183], v[52:55]
    buffer_load_dwordx4 v[176:179], v6, s[36:39], s88 offen offset:2304 sc1
    v_mfma_f32_16x16x32_bf16 v[80:83], v[116:119], v[184:187], v[80:83]
    ds_read_b128 v[116:119], v7 offset:36864
    s_waitcnt lgkmcnt(5)
    v_mfma_f32_16x16x32_bf16 v[56:59], v[120:123], v[180:183], v[56:59]
    v_mfma_f32_16x16x32_bf16 v[84:87], v[120:123], v[184:187], v[84:87]
    ds_read_b128 v[120:123], v7 offset:37888
    v_mfma_f32_16x16x32_bf16 v[60:63], v[124:127], v[180:183], v[60:63]
    s_waitcnt vmcnt(19)
    v_mfma_f32_16x16x32_bf16 v[88:91], v[124:127], v[184:187], v[88:91]
    ds_read_b128 v[124:127], v7 offset:38912
    s_waitcnt lgkmcnt(5)
    v_mfma_f32_16x16x32_bf16 v[64:67], v[128:131], v[180:183], v[64:67]
    v_swap_b32 v190, v192
    v_mfma_f32_16x16x32_bf16 v[92:95], v[128:131], v[184:187], v[92:95]
    ds_read_b128 v[128:131], v7 offset:39936
    v_mfma_f32_16x16x32_bf16 v[68:71], v[132:135], v[180:183], v[68:71]
    v_swap_b32 v191, v193
    v_mfma_f32_16x16x32_bf16 v[96:99], v[132:135], v[184:187], v[96:99]
    ds_read_b128 v[132:135], v7 offset:40960
    s_waitcnt lgkmcnt(6)
    v_mfma_f32_16x16x32_bf16 v[72:75], v[136:139], v[180:183], v[72:75]
    v_mfma_f32_16x16x32_bf16 v[100:103], v[136:139], v[184:187], v[100:103]
    ds_read_b128 v[136:139], v7 offset:41984
    s_waitcnt lgkmcnt(5)
    v_mfma_f32_16x16x32_bf16 v[48:51], v[112:115], v[188:191], v[48:51]
    s_add_u32 s88, s90, 15761408
    buffer_load_dwordx4 v[180:183], v6, s[36:39], s88 offen offset:0 sc1
    v_mfma_f32_16x16x32_bf16 v[76:79], v[112:115], v[192:195], v[76:79]
    ds_read_b128 v[112:115], v7 offset:28672
    v_mfma_f32_16x16x32_bf16 v[52:55], v[116:119], v[188:191], v[52:55]
    buffer_load_dwordx4 v[184:187], v6, s[36:39], s88 offen offset:256 sc1
    v_mfma_f32_16x16x32_bf16 v[80:83], v[116:119], v[192:195], v[80:83]
    ds_read_b128 v[116:119], v7 offset:29696
    s_waitcnt lgkmcnt(5)
    v_mfma_f32_16x16x32_bf16 v[56:59], v[120:123], v[188:191], v[56:59]
    v_mfma_f32_16x16x32_bf16 v[84:87], v[120:123], v[192:195], v[84:87]
    ds_read_b128 v[120:123], v7 offset:30720
    v_mfma_f32_16x16x32_bf16 v[60:63], v[124:127], v[188:191], v[60:63]
    s_waitcnt vmcnt(19)
    v_mfma_f32_16x16x32_bf16 v[88:91], v[124:127], v[192:195], v[88:91]
    ds_read_b128 v[124:127], v7 offset:31744
    s_waitcnt lgkmcnt(5)
    v_mfma_f32_16x16x32_bf16 v[64:67], v[128:131], v[188:191], v[64:67]
    v_swap_b32 v198, v200
    v_mfma_f32_16x16x32_bf16 v[92:95], v[128:131], v[192:195], v[92:95]
    ds_read_b128 v[128:131], v7 offset:32768
    v_mfma_f32_16x16x32_bf16 v[68:71], v[132:135], v[188:191], v[68:71]
    v_swap_b32 v199, v201
    v_mfma_f32_16x16x32_bf16 v[96:99], v[132:135], v[192:195], v[96:99]
    ds_read_b128 v[132:135], v7 offset:33792
    s_waitcnt lgkmcnt(6)
    v_mfma_f32_16x16x32_bf16 v[72:75], v[136:139], v[188:191], v[72:75]
    v_mfma_f32_16x16x32_bf16 v[100:103], v[136:139], v[192:195], v[100:103]
    ds_read_b128 v[136:139], v7 offset:34816
    s_waitcnt lgkmcnt(5)
    v_mfma_f32_16x16x32_bf16 v[48:51], v[112:115], v[196:199], v[48:51]
    buffer_load_dwordx4 v[188:191], v6, s[36:39], s88 offen offset:2048 sc1
    v_mfma_f32_16x16x32_bf16 v[76:79], v[112:115], v[200:203], v[76:79]
    ds_read_b128 v[112:115], v7 offset:21504
    v_mfma_f32_16x16x32_bf16 v[52:55], v[116:119], v[196:199], v[52:55]
    buffer_load_dwordx4 v[192:195], v6, s[36:39], s88 offen offset:2304 sc1
    v_mfma_f32_16x16x32_bf16 v[80:83], v[116:119], v[200:203], v[80:83]
    ds_read_b128 v[116:119], v7 offset:22528
    s_waitcnt lgkmcnt(5)
    v_mfma_f32_16x16x32_bf16 v[56:59], v[120:123], v[196:199], v[56:59]
    s_waitcnt vmcnt(10)
    v_cmp_ne_u32 vcc, v22, v14
    s_cbranch_vccz Lpd_77
    s_mov_b32 s96, 0
Lps_78x:
    buffer_load_dword v22, v23, s[36:39], s79 offen sc1
    s_waitcnt vmcnt(0)
    v_cmp_ne_u32 vcc, v22, v14
    s_cbranch_vccz Lpd_77
    s_sleep 1
    s_add_u32 s96, s96, 1
    s_cmp_lt_u32 s96, 100000
    s_cbranch_scc1 Lps_78x
Lpd_77:
    v_mfma_f32_16x16x32_bf16 v[84:87], v[120:123], v[200:203], v[84:87]
    ds_read_b128 v[120:123], v7 offset:23552
    v_mfma_f32_16x16x32_bf16 v[60:63], v[124:127], v[196:199], v[60:63]
    s_add_u32 s93, s92, 13107200
    v_mfma_f32_16x16x32_bf16 v[88:91], v[124:127], v[200:203], v[88:91]
    ds_read_b128 v[124:127], v7 offset:24576
    s_waitcnt lgkmcnt(5)
    v_mfma_f32_16x16x32_bf16 v[64:67], v[128:131], v[196:199], v[64:67]
    v_swap_b32 v206, v208
    buffer_load_dwordx4 a[0:3], v2, s[36:39], s93 offen offset:0 sc1
    v_mfma_f32_16x16x32_bf16 v[92:95], v[128:131], v[200:203], v[92:95]
    ds_read_b128 v[128:131], v7 offset:25600
    v_mfma_f32_16x16x32_bf16 v[68:71], v[132:135], v[196:199], v[68:71]
    v_swap_b32 v207, v209
    buffer_load_dwordx4 a[4:7], v2, s[36:39], s93 offen offset:1024 sc1
    v_mfma_f32_16x16x32_bf16 v[96:99], v[132:135], v[200:203], v[96:99]
    ds_read_b128 v[132:135], v7 offset:26624
    s_waitcnt lgkmcnt(6)
    v_mfma_f32_16x16x32_bf16 v[72:75], v[136:139], v[196:199], v[72:75]
    v_mfma_f32_16x16x32_bf16 v[100:103], v[136:139], v[200:203], v[100:103]
    ds_read_b128 v[136:139], v7 offset:27648
    s_waitcnt lgkmcnt(5)
    v_mfma_f32_16x16x32_bf16 v[48:51], v[112:115], v[204:207], v[48:51]
    s_add_u32 s88, s90, 15765504
    buffer_load_dwordx4 v[196:199], v6, s[36:39], s88 offen offset:0 sc1
    buffer_load_dwordx4 a[8:11], v2, s[36:39], s93 offen offset:2048 sc1
    v_mfma_f32_16x16x32_bf16 v[76:79], v[112:115], v[208:211], v[76:79]
    ds_read_b128 v[112:115], v7 offset:14336
    v_mfma_f32_16x16x32_bf16 v[52:55], v[116:119], v[204:207], v[52:55]
    buffer_load_dwordx4 v[200:203], v6, s[36:39], s88 offen offset:256 sc1
    v_mfma_f32_16x16x32_bf16 v[80:83], v[116:119], v[208:211], v[80:83]
    ds_read_b128 v[116:119], v7 offset:15360
    s_waitcnt lgkmcnt(5)
    v_mfma_f32_16x16x32_bf16 v[56:59], v[120:123], v[204:207], v[56:59]
    buffer_load_dwordx4 a[12:15], v2, s[36:39], s93 offen offset:3072 sc1
    v_mfma_f32_16x16x32_bf16 v[84:87], v[120:123], v[208:211], v[84:87]
    ds_read_b128 v[120:123], v7 offset:16384
    v_mfma_f32_16x16x32_bf16 v[60:63], v[124:127], v[204:207], v[60:63]
    v_mfma_f32_16x16x32_bf16 v[88:91], v[124:127], v[208:211], v[88:91]
    ds_read_b128 v[124:127], v7 offset:17408
    s_waitcnt lgkmcnt(5)
    v_mfma_f32_16x16x32_bf16 v[64:67], v[128:131], v[204:207], v[64:67]
    v_swap_b32 v214, v216
    v_mfma_f32_16x16x32_bf16 v[92:95], v[128:131], v[208:211], v[92:95]
    ds_read_b128 v[128:131], v7 offset:18432
    v_mfma_f32_16x16x32_bf16 v[68:71], v[132:135], v[204:207], v[68:71]
    v_swap_b32 v215, v217
    s_lshl_b32 s70, s61, 7
    v_mfma_f32_16x16x32_bf16 v[96:99], v[132:135], v[208:211], v[96:99]
    ds_read_b128 v[132:135], v7 offset:19456
    s_waitcnt lgkmcnt(6)
    v_mfma_f32_16x16x32_bf16 v[72:75], v[136:139], v[204:207], v[72:75]
    v_min_u32 v21, 0, v1
    v_lshlrev_b32 v21, 7, v21
    v_mfma_f32_16x16x32_bf16 v[100:103], v[136:139], v[208:211], v[100:103]
    ds_read_b128 v[136:139], v7 offset:20480
    s_waitcnt lgkmcnt(5)
    v_mfma_f32_16x16x32_bf16 v[48:51], v[112:115], v[212:215], v[48:51]
    buffer_load_dwordx4 v[204:207], v6, s[36:39], s88 offen offset:2048 sc1
    s_add_u32 s70, s70, 6586368
    v_mfma_f32_16x16x32_bf16 v[76:79], v[112:115], v[216:219], v[76:79]
    ds_read_b128 v[112:115], v7 offset:7168
    buffer_load_dword v20, v21, s[36:39], s70 offen sc1
    v_mfma_f32_16x16x32_bf16 v[52:55], v[116:119], v[212:215], v[52:55]
    buffer_load_dwordx4 v[208:211], v6, s[36:39], s88 offen offset:2304 sc1
    v_mfma_f32_16x16x32_bf16 v[80:83], v[116:119], v[216:219], v[80:83]
    ds_read_b128 v[116:119], v7 offset:8192
    s_waitcnt lgkmcnt(5)
    v_mfma_f32_16x16x32_bf16 v[56:59], v[120:123], v[212:215], v[56:59]
    s_add_u32 s93, s92, 13111296
    buffer_load_dwordx4 a[16:19], v2, s[36:39], s93 offen offset:0 sc1
    v_mfma_f32_16x16x32_bf16 v[84:87], v[120:123], v[216:219], v[84:87]
    ds_read_b128 v[120:123], v7 offset:9216
    buffer_load_dwordx4 a[20:23], v2, s[36:39], s93 offen offset:1024 sc1
    v_mfma_f32_16x16x32_bf16 v[60:63], v[124:127], v[212:215], v[60:63]
    buffer_load_dwordx4 a[24:27], v2, s[36:39], s93 offen offset:2048 sc1
    v_mfma_f32_16x16x32_bf16 v[88:91], v[124:127], v[216:219], v[88:91]
    ds_read_b128 v[124:127], v7 offset:10240
    s_waitcnt lgkmcnt(5)
    v_mfma_f32_16x16x32_bf16 v[64:67], v[128:131], v[212:215], v[64:67]
    v_swap_b32 v222, v224
    v_mfma_f32_16x16x32_bf16 v[92:95], v[128:131], v[216:219], v[92:95]
    ds_read_b128 v[128:131], v7 offset:11264
    v_mfma_f32_16x16x32_bf16 v[68:71], v[132:135], v[212:215], v[68:71]
    v_swap_b32 v223, v225
    buffer_load_dwordx4 a[28:31], v2, s[36:39], s93 offen offset:3072 sc1
    v_mfma_f32_16x16x32_bf16 v[96:99], v[132:135], v[216:219], v[96:99]
    ds_read_b128 v[132:135], v7 offset:12288
    s_waitcnt lgkmcnt(6)
    v_mfma_f32_16x16x32_bf16 v[72:75], v[136:139], v[212:215], v[72:75]
    v_min_u32 v231, 39, v1
    v_lshlrev_b32 v231, 7, v231
    v_mfma_f32_16x16x32_bf16 v[100:103], v[136:139], v[216:219], v[100:103]
    ds_read_b128 v[136:139], v7 offset:13312
    s_waitcnt lgkmcnt(5)
    v_mfma_f32_16x16x32_bf16 v[48:51], v[112:115], v[220:223], v[48:51]
    s_add_u32 s75, s65, 98304
    buffer_load_dword v228, v231, s[36:39], s75 offen sc1
    v_mfma_f32_16x16x32_bf16 v[76:79], v[112:115], v[224:227], v[76:79]
    ds_read_b128 v[112:115], v7 offset:0
    v_mfma_f32_16x16x32_bf16 v[52:55], v[116:119], v[220:223], v[52:55]
    s_add_u32 s93, s92, 13115392
    buffer_load_dwordx4 a[32:35], v2, s[36:39], s93 offen offset:0 sc1
    v_mfma_f32_16x16x32_bf16 v[80:83], v[116:119], v[224:227], v[80:83]
    ds_read_b128 v[116:119], v7 offset:1024
    s_waitcnt lgkmcnt(5)
    v_mfma_f32_16x16x32_bf16 v[56:59], v[120:123], v[220:223], v[56:59]
    buffer_load_dwordx4 a[36:39], v2, s[36:39], s93 offen offset:1024 sc1
    v_mfma_f32_16x16x32_bf16 v[84:87], v[120:123], v[224:227], v[84:87]
    ds_read_b128 v[120:123], v7 offset:2048
    v_mfma_f32_16x16x32_bf16 v[60:63], v[124:127], v[220:223], v[60:63]
    v_mfma_f32_16x16x32_bf16 v[88:91], v[124:127], v[224:227], v[88:91]
    ds_read_b128 v[124:127], v7 offset:3072
    s_waitcnt lgkmcnt(5)
    v_mfma_f32_16x16x32_bf16 v[64:67], v[128:131], v[220:223], v[64:67]
    v_swap_b32 v142, v144
    v_mfma_f32_16x16x32_bf16 v[92:95], v[128:131], v[224:227], v[92:95]
    ds_read_b128 v[128:131], v7 offset:4096
    v_mfma_f32_16x16x32_bf16 v[68:71], v[132:135], v[220:223], v[68:71]
    v_swap_b32 v143, v145
    buffer_load_dwordx4 a[40:43], v2, s[36:39], s93 offen offset:2048 sc1
    v_mfma_f32_16x16x32_bf16 v[96:99], v[132:135], v[224:227], v[96:99]
    ds_read_b128 v[132:135], v7 offset:5120
    s_waitcnt lgkmcnt(6)
    v_mfma_f32_16x16x32_bf16 v[72:75], v[136:139], v[220:223], v[72:75]
    v_mfma_f32_16x16x32_bf16 v[100:103], v[136:139], v[224:227], v[100:103]
    ds_read_b128 v[136:139], v7 offset:6144
    s_waitcnt lgkmcnt(5)
    v_mfma_f32_16x16x32_bf16 v[48:51], v[112:115], v[140:143], v[48:51]
    buffer_load_dwordx4 a[44:47], v2, s[36:39], s93 offen offset:3072 sc1
    v_mfma_f32_16x16x32_bf16 v[76:79], v[112:115], v[144:147], v[76:79]
    ds_read_b128 v[112:115], v2 offset:50176
    v_mfma_f32_16x16x32_bf16 v[52:55], v[116:119], v[140:143], v[52:55]
    v_mfma_f32_16x16x32_bf16 v[80:83], v[116:119], v[144:147], v[80:83]
    ds_read_b128 v[116:119], v2 offset:51200
    s_waitcnt lgkmcnt(5)
    v_mfma_f32_16x16x32_bf16 v[56:59], v[120:123], v[140:143], v[56:59]
    s_add_u32 s93, s92, 13119488
    buffer_load_dwordx4 a[48:51], v2, s[36:39], s93 offen offset:0 sc1
    v_mfma_f32_16x16x32_bf16 v[84:87], v[120:123], v[144:147], v[84:87]
    ds_read_b128 v[120:123], v2 offset:52224
    v_mfma_f32_16x16x32_bf16 v[60:63], v[124:127], v[140:143], v[60:63]
    v_mfma_f32_16x16x32_bf16 v[88:91], v[124:127], v[144:147], v[88:91]
    ds_read_b128 v[124:127], v2 offset:53248
    s_waitcnt lgkmcnt(5)
    v_mfma_f32_16x16x32_bf16 v[64:67], v[128:131], v[140:143], v[64:67]
    v_swap_b32 v150, v152
    v_mfma_f32_16x16x32_bf16 v[92:95], v[128:131], v[144:147], v[92:95]
    ds_read_b128 v[128:131], v2 offset:54272
    v_mfma_f32_16x16x32_bf16 v[68:71], v[132:135], v[140:143], v[68:71]
    v_swap_b32 v151, v153
    buffer_load_dwordx4 a[52:55], v2, s[36:39], s93 offen offset:1024 sc1
    v_mfma_f32_16x16x32_bf16 v[96:99], v[132:135], v[144:147], v[96:99]
    ds_read_b128 v[132:135], v2 offset:55296
    s_waitcnt lgkmcnt(6)
    v_mfma_f32_16x16x32_bf16 v[72:75], v[136:139], v[140:143], v[72:75]
    v_mfma_f32_16x16x32_bf16 v[100:103], v[136:139], v[144:147], v[100:103]
    ds_read_b128 v[136:139], v2 offset:56320
    s_waitcnt lgkmcnt(5)
    v_mfma_f32_16x16x32_bf16 v[48:51], v[112:115], v[148:151], v[48:51]
    buffer_load_dwordx4 a[56:59], v2, s[36:39], s93 offen offset:2048 sc1
    v_mfma_f32_16x16x32_bf16 v[76:79], v[112:115], v[152:155], v[76:79]
    ds_read_b128 v[112:115], v2 offset:43008
    v_mfma_f32_16x16x32_bf16 v[52:55], v[116:119], v[148:151], v[52:55]
    v_mfma_f32_16x16x32_bf16 v[80:83], v[116:119], v[152:155], v[80:83]
    ds_read_b128 v[116:119], v2 offset:44032
    s_waitcnt lgkmcnt(5)
    v_mfma_f32_16x16x32_bf16 v[56:59], v[120:123], v[148:151], v[56:59]
    buffer_load_dwordx4 a[60:63], v2, s[36:39], s93 offen offset:3072 sc1
    v_mfma_f32_16x16x32_bf16 v[84:87], v[120:123], v[152:155], v[84:87]
    ds_read_b128 v[120:123], v2 offset:45056
    v_mfma_f32_16x16x32_bf16 v[60:63], v[124:127], v[148:151], v[60:63]
    s_waitcnt vmcnt(30)
    v_mfma_f32_16x16x32_bf16 v[88:91], v[124:127], v[152:155], v[88:91]
    ds_read_b128 v[124:127], v2 offset:46080
    s_waitcnt lgkmcnt(5)
    v_mfma_f32_16x16x32_bf16 v[64:67], v[128:131], v[148:151], v[64:67]
    v_swap_b32 v158, v160
    v_mfma_f32_16x16x32_bf16 v[92:95], v[128:131], v[152:155], v[92:95]
    ds_read_b128 v[128:131], v2 offset:47104
    v_mfma_f32_16x16x32_bf16 v[68:71], v[132:135], v[148:151], v[68:71]
    v_swap_b32 v159, v161
    s_add_u32 s93, s92, 13123584
    v_mfma_f32_16x16x32_bf16 v[96:99], v[132:135], v[152:155], v[96:99]
    ds_read_b128 v[132:135], v2 offset:48128
    s_waitcnt lgkmcnt(6)
    v_mfma_f32_16x16x32_bf16 v[72:75], v[136:139], v[148:151], v[72:75]
    buffer_load_dwordx4 a[64:67], v2, s[36:39], s93 offen offset:0 sc1
    v_mfma_f32_16x16x32_bf16 v[100:103], v[136:139], v[152:155], v[100:103]
    ds_read_b128 v[136:139], v2 offset:49152
    s_waitcnt lgkmcnt(5)
    v_mfma_f32_16x16x32_bf16 v[48:51], v[112:115], v[156:159], v[48:51]
    buffer_load_dwordx4 a[68:71], v2, s[36:39], s93 offen offset:1024 sc1
    v_mfma_f32_16x16x32_bf16 v[76:79], v[112:115], v[160:163], v[76:79]
    ds_read_b128 v[112:115], v2 offset:35840
    v_mfma_f32_16x16x32_bf16 v[52:55], v[116:119], v[156:159], v[52:55]
    v_mfma_f32_16x16x32_bf16 v[80:83], v[116:119], v[160:163], v[80:83]
    ds_read_b128 v[116:119], v2 offset:36864
    s_waitcnt lgkmcnt(5)
    v_mfma_f32_16x16x32_bf16 v[56:59], v[120:123], v[156:159], v[56:59]
    buffer_load_dwordx4 a[72:75], v2, s[36:39], s93 offen offset:2048 sc1
    v_mfma_f32_16x16x32_bf16 v[84:87], v[120:123], v[160:163], v[84:87]
    ds_read_b128 v[120:123], v2 offset:37888
    v_mfma_f32_16x16x32_bf16 v[60:63], v[124:127], v[156:159], v[60:63]
    s_waitcnt vmcnt(31)
    v_mfma_f32_16x16x32_bf16 v[88:91], v[124:127], v[160:163], v[88:91]
    ds_read_b128 v[124:127], v2 offset:38912
    s_waitcnt lgkmcnt(5)
    v_mfma_f32_16x16x32_bf16 v[64:67], v[128:131], v[156:159], v[64:67]
    v_swap_b32 v166, v168
    v_mfma_f32_16x16x32_bf16 v[92:95], v[128:131], v[160:163], v[92:95]
    ds_read_b128 v[128:131], v2 offset:39936
    v_mfma_f32_16x16x32_bf16 v[68:71], v[132:135], v[156:159], v[68:71]
    v_swap_b32 v167, v169
    buffer_load_dwordx4 a[76:79], v2, s[36:39], s93 offen offset:3072 sc1
    v_mfma_f32_16x16x32_bf16 v[96:99], v[132:135], v[160:163], v[96:99]
    ds_read_b128 v[132:135], v2 offset:40960
    s_waitcnt lgkmcnt(6)
    v_mfma_f32_16x16x32_bf16 v[72:75], v[136:139], v[156:159], v[72:75]
    v_mfma_f32_16x16x32_bf16 v[100:103], v[136:139], v[160:163], v[100:103]
    ds_read_b128 v[136:139], v2 offset:41984
    s_waitcnt lgkmcnt(5)
    v_mfma_f32_16x16x32_bf16 v[48:51], v[112:115], v[164:167], v[48:51]
    s_waitcnt vmcnt(18)
    v_cmp_ne_u32 vcc, v20, v14
    s_cbranch_vccz Lpd_79
    s_mov_b32 s96, 0
Lps_80x:
    buffer_load_dword v20, v21, s[36:39], s70 offen sc1
    s_waitcnt vmcnt(0)
    v_cmp_ne_u32 vcc, v20, v14
    s_cbranch_vccz Lpd_79
    s_sleep 1
    s_add_u32 s96, s96, 1
    s_cmp_lt_u32 s96, 100000
    s_cbranch_scc1 Lps_80x
Lpd_79:
    s_lshl_b32 s70, s61, 9
    s_add_u32 s70, s70, 5373952
    buffer_load_dwordx4 v[32:35], v2, s[36:39], s70 offen sc1
    s_add_u32 s93, s92, 13127680
    v_mfma_f32_16x16x32_bf16 v[76:79], v[112:115], v[168:171], v[76:79]
    ds_read_b128 v[112:115], v2 offset:28672
    buffer_load_dwordx4 a[80:83], v2, s[36:39], s93 offen offset:0 sc1
    v_mfma_f32_16x16x32_bf16 v[52:55], v[116:119], v[164:167], v[52:55]
    v_lshrrev_b32 v36, 2, v1
    v_mul_u32_u24 v36, 7168, v36
    v_mfma_f32_16x16x32_bf16 v[80:83], v[116:119], v[168:171], v[80:83]
    ds_read_b128 v[116:119], v2 offset:29696
    s_waitcnt lgkmcnt(5)
    v_mfma_f32_16x16x32_bf16 v[56:59], v[120:123], v[164:167], v[56:59]
    s_waitcnt vmcnt(14)
    v_cmp_ne_u32 vcc, v228, v14
    s_cbranch_vccz Lpd_81
    s_mov_b32 s96, 0
Lps_82x:
    buffer_load_dword v228, v231, s[36:39], s75 offen sc1
    s_waitcnt vmcnt(0)
    v_cmp_ne_u32 vcc, v228, v14
    s_cbranch_vccz Lpd_81
    s_sleep 1
    s_add_u32 s96, s96, 1
    s_cmp_lt_u32 s96, 100000
    s_cbranch_scc1 Lps_82x
Lpd_81:
    v_and_b32 v37, 3, v1
    v_mfma_f32_16x16x32_bf16 v[84:87], v[120:123], v[168:171], v[84:87]
    ds_read_b128 v[120:123], v2 offset:30720
    v_lshlrev_b32 v37, 8, v37
    v_mfma_f32_16x16x32_bf16 v[60:63], v[124:127], v[164:167], v[60:63]
    s_barrier
    v_mfma_f32_16x16x32_bf16 v[88:91], v[124:127], v[168:171], v[88:91]
    ds_read_b128 v[124:127], v2 offset:31744
    s_waitcnt lgkmcnt(5)
    v_mfma_f32_16x16x32_bf16 v[64:67], v[128:131], v[164:167], v[64:67]
    v_swap_b32 v174, v176
    s_mul_i32 s76, s62, 40960
    v_mfma_f32_16x16x32_bf16 v[92:95], v[128:131], v[168:171], v[92:95]
    ds_read_b128 v[128:131], v2 offset:32768
    s_mul_i32 s77, s63, 5120
    v_mfma_f32_16x16x32_bf16 v[68:71], v[132:135], v[164:167], v[68:71]
    v_swap_b32 v175, v177
    s_add_u32 s76, s76, s77
    v_mfma_f32_16x16x32_bf16 v[96:99], v[132:135], v[168:171], v[96:99]
    ds_read_b128 v[132:135], v2 offset:33792
    s_waitcnt lgkmcnt(6)
    v_mfma_f32_16x16x32_bf16 v[72:75], v[136:139], v[164:167], v[72:75]
    s_and_b32 s77, s6, 1
    v_sub_u32 v36, v37, v36
    v_mfma_f32_16x16x32_bf16 v[100:103], v[136:139], v[168:171], v[100:103]
    ds_read_b128 v[136:139], v2 offset:34816
    s_waitcnt lgkmcnt(5)
    v_mfma_f32_16x16x32_bf16 v[48:51], v[112:115], v[172:175], v[48:51]
    s_add_u32 s88, s90, 17039360
    buffer_load_dwordx4 v[212:215], v6, s[36:39], s88 offen offset:0 sc1
    s_mul_i32 s77, s77, 2621440
    v_mfma_f32_16x16x32_bf16 v[76:79], v[112:115], v[176:179], v[76:79]
    ds_read_b128 v[112:115], v2 offset:21504
    s_add_u32 s76, s76, s77
    v_mfma_f32_16x16x32_bf16 v[52:55], v[116:119], v[172:175], v[52:55]
    buffer_load_dwordx4 v[216:219], v6, s[36:39], s88 offen offset:256 sc1
    s_lshr_b32 s77, s6, 1
    v_mfma_f32_16x16x32_bf16 v[80:83], v[116:119], v[176:179], v[80:83]
    ds_read_b128 v[116:119], v2 offset:22528
    s_waitcnt lgkmcnt(5)
    v_mfma_f32_16x16x32_bf16 v[56:59], v[120:123], v[172:175], v[56:59]
    buffer_load_dwordx4 v[220:223], v6, s[36:39], s88 offen offset:2048 sc1
    s_mul_i32 s77, s77, 1310720
    v_mfma_f32_16x16x32_bf16 v[84:87], v[120:123], v[176:179], v[84:87]
    ds_read_b128 v[120:123], v2 offset:23552
    s_add_u32 s76, s76, s77
    v_mfma_f32_16x16x32_bf16 v[60:63], v[124:127], v[172:175], v[60:63]
    buffer_load_dwordx4 v[224:227], v6, s[36:39], s88 offen offset:2304 sc1
    v_mfma_f32_16x16x32_bf16 v[88:91], v[124:127], v[176:179], v[88:91]
    ds_read_b128 v[124:127], v2 offset:24576
    s_waitcnt lgkmcnt(5)
    v_mfma_f32_16x16x32_bf16 v[64:67], v[128:131], v[172:175], v[64:67]
    v_swap_b32 v182, v184
    s_add_u32 s76, s76, 15728640
    v_mfma_f32_16x16x32_bf16 v[92:95], v[128:131], v[176:179], v[92:95]
    ds_read_b128 v[128:131], v2 offset:25600
    s_mul_i32 s77, s6, 5120
    v_mfma_f32_16x16x32_bf16 v[68:71], v[132:135], v[172:175], v[68:71]
    v_swap_b32 v183, v185
    v_lshlrev_b32 v229, 1, v4
    v_mfma_f32_16x16x32_bf16 v[96:99], v[132:135], v[176:179], v[96:99]
    ds_read_b128 v[132:135], v2 offset:26624
    s_waitcnt lgkmcnt(6)
    v_mfma_f32_16x16x32_bf16 v[72:75], v[136:139], v[172:175], v[72:75]
    v_and_b32 v229, 4, v229
    v_add_u32 v36, 142448, v36
    v_mfma_f32_16x16x32_bf16 v[100:103], v[136:139], v[176:179], v[100:103]
    ds_read_b128 v[136:139], v2 offset:27648
    s_waitcnt lgkmcnt(5)
    v_mfma_f32_16x16x32_bf16 v[48:51], v[112:115], v[180:183], v[48:51]
    s_add_u32 s88, s90, 17043456
    buffer_load_dwordx4 v[140:143], v6, s[36:39], s88 offen offset:0 sc1
    v_sub_u32 v229, v3, v229
    v_mfma_f32_16x16x32_bf16 v[76:79], v[112:115], v[184:187], v[76:79]
    ds_read_b128 v[112:115], v2 offset:14336
    v_and_b32 v229, 15, v229
    v_mfma_f32_16x16x32_bf16 v[52:55], v[116:119], v[180:183], v[52:55]
    buffer_load_dwordx4 v[144:147], v6, s[36:39], s88 offen offset:256 sc1
    v_lshlrev_b32 v229, 4, v229
    v_mfma_f32_16x16x32_bf16 v[80:83], v[116:119], v[184:187], v[80:83]
    ds_read_b128 v[116:119], v2 offset:15360
    s_waitcnt lgkmcnt(5)
    v_mfma_f32_16x16x32_bf16 v[56:59], v[120:123], v[180:183], v[56:59]
    buffer_load_dwordx4 v[148:151], v6, s[36:39], s88 offen offset:2048 sc1
    v_lshl_add_u32 v229, v4, 8, v229
    v_mfma_f32_16x16x32_bf16 v[84:87], v[120:123], v[184:187], v[84:87]
    ds_read_b128 v[120:123], v2 offset:16384
    v_xor_b32 v230, 0x80, v229
    v_mfma_f32_16x16x32_bf16 v[60:63], v[124:127], v[180:183], v[60:63]
    buffer_load_dwordx4 v[152:155], v6, s[36:39], s88 offen offset:2304 sc1
    v_mfma_f32_16x16x32_bf16 v[88:91], v[124:127], v[184:187], v[88:91]
    ds_read_b128 v[124:127], v2 offset:17408
    s_waitcnt lgkmcnt(5)
    v_mfma_f32_16x16x32_bf16 v[64:67], v[128:131], v[180:183], v[64:67]
    v_swap_b32 v190, v192
    s_add_u32 s78, s76, 0
    s_add_u32 m0, s77, 143360
    s_nop 0
    buffer_load_dwordx4 v229, s[36:39], s78 offen sc1 lds
    v_mfma_f32_16x16x32_bf16 v[92:95], v[128:131], v[184:187], v[92:95]
    ds_read_b128 v[128:131], v2 offset:18432
    s_add_u32 s78, s76, 1024
    s_add_u32 m0, s77, 144384
    s_nop 0
    buffer_load_dwordx4 v230, s[36:39], s78 offen sc1 lds
    v_mfma_f32_16x16x32_bf16 v[68:71], v[132:135], v[180:183], v[68:71]
    v_swap_b32 v191, v193
    s_add_u32 s78, s76, 2048
    s_add_u32 m0, s77, 145408
    s_nop 0
    buffer_load_dwordx4 v229, s[36:39], s78 offen sc1 lds
    v_mfma_f32_16x16x32_bf16 v[96:99], v[132:135], v[184:187], v[96:99]
    ds_read_b128 v[132:135], v2 offset:19456
    s_waitcnt lgkmcnt(6)
    v_mfma_f32_16x16x32_bf16 v[72:75], v[136:139], v[180:183], v[72:75]
    s_add_u32 s78, s76, 3072
    s_add_u32 m0, s77, 146432
    s_nop 0
    buffer_load_dwordx4 v230, s[36:39], s78 offen sc1 lds
    buffer_load_dwordx4 a[84:87], v2, s[36:39], s93 offen offset:1024 sc1
    v_mfma_f32_16x16x32_bf16 v[100:103], v[136:139], v[184:187], v[100:103]
    ds_read_b128 v[136:139], v2 offset:20480
    s_waitcnt lgkmcnt(5)
    v_mfma_f32_16x16x32_bf16 v[48:51], v[112:115], v[188:191], v[48:51]
    s_add_u32 s88, s90, 17047552
    buffer_load_dwordx4 v[156:159], v6, s[36:39], s88 offen offset:0 sc1
    s_add_u32 s78, s76, 4096
    s_add_u32 m0, s77, 147456
    s_nop 0
    buffer_load_dwordx4 v229, s[36:39], s78 offen sc1 lds
    v_mfma_f32_16x16x32_bf16 v[76:79], v[112:115], v[192:195], v[76:79]
    ds_read_b128 v[112:115], v2 offset:7168
    buffer_load_dwordx4 a[88:91], v2, s[36:39], s93 offen offset:2048 sc1
    v_mfma_f32_16x16x32_bf16 v[52:55], v[116:119], v[188:191], v[52:55]
    buffer_load_dwordx4 v[160:163], v6, s[36:39], s88 offen offset:256 sc1
    buffer_load_dwordx4 a[92:95], v2, s[36:39], s93 offen offset:3072 sc1
    v_mfma_f32_16x16x32_bf16 v[80:83], v[116:119], v[192:195], v[80:83]
    ds_read_b128 v[116:119], v2 offset:8192
    s_waitcnt lgkmcnt(5)
    v_mfma_f32_16x16x32_bf16 v[56:59], v[120:123], v[188:191], v[56:59]
    buffer_load_dwordx4 v[164:167], v6, s[36:39], s88 offen offset:2048 sc1
    s_add_u32 s93, s92, 13131776
    v_mfma_f32_16x16x32_bf16 v[84:87], v[120:123], v[192:195], v[84:87]
    ds_read_b128 v[120:123], v2 offset:9216
    buffer_load_dwordx4 a[96:99], v2, s[36:39], s93 offen offset:0 sc1
    v_mfma_f32_16x16x32_bf16 v[60:63], v[124:127], v[188:191], v[60:63]
    buffer_load_dwordx4 v[168:171], v6, s[36:39], s88 offen offset:2304 sc1
    v_mfma_f32_16x16x32_bf16 v[88:91], v[124:127], v[192:195], v[88:91]
    ds_read_b128 v[124:127], v2 offset:10240
    s_waitcnt lgkmcnt(5)
    v_mfma_f32_16x16x32_bf16 v[64:67], v[128:131], v[188:191], v[64:67]
    v_swap_b32 v198, v200
    buffer_load_dwordx4 a[100:103], v2, s[36:39], s93 offen offset:1024 sc1
    v_mfma_f32_16x16x32_bf16 v[92:95], v[128:131], v[192:195], v[92:95]
    ds_read_b128 v[128:131], v2 offset:11264
    buffer_load_dwordx4 a[104:107], v2, s[36:39], s93 offen offset:2048 sc1
    v_mfma_f32_16x16x32_bf16 v[68:71], v[132:135], v[188:191], v[68:71]
    v_swap_b32 v199, v201
    buffer_load_dwordx4 a[108:111], v2, s[36:39], s93 offen offset:3072 sc1
    v_mfma_f32_16x16x32_bf16 v[96:99], v[132:135], v[192:195], v[96:99]
    ds_read_b128 v[132:135], v2 offset:12288
    s_waitcnt lgkmcnt(6)
    v_mfma_f32_16x16x32_bf16 v[72:75], v[136:139], v[188:191], v[72:75]
    s_add_u32 s93, s92, 13135872
    buffer_load_dwordx4 a[112:115], v2, s[36:39], s93 offen offset:0 sc1
    v_mfma_f32_16x16x32_bf16 v[100:103], v[136:139], v[192:195], v[100:103]
    ds_read_b128 v[136:139], v2 offset:13312
    s_waitcnt lgkmcnt(0)
    v_mfma_f32_16x16x32_bf16 v[72:75], v[136:139], v[196:199], v[72:75]
    s_add_u32 s88, s90, 17051648
    buffer_load_dwordx4 v[172:175], v6, s[36:39], s88 offen offset:0 sc1
    buffer_load_dwordx4 a[116:119], v2, s[36:39], s93 offen offset:1024 sc1
    v_mfma_f32_16x16x32_bf16 v[100:103], v[136:139], v[200:203], v[100:103]
    ds_read_b128 v[136:139], v2 offset:6144
    buffer_load_dwordx4 a[120:123], v2, s[36:39], s93 offen offset:2048 sc1
    v_mfma_f32_16x16x32_bf16 v[48:51], v[112:115], v[196:199], v[48:51]
    buffer_load_dwordx4 v[176:179], v6, s[36:39], s88 offen offset:256 sc1
    buffer_load_dwordx4 a[124:127], v2, s[36:39], s93 offen offset:3072 sc1
    v_mfma_f32_16x16x32_bf16 v[76:79], v[112:115], v[200:203], v[76:79]
    ds_read_b128 v[112:115], v2 offset:0
    v_mfma_f32_16x16x32_bf16 v[52:55], v[116:119], v[196:199], v[52:55]
    buffer_load_dwordx4 v[180:183], v6, s[36:39], s88 offen offset:2048 sc1
    s_add_u32 s93, s92, 13139968
    v_mfma_f32_16x16x32_bf16 v[80:83], v[116:119], v[200:203], v[80:83]
    ds_read_b128 v[116:119], v2 offset:1024
    buffer_load_dwordx4 a[128:131], v2, s[36:39], s93 offen offset:0 sc1
    v_mfma_f32_16x16x32_bf16 v[56:59], v[120:123], v[196:199], v[56:59]
    buffer_load_dwordx4 v[184:187], v6, s[36:39], s88 offen offset:2304 sc1
    v_mfma_f32_16x16x32_bf16 v[84:87], v[120:123], v[200:203], v[84:87]
    ds_read_b128 v[120:123], v2 offset:2048
    v_mfma_f32_16x16x32_bf16 v[60:63], v[124:127], v[196:199], v[60:63]
    v_swap_b32 v206, v208
    buffer_load_dwordx4 a[132:135], v2, s[36:39], s93 offen offset:1024 sc1
    v_mfma_f32_16x16x32_bf16 v[88:91], v[124:127], v[200:203], v[88:91]
    ds_read_b128 v[124:127], v2 offset:3072
    v_mfma_f32_16x16x32_bf16 v[64:67], v[128:131], v[196:199], v[64:67]
    v_swap_b32 v207, v209
    s_waitcnt vmcnt(35)
    s_mov_b32 exec_lo, 0x0fffffff
    s_mov_b32 exec_hi, 0
    ds_write_b128 v36, v[32:35]
    s_mov_b64 exec, -1
    v_mfma_f32_16x16x32_bf16 v[92:95], v[128:131], v[200:203], v[92:95]
    ds_read_b128 v[128:131], v2 offset:4096
    v_mfma_f32_16x16x32_bf16 v[68:71], v[132:135], v[196:199], v[68:71]
    v_mfma_f32_16x16x32_bf16 v[96:99], v[132:135], v[200:203], v[96:99]
    ds_read_b128 v[132:135], v2 offset:5120
    s_waitcnt lgkmcnt(6)
    v_mfma_f32_16x16x32_bf16 v[72:75], v[136:139], v[204:207], v[72:75]
    s_add_u32 s88, s90, 17055744
    buffer_load_dwordx4 v[188:191], v6, s[36:39], s88 offen offset:0 sc1
    v_mfma_f32_16x16x32_bf16 v[100:103], v[136:139], v[208:211], v[100:103]
    ds_read_b128 v[136:139], v0 offset:0
    v_mfma_f32_16x16x32_bf16 v[48:51], v[112:115], v[204:207], v[48:51]
    buffer_load_dwordx4 v[192:195], v6, s[36:39], s88 offen offset:256 sc1
    v_mfma_f32_16x16x32_bf16 v[76:79], v[112:115], v[208:211], v[76:79]
    ds_read_b128 v[112:115], v0 offset:43008
    s_waitcnt lgkmcnt(6)
    v_mfma_f32_16x16x32_bf16 v[52:55], v[116:119], v[204:207], v[52:55]
    buffer_load_dwordx4 v[196:199], v6, s[36:39], s88 offen offset:2048 sc1
    v_mfma_f32_16x16x32_bf16 v[80:83], v[116:119], v[208:211], v[80:83]
    ds_read_b128 v[116:119], v0 offset:35840
    v_mfma_f32_16x16x32_bf16 v[56:59], v[120:123], v[204:207], v[56:59]
    ds_bpermute_b32 v104, v10, v74
    ds_bpermute_b32 v106, v10, v102
    v_mfma_f32_16x16x32_bf16 v[84:87], v[120:123], v[208:211], v[84:87]
    ds_read_b128 v[120:123], v0 offset:28672
    s_waitcnt lgkmcnt(7)
    v_mfma_f32_16x16x32_bf16 v[60:63], v[124:127], v[204:207], v[60:63]
    v_mfma_f32_16x16x32_bf16 v[88:91], v[124:127], v[208:211], v[88:91]
    ds_read_b128 v[124:127], v0 offset:21504
    v_mfma_f32_16x16x32_bf16 v[64:67], v[128:131], v[204:207], v[64:67]
    v_mfma_f32_16x16x32_bf16 v[92:95], v[128:131], v[208:211], v[92:95]
    ds_read_b128 v[128:131], v0 offset:14336
    s_waitcnt lgkmcnt(8)
    v_mfma_f32_16x16x32_bf16 v[68:71], v[132:135], v[204:207], v[68:71]
    s_waitcnt lgkmcnt(3)
    v_mul_f32 v104, 0x3acccccd, v104
    v_mfma_f32_16x16x32_bf16 v[96:99], v[132:135], v[208:211], v[96:99]
    ds_read_b128 v[132:135], v0 offset:7168
    v_mul_f32 v106, 0x3acccccd, v106
    v_cvt_pk_bf16_f32 v104, v104, v104
    v_cvt_pk_bf16_f32 v106, v106, v106
    v_lshlrev_b32 v104, 16, v104
    v_lshlrev_b32 v106, 16, v106
    s_add_u32 s72, s95, 33554432
    buffer_load_dwordx4 v[200:203], v6, s[36:39], s88 offen offset:2304 sc1
    s_add_u32 s88, s90, 17059840
    buffer_load_dwordx4 v[204:207], v6, s[36:39], s88 offen offset:0 sc1
    buffer_load_dwordx4 v[208:211], v6, s[36:39], s88 offen offset:256 sc1
    v_pk_fma_f32 v[72:73], v[136:137], v[104:105], v[72:73] op_sel_hi:[1,0,1] neg_lo:[0,1,0] neg_hi:[0,1,0]
    v_pk_fma_f32 v[74:75], v[138:139], v[104:105], v[74:75] op_sel_hi:[1,0,1] neg_lo:[0,1,0] neg_hi:[0,1,0]
    v_pk_fma_f32 v[48:49], v[112:113], v[104:105], v[48:49] op_sel_hi:[1,0,1] neg_lo:[0,1,0] neg_hi:[0,1,0]
    v_pk_fma_f32 v[50:51], v[114:115], v[104:105], v[50:51] op_sel_hi:[1,0,1] neg_lo:[0,1,0] neg_hi:[0,1,0]
    v_pk_fma_f32 v[52:53], v[116:117], v[104:105], v[52:53] op_sel_hi:[1,0,1] neg_lo:[0,1,0] neg_hi:[0,1,0]
    v_pk_fma_f32 v[54:55], v[118:119], v[104:105], v[54:55] op_sel_hi:[1,0,1] neg_lo:[0,1,0] neg_hi:[0,1,0]
    s_waitcnt lgkmcnt(3)
    v_pk_fma_f32 v[56:57], v[120:121], v[104:105], v[56:57] op_sel_hi:[1,0,1] neg_lo:[0,1,0] neg_hi:[0,1,0]
    v_pk_fma_f32 v[58:59], v[122:123], v[104:105], v[58:59] op_sel_hi:[1,0,1] neg_lo:[0,1,0] neg_hi:[0,1,0]
    s_waitcnt lgkmcnt(2)
    v_pk_fma_f32 v[60:61], v[124:125], v[104:105], v[60:61] op_sel_hi:[1,0,1] neg_lo:[0,1,0] neg_hi:[0,1,0]
    v_pk_fma_f32 v[62:63], v[126:127], v[104:105], v[62:63] op_sel_hi:[1,0,1] neg_lo:[0,1,0] neg_hi:[0,1,0]
    s_waitcnt lgkmcnt(1)
    v_pk_fma_f32 v[64:65], v[128:129], v[104:105], v[64:65] op_sel_hi:[1,0,1] neg_lo:[0,1,0] neg_hi:[0,1,0]
    v_pk_fma_f32 v[66:67], v[130:131], v[104:105], v[66:67] op_sel_hi:[1,0,1] neg_lo:[0,1,0] neg_hi:[0,1,0]
    s_waitcnt lgkmcnt(0)
    v_pk_fma_f32 v[68:69], v[132:133], v[104:105], v[68:69] op_sel_hi:[1,0,1] neg_lo:[0,1,0] neg_hi:[0,1,0]
    v_pk_fma_f32 v[70:71], v[134:135], v[104:105], v[70:71] op_sel_hi:[1,0,1] neg_lo:[0,1,0] neg_hi:[0,1,0]
    v_permlane32_swap_b32 v72, v74
    v_permlane32_swap_b32 v73, v75
    v_pk_mul_f32 v[48:49], v[48:49], v[60:61]
    v_pk_mul_f32 v[50:51], v[50:51], v[62:63]
    v_pk_mul_f32 v[52:53], v[52:53], v[64:65]
    v_pk_mul_f32 v[54:55], v[54:55], v[66:67]
    v_pk_mul_f32 v[56:57], v[56:57], v[68:69]
    v_pk_mul_f32 v[58:59], v[58:59], v[70:71]
    v_pk_mul_f32 v[60:61], v[72:73], v[74:75]
    v_cvt_pk_bf16_f32 v72, v56, v57
    v_cvt_pk_bf16_f32 v73, v58, v59
    v_mov_b32 v71, 0
    v_cvt_pk_bf16_f32 v64, v48, v49
    v_cvt_pk_bf16_f32 v65, v50, v51
    v_cvt_pk_bf16_f32 v66, v52, v53
    v_cvt_pk_bf16_f32 v67, v54, v55
    v_permlane16_swap_b32 v72, v73
    v_cvt_pk_bf16_f32 v68, v56, v57
    v_cvt_pk_bf16_f32 v69, v58, v59
    v_cvt_pk_bf16_f32 v70, v60, v61
    v_permlane32_swap_b32 v73, v71
    s_cmp_eq_u32 s30, 0
    s_cbranch_scc1 Lg_83
    buffer_store_dwordx4 v[64:67], v2, s[36:39], s72 offen
    s_mov_b32 exec_hi, 0xffff
    buffer_store_dwordx4 v[68:71], v2, s[36:39], s72 offen offset:1024
    s_mov_b64 exec, -1
Lgb_84:
    s_add_u32 s72, s72, 57344
    v_pk_fma_f32 v[100:101], v[136:137], v[106:107], v[100:101] op_sel_hi:[1,0,1] neg_lo:[0,1,0] neg_hi:[0,1,0]
    v_pk_fma_f32 v[102:103], v[138:139], v[106:107], v[102:103] op_sel_hi:[1,0,1] neg_lo:[0,1,0] neg_hi:[0,1,0]
    v_pk_fma_f32 v[76:77], v[112:113], v[106:107], v[76:77] op_sel_hi:[1,0,1] neg_lo:[0,1,0] neg_hi:[0,1,0]
    v_pk_fma_f32 v[78:79], v[114:115], v[106:107], v[78:79] op_sel_hi:[1,0,1] neg_lo:[0,1,0] neg_hi:[0,1,0]
    v_pk_fma_f32 v[80:81], v[116:117], v[106:107], v[80:81] op_sel_hi:[1,0,1] neg_lo:[0,1,0] neg_hi:[0,1,0]
    v_pk_fma_f32 v[82:83], v[118:119], v[106:107], v[82:83] op_sel_hi:[1,0,1] neg_lo:[0,1,0] neg_hi:[0,1,0]
    v_pk_fma_f32 v[84:85], v[120:121], v[106:107], v[84:85] op_sel_hi:[1,0,1] neg_lo:[0,1,0] neg_hi:[0,1,0]
    v_pk_fma_f32 v[86:87], v[122:123], v[106:107], v[86:87] op_sel_hi:[1,0,1] neg_lo:[0,1,0] neg_hi:[0,1,0]
    v_pk_fma_f32 v[88:89], v[124:125], v[106:107], v[88:89] op_sel_hi:[1,0,1] neg_lo:[0,1,0] neg_hi:[0,1,0]
    v_pk_fma_f32 v[90:91], v[126:127], v[106:107], v[90:91] op_sel_hi:[1,0,1] neg_lo:[0,1,0] neg_hi:[0,1,0]
    v_pk_fma_f32 v[92:93], v[128:129], v[106:107], v[92:93] op_sel_hi:[1,0,1] neg_lo:[0,1,0] neg_hi:[0,1,0]
    v_pk_fma_f32 v[94:95], v[130:131], v[106:107], v[94:95] op_sel_hi:[1,0,1] neg_lo:[0,1,0] neg_hi:[0,1,0]
    v_pk_fma_f32 v[96:97], v[132:133], v[106:107], v[96:97] op_sel_hi:[1,0,1] neg_lo:[0,1,0] neg_hi:[0,1,0]
    v_pk_fma_f32 v[98:99], v[134:135], v[106:107], v[98:99] op_sel_hi:[1,0,1] neg_lo:[0,1,0] neg_hi:[0,1,0]
    v_permlane32_swap_b32 v100, v102
    v_permlane32_swap_b32 v101, v103
    v_pk_mul_f32 v[76:77], v[76:77], v[88:89]
    v_pk_mul_f32 v[78:79], v[78:79], v[90:91]
    v_pk_mul_f32 v[80:81], v[80:81], v[92:93]
    v_pk_mul_f32 v[82:83], v[82:83], v[94:95]
    v_pk_mul_f32 v[84:85], v[84:85], v[96:97]
    v_pk_mul_f32 v[86:87], v[86:87], v[98:99]
    v_pk_mul_f32 v[88:89], v[100:101], v[102:103]
    v_cvt_pk_bf16_f32 v100, v84, v85
    v_cvt_pk_bf16_f32 v101, v86, v87
    v_mov_b32 v99, 0
    v_cvt_pk_bf16_f32 v92, v76, v77
    v_cvt_pk_bf16_f32 v93, v78, v79
    v_cvt_pk_bf16_f32 v94, v80, v81
    v_cvt_pk_bf16_f32 v95, v82, v83
    v_permlane16_swap_b32 v100, v101
    v_cvt_pk_bf16_f32 v96, v84, v85
    v_cvt_pk_bf16_f32 v97, v86, v87
    v_cvt_pk_bf16_f32 v98, v88, v89
    v_permlane32_swap_b32 v101, v99
    s_cmp_eq_u32 s30, 0
    s_cbranch_scc1 Lg_85
    buffer_store_dwordx4 v[92:95], v2, s[36:39], s72 offen
    s_mov_b32 exec_hi, 0xffff
    buffer_store_dwordx4 v[96:99], v2, s[36:39], s72 offen offset:1024
    s_mov_b64 exec, -1
Lgb_86:
    ds_read_b128 v[112:115], v8 offset:21504
    ds_read_b128 v[116:119], v8 offset:22528
    ds_read_b128 v[120:123], v8 offset:23552
    ds_read_b128 v[124:127], v8 offset:24576
    ds_read_b128 v[128:131], v8 offset:25600
    ds_read_b128 v[132:135], v8 offset:26624
    ds_read_b128 v[136:139], v8 offset:27648
    s_waitcnt vmcnt(42)
    v_swap_b32 v214, v216
    v_swap_b32 v215, v217
    s_waitcnt lgkmcnt(5)
    s_nop 0
    v_mfma_f32_16x16x32_bf16 v[48:51], v[112:115], v[212:215], 0
    v_mfma_f32_16x16x32_bf16 v[76:79], v[112:115], v[216:219], 0
    ds_read_b128 v[112:115], v8 offset:14336
    v_mfma_f32_16x16x32_bf16 v[52:55], v[116:119], v[212:215], 0
    buffer_load_dwordx4 a[136:139], v2, s[36:39], s93 offen offset:2048 sc1
    s_waitcnt vmcnt(30)
    s_barrier
    v_mfma_f32_16x16x32_bf16 v[80:83], v[116:119], v[216:219], 0
    ds_read_b128 v[116:119], v8 offset:15360
    s_waitcnt lgkmcnt(5)
    v_mfma_f32_16x16x32_bf16 v[56:59], v[120:123], v[212:215], 0
    s_lshl_b32 s7, s5, 2
    ds_read_b128 v[16:19], v13 offset:0
    v_mfma_f32_16x16x32_bf16 v[84:87], v[120:123], v[216:219], 0
    ds_read_b128 v[120:123], v8 offset:16384
    s_add_u32 s7, s7, s6
    v_mfma_f32_16x16x32_bf16 v[60:63], v[124:127], v[212:215], 0
    s_mul_i32 s7, s7, 384
    v_mfma_f32_16x16x32_bf16 v[88:91], v[124:127], v[216:219], 0
    ds_read_b128 v[124:127], v8 offset:17408
    s_waitcnt lgkmcnt(6)
    v_mfma_f32_16x16x32_bf16 v[64:67], v[128:131], v[212:215], 0
    v_swap_b32 v222, v224
    v_lshl_add_u32 v105, v1, 7, s7
    v_mfma_f32_16x16x32_bf16 v[92:95], v[128:131], v[216:219], 0
    ds_read_b128 v[128:131], v8 offset:18432
    v_min_u32 v105, L_last-L_join, v105
    v_mfma_f32_16x16x32_bf16 v[68:71], v[132:135], v[212:215], 0
    v_swap_b32 v223, v225
    v_add_u32 v105, L_join-Lpf_87, v105
    v_mfma_f32_16x16x32_bf16 v[96:99], v[132:135], v[216:219], 0
    ds_read_b128 v[132:135], v8 offset:19456
    s_waitcnt lgkmcnt(7)
    v_mfma_f32_16x16x32_bf16 v[72:75], v[136:139], v[212:215], 0
    s_getpc_b64 s[12:13]
Lpf_87:
    s_mov_b64 exec, 7
    global_load_dword v5, v105, s[12:13]
    s_mov_b64 exec, -1
    buffer_load_dwordx4 a[140:143], v2, s[36:39], s93 offen offset:3072 sc1
    v_mfma_f32_16x16x32_bf16 v[100:103], v[136:139], v[216:219], 0
    ds_read_b128 v[136:139], v8 offset:20480
    s_waitcnt lgkmcnt(6)
    v_mfma_f32_16x16x32_bf16 v[48:51], v[112:115], v[220:223], v[48:51]
    buffer_load_dwordx4 v[212:215], v6, s[36:39], s88 offen offset:2048 sc1
    s_add_u32 s93, s92, 13144064
    v_mfma_f32_16x16x32_bf16 v[76:79], v[112:115], v[224:227], v[76:79]
    ds_read_b128 v[112:115], v8 offset:7168
    buffer_load_dwordx4 a[144:147], v2, s[36:39], s93 offen offset:0 sc1
    v_mfma_f32_16x16x32_bf16 v[52:55], v[116:119], v[220:223], v[52:55]
    buffer_load_dwordx4 v[216:219], v6, s[36:39], s88 offen offset:2304 sc1
    ds_read_b128 v[20:23], v13 offset:256
    v_mfma_f32_16x16x32_bf16 v[80:83], v[116:119], v[224:227], v[80:83]
    ds_read_b128 v[116:119], v8 offset:8192
    s_waitcnt lgkmcnt(6)
    v_mfma_f32_16x16x32_bf16 v[56:59], v[120:123], v[220:223], v[56:59]
    v_mfma_f32_16x16x32_bf16 v[84:87], v[120:123], v[224:227], v[84:87]
    ds_read_b128 v[120:123], v8 offset:9216
    v_mfma_f32_16x16x32_bf16 v[60:63], v[124:127], v[220:223], v[60:63]
    buffer_load_dwordx4 a[148:151], v2, s[36:39], s93 offen offset:1024 sc1
    v_mfma_f32_16x16x32_bf16 v[88:91], v[124:127], v[224:227], v[88:91]
    ds_read_b128 v[124:127], v8 offset:10240
    s_waitcnt lgkmcnt(6)
    v_mfma_f32_16x16x32_bf16 v[64:67], v[128:131], v[220:223], v[64:67]
    v_swap_b32 v142, v144
    ds_read_b128 v[32:35], v13 offset:5120
    v_mfma_f32_16x16x32_bf16 v[92:95], v[128:131], v[224:227], v[92:95]
    ds_read_b128 v[128:131], v8 offset:11264
    v_mfma_f32_16x16x32_bf16 v[68:71], v[132:135], v[220:223], v[68:71]
    v_swap_b32 v143, v145
    ds_read_b128 v[36:39], v13 offset:5376
    v_mfma_f32_16x16x32_bf16 v[96:99], v[132:135], v[224:227], v[96:99]
    ds_read_b128 v[132:135], v8 offset:12288
    s_waitcnt lgkmcnt(9)
    v_mfma_f32_16x16x32_bf16 v[72:75], v[136:139], v[220:223], v[72:75]
    v_mfma_f32_16x16x32_bf16 v[100:103], v[136:139], v[224:227], v[100:103]
    ds_read_b128 v[136:139], v8 offset:13312
    s_waitcnt lgkmcnt(7)
    v_mfma_f32_16x16x32_bf16 v[48:51], v[112:115], v[140:143], v[48:51]
    s_add_u32 s88, s90, 17063936
    buffer_load_dwordx4 v[220:223], v6, s[36:39], s88 offen offset:0 sc1
    buffer_load_dwordx4 a[152:155], v2, s[36:39], s93 offen offset:2048 sc1
    v_mfma_f32_16x16x32_bf16 v[76:79], v[112:115], v[144:147], v[76:79]
    ds_read_b128 v[112:115], v8 offset:0
    ds_read_b128 v[24:27], v13 offset:10240
    v_mfma_f32_16x16x32_bf16 v[52:55], v[116:119], v[140:143], v[52:55]
    buffer_load_dwordx4 v[224:227], v6, s[36:39], s88 offen offset:256 sc1
    v_mfma_f32_16x16x32_bf16 v[80:83], v[116:119], v[144:147], v[80:83]
    ds_read_b128 v[116:119], v8 offset:1024
    s_waitcnt lgkmcnt(8)
    v_mfma_f32_16x16x32_bf16 v[56:59], v[120:123], v[140:143], v[56:59]
    ds_read_b128 v[28:31], v13 offset:10496
    v_mfma_f32_16x16x32_bf16 v[84:87], v[120:123], v[144:147], v[84:87]
    ds_read_b128 v[120:123], v8 offset:2048
    v_mfma_f32_16x16x32_bf16 v[60:63], v[124:127], v[140:143], v[60:63]
    buffer_load_dwordx4 a[156:159], v2, s[36:39], s93 offen offset:3072 sc1
    v_mfma_f32_16x16x32_bf16 v[88:91], v[124:127], v[144:147], v[88:91]
    ds_read_b128 v[124:127], v8 offset:3072
    s_waitcnt lgkmcnt(7)
    v_mfma_f32_16x16x32_bf16 v[64:67], v[128:131], v[140:143], v[64:67]
    v_swap_b32 v150, v152
    ds_read_b128 v[40:43], v13 offset:15360
    v_mfma_f32_16x16x32_bf16 v[92:95], v[128:131], v[144:147], v[92:95]
    ds_read_b128 v[128:131], v8 offset:4096
    v_mfma_f32_16x16x32_bf16 v[68:71], v[132:135], v[140:143], v[68:71]
    v_swap_b32 v151, v153
    ds_read_b128 v[44:47], v13 offset:15616
    v_mfma_f32_16x16x32_bf16 v[96:99], v[132:135], v[144:147], v[96:99]
    ds_read_b128 v[132:135], v8 offset:5120
    s_waitcnt lgkmcnt(10)
    v_mfma_f32_16x16x32_bf16 v[72:75], v[136:139], v[140:143], v[72:75]
    s_add_u32 s93, s92, 13148160
    buffer_load_dwordx4 a[160:163], v2, s[36:39], s93 offen offset:0 sc1
    v_mfma_f32_16x16x32_bf16 v[100:103], v[136:139], v[144:147], v[100:103]
    ds_read_b128 v[136:139], v8 offset:6144
    s_waitcnt lgkmcnt(8)
    v_mfma_f32_16x16x32_bf16 v[48:51], v[112:115], v[148:151], v[48:51]
    buffer_load_dwordx4 v[140:143], v6, s[36:39], s88 offen offset:2048 sc1
    v_mfma_f32_16x16x32_bf16 v[76:79], v[112:115], v[152:155], v[76:79]
    ds_read_b128 v[112:115], v7 offset:50176
    v_mfma_f32_16x16x32_bf16 v[52:55], v[116:119], v[148:151], v[52:55]
    buffer_load_dwordx4 v[144:147], v6, s[36:39], s88 offen offset:2304 sc1
    v_mfma_f32_16x16x32_bf16 v[80:83], v[116:119], v[152:155], v[80:83]
    ds_read_b128 v[116:119], v7 offset:51200
    s_waitcnt lgkmcnt(7)
    v_mfma_f32_16x16x32_bf16 v[56:59], v[120:123], v[148:151], v[56:59]
    buffer_load_dwordx4 a[164:167], v2, s[36:39], s93 offen offset:1024 sc1
    v_mfma_f32_16x16x32_bf16 v[84:87], v[120:123], v[152:155], v[84:87]
    ds_read_b128 v[120:123], v7 offset:52224
    v_mfma_f32_16x16x32_bf16 v[60:63], v[124:127], v[148:151], v[60:63]
    s_waitcnt vmcnt(42)
    s_add_u32 s73, s66, 0
    v_mfma_f32_16x16x32_bf16 v[88:91], v[124:127], v[152:155], v[88:91]
    ds_read_b128 v[124:127], v7 offset:53248
    s_waitcnt lgkmcnt(5)
    v_mfma_f32_16x16x32_bf16 v[64:67], v[128:131], v[148:151], v[64:67]
    v_swap_b32 v158, v160
    s_waitcnt vmcnt(15)
    v_mfma_f32_16x16x32_bf16 v[92:95], v[128:131], v[152:155], v[92:95]
    ds_read_b128 v[128:131], v7 offset:54272
    s_cmp_eq_u32 s30, 0
    s_cbranch_scc1 Lg_96
    s_mov_b64 exec, 1
    buffer_store_dword v14, off, s[36:39], s73
    s_mov_b64 exec, -1
Lgb_97:
    v_mfma_f32_16x16x32_bf16 v[68:71], v[132:135], v[148:151], v[68:71]
    v_swap_b32 v159, v161
    buffer_load_dwordx4 a[168:171], v2, s[36:39], s93 offen offset:2048 sc1
    v_mfma_f32_16x16x32_bf16 v[96:99], v[132:135], v[152:155], v[96:99]
    ds_read_b128 v[132:135], v7 offset:55296
    s_waitcnt lgkmcnt(6)
    v_mfma_f32_16x16x32_bf16 v[72:75], v[136:139], v[148:151], v[72:75]
    v_swap_b32 v18, v20
    v_mfma_f32_16x16x32_bf16 v[100:103], v[136:139], v[152:155], v[100:103]
    ds_read_b128 v[136:139], v7 offset:56320
    s_waitcnt lgkmcnt(5)
    v_mfma_f32_16x16x32_bf16 v[48:51], v[112:115], v[156:159], v[48:51]
    s_add_u32 s88, s90, 17068032
    buffer_load_dwordx4 v[148:151], v6, s[36:39], s88 offen offset:0 sc1
    v_swap_b32 v19, v21
    v_mfma_f32_16x16x32_bf16 v[76:79], v[112:115], v[160:163], v[76:79]
    ds_read_b128 v[112:115], v7 offset:43008
    v_swap_b32 v26, v28
    v_mfma_f32_16x16x32_bf16 v[52:55], v[116:119], v[156:159], v[52:55]
    buffer_load_dwordx4 v[152:155], v6, s[36:39], s88 offen offset:256 sc1
    buffer_load_dwordx4 a[172:175], v2, s[36:39], s93 offen offset:3072 sc1
    v_mfma_f32_16x16x32_bf16 v[80:83], v[116:119], v[160:163], v[80:83]
    ds_read_b128 v[116:119], v7 offset:44032
    s_waitcnt lgkmcnt(5)
    v_mfma_f32_16x16x32_bf16 v[56:59], v[120:123], v[156:159], v[56:59]
    v_swap_b32 v27, v29
    v_swap_b32 v34, v36
    v_mfma_f32_16x16x32_bf16 v[84:87], v[120:123], v[160:163], v[84:87]
    ds_read_b128 v[120:123], v7 offset:45056
    v_swap_b32 v35, v37
    v_mfma_f32_16x16x32_bf16 v[60:63], v[124:127], v[156:159], v[60:63]
    v_swap_b32 v42, v44
    v_mfma_f32_16x16x32_bf16 v[88:91], v[124:127], v[160:163], v[88:91]
    ds_read_b128 v[124:127], v7 offset:46080
    s_waitcnt lgkmcnt(5)
    v_mfma_f32_16x16x32_bf16 v[64:67], v[128:131], v[156:159], v[64:67]
    v_swap_b32 v166, v168
    v_swap_b32 v43, v45
    v_mfma_f32_16x16x32_bf16 v[92:95], v[128:131], v[160:163], v[92:95]
    ds_read_b128 v[128:131], v7 offset:47104
    v_mov_b32 v9, 0x3f803f80
    v_mfma_f32_16x16x32_bf16 v[68:71], v[132:135], v[156:159], v[68:71]
    v_swap_b32 v167, v169
    s_add_u32 s93, s92, 13152256
    v_mfma_f32_16x16x32_bf16 v[96:99], v[132:135], v[160:163], v[96:99]
    ds_read_b128 v[132:135], v7 offset:48128
    s_waitcnt lgkmcnt(6)
    v_mfma_f32_16x16x32_bf16 v[72:75], v[136:139], v[156:159], v[72:75]
    buffer_load_dwordx4 a[176:179], v2, s[36:39], s93 offen offset:0 sc1
    v_mov_b32 v110, v14
    v_mfma_f32_16x16x32_bf16 v[100:103], v[136:139], v[160:163], v[100:103]
    ds_read_b128 v[136:139], v7 offset:49152
    s_waitcnt lgkmcnt(5)
    v_mfma_f32_16x16x32_bf16 v[48:51], v[112:115], v[164:167], v[48:51]
    buffer_load_dwordx4 v[156:159], v6, s[36:39], s88 offen offset:2048 sc1
    buffer_load_dwordx4 a[180:183], v2, s[36:39], s93 offen offset:1024 sc1
    v_mfma_f32_16x16x32_bf16 v[76:79], v[112:115], v[168:171], v[76:79]
    ds_read_b128 v[112:115], v7 offset:35840
    v_mov_b32 v111, v14
    v_mfma_f32_16x16x32_bf16 v[52:55], v[116:119], v[164:167], v[52:55]
    buffer_load_dwordx4 v[160:163], v6, s[36:39], s88 offen offset:2304 sc1
    v_lshlrev_b32 v229, 4, v4
    v_mfma_f32_16x16x32_bf16 v[80:83], v[116:119], v[168:171], v[80:83]
    ds_read_b128 v[116:119], v7 offset:36864
    s_waitcnt lgkmcnt(5)
    v_mfma_f32_16x16x32_bf16 v[56:59], v[120:123], v[164:167], v[56:59]
    s_lshl_b32 s78, s63, 10
    s_add_u32 s78, s78, s69
    v_mfma_f32_16x16x32_bf16 v[84:87], v[120:123], v[168:171], v[84:87]
    ds_read_b128 v[120:123], v7 offset:37888
    v_dot2_f32_bf16 v108, v16, v9, 0
    v_mfma_f32_16x16x32_bf16 v[60:63], v[124:127], v[164:167], v[60:63]
    v_dot2_f32_bf16 v109, v16, v16, 0
    v_mfma_f32_16x16x32_bf16 v[88:91], v[124:127], v[168:171], v[88:91]
    ds_read_b128 v[124:127], v7 offset:38912
    s_waitcnt lgkmcnt(5)
    v_mfma_f32_16x16x32_bf16 v[64:67], v[128:131], v[164:167], v[64:67]
    v_swap_b32 v174, v176
    buffer_load_dwordx4 a[184:187], v2, s[36:39], s93 offen offset:2048 sc1
    v_mfma_f32_16x16x32_bf16 v[92:95], v[128:131], v[168:171], v[92:95]
    ds_read_b128 v[128:131], v7 offset:39936
    v_dot2_f32_bf16 v108, v17, v9, v108
    v_mfma_f32_16x16x32_bf16 v[68:71], v[132:135], v[164:167], v[68:71]
    v_swap_b32 v175, v177
    v_dot2_f32_bf16 v109, v17, v17, v109
    v_mfma_f32_16x16x32_bf16 v[96:99], v[132:135], v[168:171], v[96:99]
    ds_read_b128 v[132:135], v7 offset:40960
    s_waitcnt lgkmcnt(6)
    v_mfma_f32_16x16x32_bf16 v[72:75], v[136:139], v[164:167], v[72:75]
    v_dot2_f32_bf16 v108, v18, v9, v108
    v_dot2_f32_bf16 v109, v18, v18, v109
    v_mfma_f32_16x16x32_bf16 v[100:103], v[136:139], v[168:171], v[100:103]
    ds_read_b128 v[136:139], v7 offset:41984
    s_waitcnt lgkmcnt(5)
    v_mfma_f32_16x16x32_bf16 v[48:51], v[112:115], v[172:175], v[48:51]
    s_add_u32 s88, s90, 17072128
    buffer_load_dwordx4 v[164:167], v6, s[36:39], s88 offen offset:0 sc1
    buffer_load_dwordx4 a[188:191], v2, s[36:39], s93 offen offset:3072 sc1
    v_mfma_f32_16x16x32_bf16 v[76:79], v[112:115], v[176:179], v[76:79]
    ds_read_b128 v[112:115], v7 offset:28672
    v_dot2_f32_bf16 v108, v19, v9, v108
    v_mfma_f32_16x16x32_bf16 v[52:55], v[116:119], v[172:175], v[52:55]
    buffer_load_dwordx4 v[168:171], v6, s[36:39], s88 offen offset:256 sc1
    v_dot2_f32_bf16 v109, v19, v19, v109
    v_mfma_f32_16x16x32_bf16 v[80:83], v[116:119], v[176:179], v[80:83]
    ds_read_b128 v[116:119], v7 offset:29696
    s_waitcnt lgkmcnt(5)
    v_mfma_f32_16x16x32_bf16 v[56:59], v[120:123], v[172:175], v[56:59]
    s_nop 1
    v_cndmask_b32 v108, 0, v108, s[86:87]
    v_mfma_f32_16x16x32_bf16 v[84:87], v[120:123], v[176:179], v[84:87]
    ds_read_b128 v[120:123], v7 offset:30720
    v_cndmask_b32 v109, 0, v109, s[86:87]
    v_mfma_f32_16x16x32_bf16 v[60:63], v[124:127], v[172:175], v[60:63]
    s_add_u32 s93, s92, 13156352
    v_mfma_f32_16x16x32_bf16 v[88:91], v[124:127], v[176:179], v[88:91]
    ds_read_b128 v[124:127], v7 offset:31744
    s_waitcnt lgkmcnt(5)
    v_mfma_f32_16x16x32_bf16 v[64:67], v[128:131], v[172:175], v[64:67]
    v_swap_b32 v182, v184
    buffer_load_dwordx4 a[192:195], v2, s[36:39], s93 offen offset:0 sc1
    v_mfma_f32_16x16x32_bf16 v[92:95], v[128:131], v[176:179], v[92:95]
    ds_read_b128 v[128:131], v7 offset:32768
    v_add_f32_dpp v108, v108, v108 row_ror:8 row_mask:0xf bank_mask:0xf
    v_mfma_f32_16x16x32_bf16 v[68:71], v[132:135], v[172:175], v[68:71]
    v_swap_b32 v183, v185
    v_add_f32_dpp v109, v109, v109 row_ror:8 row_mask:0xf bank_mask:0xf
    v_mfma_f32_16x16x32_bf16 v[96:99], v[132:135], v[176:179], v[96:99]
    ds_read_b128 v[132:135], v7 offset:33792
    s_waitcnt lgkmcnt(6)
    v_mfma_f32_16x16x32_bf16 v[72:75], v[136:139], v[172:175], v[72:75]
    v_add_f32_dpp v108, v108, v108 row_ror:4 row_mask:0xf bank_mask:0xf
    v_add_f32_dpp v109, v109, v109 row_ror:4 row_mask:0xf bank_mask:0xf
    v_mfma_f32_16x16x32_bf16 v[100:103], v[136:139], v[176:179], v[100:103]
    ds_read_b128 v[136:139], v7 offset:34816
    s_waitcnt lgkmcnt(5)
    v_mfma_f32_16x16x32_bf16 v[48:51], v[112:115], v[180:183], v[48:51]
    buffer_load_dwordx4 v[172:175], v6, s[36:39], s88 offen offset:2048 sc1
    buffer_load_dwordx4 a[196:199], v2, s[36:39], s93 offen offset:1024 sc1
    v_mfma_f32_16x16x32_bf16 v[76:79], v[112:115], v[184:187], v[76:79]
    ds_read_b128 v[112:115], v7 offset:21504
    v_add_f32_dpp v108, v108, v108 row_ror:2 row_mask:0xf bank_mask:0xf
    v_mfma_f32_16x16x32_bf16 v[52:55], v[116:119], v[180:183], v[52:55]
    buffer_load_dwordx4 v[176:179], v6, s[36:39], s88 offen offset:2304 sc1
    v_add_f32_dpp v109, v109, v109 row_ror:2 row_mask:0xf bank_mask:0xf
    v_mfma_f32_16x16x32_bf16 v[80:83], v[116:119], v[184:187], v[80:83]
    ds_read_b128 v[116:119], v7 offset:22528
    s_waitcnt lgkmcnt(5)
    v_mfma_f32_16x16x32_bf16 v[56:59], v[120:123], v[180:183], v[56:59]
    buffer_load_dwordx4 a[200:203], v2, s[36:39], s93 offen offset:2048 sc1
    v_add_f32_dpp v108, v108, v108 row_ror:1 row_mask:0xf bank_mask:0xf
    v_mfma_f32_16x16x32_bf16 v[84:87], v[120:123], v[184:187], v[84:87]
    ds_read_b128 v[120:123], v7 offset:23552
    v_add_f32_dpp v109, v109, v109 row_ror:1 row_mask:0xf bank_mask:0xf
    v_mfma_f32_16x16x32_bf16 v[60:63], v[124:127], v[180:183], v[60:63]
    s_cmp_eq_u32 s30, 0
    s_cbranch_scc1 Lg_88
    s_add_u32 s74, s78, 256
    s_mov_b32 exec_lo, 0x00010001
    s_mov_b32 exec_hi, 0x00010001
    buffer_store_dwordx4 v[108:111], v229, s[36:39], s74 offen
    s_mov_b64 exec, -1
Lgb_89:
    v_mfma_f32_16x16x32_bf16 v[88:91], v[124:127], v[184:187], v[88:91]
    ds_read_b128 v[124:127], v7 offset:24576
    s_waitcnt lgkmcnt(5)
    v_mfma_f32_16x16x32_bf16 v[64:67], v[128:131], v[180:183], v[64:67]
    v_swap_b32 v190, v192
    v_dot2_f32_bf16 v108, v20, v9, 0
    v_mfma_f32_16x16x32_bf16 v[92:95], v[128:131], v[184:187], v[92:95]
    ds_read_b128 v[128:131], v7 offset:25600
    v_dot2_f32_bf16 v109, v20, v20, 0
    v_mfma_f32_16x16x32_bf16 v[68:71], v[132:135], v[180:183], v[68:71]
    v_swap_b32 v191, v193
    v_dot2_f32_bf16 v108, v21, v9, v108
    v_mfma_f32_16x16x32_bf16 v[96:99], v[132:135], v[184:187], v[96:99]
    ds_read_b128 v[132:135], v7 offset:26624
    s_waitcnt lgkmcnt(6)
    v_mfma_f32_16x16x32_bf16 v[72:75], v[136:139], v[180:183], v[72:75]
    buffer_load_dwordx4 a[204:207], v2, s[36:39], s93 offen offset:3072 sc1
    v_dot2_f32_bf16 v109, v21, v21, v109
    v_mfma_f32_16x16x32_bf16 v[100:103], v[136:139], v[184:187], v[100:103]
    ds_read_b128 v[136:139], v7 offset:27648
    s_waitcnt lgkmcnt(5)
    v_mfma_f32_16x16x32_bf16 v[48:51], v[112:115], v[188:191], v[48:51]
    s_add_u32 s88, s90, 17076224
    buffer_load_dwordx4 v[180:183], v6, s[36:39], s88 offen offset:0 sc1
    v_dot2_f32_bf16 v108, v22, v9, v108
    v_mfma_f32_16x16x32_bf16 v[76:79], v[112:115], v[192:195], v[76:79]
    ds_read_b128 v[112:115], v7 offset:14336
    v_dot2_f32_bf16 v109, v22, v22, v109
    v_mfma_f32_16x16x32_bf16 v[52:55], v[116:119], v[188:191], v[52:55]
    buffer_load_dwordx4 v[184:187], v6, s[36:39], s88 offen offset:256 sc1
    v_dot2_f32_bf16 v108, v23, v9, v108
    v_mfma_f32_16x16x32_bf16 v[80:83], v[116:119], v[192:195], v[80:83]
    ds_read_b128 v[116:119], v7 offset:15360
    s_waitcnt lgkmcnt(5)
    v_mfma_f32_16x16x32_bf16 v[56:59], v[120:123], v[188:191], v[56:59]
    s_add_u32 s93, s92, 13160448
    v_dot2_f32_bf16 v109, v23, v23, v109
    v_mfma_f32_16x16x32_bf16 v[84:87], v[120:123], v[192:195], v[84:87]
    ds_read_b128 v[120:123], v7 offset:16384
    buffer_load_dwordx4 a[208:211], v2, s[36:39], s93 offen offset:0 sc1
    v_mfma_f32_16x16x32_bf16 v[60:63], v[124:127], v[188:191], v[60:63]
    s_nop 1
    v_mfma_f32_16x16x32_bf16 v[88:91], v[124:127], v[192:195], v[88:91]
    ds_read_b128 v[124:127], v7 offset:17408
    s_waitcnt lgkmcnt(5)
    v_mfma_f32_16x16x32_bf16 v[64:67], v[128:131], v[188:191], v[64:67]
    v_swap_b32 v198, v200
    v_cndmask_b32 v108, 0, v108, s[86:87]
    v_mfma_f32_16x16x32_bf16 v[92:95], v[128:131], v[192:195], v[92:95]
    ds_read_b128 v[128:131], v7 offset:18432
    v_cndmask_b32 v109, 0, v109, s[86:87]
    v_mfma_f32_16x16x32_bf16 v[68:71], v[132:135], v[188:191], v[68:71]
    v_swap_b32 v199, v201
    buffer_load_dwordx4 a[212:215], v2, s[36:39], s93 offen offset:1024 sc1
    v_mfma_f32_16x16x32_bf16 v[96:99], v[132:135], v[192:195], v[96:99]
    ds_read_b128 v[132:135], v7 offset:19456
    s_waitcnt lgkmcnt(6)
    v_mfma_f32_16x16x32_bf16 v[72:75], v[136:139], v[188:191], v[72:75]
    v_min_u32 v231, 7, v1
    v_add_f32_dpp v108, v108, v108 row_ror:8 row_mask:0xf bank_mask:0xf
    v_mfma_f32_16x16x32_bf16 v[100:103], v[136:139], v[192:195], v[100:103]
    ds_read_b128 v[136:139], v7 offset:20480
    s_waitcnt lgkmcnt(5)
    v_mfma_f32_16x16x32_bf16 v[48:51], v[112:115], v[196:199], v[48:51]
    buffer_load_dwordx4 v[188:191], v6, s[36:39], s88 offen offset:2048 sc1
    v_lshlrev_b32 v231, 7, v231
    v_mfma_f32_16x16x32_bf16 v[76:79], v[112:115], v[200:203], v[76:79]
    ds_read_b128 v[112:115], v7 offset:7168
    s_add_u32 s75, s64, 0
    v_mfma_f32_16x16x32_bf16 v[52:55], v[116:119], v[196:199], v[52:55]
    buffer_load_dwordx4 v[192:195], v6, s[36:39], s88 offen offset:2304 sc1
    buffer_load_dword v228, v231, s[36:39], s75 offen sc1
    v_mfma_f32_16x16x32_bf16 v[80:83], v[116:119], v[200:203], v[80:83]
    ds_read_b128 v[116:119], v7 offset:8192
    s_waitcnt lgkmcnt(5)
    v_mfma_f32_16x16x32_bf16 v[56:59], v[120:123], v[196:199], v[56:59]
    v_add_f32_dpp v109, v109, v109 row_ror:8 row_mask:0xf bank_mask:0xf
    v_mfma_f32_16x16x32_bf16 v[84:87], v[120:123], v[200:203], v[84:87]
    ds_read_b128 v[120:123], v7 offset:9216
    buffer_load_dwordx4 a[216:219], v2, s[36:39], s93 offen offset:2048 sc1
    v_mfma_f32_16x16x32_bf16 v[60:63], v[124:127], v[196:199], v[60:63]
    v_add_f32_dpp v108, v108, v108 row_ror:4 row_mask:0xf bank_mask:0xf
    v_mfma_f32_16x16x32_bf16 v[88:91], v[124:127], v[200:203], v[88:91]
    ds_read_b128 v[124:127], v7 offset:10240
    s_waitcnt lgkmcnt(5)
    v_mfma_f32_16x16x32_bf16 v[64:67], v[128:131], v[196:199], v[64:67]
    v_swap_b32 v206, v208
    buffer_load_dwordx4 a[220:223], v2, s[36:39], s93 offen offset:3072 sc1
    v_mfma_f32_16x16x32_bf16 v[92:95], v[128:131], v[200:203], v[92:95]
    ds_read_b128 v[128:131], v7 offset:11264
    v_add_f32_dpp v109, v109, v109 row_ror:4 row_mask:0xf bank_mask:0xf
    v_mfma_f32_16x16x32_bf16 v[68:71], v[132:135], v[196:199], v[68:71]
    v_swap_b32 v207, v209
    v_add_f32_dpp v108, v108, v108 row_ror:2 row_mask:0xf bank_mask:0xf
    v_mfma_f32_16x16x32_bf16 v[96:99], v[132:135], v[200:203], v[96:99]
    ds_read_b128 v[132:135], v7 offset:12288
    s_waitcnt lgkmcnt(6)
    v_mfma_f32_16x16x32_bf16 v[72:75], v[136:139], v[196:199], v[72:75]
    v_add_f32_dpp v109, v109, v109 row_ror:2 row_mask:0xf bank_mask:0xf
    v_add_f32_dpp v108, v108, v108 row_ror:1 row_mask:0xf bank_mask:0xf
    v_mfma_f32_16x16x32_bf16 v[100:103], v[136:139], v[200:203], v[100:103]
    ds_read_b128 v[136:139], v7 offset:13312
    s_waitcnt lgkmcnt(5)
    v_mfma_f32_16x16x32_bf16 v[48:51], v[112:115], v[204:207], v[48:51]
    s_add_u32 s93, s92, 13164544
    v_add_f32_dpp v109, v109, v109 row_ror:1 row_mask:0xf bank_mask:0xf
    v_mfma_f32_16x16x32_bf16 v[76:79], v[112:115], v[208:211], v[76:79]
    ds_read_b128 v[112:115], v7 offset:0
    buffer_load_dwordx4 a[224:227], v2, s[36:39], s93 offen offset:0 sc1
    v_mfma_f32_16x16x32_bf16 v[52:55], v[116:119], v[204:207], v[52:55]
    s_cmp_eq_u32 s30, 0
    s_cbranch_scc1 Lg_90
    s_add_u32 s74, s78, 320
    s_mov_b32 exec_lo, 0x00010001
    s_mov_b32 exec_hi, 0x00010001
    buffer_store_dwordx4 v[108:111], v229, s[36:39], s74 offen
    s_mov_b64 exec, -1
Lgb_91:
    s_nop 0
    v_dot2_f32_bf16 v108, v24, v9, 0
    v_mfma_f32_16x16x32_bf16 v[80:83], v[116:119], v[208:211], v[80:83]
    ds_read_b128 v[116:119], v7 offset:1024
    s_waitcnt lgkmcnt(5)
    v_mfma_f32_16x16x32_bf16 v[56:59], v[120:123], v[204:207], v[56:59]
    v_dot2_f32_bf16 v109, v24, v24, 0
    v_dot2_f32_bf16 v108, v25, v9, v108
    v_mfma_f32_16x16x32_bf16 v[84:87], v[120:123], v[208:211], v[84:87]
    ds_read_b128 v[120:123], v7 offset:2048
    v_dot2_f32_bf16 v109, v25, v25, v109
    v_mfma_f32_16x16x32_bf16 v[60:63], v[124:127], v[204:207], v[60:63]
    s_waitcnt vmcnt(40)
    v_dot2_f32_bf16 v108, v26, v9, v108
    v_mfma_f32_16x16x32_bf16 v[88:91], v[124:127], v[208:211], v[88:91]
    ds_read_b128 v[124:127], v7 offset:3072
    s_waitcnt lgkmcnt(5)
    v_mfma_f32_16x16x32_bf16 v[64:67], v[128:131], v[204:207], v[64:67]
    v_swap_b32 v214, v216
    buffer_load_dwordx4 a[228:231], v2, s[36:39], s93 offen offset:1024 sc1
    v_mfma_f32_16x16x32_bf16 v[92:95], v[128:131], v[208:211], v[92:95]
    ds_read_b128 v[128:131], v7 offset:4096
    v_dot2_f32_bf16 v109, v26, v26, v109
    v_mfma_f32_16x16x32_bf16 v[68:71], v[132:135], v[204:207], v[68:71]
    v_swap_b32 v215, v217
    v_dot2_f32_bf16 v108, v27, v9, v108
    v_mfma_f32_16x16x32_bf16 v[96:99], v[132:135], v[208:211], v[96:99]
    ds_read_b128 v[132:135], v7 offset:5120
    s_waitcnt lgkmcnt(6)
    v_mfma_f32_16x16x32_bf16 v[72:75], v[136:139], v[204:207], v[72:75]
    v_dot2_f32_bf16 v109, v27, v27, v109
    s_nop 1
    v_mfma_f32_16x16x32_bf16 v[100:103], v[136:139], v[208:211], v[100:103]
    ds_read_b128 v[136:139], v7 offset:6144
    s_waitcnt lgkmcnt(5)
    v_mfma_f32_16x16x32_bf16 v[48:51], v[112:115], v[212:215], v[48:51]
    buffer_load_dwordx4 a[232:235], v2, s[36:39], s93 offen offset:2048 sc1
    v_cndmask_b32 v108, 0, v108, s[86:87]
    v_mfma_f32_16x16x32_bf16 v[76:79], v[112:115], v[216:219], v[76:79]
    ds_read_b128 v[112:115], v2 offset:50176
    v_cndmask_b32 v109, 0, v109, s[86:87]
    v_mfma_f32_16x16x32_bf16 v[52:55], v[116:119], v[212:215], v[52:55]
    v_add_f32_dpp v108, v108, v108 row_ror:8 row_mask:0xf bank_mask:0xf
    v_add_f32_dpp v109, v109, v109 row_ror:8 row_mask:0xf bank_mask:0xf
    v_mfma_f32_16x16x32_bf16 v[80:83], v[116:119], v[216:219], v[80:83]
    ds_read_b128 v[116:119], v2 offset:51200
    s_waitcnt lgkmcnt(5)
    v_mfma_f32_16x16x32_bf16 v[56:59], v[120:123], v[212:215], v[56:59]
    v_add_f32_dpp v108, v108, v108 row_ror:4 row_mask:0xf bank_mask:0xf
    v_add_f32_dpp v109, v109, v109 row_ror:4 row_mask:0xf bank_mask:0xf
    v_mfma_f32_16x16x32_bf16 v[84:87], v[120:123], v[216:219], v[84:87]
    ds_read_b128 v[120:123], v2 offset:52224
    v_add_f32_dpp v108, v108, v108 row_ror:2 row_mask:0xf bank_mask:0xf
    v_mfma_f32_16x16x32_bf16 v[60:63], v[124:127], v[212:215], v[60:63]
    s_waitcnt vmcnt(38)
    buffer_load_dwordx4 a[236:239], v2, s[36:39], s93 offen offset:3072 sc1
    v_mfma_f32_16x16x32_bf16 v[88:91], v[124:127], v[216:219], v[88:91]
    ds_read_b128 v[124:127], v2 offset:53248
    s_waitcnt lgkmcnt(5)
    v_mfma_f32_16x16x32_bf16 v[64:67], v[128:131], v[212:215], v[64:67]
    v_swap_b32 v222, v224
    s_waitcnt vmcnt(7)
    v_cmp_ne_u32 vcc, v228, v14
    s_cbranch_vccz Lpd_98
    s_mov_b32 s96, 0
Lps_99x:
    buffer_load_dword v228, v231, s[36:39], s75 offen sc1
    s_waitcnt vmcnt(0)
    v_cmp_ne_u32 vcc, v228, v14
    s_cbranch_vccz Lpd_98
    s_sleep 1
    s_add_u32 s96, s96, 1
    s_cmp_lt_u32 s96, 100000
    s_cbranch_scc1 Lps_99x
Lpd_98:
    v_mfma_f32_16x16x32_bf16 v[92:95], v[128:131], v[216:219], v[92:95]
    ds_read_b128 v[128:131], v2 offset:54272
    v_add_f32_dpp v109, v109, v109 row_ror:2 row_mask:0xf bank_mask:0xf
    v_mfma_f32_16x16x32_bf16 v[68:71], v[132:135], v[212:215], v[68:71]
    v_swap_b32 v223, v225
    v_add_f32_dpp v108, v108, v108 row_ror:1 row_mask:0xf bank_mask:0xf
    v_mfma_f32_16x16x32_bf16 v[96:99], v[132:135], v[216:219], v[96:99]
    ds_read_b128 v[132:135], v2 offset:55296
    s_waitcnt lgkmcnt(6)
    v_mfma_f32_16x16x32_bf16 v[72:75], v[136:139], v[212:215], v[72:75]
    s_add_u32 s93, s92, 13168640
    v_add_f32_dpp v109, v109, v109 row_ror:1 row_mask:0xf bank_mask:0xf
    v_mfma_f32_16x16x32_bf16 v[100:103], v[136:139], v[216:219], v[100:103]
    ds_read_b128 v[136:139], v2 offset:56320
    s_waitcnt lgkmcnt(5)
    v_mfma_f32_16x16x32_bf16 v[48:51], v[112:115], v[220:223], v[48:51]
    s_add_u32 s88, s91, 33554432
    buffer_load_dwordx4 v[196:199], v2, s[36:39], s88 offen offset:0 sc1
    buffer_load_dwordx4 a[240:243], v2, s[36:39], s93 offen offset:0 sc1
    v_mfma_f32_16x16x32_bf16 v[76:79], v[112:115], v[224:227], v[76:79]
    ds_read_b128 v[112:115], v2 offset:43008
    s_cmp_eq_u32 s30, 0
    s_cbranch_scc1 Lg_92
    s_add_u32 s74, s78, 384
    s_mov_b32 exec_lo, 0x00010001
    s_mov_b32 exec_hi, 0x00010001
    buffer_store_dwordx4 v[108:111], v229, s[36:39], s74 offen
    s_mov_b64 exec, -1
Lgb_93:
    v_mfma_f32_16x16x32_bf16 v[52:55], v[116:119], v[220:223], v[52:55]
    buffer_load_dwordx4 v[200:203], v2, s[36:39], s88 offen offset:1024 sc1
    v_dot2_f32_bf16 v108, v28, v9, 0
    v_mfma_f32_16x16x32_bf16 v[80:83], v[116:119], v[224:227], v[80:83]
    ds_read_b128 v[116:119], v2 offset:44032
    s_waitcnt lgkmcnt(5)
    v_mfma_f32_16x16x32_bf16 v[56:59], v[120:123], v[220:223], v[56:59]
    buffer_load_dwordx4 v[204:207], v2, s[36:39], s88 offen offset:2048 sc1
    buffer_load_dwordx4 a[244:247], v2, s[36:39], s93 offen offset:1024 sc1
    v_mfma_f32_16x16x32_bf16 v[84:87], v[120:123], v[224:227], v[84:87]
    ds_read_b128 v[120:123], v2 offset:45056
    v_dot2_f32_bf16 v109, v28, v28, 0
    v_mfma_f32_16x16x32_bf16 v[60:63], v[124:127], v[220:223], v[60:63]
    buffer_load_dwordx4 v[208:211], v2, s[36:39], s88 offen offset:3072 sc1
    v_mfma_f32_16x16x32_bf16 v[88:91], v[124:127], v[224:227], v[88:91]
    ds_read_b128 v[124:127], v2 offset:46080
    s_waitcnt lgkmcnt(5)
    v_mfma_f32_16x16x32_bf16 v[64:67], v[128:131], v[220:223], v[64:67]
    v_swap_b32 v142, v144
    v_dot2_f32_bf16 v108, v29, v9, v108
    v_mfma_f32_16x16x32_bf16 v[92:95], v[128:131], v[224:227], v[92:95]
    ds_read_b128 v[128:131], v2 offset:47104
    v_dot2_f32_bf16 v109, v29, v29, v109
    v_mfma_f32_16x16x32_bf16 v[68:71], v[132:135], v[220:223], v[68:71]
    v_swap_b32 v143, v145
    v_dot2_f32_bf16 v108, v30, v9, v108
    v_mfma_f32_16x16x32_bf16 v[96:99], v[132:135], v[224:227], v[96:99]
    ds_read_b128 v[132:135], v2 offset:48128
    s_waitcnt lgkmcnt(6)
    v_mfma_f32_16x16x32_bf16 v[72:75], v[136:139], v[220:223], v[72:75]
    buffer_load_dwordx4 a[248:251], v2, s[36:39], s93 offen offset:2048 sc1
    v_dot2_f32_bf16 v109, v30, v30, v109
    v_mfma_f32_16x16x32_bf16 v[100:103], v[136:139], v[224:227], v[100:103]
    ds_read_b128 v[136:139], v2 offset:49152
    s_waitcnt lgkmcnt(5)
    v_mfma_f32_16x16x32_bf16 v[48:51], v[112:115], v[140:143], v[48:51]
    s_add_u32 s88, s91, 33558528
    buffer_load_dwordx4 v[212:215], v2, s[36:39], s88 offen offset:0 sc1
    v_dot2_f32_bf16 v108, v31, v9, v108
    v_mfma_f32_16x16x32_bf16 v[76:79], v[112:115], v[144:147], v[76:79]
    ds_read_b128 v[112:115], v2 offset:35840
    v_dot2_f32_bf16 v109, v31, v31, v109
    v_mfma_f32_16x16x32_bf16 v[52:55], v[116:119], v[140:143], v[52:55]
    buffer_load_dwordx4 v[216:219], v2, s[36:39], s88 offen offset:1024 sc1
    buffer_load_dwordx4 a[252:255], v2, s[36:39], s93 offen offset:3072 sc1
    v_mfma_f32_16x16x32_bf16 v[80:83], v[116:119], v[144:147], v[80:83]
    ds_read_b128 v[116:119], v2 offset:36864
    s_waitcnt lgkmcnt(5)
    v_mfma_f32_16x16x32_bf16 v[56:59], v[120:123], v[140:143], v[56:59]
    buffer_load_dwordx4 v[220:223], v2, s[36:39], s88 offen offset:2048 sc1
    s_nop 1
    v_mfma_f32_16x16x32_bf16 v[84:87], v[120:123], v[144:147], v[84:87]
    ds_read_b128 v[120:123], v2 offset:37888
    v_cndmask_b32 v108, 0, v108, s[86:87]
    v_mfma_f32_16x16x32_bf16 v[60:63], v[124:127], v[140:143], v[60:63]
    buffer_load_dwordx4 v[224:227], v2, s[36:39], s88 offen offset:3072 sc1
    v_mfma_f32_16x16x32_bf16 v[88:91], v[124:127], v[144:147], v[88:91]
    ds_read_b128 v[124:127], v2 offset:38912
    s_waitcnt lgkmcnt(5)
    v_mfma_f32_16x16x32_bf16 v[64:67], v[128:131], v[140:143], v[64:67]
    v_swap_b32 v150, v152
    v_cndmask_b32 v109, 0, v109, s[86:87]
    v_mfma_f32_16x16x32_bf16 v[92:95], v[128:131], v[144:147], v[92:95]
    ds_read_b128 v[128:131], v2 offset:39936
    v_add_f32_dpp v108, v108, v108 row_ror:8 row_mask:0xf bank_mask:0xf
    v_mfma_f32_16x16x32_bf16 v[68:71], v[132:135], v[140:143], v[68:71]
    v_swap_b32 v151, v153
    s_add_u32 s93, s92, 13172736
    v_mfma_f32_16x16x32_bf16 v[96:99], v[132:135], v[144:147], v[96:99]
    ds_read_b128 v[132:135], v2 offset:40960
    s_waitcnt lgkmcnt(6)
    v_mfma_f32_16x16x32_bf16 v[72:75], v[136:139], v[140:143], v[72:75]
    buffer_load_dwordx4 v[232:235], v2, s[36:39], s93 offen offset:0 sc1
    v_add_f32_dpp v109, v109, v109 row_ror:8 row_mask:0xf bank_mask:0xf
    v_mfma_f32_16x16x32_bf16 v[100:103], v[136:139], v[144:147], v[100:103]
    ds_read_b128 v[136:139], v2 offset:41984
    s_waitcnt lgkmcnt(5)
    v_mfma_f32_16x16x32_bf16 v[48:51], v[112:115], v[148:151], v[48:51]
    s_add_u32 s88, s91, 33562624
    buffer_load_dwordx4 v[140:143], v2, s[36:39], s88 offen offset:0 sc1
    buffer_load_dwordx4 v[236:239], v2, s[36:39], s93 offen offset:1024 sc1
    v_mfma_f32_16x16x32_bf16 v[76:79], v[112:115], v[152:155], v[76:79]
    ds_read_b128 v[112:115], v2 offset:28672
    v_add_f32_dpp v108, v108, v108 row_ror:4 row_mask:0xf bank_mask:0xf
    v_mfma_f32_16x16x32_bf16 v[52:55], v[116:119], v[148:151], v[52:55]
    buffer_load_dwordx4 v[144:147], v2, s[36:39], s88 offen offset:1024 sc1
    v_add_f32_dpp v109, v109, v109 row_ror:4 row_mask:0xf bank_mask:0xf
    v_mfma_f32_16x16x32_bf16 v[80:83], v[116:119], v[152:155], v[80:83]
    ds_read_b128 v[116:119], v2 offset:29696
    s_waitcnt lgkmcnt(5)
    v_mfma_f32_16x16x32_bf16 v[56:59], v[120:123], v[148:151], v[56:59]
    v_add_f32_dpp v108, v108, v108 row_ror:2 row_mask:0xf bank_mask:0xf
    v_add_f32_dpp v109, v109, v109 row_ror:2 row_mask:0xf bank_mask:0xf
    v_mfma_f32_16x16x32_bf16 v[84:87], v[120:123], v[152:155], v[84:87]
    ds_read_b128 v[120:123], v2 offset:30720
    v_add_f32_dpp v108, v108, v108 row_ror:1 row_mask:0xf bank_mask:0xf
    v_mfma_f32_16x16x32_bf16 v[60:63], v[124:127], v[148:151], v[60:63]
    v_add_f32_dpp v109, v109, v109 row_ror:1 row_mask:0xf bank_mask:0xf
    v_mfma_f32_16x16x32_bf16 v[88:91], v[124:127], v[152:155], v[88:91]
    ds_read_b128 v[124:127], v2 offset:31744
    s_waitcnt lgkmcnt(5)
    v_mfma_f32_16x16x32_bf16 v[64:67], v[128:131], v[148:151], v[64:67]
    v_swap_b32 v158, v160
    buffer_load_dwordx4 v[240:243], v2, s[36:39], s93 offen offset:2048 sc1
    v_mfma_f32_16x16x32_bf16 v[92:95], v[128:131], v[152:155], v[92:95]
    ds_read_b128 v[128:131], v2 offset:32768
    s_cmp_eq_u32 s30, 0
    s_cbranch_scc1 Lg_94
    s_add_u32 s74, s78, 448
    s_mov_b32 exec_lo, 0x00010001
    s_mov_b32 exec_hi, 0x00010001
    buffer_store_dwordx4 v[108:111], v229, s[36:39], s74 offen
    s_mov_b64 exec, -1
Lgb_95:
    v_mfma_f32_16x16x32_bf16 v[68:71], v[132:135], v[148:151], v[68:71]
    v_swap_b32 v159, v161
    v_mfma_f32_16x16x32_bf16 v[96:99], v[132:135], v[152:155], v[96:99]
    ds_read_b128 v[132:135], v2 offset:33792
    s_waitcnt lgkmcnt(6)
    v_mfma_f32_16x16x32_bf16 v[72:75], v[136:139], v[148:151], v[72:75]
    v_mfma_f32_16x16x32_bf16 v[100:103], v[136:139], v[152:155], v[100:103]
    ds_read_b128 v[136:139], v2 offset:34816
    s_waitcnt lgkmcnt(5)
    v_mfma_f32_16x16x32_bf16 v[48:51], v[112:115], v[156:159], v[48:51]
    buffer_load_dwordx4 v[148:151], v2, s[36:39], s88 offen offset:2048 sc1
    buffer_load_dwordx4 v[244:247], v2, s[36:39], s93 offen offset:3072 sc1
    v_mfma_f32_16x16x32_bf16 v[76:79], v[112:115], v[160:163], v[76:79]
    ds_read_b128 v[112:115], v2 offset:21504
    v_mfma_f32_16x16x32_bf16 v[52:55], v[116:119], v[156:159], v[52:55]
    buffer_load_dwordx4 v[152:155], v2, s[36:39], s88 offen offset:3072 sc1
    v_mfma_f32_16x16x32_bf16 v[80:83], v[116:119], v[160:163], v[80:83]
    ds_read_b128 v[116:119], v2 offset:22528
    s_waitcnt lgkmcnt(5)
    v_mfma_f32_16x16x32_bf16 v[56:59], v[120:123], v[156:159], v[56:59]
    v_mfma_f32_16x16x32_bf16 v[84:87], v[120:123], v[160:163], v[84:87]
    ds_read_b128 v[120:123], v2 offset:23552
    v_mfma_f32_16x16x32_bf16 v[60:63], v[124:127], v[156:159], v[60:63]
    s_add_u32 s93, s92, 13176832
    v_mfma_f32_16x16x32_bf16 v[88:91], v[124:127], v[160:163], v[88:91]
    ds_read_b128 v[124:127], v2 offset:24576
    s_waitcnt lgkmcnt(5)
    v_mfma_f32_16x16x32_bf16 v[64:67], v[128:131], v[156:159], v[64:67]
    v_swap_b32 v166, v168
    buffer_load_dwordx4 v[248:251], v2, s[36:39], s93 offen offset:0 sc1
    v_mfma_f32_16x16x32_bf16 v[92:95], v[128:131], v[160:163], v[92:95]
    ds_read_b128 v[128:131], v2 offset:25600
    v_mfma_f32_16x16x32_bf16 v[68:71], v[132:135], v[156:159], v[68:71]
    v_swap_b32 v167, v169
    v_mfma_f32_16x16x32_bf16 v[96:99], v[132:135], v[160:163], v[96:99]
    ds_read_b128 v[132:135], v2 offset:26624
    s_waitcnt lgkmcnt(6)
    v_mfma_f32_16x16x32_bf16 v[72:75], v[136:139], v[156:159], v[72:75]
    v_mfma_f32_16x16x32_bf16 v[100:103], v[136:139], v[160:163], v[100:103]
    ds_read_b128 v[136:139], v2 offset:27648
    s_waitcnt lgkmcnt(5)
    v_mfma_f32_16x16x32_bf16 v[48:51], v[112:115], v[164:167], v[48:51]
    s_add_u32 s88, s91, 33566720
    buffer_load_dwordx4 v[156:159], v2, s[36:39], s88 offen offset:0 sc1
    buffer_load_dwordx4 v[252:255], v2, s[36:39], s93 offen offset:1024 sc1
    v_mfma_f32_16x16x32_bf16 v[76:79], v[112:115], v[168:171], v[76:79]
    ds_read_b128 v[112:115], v2 offset:14336
    v_mfma_f32_16x16x32_bf16 v[52:55], v[116:119], v[164:167], v[52:55]
    buffer_load_dwordx4 v[160:163], v2, s[36:39], s88 offen offset:1024 sc1
    v_mfma_f32_16x16x32_bf16 v[80:83], v[116:119], v[168:171], v[80:83]
    ds_read_b128 v[116:119], v2 offset:15360
    s_waitcnt lgkmcnt(5)
    v_mfma_f32_16x16x32_bf16 v[56:59], v[120:123], v[164:167], v[56:59]
    v_mfma_f32_16x16x32_bf16 v[84:87], v[120:123], v[168:171], v[84:87]
    ds_read_b128 v[120:123], v2 offset:16384
    v_mfma_f32_16x16x32_bf16 v[60:63], v[124:127], v[164:167], v[60:63]
    v_mfma_f32_16x16x32_bf16 v[88:91], v[124:127], v[168:171], v[88:91]
    ds_read_b128 v[124:127], v2 offset:17408
    s_waitcnt lgkmcnt(5)
    v_mfma_f32_16x16x32_bf16 v[64:67], v[128:131], v[164:167], v[64:67]
    v_swap_b32 v174, v176
    v_mfma_f32_16x16x32_bf16 v[92:95], v[128:131], v[168:171], v[92:95]
    ds_read_b128 v[128:131], v2 offset:18432
    v_mfma_f32_16x16x32_bf16 v[68:71], v[132:135], v[164:167], v[68:71]
    v_swap_b32 v175, v177
    v_mfma_f32_16x16x32_bf16 v[96:99], v[132:135], v[168:171], v[96:99]
    ds_read_b128 v[132:135], v2 offset:19456
    s_waitcnt lgkmcnt(6)
    v_mfma_f32_16x16x32_bf16 v[72:75], v[136:139], v[164:167], v[72:75]
    v_mfma_f32_16x16x32_bf16 v[100:103], v[136:139], v[168:171], v[100:103]
    ds_read_b128 v[136:139], v2 offset:20480
    s_waitcnt lgkmcnt(5)
    v_mfma_f32_16x16x32_bf16 v[48:51], v[112:115], v[172:175], v[48:51]
    s_add_u32 s88, s91, 33611776
    buffer_load_dwordx4 v[164:167], v2, s[36:39], s88 offen offset:0 sc1
    v_mfma_f32_16x16x32_bf16 v[76:79], v[112:115], v[176:179], v[76:79]
    ds_read_b128 v[112:115], v2 offset:7168
    v_mfma_f32_16x16x32_bf16 v[52:55], v[116:119], v[172:175], v[52:55]
    buffer_load_dwordx4 v[168:171], v2, s[36:39], s88 offen offset:1024 sc1
    v_mfma_f32_16x16x32_bf16 v[80:83], v[116:119], v[176:179], v[80:83]
    ds_read_b128 v[116:119], v2 offset:8192
    s_waitcnt lgkmcnt(5)
    v_mfma_f32_16x16x32_bf16 v[56:59], v[120:123], v[172:175], v[56:59]
    v_mfma_f32_16x16x32_bf16 v[84:87], v[120:123], v[176:179], v[84:87]
    ds_read_b128 v[120:123], v2 offset:9216
    v_mfma_f32_16x16x32_bf16 v[60:63], v[124:127], v[172:175], v[60:63]
    v_mfma_f32_16x16x32_bf16 v[88:91], v[124:127], v[176:179], v[88:91]
    ds_read_b128 v[124:127], v2 offset:10240
    s_waitcnt lgkmcnt(5)
    v_mfma_f32_16x16x32_bf16 v[64:67], v[128:131], v[172:175], v[64:67]
    v_swap_b32 v182, v184
    v_mfma_f32_16x16x32_bf16 v[92:95], v[128:131], v[176:179], v[92:95]
    ds_read_b128 v[128:131], v2 offset:11264
    v_mfma_f32_16x16x32_bf16 v[68:71], v[132:135], v[172:175], v[68:71]
    v_swap_b32 v183, v185
    v_mfma_f32_16x16x32_bf16 v[96:99], v[132:135], v[176:179], v[96:99]
    ds_read_b128 v[132:135], v2 offset:12288
    s_waitcnt lgkmcnt(6)
    v_mfma_f32_16x16x32_bf16 v[72:75], v[136:139], v[172:175], v[72:75]
    v_mfma_f32_16x16x32_bf16 v[100:103], v[136:139], v[176:179], v[100:103]
    ds_read_b128 v[136:139], v2 offset:13312
    s_waitcnt lgkmcnt(0)
    v_mfma_f32_16x16x32_bf16 v[72:75], v[136:139], v[180:183], v[72:75]
    buffer_load_dwordx4 v[172:175], v2, s[36:39], s88 offen offset:2048 sc1
    v_mfma_f32_16x16x32_bf16 v[100:103], v[136:139], v[184:187], v[100:103]
    ds_read_b128 v[136:139], v2 offset:6144
    v_mfma_f32_16x16x32_bf16 v[48:51], v[112:115], v[180:183], v[48:51]
    buffer_load_dwordx4 v[176:179], v2, s[36:39], s88 offen offset:3072 sc1
    v_mfma_f32_16x16x32_bf16 v[76:79], v[112:115], v[184:187], v[76:79]
    ds_read_b128 v[112:115], v2 offset:0
    v_mfma_f32_16x16x32_bf16 v[52:55], v[116:119], v[180:183], v[52:55]
    v_and_b32 v105, 7, v1
    v_lshlrev_b32 v105, 10, v105
    v_mfma_f32_16x16x32_bf16 v[80:83], v[116:119], v[184:187], v[80:83]
    ds_read_b128 v[116:119], v2 offset:1024
    v_lshl_add_u32 v105, v4, 4, v105
    v_mfma_f32_16x16x32_bf16 v[56:59], v[120:123], v[180:183], v[56:59]
    v_and_b32 v107, 8, v1
    v_mfma_f32_16x16x32_bf16 v[84:87], v[120:123], v[184:187], v[84:87]
    ds_read_b128 v[120:123], v2 offset:2048
    v_mfma_f32_16x16x32_bf16 v[60:63], v[124:127], v[180:183], v[60:63]
    v_swap_b32 v190, v192
    v_lshl_add_u32 v105, v107, 3, v105
    v_mfma_f32_16x16x32_bf16 v[88:91], v[124:127], v[184:187], v[88:91]
    ds_read_b128 v[124:127], v2 offset:3072
    s_add_u32 s79, s69, 256
    v_mfma_f32_16x16x32_bf16 v[64:67], v[128:131], v[180:183], v[64:67]
    v_swap_b32 v191, v193
    buffer_load_dwordx4 v[108:111], v105, s[36:39], s79 offen offset:0 sc1
    v_mfma_f32_16x16x32_bf16 v[92:95], v[128:131], v[184:187], v[92:95]
    ds_read_b128 v[128:131], v2 offset:4096
    v_mfma_f32_16x16x32_bf16 v[68:71], v[132:135], v[180:183], v[68:71]
    buffer_load_dwordx4 v[228:231], v105, s[36:39], s79 offen offset:128 sc1
    v_mfma_f32_16x16x32_bf16 v[96:99], v[132:135], v[184:187], v[96:99]
    ds_read_b128 v[132:135], v2 offset:5120
    s_waitcnt lgkmcnt(5)
    v_mfma_f32_16x16x32_bf16 v[72:75], v[136:139], v[188:191], v[72:75]
    s_add_u32 s88, s91, 33615872
    buffer_load_dwordx4 v[180:183], v2, s[36:39], s88 offen offset:0 sc1
    v_mfma_f32_16x16x32_bf16 v[100:103], v[136:139], v[192:195], v[100:103]
    ds_read_b128 v[136:139], v0 offset:0
    v_mfma_f32_16x16x32_bf16 v[48:51], v[112:115], v[188:191], v[48:51]
    buffer_load_dwordx4 v[184:187], v2, s[36:39], s88 offen offset:1024 sc1
    v_mfma_f32_16x16x32_bf16 v[76:79], v[112:115], v[192:195], v[76:79]
    ds_read_b128 v[112:115], v0 offset:43008
    s_waitcnt lgkmcnt(5)
    v_mfma_f32_16x16x32_bf16 v[52:55], v[116:119], v[188:191], v[52:55]
    v_mfma_f32_16x16x32_bf16 v[80:83], v[116:119], v[192:195], v[80:83]
    ds_read_b128 v[116:119], v0 offset:35840
    v_mfma_f32_16x16x32_bf16 v[56:59], v[120:123], v[188:191], v[56:59]
    ds_bpermute_b32 v104, v10, v74
    ds_bpermute_b32 v106, v10, v102
    v_mfma_f32_16x16x32_bf16 v[84:87], v[120:123], v[192:195], v[84:87]
    ds_read_b128 v[120:123], v0 offset:28672
    s_waitcnt lgkmcnt(7)
    v_mfma_f32_16x16x32_bf16 v[60:63], v[124:127], v[188:191], v[60:63]
    v_mfma_f32_16x16x32_bf16 v[88:91], v[124:127], v[192:195], v[88:91]
    ds_read_b128 v[124:127], v0 offset:21504
    v_mfma_f32_16x16x32_bf16 v[64:67], v[128:131], v[188:191], v[64:67]
    v_mfma_f32_16x16x32_bf16 v[92:95], v[128:131], v[192:195], v[92:95]
    ds_read_b128 v[128:131], v0 offset:14336
    s_waitcnt lgkmcnt(8)
    v_mfma_f32_16x16x32_bf16 v[68:71], v[132:135], v[188:191], v[68:71]
    s_waitcnt lgkmcnt(3)
    v_mul_f32 v104, 0x3acccccd, v104
    v_mfma_f32_16x16x32_bf16 v[96:99], v[132:135], v[192:195], v[96:99]
    ds_read_b128 v[132:135], v0 offset:7168
    v_mul_f32 v106, 0x3acccccd, v106
    v_cvt_pk_bf16_f32 v104, v104, v104
    v_cvt_pk_bf16_f32 v106, v106, v106
    v_lshlrev_b32 v104, 16, v104
    v_lshlrev_b32 v106, 16, v106
    s_add_u32 s72, s95, 23592960
    buffer_load_dwordx4 v[188:191], v2, s[36:39], s88 offen offset:2048 sc1
    buffer_load_dwordx4 v[192:195], v2, s[36:39], s88 offen offset:3072 sc1
    v_pk_fma_f32 v[72:73], v[136:137], v[104:105], v[72:73] op_sel_hi:[1,0,1] neg_lo:[0,1,0] neg_hi:[0,1,0]
    v_pk_fma_f32 v[74:75], v[138:139], v[104:105], v[74:75] op_sel_hi:[1,0,1] neg_lo:[0,1,0] neg_hi:[0,1,0]
    v_pk_fma_f32 v[48:49], v[112:113], v[104:105], v[48:49] op_sel_hi:[1,0,1] neg_lo:[0,1,0] neg_hi:[0,1,0]
    v_pk_fma_f32 v[50:51], v[114:115], v[104:105], v[50:51] op_sel_hi:[1,0,1] neg_lo:[0,1,0] neg_hi:[0,1,0]
    v_pk_fma_f32 v[52:53], v[116:117], v[104:105], v[52:53] op_sel_hi:[1,0,1] neg_lo:[0,1,0] neg_hi:[0,1,0]
    v_pk_fma_f32 v[54:55], v[118:119], v[104:105], v[54:55] op_sel_hi:[1,0,1] neg_lo:[0,1,0] neg_hi:[0,1,0]
    s_waitcnt lgkmcnt(3)
    v_pk_fma_f32 v[56:57], v[120:121], v[104:105], v[56:57] op_sel_hi:[1,0,1] neg_lo:[0,1,0] neg_hi:[0,1,0]
    v_pk_fma_f32 v[58:59], v[122:123], v[104:105], v[58:59] op_sel_hi:[1,0,1] neg_lo:[0,1,0] neg_hi:[0,1,0]
    s_waitcnt lgkmcnt(2)
    v_pk_fma_f32 v[60:61], v[124:125], v[104:105], v[60:61] op_sel_hi:[1,0,1] neg_lo:[0,1,0] neg_hi:[0,1,0]
    v_pk_fma_f32 v[62:63], v[126:127], v[104:105], v[62:63] op_sel_hi:[1,0,1] neg_lo:[0,1,0] neg_hi:[0,1,0]
    s_waitcnt lgkmcnt(1)
    v_pk_fma_f32 v[64:65], v[128:129], v[104:105], v[64:65] op_sel_hi:[1,0,1] neg_lo:[0,1,0] neg_hi:[0,1,0]
    v_pk_fma_f32 v[66:67], v[130:131], v[104:105], v[66:67] op_sel_hi:[1,0,1] neg_lo:[0,1,0] neg_hi:[0,1,0]
    s_waitcnt lgkmcnt(0)
    v_pk_fma_f32 v[68:69], v[132:133], v[104:105], v[68:69] op_sel_hi:[1,0,1] neg_lo:[0,1,0] neg_hi:[0,1,0]
    v_pk_fma_f32 v[70:71], v[134:135], v[104:105], v[70:71] op_sel_hi:[1,0,1] neg_lo:[0,1,0] neg_hi:[0,1,0]
    v_permlane32_swap_b32 v72, v74
    v_permlane32_swap_b32 v73, v75
    v_pk_mul_f32 v[48:49], v[48:49], v[60:61]
    v_pk_mul_f32 v[50:51], v[50:51], v[62:63]
    v_pk_mul_f32 v[52:53], v[52:53], v[64:65]
    v_pk_mul_f32 v[54:55], v[54:55], v[66:67]
    v_pk_mul_f32 v[56:57], v[56:57], v[68:69]
    v_pk_mul_f32 v[58:59], v[58:59], v[70:71]
    v_pk_mul_f32 v[60:61], v[72:73], v[74:75]
    v_cvt_pk_bf16_f32 v72, v56, v57
    v_cvt_pk_bf16_f32 v73, v58, v59
    v_mov_b32 v71, 0
    v_cvt_pk_bf16_f32 v64, v48, v49
    v_cvt_pk_bf16_f32 v65, v50, v51
    v_cvt_pk_bf16_f32 v66, v52, v53
    v_cvt_pk_bf16_f32 v67, v54, v55
    v_permlane16_swap_b32 v72, v73
    v_cvt_pk_bf16_f32 v68, v56, v57
    v_cvt_pk_bf16_f32 v69, v58, v59
    v_cvt_pk_bf16_f32 v70, v60, v61
    v_permlane32_swap_b32 v73, v71
    buffer_store_dwordx4 v[64:67], v2, s[36:39], s72 offen sc1
    s_mov_b32 exec_hi, 0xffff
    buffer_store_dwordx4 v[68:71], v2, s[36:39], s72 offen offset:1024 sc1
    s_mov_b64 exec, -1
    s_add_u32 s72, s72, 57344
    v_pk_fma_f32 v[100:101], v[136:137], v[106:107], v[100:101] op_sel_hi:[1,0,1] neg_lo:[0,1,0] neg_hi:[0,1,0]
    v_pk_fma_f32 v[102:103], v[138:139], v[106:107], v[102:103] op_sel_hi:[1,0,1] neg_lo:[0,1,0] neg_hi:[0,1,0]
    v_pk_fma_f32 v[76:77], v[112:113], v[106:107], v[76:77] op_sel_hi:[1,0,1] neg_lo:[0,1,0] neg_hi:[0,1,0]
    v_pk_fma_f32 v[78:79], v[114:115], v[106:107], v[78:79] op_sel_hi:[1,0,1] neg_lo:[0,1,0] neg_hi:[0,1,0]
    v_pk_fma_f32 v[80:81], v[116:117], v[106:107], v[80:81] op_sel_hi:[1,0,1] neg_lo:[0,1,0] neg_hi:[0,1,0]
    v_pk_fma_f32 v[82:83], v[118:119], v[106:107], v[82:83] op_sel_hi:[1,0,1] neg_lo:[0,1,0] neg_hi:[0,1,0]
    v_pk_fma_f32 v[84:85], v[120:121], v[106:107], v[84:85] op_sel_hi:[1,0,1] neg_lo:[0,1,0] neg_hi:[0,1,0]
    v_pk_fma_f32 v[86:87], v[122:123], v[106:107], v[86:87] op_sel_hi:[1,0,1] neg_lo:[0,1,0] neg_hi:[0,1,0]
    v_pk_fma_f32 v[88:89], v[124:125], v[106:107], v[88:89] op_sel_hi:[1,0,1] neg_lo:[0,1,0] neg_hi:[0,1,0]
    v_pk_fma_f32 v[90:91], v[126:127], v[106:107], v[90:91] op_sel_hi:[1,0,1] neg_lo:[0,1,0] neg_hi:[0,1,0]
    v_pk_fma_f32 v[92:93], v[128:129], v[106:107], v[92:93] op_sel_hi:[1,0,1] neg_lo:[0,1,0] neg_hi:[0,1,0]
    v_pk_fma_f32 v[94:95], v[130:131], v[106:107], v[94:95] op_sel_hi:[1,0,1] neg_lo:[0,1,0] neg_hi:[0,1,0]
    v_pk_fma_f32 v[96:97], v[132:133], v[106:107], v[96:97] op_sel_hi:[1,0,1] neg_lo:[0,1,0] neg_hi:[0,1,0]
    v_pk_fma_f32 v[98:99], v[134:135], v[106:107], v[98:99] op_sel_hi:[1,0,1] neg_lo:[0,1,0] neg_hi:[0,1,0]
    v_permlane32_swap_b32 v100, v102
    v_permlane32_swap_b32 v101, v103
    v_pk_mul_f32 v[76:77], v[76:77], v[88:89]
    v_pk_mul_f32 v[78:79], v[78:79], v[90:91]
    v_pk_mul_f32 v[80:81], v[80:81], v[92:93]
    v_pk_mul_f32 v[82:83], v[82:83], v[94:95]
    v_pk_mul_f32 v[84:85], v[84:85], v[96:97]
    v_pk_mul_f32 v[86:87], v[86:87], v[98:99]
    v_pk_mul_f32 v[88:89], v[100:101], v[102:103]
    v_cvt_pk_bf16_f32 v100, v84, v85
    v_cvt_pk_bf16_f32 v101, v86, v87
    v_mov_b32 v99, 0
    v_cvt_pk_bf16_f32 v92, v76, v77
    v_cvt_pk_bf16_f32 v93, v78, v79
    v_cvt_pk_bf16_f32 v94, v80, v81
    v_cvt_pk_bf16_f32 v95, v82, v83
    v_permlane16_swap_b32 v100, v101
    v_cvt_pk_bf16_f32 v96, v84, v85
    v_cvt_pk_bf16_f32 v97, v86, v87
    v_cvt_pk_bf16_f32 v98, v88, v89
    v_permlane32_swap_b32 v101, v99
    buffer_store_dwordx4 v[92:95], v2, s[36:39], s72 offen sc1
    s_mov_b32 exec_hi, 0xffff
    buffer_store_dwordx4 v[96:99], v2, s[36:39], s72 offen offset:1024 sc1
    s_mov_b64 exec, -1
    s_waitcnt vmcnt(15)
    s_waitcnt vmcnt(14)
L_join:
    v_mfma_f32_16x16x32_bf16 v[48:51], a[0:3], v[196:199], 0
    v_mfma_f32_16x16x32_bf16 v[52:55], a[4:7], v[196:199], 0
    v_lshlrev_b32 v132, 9, v3
    v_lshl_add_u32 v132, v4, 4, v132
    v_mfma_f32_16x16x32_bf16 v[56:59], a[8:11], v[196:199], 0
    v_mul_u32_u24 v134, 1280, v4
    v_lshl_add_u32 v134, v3, 4, v134
    v_mfma_f32_16x16x32_bf16 v[60:63], a[12:15], v[196:199], 0
    v_lshlrev_b32 v135, 4, v4
    v_and_b32 v136, 7, v1
    v_mfma_f32_16x16x32_bf16 v[64:67], a[16:19], v[196:199], 0
    v_lshl_add_u32 v136, v136, 10, v135
    v_mov_b32 v130, v14
    v_mfma_f32_16x16x32_bf16 v[48:51], a[20:23], v[200:203], v[48:51]
    v_mov_b32 v131, v14
    s_mul_i32 s76, s62, 40960
    v_mfma_f32_16x16x32_bf16 v[52:55], a[24:27], v[200:203], v[52:55]
    s_add_u32 s88, s91, 33619968
    buffer_load_dwordx4 v[196:199], v2, s[36:39], s88 offen offset:0 sc1
    v_mfma_f32_16x16x32_bf16 v[56:59], a[28:31], v[200:203], v[56:59]
    s_mul_i32 s77, s63, 5120
    s_add_u32 s76, s76, s77
    v_mfma_f32_16x16x32_bf16 v[60:63], a[32:35], v[200:203], v[60:63]
    s_lshl_b32 s77, s6, 6
    s_add_u32 s76, s76, s77
    v_mfma_f32_16x16x32_bf16 v[64:67], a[36:39], v[200:203], v[64:67]
    s_lshl_b32 s77, s62, 3
    s_add_u32 s77, s77, s6
    v_mfma_f32_16x16x32_bf16 v[48:51], a[40:43], v[204:207], v[48:51]
    s_mul_i32 s77, s77, 5120
    s_mul_i32 s78, s63, 160
    v_mfma_f32_16x16x32_bf16 v[52:55], a[44:47], v[204:207], v[52:55]
    s_add_u32 s77, s77, s78
    s_lshl_b32 s78, s63, 10
    v_mfma_f32_16x16x32_bf16 v[56:59], a[48:51], v[204:207], v[56:59]
    buffer_load_dwordx4 v[200:203], v2, s[36:39], s88 offen offset:1024 sc1
    s_add_u32 s78, s78, s69
    v_mfma_f32_16x16x32_bf16 v[60:63], a[52:55], v[204:207], v[60:63]
    s_waitcnt vmcnt(11)
    v_cmp_ne_u32 vcc, v111, v14
    s_cbranch_vccnz Lps_101
Lpd_100:
    v_add_f32_dpp v108, v108, v108 quad_perm:[1,0,3,2] row_mask:0xf bank_mask:0xf
    v_mfma_f32_16x16x32_bf16 v[64:67], a[56:59], v[204:207], v[64:67]
    v_add_f32_dpp v109, v109, v109 quad_perm:[1,0,3,2] row_mask:0xf bank_mask:0xf
    v_add_f32_dpp v108, v108, v108 quad_perm:[2,3,0,1] row_mask:0xf bank_mask:0xf
    v_mfma_f32_16x16x32_bf16 v[48:51], a[60:63], v[208:211], v[48:51]
    buffer_load_dwordx4 v[204:207], v2, s[36:39], s88 offen offset:2048 sc1
    v_add_f32_dpp v109, v109, v109 quad_perm:[2,3,0,1] row_mask:0xf bank_mask:0xf
    v_mfma_f32_16x16x32_bf16 v[52:55], a[64:67], v[208:211], v[52:55]
    v_add_f32_dpp v108, v108, v108 row_half_mirror row_mask:0xf bank_mask:0xf
    v_mfma_f32_16x16x32_bf16 v[56:59], a[68:71], v[208:211], v[56:59]
    v_add_f32_dpp v109, v109, v109 row_half_mirror row_mask:0xf bank_mask:0xf
    v_mul_f32 v108, 0x3acccccd, v108
    v_mfma_f32_16x16x32_bf16 v[60:63], a[72:75], v[208:211], v[60:63]
    v_mul_f32 v109, 0x3acccccd, v109
    v_fma_f32 v109, -v108, v108, v109
    v_mfma_f32_16x16x32_bf16 v[64:67], a[76:79], v[208:211], v[64:67]
    v_max_f32 v109, 0, v109
    v_cvt_pk_bf16_f32 v109, v109, v109
    v_mfma_f32_16x16x32_bf16 v[48:51], a[80:83], v[212:215], v[48:51]
    v_lshlrev_b32 v109, 16, v109
    v_add_f32 v109, 0x3727c5ac, v109
    v_mfma_f32_16x16x32_bf16 v[52:55], a[84:87], v[212:215], v[52:55]
    buffer_load_dwordx4 v[208:211], v2, s[36:39], s88 offen offset:3072 sc1
    v_cvt_pk_bf16_f32 v109, v109, v109
    v_mfma_f32_16x16x32_bf16 v[56:59], a[88:91], v[212:215], v[56:59]
    v_lshlrev_b32 v109, 16, v109
    v_sqrt_f32 v109, v109
    v_mfma_f32_16x16x32_bf16 v[60:63], a[92:95], v[212:215], v[60:63]
    v_cvt_pk_bf16_f32 v109, v109, v109
    v_lshlrev_b32 v109, 16, v109
    v_mfma_f32_16x16x32_bf16 v[64:67], a[96:99], v[212:215], v[64:67]
    v_rcp_f32 v109, v109
    s_nop 0
    v_mul_f32 v9, v109, v109
    v_mfma_f32_16x16x32_bf16 v[48:51], a[100:103], v[216:219], v[48:51]
    v_mul_f32 v5, v109, v109
    v_mul_f32 v109, v109, v109
    v_mfma_f32_16x16x32_bf16 v[52:55], a[104:107], v[216:219], v[52:55]
    s_nop 0
    v_mov_b32_dpp v9, v109 row_shr:8 row_mask:0xf bank_mask:0xf
    v_mfma_f32_16x16x32_bf16 v[56:59], a[108:111], v[216:219], v[56:59]
    s_add_u32 s88, s91, 33624064
    buffer_load_dwordx4 v[212:215], v2, s[36:39], s88 offen offset:0 sc1
    v_mov_b32_dpp v5, v109 row_shl:8 row_mask:0xf bank_mask:0xf
    v_mfma_f32_16x16x32_bf16 v[60:63], a[112:115], v[216:219], v[60:63]
    s_waitcnt vmcnt(13)
    v_cmp_ne_u32 vcc, v231, v14
    s_cbranch_vccnz Lps_103
Lpd_102:
    v_add_f32_dpp v228, v228, v228 quad_perm:[1,0,3,2] row_mask:0xf bank_mask:0xf
    v_mfma_f32_16x16x32_bf16 v[64:67], a[116:119], v[216:219], v[64:67]
    v_add_f32_dpp v229, v229, v229 quad_perm:[1,0,3,2] row_mask:0xf bank_mask:0xf
    v_add_f32_dpp v228, v228, v228 quad_perm:[2,3,0,1] row_mask:0xf bank_mask:0xf
    v_mfma_f32_16x16x32_bf16 v[48:51], a[120:123], v[220:223], v[48:51]
    buffer_load_dwordx4 v[216:219], v2, s[36:39], s88 offen offset:1024 sc1
    v_add_f32_dpp v229, v229, v229 quad_perm:[2,3,0,1] row_mask:0xf bank_mask:0xf
    v_mfma_f32_16x16x32_bf16 v[52:55], a[124:127], v[220:223], v[52:55]
    v_add_f32_dpp v228, v228, v228 row_half_mirror row_mask:0xf bank_mask:0xf
    v_add_f32_dpp v229, v229, v229 row_half_mirror row_mask:0xf bank_mask:0xf
    v_mfma_f32_16x16x32_bf16 v[56:59], a[128:131], v[220:223], v[56:59]
    v_mul_f32 v228, 0x3acccccd, v228
    v_mul_f32 v229, 0x3acccccd, v229
    v_mfma_f32_16x16x32_bf16 v[60:63], a[132:135], v[220:223], v[60:63]
    v_fma_f32 v229, -v228, v228, v229
    v_max_f32 v229, 0, v229
    v_mfma_f32_16x16x32_bf16 v[64:67], a[136:139], v[220:223], v[64:67]
    v_cvt_pk_bf16_f32 v229, v229, v229
    v_lshlrev_b32 v229, 16, v229
    v_mfma_f32_16x16x32_bf16 v[48:51], a[140:143], v[224:227], v[48:51]
    v_add_f32 v229, 0x3727c5ac, v229
    v_cvt_pk_bf16_f32 v229, v229, v229
    v_mfma_f32_16x16x32_bf16 v[52:55], a[144:147], v[224:227], v[52:55]
    v_lshlrev_b32 v229, 16, v229
    v_mfma_f32_16x16x32_bf16 v[56:59], a[148:151], v[224:227], v[56:59]
    v_sqrt_f32 v229, v229
    s_nop 0
    v_cvt_pk_bf16_f32 v229, v229, v229
    v_mfma_f32_16x16x32_bf16 v[60:63], a[152:155], v[224:227], v[60:63]
    v_lshlrev_b32 v229, 16, v229
    v_rcp_f32 v229, v229
    v_mfma_f32_16x16x32_bf16 v[64:67], a[156:159], v[224:227], v[64:67]
    v_mul_f32 v137, v229, v229
    v_mul_f32 v138, v229, v229
    v_mfma_f32_16x16x32_bf16 v[48:51], a[160:163], v[140:143], v[48:51]
    v_mul_f32 v229, v229, v229
    s_nop 1
    v_mov_b32_dpp v137, v229 row_shr:8 row_mask:0xf bank_mask:0xf
    v_mfma_f32_16x16x32_bf16 v[52:55], a[164:167], v[140:143], v[52:55]
    v_mov_b32_dpp v138, v229 row_shl:8 row_mask:0xf bank_mask:0xf
    v_mfma_f32_16x16x32_bf16 v[56:59], a[168:171], v[140:143], v[56:59]
    v_mfma_f32_16x16x32_bf16 v[60:63], a[172:175], v[140:143], v[60:63]
    v_mfma_f32_16x16x32_bf16 v[64:67], a[176:179], v[140:143], v[64:67]
    v_mfma_f32_16x16x32_bf16 v[48:51], a[180:183], v[144:147], v[48:51]
    v_mfma_f32_16x16x32_bf16 v[52:55], a[184:187], v[144:147], v[52:55]
    v_mfma_f32_16x16x32_bf16 v[56:59], a[188:191], v[144:147], v[56:59]
    v_mfma_f32_16x16x32_bf16 v[60:63], a[192:195], v[144:147], v[60:63]
    v_mfma_f32_16x16x32_bf16 v[64:67], a[196:199], v[144:147], v[64:67]
    v_mfma_f32_16x16x32_bf16 v[48:51], a[200:203], v[148:151], v[48:51]
    v_mfma_f32_16x16x32_bf16 v[52:55], a[204:207], v[148:151], v[52:55]
    v_mfma_f32_16x16x32_bf16 v[56:59], a[208:211], v[148:151], v[56:59]
    v_mfma_f32_16x16x32_bf16 v[60:63], a[212:215], v[148:151], v[60:63]
    v_mfma_f32_16x16x32_bf16 v[64:67], a[216:219], v[148:151], v[64:67]
    v_mfma_f32_16x16x32_bf16 v[48:51], a[220:223], v[152:155], v[48:51]
    v_mfma_f32_16x16x32_bf16 v[52:55], a[224:227], v[152:155], v[52:55]
    v_mfma_f32_16x16x32_bf16 v[56:59], a[228:231], v[152:155], v[56:59]
    v_mfma_f32_16x16x32_bf16 v[60:63], a[232:235], v[152:155], v[60:63]
    v_mfma_f32_16x16x32_bf16 v[64:67], a[236:239], v[152:155], v[64:67]
    v_mfma_f32_16x16x32_bf16 v[48:51], a[240:243], v[156:159], v[48:51]
    v_mfma_f32_16x16x32_bf16 v[52:55], a[244:247], v[156:159], v[52:55]
    v_mfma_f32_16x16x32_bf16 v[56:59], a[248:251], v[156:159], v[56:59]
    v_mfma_f32_16x16x32_bf16 v[60:63], a[252:255], v[156:159], v[60:63]
    v_mfma_f32_16x16x32_bf16 v[64:67], v[232:235], v[156:159], v[64:67]
    v_mfma_f32_16x16x32_bf16 v[48:51], v[236:239], v[160:163], v[48:51]
    v_mfma_f32_16x16x32_bf16 v[52:55], v[240:243], v[160:163], v[52:55]
    v_mfma_f32_16x16x32_bf16 v[56:59], v[244:247], v[160:163], v[56:59]
    v_mfma_f32_16x16x32_bf16 v[60:63], v[248:251], v[160:163], v[60:63]
    s_add_u32 s73, s66, 4
    s_waitcnt vmcnt(6)
    v_mfma_f32_16x16x32_bf16 v[64:67], v[252:255], v[160:163], v[64:67]
    s_cmp_eq_u32 s30, 0
    s_cbranch_scc1 Lg_104
    s_mov_b64 exec, 1
    buffer_store_dword v14, off, s[36:39], s73
    s_mov_b64 exec, -1
Lgb_105:
    v_mfma_f32_16x16x32_bf16 v[68:71], a[0:3], v[164:167], 0
    v_mfma_f32_16x16x32_bf16 v[72:75], a[4:7], v[164:167], 0
    v_mfma_f32_16x16x32_bf16 v[76:79], a[8:11], v[164:167], 0
    v_mfma_f32_16x16x32_bf16 v[80:83], a[12:15], v[164:167], 0
    s_barrier
    ds_write_b128 v11, v[48:51] offset:0
    v_mfma_f32_16x16x32_bf16 v[84:87], a[16:19], v[164:167], 0
    v_lshlrev_b32 v120, 16, v16
    v_and_b32 v121, 0xffff0000, v16
    v_mfma_f32_16x16x32_bf16 v[68:71], a[20:23], v[168:171], v[68:71]
    v_mfma_f32_16x16x32_bf16 v[72:75], a[24:27], v[168:171], v[72:75]
    ds_write_b128 v12, v[52:55] offset:1024
    v_mfma_f32_16x16x32_bf16 v[76:79], a[28:31], v[168:171], v[76:79]
    v_lshlrev_b32 v122, 16, v17
    v_and_b32 v123, 0xffff0000, v17
    v_mfma_f32_16x16x32_bf16 v[80:83], a[32:35], v[168:171], v[80:83]
    v_mfma_f32_16x16x32_bf16 v[84:87], a[36:39], v[168:171], v[84:87]
    ds_write_b128 v11, v[56:59] offset:2048
    v_lshlrev_b32 v124, 16, v18
    v_mfma_f32_16x16x32_bf16 v[68:71], a[40:43], v[172:175], v[68:71]
    v_and_b32 v125, 0xffff0000, v18
    v_mfma_f32_16x16x32_bf16 v[72:75], a[44:47], v[172:175], v[72:75]
    ds_write_b128 v12, v[60:63] offset:3072
    v_lshlrev_b32 v126, 16, v19
    v_mfma_f32_16x16x32_bf16 v[76:79], a[48:51], v[172:175], v[76:79]
    v_and_b32 v127, 0xffff0000, v19
    v_mfma_f32_16x16x32_bf16 v[80:83], a[52:55], v[172:175], v[80:83]
    ds_write_b128 v11, v[64:67] offset:4096
    v_mfma_f32_16x16x32_bf16 v[84:87], a[56:59], v[172:175], v[84:87]
    v_mfma_f32_16x16x32_bf16 v[68:71], a[60:63], v[176:179], v[68:71]
    v_mfma_f32_16x16x32_bf16 v[72:75], a[64:67], v[176:179], v[72:75]
    v_mfma_f32_16x16x32_bf16 v[76:79], a[68:71], v[176:179], v[76:79]
    v_mfma_f32_16x16x32_bf16 v[80:83], a[72:75], v[176:179], v[80:83]
    v_mfma_f32_16x16x32_bf16 v[84:87], a[76:79], v[176:179], v[84:87]
    s_waitcnt lgkmcnt(0)
    s_barrier
    ds_read_b128 v[88:91], v13 offset:0
    v_mfma_f32_16x16x32_bf16 v[68:71], a[80:83], v[180:183], v[68:71]
    ds_read_b128 v[92:95], v13 offset:256
    ds_read_b128 v[96:99], v13 offset:5120
    v_mfma_f32_16x16x32_bf16 v[72:75], a[84:87], v[180:183], v[72:75]
    ds_read_b128 v[100:103], v13 offset:5376
    ds_read_b128 v[104:107], v13 offset:10240
    v_mfma_f32_16x16x32_bf16 v[76:79], a[88:91], v[180:183], v[76:79]
    ds_read_b128 v[108:111], v13 offset:10496
    ds_read_b128 v[112:115], v13 offset:15360
    v_mfma_f32_16x16x32_bf16 v[80:83], a[92:95], v[180:183], v[80:83]
    ds_read_b128 v[116:119], v13 offset:15616
    v_mfma_f32_16x16x32_bf16 v[84:87], a[96:99], v[180:183], v[84:87]
    v_mfma_f32_16x16x32_bf16 v[68:71], a[100:103], v[184:187], v[68:71]
    v_min_u32 v231, 7, v1
    v_lshlrev_b32 v231, 7, v231
    v_mfma_f32_16x16x32_bf16 v[72:75], a[104:107], v[184:187], v[72:75]
    s_add_u32 s75, s64, 4
    v_mfma_f32_16x16x32_bf16 v[76:79], a[108:111], v[184:187], v[76:79]
    buffer_load_dword v228, v231, s[36:39], s75 offen sc1
    v_mfma_f32_16x16x32_bf16 v[80:83], a[112:115], v[184:187], v[80:83]
    v_mfma_f32_16x16x32_bf16 v[84:87], a[116:119], v[184:187], v[84:87]
    s_waitcnt lgkmcnt(4)
    v_add_f32 v88, v88, v96
    v_mfma_f32_16x16x32_bf16 v[68:71], a[120:123], v[188:191], v[68:71]
    v_add_f32 v89, v89, v97
    v_add_f32 v90, v90, v98
    v_mfma_f32_16x16x32_bf16 v[72:75], a[124:127], v[188:191], v[72:75]
    v_add_f32 v91, v91, v99
    v_add_f32 v92, v92, v100
    v_mfma_f32_16x16x32_bf16 v[76:79], a[128:131], v[188:191], v[76:79]
    v_add_f32 v93, v93, v101
    v_add_f32 v94, v94, v102
    v_mfma_f32_16x16x32_bf16 v[80:83], a[132:135], v[188:191], v[80:83]
    v_add_f32 v95, v95, v103
    s_waitcnt lgkmcnt(0)
    v_mfma_f32_16x16x32_bf16 v[84:87], a[136:139], v[188:191], v[84:87]
    v_add_f32 v104, v104, v112
    v_add_f32 v105, v105, v113
    v_mfma_f32_16x16x32_bf16 v[68:71], a[140:143], v[192:195], v[68:71]
    v_add_f32 v106, v106, v114
    v_add_f32 v107, v107, v115
    v_mfma_f32_16x16x32_bf16 v[72:75], a[144:147], v[192:195], v[72:75]
    s_waitcnt vmcnt(6)
    v_add_f32 v108, v108, v116
    v_mfma_f32_16x16x32_bf16 v[76:79], a[148:151], v[192:195], v[76:79]
    v_add_f32 v109, v109, v117
    v_add_f32 v110, v110, v118
    v_mfma_f32_16x16x32_bf16 v[80:83], a[152:155], v[192:195], v[80:83]
    v_add_f32 v111, v111, v119
    v_add_f32 v88, v88, v104
    v_mfma_f32_16x16x32_bf16 v[84:87], a[156:159], v[192:195], v[84:87]
    v_add_f32 v89, v89, v105
    v_add_f32 v90, v90, v106
    v_mfma_f32_16x16x32_bf16 v[68:71], a[160:163], v[196:199], v[68:71]
    v_add_f32 v91, v91, v107
    v_add_f32 v92, v92, v108
    v_mfma_f32_16x16x32_bf16 v[72:75], a[164:167], v[196:199], v[72:75]
    v_add_f32 v93, v93, v109
    v_add_f32 v94, v94, v110
    v_mfma_f32_16x16x32_bf16 v[76:79], a[168:171], v[196:199], v[76:79]
    v_add_f32 v95, v95, v111
    v_fmac_f32 v120, v88, v9
    v_mfma_f32_16x16x32_bf16 v[80:83], a[172:175], v[196:199], v[80:83]
    v_fmac_f32 v121, v89, v9
    v_fmac_f32 v122, v90, v9
    v_mfma_f32_16x16x32_bf16 v[84:87], a[176:179], v[196:199], v[84:87]
    v_fmac_f32 v123, v91, v9
    v_fmac_f32 v124, v92, v9
    v_mfma_f32_16x16x32_bf16 v[68:71], a[180:183], v[200:203], v[68:71]
    s_waitcnt vmcnt(0)
    v_cmp_ne_u32 vcc, v228, v14
    s_cbranch_vccnz Lps_109
Lpd_108:
    v_fmac_f32 v125, v93, v9
    v_mfma_f32_16x16x32_bf16 v[72:75], a[184:187], v[200:203], v[72:75]
    v_fmac_f32 v126, v94, v9
    v_mfma_f32_16x16x32_bf16 v[76:79], a[188:191], v[200:203], v[76:79]
    v_fmac_f32 v127, v95, v9
    v_cvt_pk_bf16_f32 v16, v120, v121
    v_mfma_f32_16x16x32_bf16 v[80:83], a[192:195], v[200:203], v[80:83]
    s_add_u32 s88, s91, 23592960
    buffer_load_dwordx4 v[220:223], v2, s[36:39], s88 offen offset:0 sc1
    v_cvt_pk_bf16_f32 v17, v122, v123
    v_mfma_f32_16x16x32_bf16 v[84:87], a[196:199], v[200:203], v[84:87]
    v_cvt_pk_bf16_f32 v18, v124, v125
    v_cvt_pk_bf16_f32 v19, v126, v127
    v_mfma_f32_16x16x32_bf16 v[68:71], a[200:203], v[204:207], v[68:71]
    v_add_f32 v128, v120, v121
    v_mul_f32 v129, v120, v120
    v_mfma_f32_16x16x32_bf16 v[72:75], a[204:207], v[204:207], v[72:75]
    buffer_load_dwordx4 v[224:227], v2, s[36:39], s88 offen offset:1024 sc1
    v_fmac_f32 v129, v121, v121
    v_mfma_f32_16x16x32_bf16 v[76:79], a[208:211], v[204:207], v[76:79]
    v_add_f32 v128, v128, v122
    v_fmac_f32 v129, v122, v122
    v_mfma_f32_16x16x32_bf16 v[80:83], a[212:215], v[204:207], v[80:83]
    v_add_f32 v128, v128, v123
    v_fmac_f32 v129, v123, v123
    v_mfma_f32_16x16x32_bf16 v[84:87], a[216:219], v[204:207], v[84:87]
    buffer_load_dwordx4 v[140:143], v2, s[36:39], s88 offen offset:2048 sc1
    v_add_f32 v128, v128, v124
    v_mfma_f32_16x16x32_bf16 v[68:71], a[220:223], v[208:211], v[68:71]
    v_fmac_f32 v129, v124, v124
    v_add_f32 v128, v128, v125
    v_mfma_f32_16x16x32_bf16 v[72:75], a[224:227], v[208:211], v[72:75]
    v_fmac_f32 v129, v125, v125
    v_mfma_f32_16x16x32_bf16 v[76:79], a[228:231], v[208:211], v[76:79]
    buffer_load_dwordx4 v[144:147], v2, s[36:39], s88 offen offset:3072 sc1
    v_add_f32 v128, v128, v126
    v_mfma_f32_16x16x32_bf16 v[80:83], a[232:235], v[208:211], v[80:83]
    v_fmac_f32 v129, v126, v126
    v_add_f32 v128, v128, v127
    v_mfma_f32_16x16x32_bf16 v[84:87], a[236:239], v[208:211], v[84:87]
    v_fmac_f32 v129, v127, v127
    v_cndmask_b32 v128, 0, v128, s[86:87]
    v_mfma_f32_16x16x32_bf16 v[68:71], a[240:243], v[212:215], v[68:71]
    s_add_u32 s88, s91, 23597056
    buffer_load_dwordx4 v[148:151], v2, s[36:39], s88 offen offset:0 sc1
    v_cndmask_b32 v129, 0, v129, s[86:87]
    v_mfma_f32_16x16x32_bf16 v[72:75], a[244:247], v[212:215], v[72:75]
    v_add_f32_dpp v128, v128, v128 row_ror:8 row_mask:0xf bank_mask:0xf
    v_add_f32_dpp v129, v129, v129 row_ror:8 row_mask:0xf bank_mask:0xf
    v_mfma_f32_16x16x32_bf16 v[76:79], a[248:251], v[212:215], v[76:79]
    v_add_f32_dpp v128, v128, v128 row_ror:4 row_mask:0xf bank_mask:0xf
    v_add_f32_dpp v129, v129, v129 row_ror:4 row_mask:0xf bank_mask:0xf
    v_mfma_f32_16x16x32_bf16 v[80:83], a[252:255], v[212:215], v[80:83]
    buffer_load_dwordx4 v[152:155], v2, s[36:39], s88 offen offset:1024 sc1
    v_add_f32_dpp v128, v128, v128 row_ror:2 row_mask:0xf bank_mask:0xf
    v_mfma_f32_16x16x32_bf16 v[84:87], v[232:235], v[212:215], v[84:87]
    v_add_f32_dpp v129, v129, v129 row_ror:2 row_mask:0xf bank_mask:0xf
    v_add_f32_dpp v128, v128, v128 row_ror:1 row_mask:0xf bank_mask:0xf
    v_mfma_f32_16x16x32_bf16 v[68:71], v[236:239], v[216:219], v[68:71]
    v_add_f32_dpp v129, v129, v129 row_ror:1 row_mask:0xf bank_mask:0xf
    s_cmp_eq_u32 s30, 0
    s_cbranch_scc1 Lg_106
    s_add_u32 s74, s78, 0
    s_mov_b32 exec_lo, 0x00010001
    s_mov_b32 exec_hi, 0x00010001
    buffer_store_dwordx4 v[128:131], v135, s[36:39], s74 offen
    s_mov_b64 exec, -1
Lgb_107:
    v_mfma_f32_16x16x32_bf16 v[72:75], v[240:243], v[216:219], v[72:75]
    buffer_load_dwordx4 v[156:159], v2, s[36:39], s88 offen offset:2048 sc1
    s_waitcnt vmcnt(6)
    v_mfma_f32_16x16x32_bf16 v[76:79], v[244:247], v[216:219], v[76:79]
    v_mfma_f32_16x16x32_bf16 v[80:83], v[248:251], v[216:219], v[80:83]
    v_mfma_f32_16x16x32_bf16 v[84:87], v[252:255], v[216:219], v[84:87]
    buffer_load_dwordx4 v[160:163], v2, s[36:39], s88 offen offset:3072 sc1
    v_mfma_f32_16x16x32_bf16 v[48:51], a[0:3], v[220:223], 0
    s_add_u32 s88, s91, 23601152
    buffer_load_dwordx4 v[164:167], v2, s[36:39], s88 offen offset:0 sc1
    v_mfma_f32_16x16x32_bf16 v[52:55], a[4:7], v[220:223], 0
    v_mfma_f32_16x16x32_bf16 v[56:59], a[8:11], v[220:223], 0
    v_mfma_f32_16x16x32_bf16 v[60:63], a[12:15], v[220:223], 0
    buffer_load_dwordx4 v[168:171], v2, s[36:39], s88 offen offset:1024 sc1
    s_barrier
    v_mfma_f32_16x16x32_bf16 v[64:67], a[16:19], v[220:223], 0
    ds_write_b128 v11, v[68:71] offset:0
    v_lshlrev_b32 v120, 16, v20
    v_mfma_f32_16x16x32_bf16 v[48:51], a[20:23], v[224:227], v[48:51]
    v_and_b32 v121, 0xffff0000, v20
    v_mfma_f32_16x16x32_bf16 v[52:55], a[24:27], v[224:227], v[52:55]
    buffer_load_dwordx4 v[172:175], v2, s[36:39], s88 offen offset:2048 sc1
    s_waitcnt vmcnt(8)
    v_mfma_f32_16x16x32_bf16 v[56:59], a[28:31], v[224:227], v[56:59]
    ds_write_b128 v12, v[72:75] offset:1024
    v_lshlrev_b32 v122, 16, v21
    v_mfma_f32_16x16x32_bf16 v[60:63], a[32:35], v[224:227], v[60:63]
    v_and_b32 v123, 0xffff0000, v21
    v_mfma_f32_16x16x32_bf16 v[64:67], a[36:39], v[224:227], v[64:67]
    buffer_load_dwordx4 v[176:179], v2, s[36:39], s88 offen offset:3072 sc1
    ds_write_b128 v11, v[76:79] offset:2048
    v_mfma_f32_16x16x32_bf16 v[48:51], a[40:43], v[140:143], v[48:51]
    v_lshlrev_b32 v124, 16, v22
    v_and_b32 v125, 0xffff0000, v22
    v_mfma_f32_16x16x32_bf16 v[52:55], a[44:47], v[140:143], v[52:55]
    v_mfma_f32_16x16x32_bf16 v[56:59], a[48:51], v[140:143], v[56:59]
    s_add_u32 s88, s91, 23605248
    buffer_load_dwordx4 v[180:183], v2, s[36:39], s88 offen offset:0 sc1
    ds_write_b128 v12, v[80:83] offset:3072
    v_mfma_f32_16x16x32_bf16 v[60:63], a[52:55], v[140:143], v[60:63]
    v_lshlrev_b32 v126, 16, v23
    v_and_b32 v127, 0xffff0000, v23
    v_mfma_f32_16x16x32_bf16 v[64:67], a[56:59], v[140:143], v[64:67]
    v_mfma_f32_16x16x32_bf16 v[48:51], a[60:63], v[144:147], v[48:51]
    buffer_load_dwordx4 v[184:187], v2, s[36:39], s88 offen offset:1024 sc1
    ds_write_b128 v11, v[84:87] offset:4096
    v_mfma_f32_16x16x32_bf16 v[52:55], a[64:67], v[144:147], v[52:55]
    s_waitcnt vmcnt(9)
    v_mfma_f32_16x16x32_bf16 v[56:59], a[68:71], v[144:147], v[56:59]
    v_mfma_f32_16x16x32_bf16 v[60:63], a[72:75], v[144:147], v[60:63]
    s_add_u32 s88, s91, 23650304
    buffer_load_dwordx4 v[188:191], v2, s[36:39], s88 offen offset:0 sc1
    v_mfma_f32_16x16x32_bf16 v[64:67], a[76:79], v[144:147], v[64:67]
    v_mfma_f32_16x16x32_bf16 v[48:51], a[80:83], v[148:151], v[48:51]
    v_mfma_f32_16x16x32_bf16 v[52:55], a[84:87], v[148:151], v[52:55]
    buffer_load_dwordx4 v[192:195], v2, s[36:39], s88 offen offset:1024 sc1
    v_mfma_f32_16x16x32_bf16 v[56:59], a[88:91], v[148:151], v[56:59]
    s_waitcnt lgkmcnt(0)
    s_barrier
    ds_read_b128 v[88:91], v13 offset:0
    v_mfma_f32_16x16x32_bf16 v[60:63], a[92:95], v[148:151], v[60:63]
    ds_read_b128 v[92:95], v13 offset:256
    ds_read_b128 v[96:99], v13 offset:5120
    v_mfma_f32_16x16x32_bf16 v[64:67], a[96:99], v[148:151], v[64:67]
    buffer_load_dwordx4 v[196:199], v2, s[36:39], s88 offen offset:2048 sc1
    ds_read_b128 v[100:103], v13 offset:5376
    v_mfma_f32_16x16x32_bf16 v[48:51], a[100:103], v[152:155], v[48:51]
    ds_read_b128 v[104:107], v13 offset:10240
    ds_read_b128 v[108:111], v13 offset:10496
    v_mfma_f32_16x16x32_bf16 v[52:55], a[104:107], v[152:155], v[52:55]
    s_waitcnt vmcnt(9)
    ds_read_b128 v[112:115], v13 offset:15360
    v_mfma_f32_16x16x32_bf16 v[56:59], a[108:111], v[152:155], v[56:59]
    buffer_load_dwordx4 v[200:203], v2, s[36:39], s88 offen offset:3072 sc1
    ds_read_b128 v[116:119], v13 offset:15616
    v_mfma_f32_16x16x32_bf16 v[60:63], a[112:115], v[152:155], v[60:63]
    v_mfma_f32_16x16x32_bf16 v[64:67], a[116:119], v[152:155], v[64:67]
    v_mfma_f32_16x16x32_bf16 v[48:51], a[120:123], v[156:159], v[48:51]
    s_add_u32 s88, s91, 23654400
    buffer_load_dwordx4 v[204:207], v2, s[36:39], s88 offen offset:0 sc1
    v_mfma_f32_16x16x32_bf16 v[52:55], a[124:127], v[156:159], v[52:55]
    v_mfma_f32_16x16x32_bf16 v[56:59], a[128:131], v[156:159], v[56:59]
    v_mfma_f32_16x16x32_bf16 v[60:63], a[132:135], v[156:159], v[60:63]
    buffer_load_dwordx4 v[208:211], v2, s[36:39], s88 offen offset:1024 sc1
    v_mfma_f32_16x16x32_bf16 v[64:67], a[136:139], v[156:159], v[64:67]
    s_waitcnt lgkmcnt(4)
    v_add_f32 v88, v88, v96
    v_mfma_f32_16x16x32_bf16 v[48:51], a[140:143], v[160:163], v[48:51]
    v_add_f32 v89, v89, v97
    v_add_f32 v90, v90, v98
    v_mfma_f32_16x16x32_bf16 v[52:55], a[144:147], v[160:163], v[52:55]
    buffer_load_dwordx4 v[212:215], v2, s[36:39], s88 offen offset:2048 sc1
    s_waitcnt vmcnt(11)
    v_mfma_f32_16x16x32_bf16 v[56:59], a[148:151], v[160:163], v[56:59]
    v_add_f32 v91, v91, v99
    v_add_f32 v92, v92, v100
    v_mfma_f32_16x16x32_bf16 v[60:63], a[152:155], v[160:163], v[60:63]
    v_add_f32 v93, v93, v101
    v_add_f32 v94, v94, v102
    v_mfma_f32_16x16x32_bf16 v[64:67], a[156:159], v[160:163], v[64:67]
    buffer_load_dwordx4 v[216:219], v2, s[36:39], s88 offen offset:3072 sc1
    v_add_f32 v95, v95, v103
    v_mfma_f32_16x16x32_bf16 v[48:51], a[160:163], v[164:167], v[48:51]
    s_waitcnt lgkmcnt(0)
    v_add_f32 v104, v104, v112
    v_mfma_f32_16x16x32_bf16 v[52:55], a[164:167], v[164:167], v[52:55]
    v_add_f32 v105, v105, v113
    v_add_f32 v106, v106, v114
    v_mfma_f32_16x16x32_bf16 v[56:59], a[168:171], v[164:167], v[56:59]
    s_add_u32 s88, s91, 23658496
    buffer_load_dwordx4 v[220:223], v2, s[36:39], s88 offen offset:0 sc1
    v_add_f32 v107, v107, v115
    v_mfma_f32_16x16x32_bf16 v[60:63], a[172:175], v[164:167], v[60:63]
    v_add_f32 v108, v108, v116
    v_add_f32 v109, v109, v117
    v_mfma_f32_16x16x32_bf16 v[64:67], a[176:179], v[164:167], v[64:67]
    v_add_f32 v110, v110, v118
    v_add_f32 v111, v111, v119
    v_mfma_f32_16x16x32_bf16 v[48:51], a[180:183], v[168:171], v[48:51]
    buffer_load_dwordx4 v[224:227], v2, s[36:39], s88 offen offset:1024 sc1
    v_add_f32 v88, v88, v104
    v_mfma_f32_16x16x32_bf16 v[52:55], a[184:187], v[168:171], v[52:55]
    s_waitcnt vmcnt(12)
    v_add_f32 v89, v89, v105
    v_mfma_f32_16x16x32_bf16 v[56:59], a[188:191], v[168:171], v[56:59]
    v_add_f32 v90, v90, v106
    v_add_f32 v91, v91, v107
    v_mfma_f32_16x16x32_bf16 v[60:63], a[192:195], v[168:171], v[60:63]
    buffer_load_dwordx4 v[140:143], v2, s[36:39], s88 offen offset:2048 sc1
    v_add_f32 v92, v92, v108
    v_mfma_f32_16x16x32_bf16 v[64:67], a[196:199], v[168:171], v[64:67]
    v_add_f32 v93, v93, v109
    v_add_f32 v94, v94, v110
    v_mfma_f32_16x16x32_bf16 v[48:51], a[200:203], v[172:175], v[48:51]
    v_add_f32 v95, v95, v111
    v_fmac_f32 v120, v88, v5
    v_mfma_f32_16x16x32_bf16 v[52:55], a[204:207], v[172:175], v[52:55]
    buffer_load_dwordx4 v[144:147], v2, s[36:39], s88 offen offset:3072 sc1
    v_fmac_f32 v121, v89, v5
    v_mfma_f32_16x16x32_bf16 v[56:59], a[208:211], v[172:175], v[56:59]
    v_fmac_f32 v122, v90, v5
    v_fmac_f32 v123, v91, v5
    v_mfma_f32_16x16x32_bf16 v[60:63], a[212:215], v[172:175], v[60:63]
    v_fmac_f32 v124, v92, v5
    v_fmac_f32 v125, v93, v5
    v_mfma_f32_16x16x32_bf16 v[64:67], a[216:219], v[172:175], v[64:67]
    s_add_u32 s88, s91, 23662592
    buffer_load_dwordx4 v[148:151], v2, s[36:39], s88 offen offset:0 sc1
    v_fmac_f32 v126, v94, v5
    v_mfma_f32_16x16x32_bf16 v[48:51], a[220:223], v[176:179], v[48:51]
    v_fmac_f32 v127, v95, v5
    v_cvt_pk_bf16_f32 v20, v120, v121
    v_mfma_f32_16x16x32_bf16 v[52:55], a[224:227], v[176:179], v[52:55]
    s_waitcnt vmcnt(13)
    v_cvt_pk_bf16_f32 v21, v122, v123
    v_mfma_f32_16x16x32_bf16 v[56:59], a[228:231], v[176:179], v[56:59]
    buffer_load_dwordx4 v[152:155], v2, s[36:39], s88 offen offset:1024 sc1
    v_cvt_pk_bf16_f32 v22, v124, v125
    v_mfma_f32_16x16x32_bf16 v[60:63], a[232:235], v[176:179], v[60:63]
    v_cvt_pk_bf16_f32 v23, v126, v127
    v_add_f32 v128, v120, v121
    v_mfma_f32_16x16x32_bf16 v[64:67], a[236:239], v[176:179], v[64:67]
    v_mul_f32 v129, v120, v120
    v_fmac_f32 v129, v121, v121
    v_mfma_f32_16x16x32_bf16 v[48:51], a[240:243], v[180:183], v[48:51]
    v_add_f32 v128, v128, v122
    v_fmac_f32 v129, v122, v122
    v_mfma_f32_16x16x32_bf16 v[52:55], a[244:247], v[180:183], v[52:55]
    v_add_f32 v128, v128, v123
    v_fmac_f32 v129, v123, v123
    v_mfma_f32_16x16x32_bf16 v[56:59], a[248:251], v[180:183], v[56:59]
    v_add_f32 v128, v128, v124
    v_fmac_f32 v129, v124, v124
    v_mfma_f32_16x16x32_bf16 v[60:63], a[252:255], v[180:183], v[60:63]
    v_add_f32 v128, v128, v125
    v_fmac_f32 v129, v125, v125
    v_mfma_f32_16x16x32_bf16 v[64:67], v[232:235], v[180:183], v[64:67]
    v_add_f32 v128, v128, v126
    v_fmac_f32 v129, v126, v126
    v_mfma_f32_16x16x32_bf16 v[48:51], v[236:239], v[184:187], v[48:51]
    v_add_f32 v128, v128, v127
    v_fmac_f32 v129, v127, v127
    v_mfma_f32_16x16x32_bf16 v[52:55], v[240:243], v[184:187], v[52:55]
    s_waitcnt vmcnt(12)
    v_cndmask_b32 v128, 0, v128, s[86:87]
    v_mfma_f32_16x16x32_bf16 v[56:59], v[244:247], v[184:187], v[56:59]
    v_cndmask_b32 v129, 0, v129, s[86:87]
    v_add_f32_dpp v128, v128, v128 row_ror:8 row_mask:0xf bank_mask:0xf
    v_mfma_f32_16x16x32_bf16 v[60:63], v[248:251], v[184:187], v[60:63]
    v_add_f32_dpp v129, v129, v129 row_ror:8 row_mask:0xf bank_mask:0xf
    v_add_f32_dpp v128, v128, v128 row_ror:4 row_mask:0xf bank_mask:0xf
    v_mfma_f32_16x16x32_bf16 v[64:67], v[252:255], v[184:187], v[64:67]
    v_add_f32_dpp v129, v129, v129 row_ror:4 row_mask:0xf bank_mask:0xf
    v_add_f32_dpp v128, v128, v128 row_ror:2 row_mask:0xf bank_mask:0xf
    s_nop 0
    v_add_f32_dpp v129, v129, v129 row_ror:2 row_mask:0xf bank_mask:0xf
    v_add_f32_dpp v128, v128, v128 row_ror:1 row_mask:0xf bank_mask:0xf
    s_nop 0
    v_add_f32_dpp v129, v129, v129 row_ror:1 row_mask:0xf bank_mask:0xf
    s_cmp_eq_u32 s30, 0
    s_cbranch_scc1 Lg_110
    s_add_u32 s74, s78, 64
    s_mov_b32 exec_lo, 0x00010001
    s_mov_b32 exec_hi, 0x00010001
    buffer_store_dwordx4 v[128:131], v135, s[36:39], s74 offen
    s_mov_b64 exec, -1
Lgb_111:
    v_mfma_f32_16x16x32_bf16 v[68:71], a[0:3], v[188:191], 0
    v_mfma_f32_16x16x32_bf16 v[72:75], a[4:7], v[188:191], 0
    v_mfma_f32_16x16x32_bf16 v[76:79], a[8:11], v[188:191], 0
    v_mfma_f32_16x16x32_bf16 v[80:83], a[12:15], v[188:191], 0
    s_barrier
    ds_write_b128 v11, v[48:51] offset:0
    v_mfma_f32_16x16x32_bf16 v[84:87], a[16:19], v[188:191], 0
    v_lshlrev_b32 v120, 16, v24
    v_and_b32 v121, 0xffff0000, v24
    v_mfma_f32_16x16x32_bf16 v[68:71], a[20:23], v[192:195], v[68:71]
    v_mfma_f32_16x16x32_bf16 v[72:75], a[24:27], v[192:195], v[72:75]
    s_waitcnt vmcnt(11)
    ds_write_b128 v12, v[52:55] offset:1024
    v_mfma_f32_16x16x32_bf16 v[76:79], a[28:31], v[192:195], v[76:79]
    v_lshlrev_b32 v122, 16, v25
    v_and_b32 v123, 0xffff0000, v25
    v_mfma_f32_16x16x32_bf16 v[80:83], a[32:35], v[192:195], v[80:83]
    v_mfma_f32_16x16x32_bf16 v[84:87], a[36:39], v[192:195], v[84:87]
    ds_write_b128 v11, v[56:59] offset:2048
    v_lshlrev_b32 v124, 16, v26
    v_mfma_f32_16x16x32_bf16 v[68:71], a[40:43], v[196:199], v[68:71]
    v_and_b32 v125, 0xffff0000, v26
    v_mfma_f32_16x16x32_bf16 v[72:75], a[44:47], v[196:199], v[72:75]
    ds_write_b128 v12, v[60:63] offset:3072
    v_lshlrev_b32 v126, 16, v27
    v_mfma_f32_16x16x32_bf16 v[76:79], a[48:51], v[196:199], v[76:79]
    v_and_b32 v127, 0xffff0000, v27
    v_mfma_f32_16x16x32_bf16 v[80:83], a[52:55], v[196:199], v[80:83]
    ds_write_b128 v11, v[64:67] offset:4096
    v_mfma_f32_16x16x32_bf16 v[84:87], a[56:59], v[196:199], v[84:87]
    v_mfma_f32_16x16x32_bf16 v[68:71], a[60:63], v[200:203], v[68:71]
    v_mfma_f32_16x16x32_bf16 v[72:75], a[64:67], v[200:203], v[72:75]
    s_waitcnt vmcnt(9)
    v_mfma_f32_16x16x32_bf16 v[76:79], a[68:71], v[200:203], v[76:79]
    v_mfma_f32_16x16x32_bf16 v[80:83], a[72:75], v[200:203], v[80:83]
    v_mfma_f32_16x16x32_bf16 v[84:87], a[76:79], v[200:203], v[84:87]
    s_waitcnt lgkmcnt(0)
    s_barrier
    ds_read_b128 v[88:91], v13 offset:0
    v_mfma_f32_16x16x32_bf16 v[68:71], a[80:83], v[204:207], v[68:71]
    ds_read_b128 v[92:95], v13 offset:256
    ds_read_b128 v[96:99], v13 offset:5120
    v_mfma_f32_16x16x32_bf16 v[72:75], a[84:87], v[204:207], v[72:75]
    ds_read_b128 v[100:103], v13 offset:5376
    ds_read_b128 v[104:107], v13 offset:10240
    v_mfma_f32_16x16x32_bf16 v[76:79], a[88:91], v[204:207], v[76:79]
    ds_read_b128 v[108:111], v13 offset:10496
    ds_read_b128 v[112:115], v13 offset:15360
    v_mfma_f32_16x16x32_bf16 v[80:83], a[92:95], v[204:207], v[80:83]
    ds_read_b128 v[116:119], v13 offset:15616
    v_mfma_f32_16x16x32_bf16 v[84:87], a[96:99], v[204:207], v[84:87]
    v_mfma_f32_16x16x32_bf16 v[68:71], a[100:103], v[208:211], v[68:71]
    v_mfma_f32_16x16x32_bf16 v[72:75], a[104:107], v[208:211], v[72:75]
    s_waitcnt vmcnt(7)
    v_mfma_f32_16x16x32_bf16 v[76:79], a[108:111], v[208:211], v[76:79]
    v_mfma_f32_16x16x32_bf16 v[80:83], a[112:115], v[208:211], v[80:83]
    v_mfma_f32_16x16x32_bf16 v[84:87], a[116:119], v[208:211], v[84:87]
    s_waitcnt lgkmcnt(4)
    v_add_f32 v88, v88, v96
    v_mfma_f32_16x16x32_bf16 v[68:71], a[120:123], v[212:215], v[68:71]
    v_add_f32 v89, v89, v97
    v_add_f32 v90, v90, v98
    v_mfma_f32_16x16x32_bf16 v[72:75], a[124:127], v[212:215], v[72:75]
    v_add_f32 v91, v91, v99
    v_add_f32 v92, v92, v100
    v_mfma_f32_16x16x32_bf16 v[76:79], a[128:131], v[212:215], v[76:79]
    v_add_f32 v93, v93, v101
    v_add_f32 v94, v94, v102
    v_mfma_f32_16x16x32_bf16 v[80:83], a[132:135], v[212:215], v[80:83]
    v_add_f32 v95, v95, v103
    s_waitcnt lgkmcnt(0)
    v_mfma_f32_16x16x32_bf16 v[84:87], a[136:139], v[212:215], v[84:87]
    v_add_f32 v104, v104, v112
    v_add_f32 v105, v105, v113
    v_mfma_f32_16x16x32_bf16 v[68:71], a[140:143], v[216:219], v[68:71]
    v_add_f32 v106, v106, v114
    v_add_f32 v107, v107, v115
    v_mfma_f32_16x16x32_bf16 v[72:75], a[144:147], v[216:219], v[72:75]
    s_waitcnt vmcnt(5)
    v_add_f32 v108, v108, v116
    v_mfma_f32_16x16x32_bf16 v[76:79], a[148:151], v[216:219], v[76:79]
    v_add_f32 v109, v109, v117
    v_add_f32 v110, v110, v118
    v_mfma_f32_16x16x32_bf16 v[80:83], a[152:155], v[216:219], v[80:83]
    v_add_f32 v111, v111, v119
    v_add_f32 v88, v88, v104
    v_mfma_f32_16x16x32_bf16 v[84:87], a[156:159], v[216:219], v[84:87]
    v_add_f32 v89, v89, v105
    v_add_f32 v90, v90, v106
    v_mfma_f32_16x16x32_bf16 v[68:71], a[160:163], v[220:223], v[68:71]
    s_add_u32 s79, s69, 0
    v_add_f32 v91, v91, v107
    v_mfma_f32_16x16x32_bf16 v[72:75], a[164:167], v[220:223], v[72:75]
    buffer_load_dwordx4 v[228:231], v136, s[36:39], s79 offen sc1
    v_add_f32 v92, v92, v108
    v_mfma_f32_16x16x32_bf16 v[76:79], a[168:171], v[220:223], v[76:79]
    s_add_u32 s71, s69, 64
    v_add_f32 v93, v93, v109
    v_mfma_f32_16x16x32_bf16 v[80:83], a[172:175], v[220:223], v[80:83]
    buffer_load_dwordx4 v[48:51], v136, s[36:39], s71 offen sc1
    v_add_f32 v94, v94, v110
    v_mfma_f32_16x16x32_bf16 v[84:87], a[176:179], v[220:223], v[84:87]
    v_add_f32 v95, v95, v111
    v_fmac_f32 v120, v88, v137
    v_mfma_f32_16x16x32_bf16 v[68:71], a[180:183], v[224:227], v[68:71]
    v_fmac_f32 v121, v89, v137
    v_fmac_f32 v122, v90, v137
    v_mfma_f32_16x16x32_bf16 v[72:75], a[184:187], v[224:227], v[72:75]
    s_waitcnt vmcnt(5)
    v_fmac_f32 v123, v91, v137
    v_mfma_f32_16x16x32_bf16 v[76:79], a[188:191], v[224:227], v[76:79]
    v_fmac_f32 v124, v92, v137
    v_fmac_f32 v125, v93, v137
    v_mfma_f32_16x16x32_bf16 v[80:83], a[192:195], v[224:227], v[80:83]
    v_fmac_f32 v126, v94, v137
    v_fmac_f32 v127, v95, v137
    v_mfma_f32_16x16x32_bf16 v[84:87], a[196:199], v[224:227], v[84:87]
    v_cvt_pk_bf16_f32 v24, v120, v121
    v_cvt_pk_bf16_f32 v25, v122, v123
    v_mfma_f32_16x16x32_bf16 v[68:71], a[200:203], v[140:143], v[68:71]
    v_cvt_pk_bf16_f32 v26, v124, v125
    v_cvt_pk_bf16_f32 v27, v126, v127
    v_mfma_f32_16x16x32_bf16 v[72:75], a[204:207], v[140:143], v[72:75]
    v_add_f32 v128, v120, v121
    v_mul_f32 v129, v120, v120
    v_mfma_f32_16x16x32_bf16 v[76:79], a[208:211], v[140:143], v[76:79]
    v_fmac_f32 v129, v121, v121
    v_add_f32 v128, v128, v122
    v_mfma_f32_16x16x32_bf16 v[80:83], a[212:215], v[140:143], v[80:83]
    v_fmac_f32 v129, v122, v122
    v_add_f32 v128, v128, v123
    v_mfma_f32_16x16x32_bf16 v[84:87], a[216:219], v[140:143], v[84:87]
    v_fmac_f32 v129, v123, v123
    v_add_f32 v128, v128, v124
    v_mfma_f32_16x16x32_bf16 v[68:71], a[220:223], v[144:147], v[68:71]
    v_fmac_f32 v129, v124, v124
    v_add_f32 v128, v128, v125
    v_mfma_f32_16x16x32_bf16 v[72:75], a[224:227], v[144:147], v[72:75]
    s_waitcnt vmcnt(3)
    v_fmac_f32 v129, v125, v125
    v_mfma_f32_16x16x32_bf16 v[76:79], a[228:231], v[144:147], v[76:79]
    v_add_f32 v128, v128, v126
    v_fmac_f32 v129, v126, v126
    v_mfma_f32_16x16x32_bf16 v[80:83], a[232:235], v[144:147], v[80:83]
    v_add_f32 v128, v128, v127
    v_fmac_f32 v129, v127, v127
    v_mfma_f32_16x16x32_bf16 v[84:87], a[236:239], v[144:147], v[84:87]
    v_cndmask_b32 v128, 0, v128, s[86:87]
    v_cndmask_b32 v129, 0, v129, s[86:87]
    v_mfma_f32_16x16x32_bf16 v[68:71], a[240:243], v[148:151], v[68:71]
    v_add_f32_dpp v128, v128, v128 row_ror:8 row_mask:0xf bank_mask:0xf
    v_add_f32_dpp v129, v129, v129 row_ror:8 row_mask:0xf bank_mask:0xf
    v_mfma_f32_16x16x32_bf16 v[72:75], a[244:247], v[148:151], v[72:75]
    v_add_f32_dpp v128, v128, v128 row_ror:4 row_mask:0xf bank_mask:0xf
    v_add_f32_dpp v129, v129, v129 row_ror:4 row_mask:0xf bank_mask:0xf
    v_mfma_f32_16x16x32_bf16 v[76:79], a[248:251], v[148:151], v[76:79]
    v_add_f32_dpp v128, v128, v128 row_ror:2 row_mask:0xf bank_mask:0xf
    v_add_f32_dpp v129, v129, v129 row_ror:2 row_mask:0xf bank_mask:0xf
    v_mfma_f32_16x16x32_bf16 v[80:83], a[252:255], v[148:151], v[80:83]
    v_add_f32_dpp v128, v128, v128 row_ror:1 row_mask:0xf bank_mask:0xf
    v_add_f32_dpp v129, v129, v129 row_ror:1 row_mask:0xf bank_mask:0xf
    v_mfma_f32_16x16x32_bf16 v[84:87], v[232:235], v[148:151], v[84:87]
    s_cmp_eq_u32 s30, 0
    s_cbranch_scc1 Lg_112
    s_add_u32 s74, s78, 128
    s_mov_b32 exec_lo, 0x00010001
    s_mov_b32 exec_hi, 0x00010001
    buffer_store_dwordx4 v[128:131], v135, s[36:39], s74 offen
    s_mov_b64 exec, -1
Lgb_113:
    v_mfma_f32_16x16x32_bf16 v[68:71], v[236:239], v[152:155], v[68:71]
    v_mfma_f32_16x16x32_bf16 v[72:75], v[240:243], v[152:155], v[72:75]
    v_mfma_f32_16x16x32_bf16 v[76:79], v[244:247], v[152:155], v[76:79]
    v_mfma_f32_16x16x32_bf16 v[80:83], v[248:251], v[152:155], v[80:83]
    v_mfma_f32_16x16x32_bf16 v[84:87], v[252:255], v[152:155], v[84:87]
    s_barrier
    s_nop 2
    ds_write_b128 v11, v[68:71] offset:0
    ds_write_b128 v12, v[72:75] offset:1024
    ds_write_b128 v11, v[76:79] offset:2048
    ds_write_b128 v12, v[80:83] offset:3072
    ds_write_b128 v11, v[84:87] offset:4096
    v_lshlrev_b32 v120, 16, v28
    v_and_b32 v121, 0xffff0000, v28
    v_lshlrev_b32 v122, 16, v29
    v_and_b32 v123, 0xffff0000, v29
    v_lshlrev_b32 v124, 16, v30
    v_and_b32 v125, 0xffff0000, v30
    v_lshlrev_b32 v126, 16, v31
    v_and_b32 v127, 0xffff0000, v31
    s_waitcnt vmcnt(2)
    v_cmp_ne_u32 vcc, v231, v14
    s_cbranch_vccnz Lps_115
Lpd_114:
    v_add_f32_dpp v228, v228, v228 row_ror:4 row_mask:0xf bank_mask:0xf
    v_add_f32_dpp v229, v229, v229 row_ror:4 row_mask:0xf bank_mask:0xf
    s_nop 0
    v_add_f32_dpp v228, v228, v228 row_ror:2 row_mask:0xf bank_mask:0xf
    v_add_f32_dpp v229, v229, v229 row_ror:2 row_mask:0xf bank_mask:0xf
    s_nop 0
    v_add_f32_dpp v228, v228, v228 row_ror:1 row_mask:0xf bank_mask:0xf
    v_add_f32_dpp v229, v229, v229 row_ror:1 row_mask:0xf bank_mask:0xf
    v_mul_f32 v228, 0x3acccccd, v228
    v_mul_f32 v229, 0x3acccccd, v229
    v_fma_f32 v229, -v228, v228, v229
    v_max_f32 v229, 0, v229
    v_cvt_pk_bf16_f32 v228, v228, v228
    v_lshlrev_b32 v228, 16, v228
    v_cvt_pk_bf16_f32 v229, v229, v229
    v_lshlrev_b32 v229, 16, v229
    v_add_f32 v229, 0x3727c5ac, v229
    v_cvt_pk_bf16_f32 v229, v229, v229
    v_lshlrev_b32 v229, 16, v229
    v_sqrt_f32 v229, v229
    s_nop 0
    v_cvt_pk_bf16_f32 v229, v229, v229
    v_lshlrev_b32 v229, 16, v229
    v_rcp_f32 v229, v229
    v_lshlrev_b32 v52, 16, v16
    v_and_b32 v53, 0xffff0000, v16
    v_lshlrev_b32 v54, 16, v17
    v_and_b32 v55, 0xffff0000, v17
    v_lshlrev_b32 v56, 16, v32
    v_and_b32 v57, 0xffff0000, v32
    v_lshlrev_b32 v58, 16, v33
    v_and_b32 v59, 0xffff0000, v33
    v_pk_add_f32 v[60:61], v[52:53], v[228:229] op_sel_hi:[1,0] neg_lo:[0,1] neg_hi:[0,1]
    v_pk_add_f32 v[62:63], v[54:55], v[228:229] op_sel_hi:[1,0] neg_lo:[0,1] neg_hi:[0,1]
    v_pk_mul_f32 v[56:57], v[56:57], v[228:229] op_sel:[0,1] op_sel_hi:[1,1]
    v_pk_mul_f32 v[58:59], v[58:59], v[228:229] op_sel:[0,1] op_sel_hi:[1,1]
    v_pk_fma_f32 v[52:53], v[60:61], v[56:57], v[52:53]
    v_pk_fma_f32 v[54:55], v[62:63], v[58:59], v[54:55]
    v_cvt_pk_bf16_f32 v16, v52, v53
    v_cvt_pk_bf16_f32 v17, v54, v55
    v_lshlrev_b32 v52, 16, v18
    v_and_b32 v53, 0xffff0000, v18
    v_lshlrev_b32 v54, 16, v19
    v_and_b32 v55, 0xffff0000, v19
    v_lshlrev_b32 v56, 16, v34
    v_and_b32 v57, 0xffff0000, v34
    v_lshlrev_b32 v58, 16, v35
    v_and_b32 v59, 0xffff0000, v35
    v_pk_add_f32 v[60:61], v[52:53], v[228:229] op_sel_hi:[1,0] neg_lo:[0,1] neg_hi:[0,1]
    v_pk_add_f32 v[62:63], v[54:55], v[228:229] op_sel_hi:[1,0] neg_lo:[0,1] neg_hi:[0,1]
    v_pk_mul_f32 v[56:57], v[56:57], v[228:229] op_sel:[0,1] op_sel_hi:[1,1]
    v_pk_mul_f32 v[58:59], v[58:59], v[228:229] op_sel:[0,1] op_sel_hi:[1,1]
    v_pk_fma_f32 v[52:53], v[60:61], v[56:57], v[52:53]
    v_pk_fma_f32 v[54:55], v[62:63], v[58:59], v[54:55]
    v_cvt_pk_bf16_f32 v18, v52, v53
    v_cvt_pk_bf16_f32 v19, v54, v55
    s_cmp_eq_u32 s30, 0
    s_cbranch_scc1 Lg_116
    s_add_u32 s74, s76, 15728640
    s_mov_b64 exec, s[86:87]
    buffer_store_dwordx4 v[16:19], v132, s[36:39], s74 offen
    s_mov_b64 exec, -1
Lgb_117:
    s_waitcnt lgkmcnt(0)
    s_barrier
    ds_read_b128 v[88:91], v13 offset:0
    ds_read_b128 v[92:95], v13 offset:256
    ds_read_b128 v[96:99], v13 offset:5120
    ds_read_b128 v[100:103], v13 offset:5376
    ds_read_b128 v[104:107], v13 offset:10240
    ds_read_b128 v[108:111], v13 offset:10496
    ds_read_b128 v[112:115], v13 offset:15360
    ds_read_b128 v[116:119], v13 offset:15616
    s_waitcnt vmcnt(2)
    v_cmp_ne_u32 vcc, v51, v14
    s_cbranch_vccnz Lps_119
Lpd_118:
    v_add_f32_dpp v48, v48, v48 row_ror:4 row_mask:0xf bank_mask:0xf
    v_add_f32_dpp v49, v49, v49 row_ror:4 row_mask:0xf bank_mask:0xf
    s_nop 0
    v_add_f32_dpp v48, v48, v48 row_ror:2 row_mask:0xf bank_mask:0xf
    v_add_f32_dpp v49, v49, v49 row_ror:2 row_mask:0xf bank_mask:0xf
    s_nop 0
    v_add_f32_dpp v48, v48, v48 row_ror:1 row_mask:0xf bank_mask:0xf
    v_add_f32_dpp v49, v49, v49 row_ror:1 row_mask:0xf bank_mask:0xf
    v_mul_f32 v48, 0x3acccccd, v48
    v_mul_f32 v49, 0x3acccccd, v49
    v_fma_f32 v49, -v48, v48, v49
    v_max_f32 v49, 0, v49
    v_cvt_pk_bf16_f32 v48, v48, v48
    v_lshlrev_b32 v48, 16, v48
    v_cvt_pk_bf16_f32 v49, v49, v49
    v_lshlrev_b32 v49, 16, v49
    v_add_f32 v49, 0x3727c5ac, v49
    v_cvt_pk_bf16_f32 v49, v49, v49
    v_lshlrev_b32 v49, 16, v49
    v_sqrt_f32 v49, v49
    s_nop 0
    v_cvt_pk_bf16_f32 v49, v49, v49
    v_lshlrev_b32 v49, 16, v49
    v_rcp_f32 v49, v49
    v_lshlrev_b32 v52, 16, v20
    v_and_b32 v53, 0xffff0000, v20
    v_lshlrev_b32 v54, 16, v21
    v_and_b32 v55, 0xffff0000, v21
    v_lshlrev_b32 v56, 16, v36
    v_and_b32 v57, 0xffff0000, v36
    v_lshlrev_b32 v58, 16, v37
    v_and_b32 v59, 0xffff0000, v37
    v_pk_add_f32 v[60:61], v[52:53], v[48:49] op_sel_hi:[1,0] neg_lo:[0,1] neg_hi:[0,1]
    v_pk_add_f32 v[62:63], v[54:55], v[48:49] op_sel_hi:[1,0] neg_lo:[0,1] neg_hi:[0,1]
    v_pk_mul_f32 v[56:57], v[56:57], v[48:49] op_sel:[0,1] op_sel_hi:[1,1]
    v_pk_mul_f32 v[58:59], v[58:59], v[48:49] op_sel:[0,1] op_sel_hi:[1,1]
    v_pk_fma_f32 v[52:53], v[60:61], v[56:57], v[52:53]
    v_pk_fma_f32 v[54:55], v[62:63], v[58:59], v[54:55]
    v_cvt_pk_bf16_f32 v20, v52, v53
    v_cvt_pk_bf16_f32 v21, v54, v55
    v_lshlrev_b32 v52, 16, v22
    v_and_b32 v53, 0xffff0000, v22
    v_lshlrev_b32 v54, 16, v23
    v_and_b32 v55, 0xffff0000, v23
    v_lshlrev_b32 v56, 16, v38
    v_and_b32 v57, 0xffff0000, v38
    v_lshlrev_b32 v58, 16, v39
    v_and_b32 v59, 0xffff0000, v39
    v_pk_add_f32 v[60:61], v[52:53], v[48:49] op_sel_hi:[1,0] neg_lo:[0,1] neg_hi:[0,1]
    v_pk_add_f32 v[62:63], v[54:55], v[48:49] op_sel_hi:[1,0] neg_lo:[0,1] neg_hi:[0,1]
    v_pk_mul_f32 v[56:57], v[56:57], v[48:49] op_sel:[0,1] op_sel_hi:[1,1]
    v_pk_mul_f32 v[58:59], v[58:59], v[48:49] op_sel:[0,1] op_sel_hi:[1,1]
    v_pk_fma_f32 v[52:53], v[60:61], v[56:57], v[52:53]
    v_pk_fma_f32 v[54:55], v[62:63], v[58:59], v[54:55]
    v_cvt_pk_bf16_f32 v22, v52, v53
    v_cvt_pk_bf16_f32 v23, v54, v55
    s_add_u32 s79, s69, 128
    buffer_load_dwordx4 v[32:35], v136, s[36:39], s79 offen sc1
    s_cmp_eq_u32 s30, 0
    s_cbranch_scc1 Lg_120
    s_add_u32 s74, s76, 15728896
    s_mov_b64 exec, s[86:87]
    buffer_store_dwordx4 v[20:23], v132, s[36:39], s74 offen
    s_mov_b64 exec, -1
Lgb_121:
    s_waitcnt lgkmcnt(4)
    v_pk_add_f32 v[88:89], v[88:89], v[96:97]
    v_pk_add_f32 v[90:91], v[90:91], v[98:99]
    v_pk_add_f32 v[92:93], v[92:93], v[100:101]
    v_pk_add_f32 v[94:95], v[94:95], v[102:103]
    s_waitcnt lgkmcnt(0)
    v_pk_add_f32 v[104:105], v[104:105], v[112:113]
    v_pk_add_f32 v[106:107], v[106:107], v[114:115]
    v_pk_add_f32 v[108:109], v[108:109], v[116:117]
    v_pk_add_f32 v[110:111], v[110:111], v[118:119]
    v_pk_add_f32 v[88:89], v[88:89], v[104:105]
    v_pk_add_f32 v[90:91], v[90:91], v[106:107]
    v_pk_add_f32 v[92:93], v[92:93], v[108:109]
    v_pk_add_f32 v[94:95], v[94:95], v[110:111]
    v_fmac_f32 v120, v88, v138
    v_fmac_f32 v121, v89, v138
    v_fmac_f32 v122, v90, v138
    v_fmac_f32 v123, v91, v138
    v_fmac_f32 v124, v92, v138
    v_fmac_f32 v125, v93, v138
    v_fmac_f32 v126, v94, v138
    v_fmac_f32 v127, v95, v138
    v_cvt_pk_bf16_f32 v28, v120, v121
    v_cvt_pk_bf16_f32 v29, v122, v123
    v_cvt_pk_bf16_f32 v30, v124, v125
    v_cvt_pk_bf16_f32 v31, v126, v127
    v_pk_add_f32 v[88:89], v[120:121], v[122:123]
    v_pk_mul_f32 v[90:91], v[120:121], v[120:121]
    v_pk_add_f32 v[92:93], v[124:125], v[126:127]
    v_pk_fma_f32 v[90:91], v[122:123], v[122:123], v[90:91]
    v_pk_add_f32 v[88:89], v[88:89], v[92:93]
    v_pk_fma_f32 v[90:91], v[124:125], v[124:125], v[90:91]
    v_add_f32 v128, v88, v89
    v_pk_fma_f32 v[90:91], v[126:127], v[126:127], v[90:91]
    v_cndmask_b32 v128, 0, v128, s[86:87]
    v_add_f32 v129, v90, v91
    v_cndmask_b32 v129, 0, v129, s[86:87]
    v_add_f32_dpp v128, v128, v128 row_ror:8 row_mask:0xf bank_mask:0xf
    s_nop 0
    v_add_f32_dpp v129, v129, v129 row_ror:8 row_mask:0xf bank_mask:0xf
    v_add_f32_dpp v128, v128, v128 row_ror:4 row_mask:0xf bank_mask:0xf
    s_nop 0
    v_add_f32_dpp v129, v129, v129 row_ror:4 row_mask:0xf bank_mask:0xf
    v_add_f32_dpp v128, v128, v128 row_ror:2 row_mask:0xf bank_mask:0xf
    s_nop 0
    v_add_f32_dpp v129, v129, v129 row_ror:2 row_mask:0xf bank_mask:0xf
    v_add_f32_dpp v128, v128, v128 row_ror:1 row_mask:0xf bank_mask:0xf
    s_nop 0
    v_add_f32_dpp v129, v129, v129 row_ror:1 row_mask:0xf bank_mask:0xf
    s_cmp_eq_u32 s30, 0
    s_cbranch_scc1 Lg_122
    s_add_u32 s74, s78, 192
    s_mov_b32 exec_lo, 0x00010001
    s_mov_b32 exec_hi, 0x00010001
    buffer_store_dwordx4 v[128:131], v135, s[36:39], s74 offen
    s_mov_b64 exec, -1
Lgb_123:
    s_add_u32 s73, s67, 0
    s_waitcnt vmcnt(1)
    s_cmp_eq_u32 s30, 0
    s_cbranch_scc1 Lg_124
    s_mov_b64 exec, 1
    buffer_store_dword v14, off, s[36:39], s73
    s_mov_b64 exec, -1
Lgb_125:
    v_min_u32 v231, 31, v1
    v_lshlrev_b32 v231, 7, v231
    v_mov_b32 v229, v136
    v_mov_b32 v230, v132
    v_cmp_ne_u32 vcc, v35, v14
    s_cbranch_vccnz Lps_127
Lpd_126:
    v_add_f32_dpp v32, v32, v32 row_ror:4 row_mask:0xf bank_mask:0xf
    v_add_f32_dpp v33, v33, v33 row_ror:4 row_mask:0xf bank_mask:0xf
    s_nop 0
    v_add_f32_dpp v32, v32, v32 row_ror:2 row_mask:0xf bank_mask:0xf
    v_add_f32_dpp v33, v33, v33 row_ror:2 row_mask:0xf bank_mask:0xf
    s_nop 0
    v_add_f32_dpp v32, v32, v32 row_ror:1 row_mask:0xf bank_mask:0xf
    v_add_f32_dpp v33, v33, v33 row_ror:1 row_mask:0xf bank_mask:0xf
    v_mul_f32 v32, 0x3acccccd, v32
    v_mul_f32 v33, 0x3acccccd, v33
    v_fma_f32 v33, -v32, v32, v33
    v_max_f32 v33, 0, v33
    v_cvt_pk_bf16_f32 v32, v32, v32
    v_lshlrev_b32 v32, 16, v32
    v_cvt_pk_bf16_f32 v33, v33, v33
    v_lshlrev_b32 v33, 16, v33
    v_add_f32 v33, 0x3727c5ac, v33
    v_cvt_pk_bf16_f32 v33, v33, v33
    v_lshlrev_b32 v33, 16, v33
    v_sqrt_f32 v33, v33
    s_nop 0
    v_cvt_pk_bf16_f32 v33, v33, v33
    v_lshlrev_b32 v33, 16, v33
    v_rcp_f32 v33, v33
    v_lshlrev_b32 v88, 16, v24
    v_and_b32 v89, 0xffff0000, v24
    v_lshlrev_b32 v90, 16, v25
    v_and_b32 v91, 0xffff0000, v25
    v_lshlrev_b32 v92, 16, v26
    v_and_b32 v93, 0xffff0000, v26
    v_lshlrev_b32 v94, 16, v27
    v_and_b32 v95, 0xffff0000, v27
    v_lshlrev_b32 v96, 16, v40
    v_and_b32 v97, 0xffff0000, v40
    v_lshlrev_b32 v98, 16, v41
    v_and_b32 v99, 0xffff0000, v41
    v_lshlrev_b32 v100, 16, v42
    v_and_b32 v101, 0xffff0000, v42
    v_lshlrev_b32 v102, 16, v43
    v_and_b32 v103, 0xffff0000, v43
    v_pk_add_f32 v[104:105], v[88:89], v[32:33] op_sel_hi:[1,0] neg_lo:[0,1] neg_hi:[0,1]
    v_pk_add_f32 v[106:107], v[90:91], v[32:33] op_sel_hi:[1,0] neg_lo:[0,1] neg_hi:[0,1]
    v_pk_add_f32 v[108:109], v[92:93], v[32:33] op_sel_hi:[1,0] neg_lo:[0,1] neg_hi:[0,1]
    v_pk_add_f32 v[110:111], v[94:95], v[32:33] op_sel_hi:[1,0] neg_lo:[0,1] neg_hi:[0,1]
    v_pk_mul_f32 v[96:97], v[96:97], v[32:33] op_sel:[0,1] op_sel_hi:[1,1]
    v_pk_mul_f32 v[98:99], v[98:99], v[32:33] op_sel:[0,1] op_sel_hi:[1,1]
    v_pk_mul_f32 v[100:101], v[100:101], v[32:33] op_sel:[0,1] op_sel_hi:[1,1]
    v_pk_mul_f32 v[102:103], v[102:103], v[32:33] op_sel:[0,1] op_sel_hi:[1,1]
    v_pk_fma_f32 v[88:89], v[104:105], v[96:97], v[88:89]
    v_pk_fma_f32 v[90:91], v[106:107], v[98:99], v[90:91]
    v_pk_fma_f32 v[92:93], v[108:109], v[100:101], v[92:93]
    v_pk_fma_f32 v[94:95], v[110:111], v[102:103], v[94:95]
    v_cvt_pk_bf16_f32 v24, v88, v89
    v_cvt_pk_bf16_f32 v25, v90, v91
    v_cvt_pk_bf16_f32 v26, v92, v93
    v_cvt_pk_bf16_f32 v27, v94, v95
    buffer_load_dword v228, v231, s[36:39], s35 offen sc1
    s_cmp_eq_u32 s30, 0
    s_cbranch_scc1 Lg_128
    s_add_u32 s74, s76, 17039360
    s_mov_b64 exec, s[86:87]
    buffer_store_dwordx4 v[24:27], v132, s[36:39], s74 offen
    s_mov_b64 exec, -1
Lgb_129:
    s_waitcnt vmcnt(1)
    v_cmp_ne_u32 vcc, v228, v14
    s_cbranch_vccnz Lps_131
Lpd_130:
    s_add_u32 s88, s90, 15728640
    buffer_load_dwordx4 v[156:159], v6, s[36:39], s88 offen offset:0 sc1
    buffer_load_dwordx4 v[160:163], v6, s[36:39], s88 offen offset:256 sc1
    buffer_load_dwordx4 v[164:167], v6, s[36:39], s88 offen offset:2048 sc1
    buffer_load_dwordx4 v[168:171], v6, s[36:39], s88 offen offset:2304 sc1
    s_add_u32 s88, s90, 15732736
    buffer_load_dwordx4 v[172:175], v6, s[36:39], s88 offen offset:0 sc1
    buffer_load_dwordx4 v[176:179], v6, s[36:39], s88 offen offset:256 sc1
    buffer_load_dwordx4 v[180:183], v6, s[36:39], s88 offen offset:2048 sc1
    buffer_load_dwordx4 v[184:187], v6, s[36:39], s88 offen offset:2304 sc1
    s_add_u32 s88, s90, 15736832
    buffer_load_dwordx4 v[188:191], v6, s[36:39], s88 offen offset:0 sc1
    buffer_load_dwordx4 v[192:195], v6, s[36:39], s88 offen offset:256 sc1
    ds_read_b128 v[112:115], v8 offset:21504
    ds_read_b128 v[116:119], v8 offset:22528
    ds_read_b128 v[120:123], v8 offset:23552
    ds_read_b128 v[124:127], v8 offset:24576
    ds_read_b128 v[128:131], v8 offset:25600
    ds_read_b128 v[132:135], v8 offset:26624
    ds_read_b128 v[136:139], v8 offset:27648
    s_waitcnt vmcnt(8)
    s_waitcnt lgkmcnt(5)
    v_mfma_f32_16x16x32_bf16 v[48:51], v[112:115], v[156:159], 0
    buffer_load_dwordx4 v[196:199], v6, s[36:39], s88 offen offset:2048 sc1
    s_add_u32 s71, s69, 192
    v_mfma_f32_16x16x32_bf16 v[76:79], v[112:115], v[160:163], 0
    ds_read_b128 v[112:115], v8 offset:14336
    buffer_load_dwordx4 v[32:35], v229, s[36:39], s71 offen sc1
    v_mfma_f32_16x16x32_bf16 v[52:55], v[116:119], v[156:159], 0
    buffer_load_dwordx4 v[200:203], v6, s[36:39], s88 offen offset:2304 sc1
    v_mfma_f32_16x16x32_bf16 v[80:83], v[116:119], v[160:163], 0
    ds_read_b128 v[116:119], v8 offset:15360
    s_waitcnt lgkmcnt(5)
    v_mfma_f32_16x16x32_bf16 v[56:59], v[120:123], v[156:159], 0
    s_add_u32 s88, s90, 15740928
    buffer_load_dwordx4 v[204:207], v6, s[36:39], s88 offen offset:0 sc1
    v_mfma_f32_16x16x32_bf16 v[84:87], v[120:123], v[160:163], 0
    ds_read_b128 v[120:123], v8 offset:16384
    v_mfma_f32_16x16x32_bf16 v[60:63], v[124:127], v[156:159], 0
    buffer_load_dwordx4 v[208:211], v6, s[36:39], s88 offen offset:256 sc1
    s_waitcnt vmcnt(11)
    v_mfma_f32_16x16x32_bf16 v[88:91], v[124:127], v[160:163], 0
    ds_read_b128 v[124:127], v8 offset:17408
    s_waitcnt lgkmcnt(5)
    v_mfma_f32_16x16x32_bf16 v[64:67], v[128:131], v[156:159], 0
    v_mfma_f32_16x16x32_bf16 v[92:95], v[128:131], v[160:163], 0
    ds_read_b128 v[128:131], v8 offset:18432
    v_mfma_f32_16x16x32_bf16 v[68:71], v[132:135], v[156:159], 0
    v_mfma_f32_16x16x32_bf16 v[96:99], v[132:135], v[160:163], 0
    ds_read_b128 v[132:135], v8 offset:19456
    s_waitcnt lgkmcnt(6)
    v_mfma_f32_16x16x32_bf16 v[72:75], v[136:139], v[156:159], 0
    v_mfma_f32_16x16x32_bf16 v[100:103], v[136:139], v[160:163], 0
    ds_read_b128 v[136:139], v8 offset:20480
    s_waitcnt lgkmcnt(5)
    v_mfma_f32_16x16x32_bf16 v[48:51], v[112:115], v[164:167], v[48:51]
    buffer_load_dwordx4 v[212:215], v6, s[36:39], s88 offen offset:2048 sc1
    v_mfma_f32_16x16x32_bf16 v[76:79], v[112:115], v[168:171], v[76:79]
    ds_read_b128 v[112:115], v8 offset:7168
    v_mfma_f32_16x16x32_bf16 v[52:55], v[116:119], v[164:167], v[52:55]
    buffer_load_dwordx4 v[216:219], v6, s[36:39], s88 offen offset:2304 sc1
    v_mfma_f32_16x16x32_bf16 v[80:83], v[116:119], v[168:171], v[80:83]
    ds_read_b128 v[116:119], v8 offset:8192
    s_waitcnt lgkmcnt(5)
    v_mfma_f32_16x16x32_bf16 v[56:59], v[120:123], v[164:167], v[56:59]
    s_add_u32 s88, s90, 15745024
    buffer_load_dwordx4 v[220:223], v6, s[36:39], s88 offen offset:0 sc1
    v_mfma_f32_16x16x32_bf16 v[84:87], v[120:123], v[168:171], v[84:87]
    ds_read_b128 v[120:123], v8 offset:9216
    v_mfma_f32_16x16x32_bf16 v[60:63], v[124:127], v[164:167], v[60:63]
    buffer_load_dwordx4 v[224:227], v6, s[36:39], s88 offen offset:256 sc1
    s_waitcnt vmcnt(13)
    v_mfma_f32_16x16x32_bf16 v[88:91], v[124:127], v[168:171], v[88:91]
    ds_read_b128 v[124:127], v8 offset:10240
    s_waitcnt lgkmcnt(5)
    v_mfma_f32_16x16x32_bf16 v[64:67], v[128:131], v[164:167], v[64:67]
    v_mfma_f32_16x16x32_bf16 v[92:95], v[128:131], v[168:171], v[92:95]
    ds_read_b128 v[128:131], v8 offset:11264
    v_mfma_f32_16x16x32_bf16 v[68:71], v[132:135], v[164:167], v[68:71]
    v_mfma_f32_16x16x32_bf16 v[96:99], v[132:135], v[168:171], v[96:99]
    ds_read_b128 v[132:135], v8 offset:12288
    s_waitcnt lgkmcnt(6)
    v_mfma_f32_16x16x32_bf16 v[72:75], v[136:139], v[164:167], v[72:75]
    v_mfma_f32_16x16x32_bf16 v[100:103], v[136:139], v[168:171], v[100:103]
    ds_read_b128 v[136:139], v8 offset:13312
    s_waitcnt lgkmcnt(5)
    v_mfma_f32_16x16x32_bf16 v[48:51], v[112:115], v[172:175], v[48:51]
    buffer_load_dwordx4 v[140:143], v6, s[36:39], s88 offen offset:2048 sc1
    v_mfma_f32_16x16x32_bf16 v[76:79], v[112:115], v[176:179], v[76:79]
    ds_read_b128 v[112:115], v8 offset:0
    v_mfma_f32_16x16x32_bf16 v[52:55], v[116:119], v[172:175], v[52:55]
    buffer_load_dwordx4 v[144:147], v6, s[36:39], s88 offen offset:2304 sc1
    v_mfma_f32_16x16x32_bf16 v[80:83], v[116:119], v[176:179], v[80:83]
    ds_read_b128 v[116:119], v8 offset:1024
    s_waitcnt lgkmcnt(5)
    v_mfma_f32_16x16x32_bf16 v[56:59], v[120:123], v[172:175], v[56:59]
    s_add_u32 s88, s90, 15749120
    buffer_load_dwordx4 v[148:151], v6, s[36:39], s88 offen offset:0 sc1
    v_mfma_f32_16x16x32_bf16 v[84:87], v[120:123], v[176:179], v[84:87]
    ds_read_b128 v[120:123], v8 offset:2048
    v_mfma_f32_16x16x32_bf16 v[60:63], v[124:127], v[172:175], v[60:63]
    buffer_load_dwordx4 v[152:155], v6, s[36:39], s88 offen offset:256 sc1
    s_waitcnt vmcnt(15)
    v_mfma_f32_16x16x32_bf16 v[88:91], v[124:127], v[176:179], v[88:91]
    ds_read_b128 v[124:127], v8 offset:3072
    s_waitcnt lgkmcnt(5)
    v_mfma_f32_16x16x32_bf16 v[64:67], v[128:131], v[172:175], v[64:67]
    v_mfma_f32_16x16x32_bf16 v[92:95], v[128:131], v[176:179], v[92:95]
    ds_read_b128 v[128:131], v8 offset:4096
    v_mfma_f32_16x16x32_bf16 v[68:71], v[132:135], v[172:175], v[68:71]
    v_mfma_f32_16x16x32_bf16 v[96:99], v[132:135], v[176:179], v[96:99]
    ds_read_b128 v[132:135], v8 offset:5120
    s_waitcnt lgkmcnt(6)
    v_mfma_f32_16x16x32_bf16 v[72:75], v[136:139], v[172:175], v[72:75]
    v_mfma_f32_16x16x32_bf16 v[100:103], v[136:139], v[176:179], v[100:103]
    ds_read_b128 v[136:139], v8 offset:6144
    s_waitcnt lgkmcnt(5)
    v_mfma_f32_16x16x32_bf16 v[48:51], v[112:115], v[180:183], v[48:51]
    buffer_load_dwordx4 v[156:159], v6, s[36:39], s88 offen offset:2048 sc1
    s_waitcnt vmcnt(12)
    v_cmp_ne_u32 vcc, v35, v14
    s_cbranch_vccnz Lps_133
Lpd_132:
    v_mfma_f32_16x16x32_bf16 v[76:79], v[112:115], v[184:187], v[76:79]
    ds_read_b128 v[112:115], v7 offset:50176
    v_add_f32_dpp v32, v32, v32 row_ror:4 row_mask:0xf bank_mask:0xf
    v_mfma_f32_16x16x32_bf16 v[52:55], v[116:119], v[180:183], v[52:55]
    buffer_load_dwordx4 v[160:163], v6, s[36:39], s88 offen offset:2304 sc1
    v_add_f32_dpp v33, v33, v33 row_ror:4 row_mask:0xf bank_mask:0xf
    v_mfma_f32_16x16x32_bf16 v[80:83], v[116:119], v[184:187], v[80:83]
    ds_read_b128 v[116:119], v7 offset:51200
    s_waitcnt lgkmcnt(5)
    v_mfma_f32_16x16x32_bf16 v[56:59], v[120:123], v[180:183], v[56:59]
    s_add_u32 s88, s90, 15753216
    buffer_load_dwordx4 v[164:167], v6, s[36:39], s88 offen offset:0 sc1
    v_add_f32_dpp v32, v32, v32 row_ror:2 row_mask:0xf bank_mask:0xf
    v_mfma_f32_16x16x32_bf16 v[84:87], v[120:123], v[184:187], v[84:87]
    ds_read_b128 v[120:123], v7 offset:52224
    v_add_f32_dpp v33, v33, v33 row_ror:2 row_mask:0xf bank_mask:0xf
    v_mfma_f32_16x16x32_bf16 v[60:63], v[124:127], v[180:183], v[60:63]
    buffer_load_dwordx4 v[168:171], v6, s[36:39], s88 offen offset:256 sc1
    v_mfma_f32_16x16x32_bf16 v[88:91], v[124:127], v[184:187], v[88:91]
    ds_read_b128 v[124:127], v7 offset:53248
    s_waitcnt lgkmcnt(5)
    v_mfma_f32_16x16x32_bf16 v[64:67], v[128:131], v[180:183], v[64:67]
    v_add_f32_dpp v32, v32, v32 row_ror:1 row_mask:0xf bank_mask:0xf
    v_add_f32_dpp v33, v33, v33 row_ror:1 row_mask:0xf bank_mask:0xf
    v_mfma_f32_16x16x32_bf16 v[92:95], v[128:131], v[184:187], v[92:95]
    ds_read_b128 v[128:131], v7 offset:54272
    v_mul_f32 v32, 0x3acccccd, v32
    v_mfma_f32_16x16x32_bf16 v[68:71], v[132:135], v[180:183], v[68:71]
    v_mul_f32 v33, 0x3acccccd, v33
    v_fma_f32 v33, -v32, v32, v33
    v_mfma_f32_16x16x32_bf16 v[96:99], v[132:135], v[184:187], v[96:99]
    ds_read_b128 v[132:135], v7 offset:55296
    s_waitcnt lgkmcnt(6)
    v_mfma_f32_16x16x32_bf16 v[72:75], v[136:139], v[180:183], v[72:75]
    v_max_f32 v33, 0, v33
    v_cvt_pk_bf16_f32 v32, v32, v32
    v_mfma_f32_16x16x32_bf16 v[100:103], v[136:139], v[184:187], v[100:103]
    ds_read_b128 v[136:139], v7 offset:56320
    s_waitcnt lgkmcnt(5)
    v_mfma_f32_16x16x32_bf16 v[48:51], v[112:115], v[188:191], v[48:51]
    buffer_load_dwordx4 v[172:175], v6, s[36:39], s88 offen offset:2048 sc1
    v_lshlrev_b32 v32, 16, v32
    v_mfma_f32_16x16x32_bf16 v[76:79], v[112:115], v[192:195], v[76:79]
    ds_read_b128 v[112:115], v7 offset:43008
    v_cvt_pk_bf16_f32 v33, v33, v33
    v_mfma_f32_16x16x32_bf16 v[52:55], v[116:119], v[188:191], v[52:55]
    buffer_load_dwordx4 v[176:179], v6, s[36:39], s88 offen offset:2304 sc1
    v_lshlrev_b32 v33, 16, v33
    v_mfma_f32_16x16x32_bf16 v[80:83], v[116:119], v[192:195], v[80:83]
    ds_read_b128 v[116:119], v7 offset:44032
    s_waitcnt lgkmcnt(5)
    v_mfma_f32_16x16x32_bf16 v[56:59], v[120:123], v[188:191], v[56:59]
    s_add_u32 s88, s90, 15757312
    buffer_load_dwordx4 v[180:183], v6, s[36:39], s88 offen offset:0 sc1
    v_add_f32 v33, 0x3727c5ac, v33
    v_mfma_f32_16x16x32_bf16 v[84:87], v[120:123], v[192:195], v[84:87]
    ds_read_b128 v[120:123], v7 offset:45056
    v_cvt_pk_bf16_f32 v33, v33, v33
    v_mfma_f32_16x16x32_bf16 v[60:63], v[124:127], v[188:191], v[60:63]
    buffer_load_dwordx4 v[184:187], v6, s[36:39], s88 offen offset:256 sc1
    s_waitcnt vmcnt(18)
    v_mfma_f32_16x16x32_bf16 v[88:91], v[124:127], v[192:195], v[88:91]
    ds_read_b128 v[124:127], v7 offset:46080
    s_waitcnt lgkmcnt(5)
    v_mfma_f32_16x16x32_bf16 v[64:67], v[128:131], v[188:191], v[64:67]
    v_lshlrev_b32 v33, 16, v33
    v_sqrt_f32 v33, v33
    v_mfma_f32_16x16x32_bf16 v[92:95], v[128:131], v[192:195], v[92:95]
    ds_read_b128 v[128:131], v7 offset:47104
    v_cvt_pk_bf16_f32 v33, v33, v33
    v_mfma_f32_16x16x32_bf16 v[68:71], v[132:135], v[188:191], v[68:71]
    v_lshlrev_b32 v33, 16, v33
    v_rcp_f32 v33, v33
    v_mfma_f32_16x16x32_bf16 v[96:99], v[132:135], v[192:195], v[96:99]
    ds_read_b128 v[132:135], v7 offset:48128
    s_waitcnt lgkmcnt(6)
    v_mfma_f32_16x16x32_bf16 v[72:75], v[136:139], v[188:191], v[72:75]
    v_lshlrev_b32 v34, 16, v28
    v_and_b32 v35, 0xffff0000, v28
    v_mfma_f32_16x16x32_bf16 v[100:103], v[136:139], v[192:195], v[100:103]
    ds_read_b128 v[136:139], v7 offset:49152
    s_waitcnt lgkmcnt(5)
    v_mfma_f32_16x16x32_bf16 v[48:51], v[112:115], v[196:199], v[48:51]
    buffer_load_dwordx4 v[188:191], v6, s[36:39], s88 offen offset:2048 sc1
    v_lshlrev_b32 v36, 16, v44
    v_mfma_f32_16x16x32_bf16 v[76:79], v[112:115], v[200:203], v[76:79]
    ds_read_b128 v[112:115], v7 offset:35840
    v_and_b32 v37, 0xffff0000, v44
    v_mfma_f32_16x16x32_bf16 v[52:55], v[116:119], v[196:199], v[52:55]
    buffer_load_dwordx4 v[192:195], v6, s[36:39], s88 offen offset:2304 sc1
    v_sub_f32 v38, v34, v32
    v_mfma_f32_16x16x32_bf16 v[80:83], v[116:119], v[200:203], v[80:83]
    ds_read_b128 v[116:119], v7 offset:36864
    s_waitcnt lgkmcnt(5)
    v_mfma_f32_16x16x32_bf16 v[56:59], v[120:123], v[196:199], v[56:59]
    v_sub_f32 v39, v35, v32
    v_mul_f32 v36, v36, v33
    v_mfma_f32_16x16x32_bf16 v[84:87], v[120:123], v[200:203], v[84:87]
    ds_read_b128 v[120:123], v7 offset:37888
    v_mul_f32 v37, v37, v33
    v_mfma_f32_16x16x32_bf16 v[60:63], v[124:127], v[196:199], v[60:63]
    s_waitcnt vmcnt(18)
    v_fmac_f32 v34, v38, v36
    v_mfma_f32_16x16x32_bf16 v[88:91], v[124:127], v[200:203], v[88:91]
    ds_read_b128 v[124:127], v7 offset:38912
    s_waitcnt lgkmcnt(5)
    v_mfma_f32_16x16x32_bf16 v[64:67], v[128:131], v[196:199], v[64:67]
    v_fmac_f32 v35, v39, v37
    v_cvt_pk_bf16_f32 v28, v34, v35
    v_mfma_f32_16x16x32_bf16 v[92:95], v[128:131], v[200:203], v[92:95]
    ds_read_b128 v[128:131], v7 offset:39936
    v_lshlrev_b32 v34, 16, v29
    v_mfma_f32_16x16x32_bf16 v[68:71], v[132:135], v[196:199], v[68:71]
    v_and_b32 v35, 0xffff0000, v29
    v_lshlrev_b32 v36, 16, v45
    v_mfma_f32_16x16x32_bf16 v[96:99], v[132:135], v[200:203], v[96:99]
    ds_read_b128 v[132:135], v7 offset:40960
    s_waitcnt lgkmcnt(6)
    v_mfma_f32_16x16x32_bf16 v[72:75], v[136:139], v[196:199], v[72:75]
    v_and_b32 v37, 0xffff0000, v45
    v_sub_f32 v38, v34, v32
    v_mfma_f32_16x16x32_bf16 v[100:103], v[136:139], v[200:203], v[100:103]
    ds_read_b128 v[136:139], v7 offset:41984
    s_waitcnt lgkmcnt(5)
    v_mfma_f32_16x16x32_bf16 v[48:51], v[112:115], v[204:207], v[48:51]
    s_add_u32 s88, s90, 15761408
    buffer_load_dwordx4 v[196:199], v6, s[36:39], s88 offen offset:0 sc1
    v_sub_f32 v39, v35, v32
    v_mfma_f32_16x16x32_bf16 v[76:79], v[112:115], v[208:211], v[76:79]
    ds_read_b128 v[112:115], v7 offset:28672
    v_mul_f32 v36, v36, v33
    v_mfma_f32_16x16x32_bf16 v[52:55], v[116:119], v[204:207], v[52:55]
    buffer_load_dwordx4 v[200:203], v6, s[36:39], s88 offen offset:256 sc1
    v_mul_f32 v37, v37, v33
    v_mfma_f32_16x16x32_bf16 v[80:83], v[116:119], v[208:211], v[80:83]
    ds_read_b128 v[116:119], v7 offset:29696
    s_waitcnt lgkmcnt(5)
    v_mfma_f32_16x16x32_bf16 v[56:59], v[120:123], v[204:207], v[56:59]
    v_fmac_f32 v34, v38, v36
    v_fmac_f32 v35, v39, v37
    v_mfma_f32_16x16x32_bf16 v[84:87], v[120:123], v[208:211], v[84:87]
    ds_read_b128 v[120:123], v7 offset:30720
    v_cvt_pk_bf16_f32 v29, v34, v35
    v_mfma_f32_16x16x32_bf16 v[60:63], v[124:127], v[204:207], v[60:63]
    s_waitcnt vmcnt(18)
    v_lshlrev_b32 v34, 16, v30
    v_mfma_f32_16x16x32_bf16 v[88:91], v[124:127], v[208:211], v[88:91]
    ds_read_b128 v[124:127], v7 offset:31744
    s_waitcnt lgkmcnt(5)
    v_mfma_f32_16x16x32_bf16 v[64:67], v[128:131], v[204:207], v[64:67]
    v_and_b32 v35, 0xffff0000, v30
    v_lshlrev_b32 v36, 16, v46
    v_mfma_f32_16x16x32_bf16 v[92:95], v[128:131], v[208:211], v[92:95]
    ds_read_b128 v[128:131], v7 offset:32768
    v_and_b32 v37, 0xffff0000, v46
    v_mfma_f32_16x16x32_bf16 v[68:71], v[132:135], v[204:207], v[68:71]
    v_sub_f32 v38, v34, v32
    v_sub_f32 v39, v35, v32
    v_mfma_f32_16x16x32_bf16 v[96:99], v[132:135], v[208:211], v[96:99]
    ds_read_b128 v[132:135], v7 offset:33792
    s_waitcnt lgkmcnt(6)
    v_mfma_f32_16x16x32_bf16 v[72:75], v[136:139], v[204:207], v[72:75]
    v_mul_f32 v36, v36, v33
    v_mul_f32 v37, v37, v33
    v_mfma_f32_16x16x32_bf16 v[100:103], v[136:139], v[208:211], v[100:103]
    ds_read_b128 v[136:139], v7 offset:34816
    s_waitcnt lgkmcnt(5)
    v_mfma_f32_16x16x32_bf16 v[48:51], v[112:115], v[212:215], v[48:51]
    buffer_load_dwordx4 v[204:207], v6, s[36:39], s88 offen offset:2048 sc1
    v_fmac_f32 v34, v38, v36
    v_mfma_f32_16x16x32_bf16 v[76:79], v[112:115], v[216:219], v[76:79]
    ds_read_b128 v[112:115], v7 offset:21504
    v_fmac_f32 v35, v39, v37
    v_mfma_f32_16x16x32_bf16 v[52:55], v[116:119], v[212:215], v[52:55]
    buffer_load_dwordx4 v[208:211], v6, s[36:39], s88 offen offset:2304 sc1
    v_cvt_pk_bf16_f32 v30, v34, v35
    v_mfma_f32_16x16x32_bf16 v[80:83], v[116:119], v[216:219], v[80:83]
    ds_read_b128 v[116:119], v7 offset:22528
    s_waitcnt lgkmcnt(5)
    v_mfma_f32_16x16x32_bf16 v[56:59], v[120:123], v[212:215], v[56:59]
    v_lshlrev_b32 v34, 16, v31
    v_and_b32 v35, 0xffff0000, v31
    v_mfma_f32_16x16x32_bf16 v[84:87], v[120:123], v[216:219], v[84:87]
    ds_read_b128 v[120:123], v7 offset:23552
    v_lshlrev_b32 v36, 16, v47
    v_mfma_f32_16x16x32_bf16 v[60:63], v[124:127], v[212:215], v[60:63]
    s_waitcnt vmcnt(18)
    v_and_b32 v37, 0xffff0000, v47
    v_mfma_f32_16x16x32_bf16 v[88:91], v[124:127], v[216:219], v[88:91]
    ds_read_b128 v[124:127], v7 offset:24576
    s_waitcnt lgkmcnt(5)
    v_mfma_f32_16x16x32_bf16 v[64:67], v[128:131], v[212:215], v[64:67]
    v_sub_f32 v38, v34, v32
    v_sub_f32 v39, v35, v32
    v_mfma_f32_16x16x32_bf16 v[92:95], v[128:131], v[216:219], v[92:95]
    ds_read_b128 v[128:131], v7 offset:25600
    v_mul_f32 v36, v36, v33
    v_mfma_f32_16x16x32_bf16 v[68:71], v[132:135], v[212:215], v[68:71]
    v_mul_f32 v37, v37, v33
    v_fmac_f32 v34, v38, v36
    v_mfma_f32_16x16x32_bf16 v[96:99], v[132:135], v[216:219], v[96:99]
    ds_read_b128 v[132:135], v7 offset:26624
    s_waitcnt lgkmcnt(6)
    v_mfma_f32_16x16x32_bf16 v[72:75], v[136:139], v[212:215], v[72:75]
    v_fmac_f32 v35, v39, v37
    v_cvt_pk_bf16_f32 v31, v34, v35
    v_mfma_f32_16x16x32_bf16 v[100:103], v[136:139], v[216:219], v[100:103]
    ds_read_b128 v[136:139], v7 offset:27648
    s_waitcnt lgkmcnt(5)
    v_mfma_f32_16x16x32_bf16 v[48:51], v[112:115], v[220:223], v[48:51]
    s_add_u32 s88, s90, 15765504
    buffer_load_dwordx4 v[212:215], v6, s[36:39], s88 offen offset:0 sc1
    s_cmp_eq_u32 s30, 0
    s_cbranch_scc1 Lg_134
    s_add_u32 s74, s76, 17039616
    s_mov_b64 exec, s[86:87]
    buffer_store_dwordx4 v[28:31], v230, s[36:39], s74 offen
    s_mov_b64 exec, -1
Lgb_135:
    v_mfma_f32_16x16x32_bf16 v[76:79], v[112:115], v[224:227], v[76:79]
    ds_read_b128 v[112:115], v7 offset:14336
    v_mfma_f32_16x16x32_bf16 v[52:55], v[116:119], v[220:223], v[52:55]
    buffer_load_dwordx4 v[216:219], v6, s[36:39], s88 offen offset:256 sc1
    v_mfma_f32_16x16x32_bf16 v[80:83], v[116:119], v[224:227], v[80:83]
    ds_read_b128 v[116:119], v7 offset:15360
    s_waitcnt lgkmcnt(5)
    v_mfma_f32_16x16x32_bf16 v[56:59], v[120:123], v[220:223], v[56:59]
    v_mfma_f32_16x16x32_bf16 v[84:87], v[120:123], v[224:227], v[84:87]
    ds_read_b128 v[120:123], v7 offset:16384
    v_mfma_f32_16x16x32_bf16 v[60:63], v[124:127], v[220:223], v[60:63]
    s_waitcnt vmcnt(19)
    v_mfma_f32_16x16x32_bf16 v[88:91], v[124:127], v[224:227], v[88:91]
    ds_read_b128 v[124:127], v7 offset:17408
    s_waitcnt lgkmcnt(5)
    v_mfma_f32_16x16x32_bf16 v[64:67], v[128:131], v[220:223], v[64:67]
    v_mfma_f32_16x16x32_bf16 v[92:95], v[128:131], v[224:227], v[92:95]
    ds_read_b128 v[128:131], v7 offset:18432
    v_mfma_f32_16x16x32_bf16 v[68:71], v[132:135], v[220:223], v[68:71]
    v_mfma_f32_16x16x32_bf16 v[96:99], v[132:135], v[224:227], v[96:99]
    ds_read_b128 v[132:135], v7 offset:19456
    s_waitcnt lgkmcnt(6)
    v_mfma_f32_16x16x32_bf16 v[72:75], v[136:139], v[220:223], v[72:75]
    v_mfma_f32_16x16x32_bf16 v[100:103], v[136:139], v[224:227], v[100:103]
    ds_read_b128 v[136:139], v7 offset:20480
    s_waitcnt lgkmcnt(5)
    v_mfma_f32_16x16x32_bf16 v[48:51], v[112:115], v[140:143], v[48:51]
    buffer_load_dwordx4 v[220:223], v6, s[36:39], s88 offen offset:2048 sc1
    v_mfma_f32_16x16x32_bf16 v[76:79], v[112:115], v[144:147], v[76:79]
    ds_read_b128 v[112:115], v7 offset:7168
    v_mfma_f32_16x16x32_bf16 v[52:55], v[116:119], v[140:143], v[52:55]
    buffer_load_dwordx4 v[224:227], v6, s[36:39], s88 offen offset:2304 sc1
    v_mfma_f32_16x16x32_bf16 v[80:83], v[116:119], v[144:147], v[80:83]
    ds_read_b128 v[116:119], v7 offset:8192
    s_waitcnt lgkmcnt(5)
    v_mfma_f32_16x16x32_bf16 v[56:59], v[120:123], v[140:143], v[56:59]
    v_mfma_f32_16x16x32_bf16 v[84:87], v[120:123], v[144:147], v[84:87]
    ds_read_b128 v[120:123], v7 offset:9216
    v_mfma_f32_16x16x32_bf16 v[60:63], v[124:127], v[140:143], v[60:63]
    s_waitcnt vmcnt(19)
    v_mfma_f32_16x16x32_bf16 v[88:91], v[124:127], v[144:147], v[88:91]
    ds_read_b128 v[124:127], v7 offset:10240
    s_waitcnt lgkmcnt(5)
    v_mfma_f32_16x16x32_bf16 v[64:67], v[128:131], v[140:143], v[64:67]
    v_mfma_f32_16x16x32_bf16 v[92:95], v[128:131], v[144:147], v[92:95]
    ds_read_b128 v[128:131], v7 offset:11264
    v_mfma_f32_16x16x32_bf16 v[68:71], v[132:135], v[140:143], v[68:71]
    v_mfma_f32_16x16x32_bf16 v[96:99], v[132:135], v[144:147], v[96:99]
    ds_read_b128 v[132:135], v7 offset:12288
    s_waitcnt lgkmcnt(6)
    v_mfma_f32_16x16x32_bf16 v[72:75], v[136:139], v[140:143], v[72:75]
    v_mfma_f32_16x16x32_bf16 v[100:103], v[136:139], v[144:147], v[100:103]
    ds_read_b128 v[136:139], v7 offset:13312
    s_waitcnt lgkmcnt(5)
    v_mfma_f32_16x16x32_bf16 v[48:51], v[112:115], v[148:151], v[48:51]
    s_add_u32 s73, s67, 4
    s_waitcnt vmcnt(3)
    v_mfma_f32_16x16x32_bf16 v[76:79], v[112:115], v[152:155], v[76:79]
    ds_read_b128 v[112:115], v7 offset:0
    s_cmp_eq_u32 s30, 0
    s_cbranch_scc1 Lg_136
    s_mov_b64 exec, 1
    buffer_store_dword v14, off, s[36:39], s73
    s_mov_b64 exec, -1
Lgb_137:
    v_mfma_f32_16x16x32_bf16 v[52:55], v[116:119], v[148:151], v[52:55]
    v_mfma_f32_16x16x32_bf16 v[80:83], v[116:119], v[152:155], v[80:83]
    ds_read_b128 v[116:119], v7 offset:1024
    s_waitcnt lgkmcnt(5)
    v_mfma_f32_16x16x32_bf16 v[56:59], v[120:123], v[148:151], v[56:59]
    v_mfma_f32_16x16x32_bf16 v[84:87], v[120:123], v[152:155], v[84:87]
    ds_read_b128 v[120:123], v7 offset:2048
    v_mfma_f32_16x16x32_bf16 v[60:63], v[124:127], v[148:151], v[60:63]
    v_mfma_f32_16x16x32_bf16 v[88:91], v[124:127], v[152:155], v[88:91]
    ds_read_b128 v[124:127], v7 offset:3072
    s_waitcnt lgkmcnt(5)
    v_mfma_f32_16x16x32_bf16 v[64:67], v[128:131], v[148:151], v[64:67]
    v_mfma_f32_16x16x32_bf16 v[92:95], v[128:131], v[152:155], v[92:95]
    ds_read_b128 v[128:131], v7 offset:4096
    v_mfma_f32_16x16x32_bf16 v[68:71], v[132:135], v[148:151], v[68:71]
    v_mfma_f32_16x16x32_bf16 v[96:99], v[132:135], v[152:155], v[96:99]
    ds_read_b128 v[132:135], v7 offset:5120
    s_waitcnt lgkmcnt(6)
    v_mfma_f32_16x16x32_bf16 v[72:75], v[136:139], v[148:151], v[72:75]
    v_mfma_f32_16x16x32_bf16 v[100:103], v[136:139], v[152:155], v[100:103]
    ds_read_b128 v[136:139], v7 offset:6144
    s_waitcnt lgkmcnt(5)
    v_mfma_f32_16x16x32_bf16 v[48:51], v[112:115], v[156:159], v[48:51]
    v_mfma_f32_16x16x32_bf16 v[76:79], v[112:115], v[160:163], v[76:79]
    ds_read_b128 v[112:115], v2 offset:50176
    v_mfma_f32_16x16x32_bf16 v[52:55], v[116:119], v[156:159], v[52:55]
    v_min_u32 v231, 31, v1
    v_lshlrev_b32 v231, 7, v231
    v_mfma_f32_16x16x32_bf16 v[80:83], v[116:119], v[160:163], v[80:83]
    ds_read_b128 v[116:119], v2 offset:51200
    s_waitcnt lgkmcnt(5)
    v_mfma_f32_16x16x32_bf16 v[56:59], v[120:123], v[156:159], v[56:59]
    s_add_u32 s75, s35, 4
    buffer_load_dword v228, v231, s[36:39], s75 offen sc1
    v_mfma_f32_16x16x32_bf16 v[84:87], v[120:123], v[160:163], v[84:87]
    ds_read_b128 v[120:123], v2 offset:52224
    v_mfma_f32_16x16x32_bf16 v[60:63], v[124:127], v[156:159], v[60:63]
    v_mfma_f32_16x16x32_bf16 v[88:91], v[124:127], v[160:163], v[88:91]
    ds_read_b128 v[124:127], v2 offset:53248
    s_waitcnt lgkmcnt(5)
    v_mfma_f32_16x16x32_bf16 v[64:67], v[128:131], v[156:159], v[64:67]
    v_mfma_f32_16x16x32_bf16 v[92:95], v[128:131], v[160:163], v[92:95]
    ds_read_b128 v[128:131], v2 offset:54272
    v_mfma_f32_16x16x32_bf16 v[68:71], v[132:135], v[156:159], v[68:71]
    v_mfma_f32_16x16x32_bf16 v[96:99], v[132:135], v[160:163], v[96:99]
    ds_read_b128 v[132:135], v2 offset:55296
    s_waitcnt lgkmcnt(6)
    v_mfma_f32_16x16x32_bf16 v[72:75], v[136:139], v[156:159], v[72:75]
    v_mfma_f32_16x16x32_bf16 v[100:103], v[136:139], v[160:163], v[100:103]
    ds_read_b128 v[136:139], v2 offset:56320
    s_waitcnt lgkmcnt(5)
    v_mfma_f32_16x16x32_bf16 v[48:51], v[112:115], v[164:167], v[48:51]
    v_mfma_f32_16x16x32_bf16 v[76:79], v[112:115], v[168:171], v[76:79]
    ds_read_b128 v[112:115], v2 offset:43008
    v_mfma_f32_16x16x32_bf16 v[52:55], v[116:119], v[164:167], v[52:55]
    v_mfma_f32_16x16x32_bf16 v[80:83], v[116:119], v[168:171], v[80:83]
    ds_read_b128 v[116:119], v2 offset:44032
    s_waitcnt lgkmcnt(5)
    v_mfma_f32_16x16x32_bf16 v[56:59], v[120:123], v[164:167], v[56:59]
    v_mfma_f32_16x16x32_bf16 v[84:87], v[120:123], v[168:171], v[84:87]
    ds_read_b128 v[120:123], v2 offset:45056
    v_mfma_f32_16x16x32_bf16 v[60:63], v[124:127], v[164:167], v[60:63]
    v_mfma_f32_16x16x32_bf16 v[88:91], v[124:127], v[168:171], v[88:91]
    ds_read_b128 v[124:127], v2 offset:46080
    s_waitcnt lgkmcnt(5)
    v_mfma_f32_16x16x32_bf16 v[64:67], v[128:131], v[164:167], v[64:67]
    v_mfma_f32_16x16x32_bf16 v[92:95], v[128:131], v[168:171], v[92:95]
    ds_read_b128 v[128:131], v2 offset:47104
    v_mfma_f32_16x16x32_bf16 v[68:71], v[132:135], v[164:167], v[68:71]
    v_mfma_f32_16x16x32_bf16 v[96:99], v[132:135], v[168:171], v[96:99]
    ds_read_b128 v[132:135], v2 offset:48128
    s_waitcnt lgkmcnt(6)
    v_mfma_f32_16x16x32_bf16 v[72:75], v[136:139], v[164:167], v[72:75]
    v_mfma_f32_16x16x32_bf16 v[100:103], v[136:139], v[168:171], v[100:103]
    ds_read_b128 v[136:139], v2 offset:49152
    s_waitcnt lgkmcnt(5)
    v_mfma_f32_16x16x32_bf16 v[48:51], v[112:115], v[172:175], v[48:51]
    v_mfma_f32_16x16x32_bf16 v[76:79], v[112:115], v[176:179], v[76:79]
    ds_read_b128 v[112:115], v2 offset:35840
    v_mfma_f32_16x16x32_bf16 v[52:55], v[116:119], v[172:175], v[52:55]
    v_mfma_f32_16x16x32_bf16 v[80:83], v[116:119], v[176:179], v[80:83]
    ds_read_b128 v[116:119], v2 offset:36864
    s_waitcnt lgkmcnt(5)
    v_mfma_f32_16x16x32_bf16 v[56:59], v[120:123], v[172:175], v[56:59]
    v_mfma_f32_16x16x32_bf16 v[84:87], v[120:123], v[176:179], v[84:87]
    ds_read_b128 v[120:123], v2 offset:37888
    v_mfma_f32_16x16x32_bf16 v[60:63], v[124:127], v[172:175], v[60:63]
    v_mfma_f32_16x16x32_bf16 v[88:91], v[124:127], v[176:179], v[88:91]
    ds_read_b128 v[124:127], v2 offset:38912
    s_waitcnt lgkmcnt(5)
    v_mfma_f32_16x16x32_bf16 v[64:67], v[128:131], v[172:175], v[64:67]
    v_mfma_f32_16x16x32_bf16 v[92:95], v[128:131], v[176:179], v[92:95]
    ds_read_b128 v[128:131], v2 offset:39936
    v_mfma_f32_16x16x32_bf16 v[68:71], v[132:135], v[172:175], v[68:71]
    s_waitcnt vmcnt(0)
    v_cmp_ne_u32 vcc, v228, v14
    s_cbranch_vccnz Lps_139
Lpd_138:
    v_mfma_f32_16x16x32_bf16 v[96:99], v[132:135], v[176:179], v[96:99]
    ds_read_b128 v[132:135], v2 offset:40960
    s_waitcnt lgkmcnt(6)
    v_mfma_f32_16x16x32_bf16 v[72:75], v[136:139], v[172:175], v[72:75]
    v_mfma_f32_16x16x32_bf16 v[100:103], v[136:139], v[176:179], v[100:103]
    ds_read_b128 v[136:139], v2 offset:41984
    s_waitcnt lgkmcnt(5)
    v_mfma_f32_16x16x32_bf16 v[48:51], v[112:115], v[180:183], v[48:51]
    s_add_u32 s88, s90, 17039360
    buffer_load_dwordx4 v[140:143], v6, s[36:39], s88 offen offset:0 sc1
    v_mfma_f32_16x16x32_bf16 v[76:79], v[112:115], v[184:187], v[76:79]
    ds_read_b128 v[112:115], v2 offset:28672
    v_mfma_f32_16x16x32_bf16 v[52:55], v[116:119], v[180:183], v[52:55]
    buffer_load_dwordx4 v[144:147], v6, s[36:39], s88 offen offset:256 sc1
    v_mfma_f32_16x16x32_bf16 v[80:83], v[116:119], v[184:187], v[80:83]
    ds_read_b128 v[116:119], v2 offset:29696
    s_waitcnt lgkmcnt(5)
    v_mfma_f32_16x16x32_bf16 v[56:59], v[120:123], v[180:183], v[56:59]
    buffer_load_dwordx4 v[148:151], v6, s[36:39], s88 offen offset:2048 sc1
    v_mfma_f32_16x16x32_bf16 v[84:87], v[120:123], v[184:187], v[84:87]
    ds_read_b128 v[120:123], v2 offset:30720
    v_mfma_f32_16x16x32_bf16 v[60:63], v[124:127], v[180:183], v[60:63]
    buffer_load_dwordx4 v[152:155], v6, s[36:39], s88 offen offset:2304 sc1
    v_mfma_f32_16x16x32_bf16 v[88:91], v[124:127], v[184:187], v[88:91]
    ds_read_b128 v[124:127], v2 offset:31744
    s_waitcnt lgkmcnt(5)
    v_mfma_f32_16x16x32_bf16 v[64:67], v[128:131], v[180:183], v[64:67]
    v_mfma_f32_16x16x32_bf16 v[92:95], v[128:131], v[184:187], v[92:95]
    ds_read_b128 v[128:131], v2 offset:32768
    v_mfma_f32_16x16x32_bf16 v[68:71], v[132:135], v[180:183], v[68:71]
    v_mfma_f32_16x16x32_bf16 v[96:99], v[132:135], v[184:187], v[96:99]
    ds_read_b128 v[132:135], v2 offset:33792
    s_waitcnt lgkmcnt(6)
    v_mfma_f32_16x16x32_bf16 v[72:75], v[136:139], v[180:183], v[72:75]
    v_mfma_f32_16x16x32_bf16 v[100:103], v[136:139], v[184:187], v[100:103]
    ds_read_b128 v[136:139], v2 offset:34816
    s_waitcnt lgkmcnt(5)
    v_mfma_f32_16x16x32_bf16 v[48:51], v[112:115], v[188:191], v[48:51]
    s_add_u32 s88, s90, 17043456
    buffer_load_dwordx4 v[156:159], v6, s[36:39], s88 offen offset:0 sc1
    v_mfma_f32_16x16x32_bf16 v[76:79], v[112:115], v[192:195], v[76:79]
    ds_read_b128 v[112:115], v2 offset:21504
    v_mfma_f32_16x16x32_bf16 v[52:55], v[116:119], v[188:191], v[52:55]
    buffer_load_dwordx4 v[160:163], v6, s[36:39], s88 offen offset:256 sc1
    v_mfma_f32_16x16x32_bf16 v[80:83], v[116:119], v[192:195], v[80:83]
    ds_read_b128 v[116:119], v2 offset:22528
    s_waitcnt lgkmcnt(5)
    v_mfma_f32_16x16x32_bf16 v[56:59], v[120:123], v[188:191], v[56:59]
    buffer_load_dwordx4 v[164:167], v6, s[36:39], s88 offen offset:2048 sc1
    v_mfma_f32_16x16x32_bf16 v[84:87], v[120:123], v[192:195], v[84:87]
    ds_read_b128 v[120:123], v2 offset:23552
    v_mfma_f32_16x16x32_bf16 v[60:63], v[124:127], v[188:191], v[60:63]
    buffer_load_dwordx4 v[168:171], v6, s[36:39], s88 offen offset:2304 sc1
    v_mfma_f32_16x16x32_bf16 v[88:91], v[124:127], v[192:195], v[88:91]
    ds_read_b128 v[124:127], v2 offset:24576
    s_waitcnt lgkmcnt(5)
    v_mfma_f32_16x16x32_bf16 v[64:67], v[128:131], v[188:191], v[64:67]
    v_mfma_f32_16x16x32_bf16 v[92:95], v[128:131], v[192:195], v[92:95]
    ds_read_b128 v[128:131], v2 offset:25600
    v_mfma_f32_16x16x32_bf16 v[68:71], v[132:135], v[188:191], v[68:71]
    v_mfma_f32_16x16x32_bf16 v[96:99], v[132:135], v[192:195], v[96:99]
    ds_read_b128 v[132:135], v2 offset:26624
    s_waitcnt lgkmcnt(6)
    v_mfma_f32_16x16x32_bf16 v[72:75], v[136:139], v[188:191], v[72:75]
    v_mfma_f32_16x16x32_bf16 v[100:103], v[136:139], v[192:195], v[100:103]
    ds_read_b128 v[136:139], v2 offset:27648
    s_waitcnt lgkmcnt(5)
    v_mfma_f32_16x16x32_bf16 v[48:51], v[112:115], v[196:199], v[48:51]
    s_add_u32 s88, s90, 17047552
    buffer_load_dwordx4 v[172:175], v6, s[36:39], s88 offen offset:0 sc1
    v_mfma_f32_16x16x32_bf16 v[76:79], v[112:115], v[200:203], v[76:79]
    ds_read_b128 v[112:115], v2 offset:14336
    v_mfma_f32_16x16x32_bf16 v[52:55], v[116:119], v[196:199], v[52:55]
    buffer_load_dwordx4 v[176:179], v6, s[36:39], s88 offen offset:256 sc1
    v_mfma_f32_16x16x32_bf16 v[80:83], v[116:119], v[200:203], v[80:83]
    ds_read_b128 v[116:119], v2 offset:15360
    s_waitcnt lgkmcnt(5)
    v_mfma_f32_16x16x32_bf16 v[56:59], v[120:123], v[196:199], v[56:59]
    buffer_load_dwordx4 v[180:183], v6, s[36:39], s88 offen offset:2048 sc1
    v_mfma_f32_16x16x32_bf16 v[84:87], v[120:123], v[200:203], v[84:87]
    ds_read_b128 v[120:123], v2 offset:16384
    v_mfma_f32_16x16x32_bf16 v[60:63], v[124:127], v[196:199], v[60:63]
    buffer_load_dwordx4 v[184:187], v6, s[36:39], s88 offen offset:2304 sc1
    v_mfma_f32_16x16x32_bf16 v[88:91], v[124:127], v[200:203], v[88:91]
    ds_read_b128 v[124:127], v2 offset:17408
    s_waitcnt lgkmcnt(5)
    v_mfma_f32_16x16x32_bf16 v[64:67], v[128:131], v[196:199], v[64:67]
    v_mfma_f32_16x16x32_bf16 v[92:95], v[128:131], v[200:203], v[92:95]
    ds_read_b128 v[128:131], v2 offset:18432
    v_mfma_f32_16x16x32_bf16 v[68:71], v[132:135], v[196:199], v[68:71]
    v_mfma_f32_16x16x32_bf16 v[96:99], v[132:135], v[200:203], v[96:99]
    ds_read_b128 v[132:135], v2 offset:19456
    s_waitcnt lgkmcnt(6)
    v_mfma_f32_16x16x32_bf16 v[72:75], v[136:139], v[196:199], v[72:75]
    v_mfma_f32_16x16x32_bf16 v[100:103], v[136:139], v[200:203], v[100:103]
    ds_read_b128 v[136:139], v2 offset:20480
    s_waitcnt lgkmcnt(5)
    v_mfma_f32_16x16x32_bf16 v[48:51], v[112:115], v[204:207], v[48:51]
    s_add_u32 s88, s90, 17051648
    buffer_load_dwordx4 v[188:191], v6, s[36:39], s88 offen offset:0 sc1
    v_mfma_f32_16x16x32_bf16 v[76:79], v[112:115], v[208:211], v[76:79]
    ds_read_b128 v[112:115], v2 offset:7168
    v_mfma_f32_16x16x32_bf16 v[52:55], v[116:119], v[204:207], v[52:55]
    buffer_load_dwordx4 v[192:195], v6, s[36:39], s88 offen offset:256 sc1
    v_mfma_f32_16x16x32_bf16 v[80:83], v[116:119], v[208:211], v[80:83]
    ds_read_b128 v[116:119], v2 offset:8192
    s_waitcnt lgkmcnt(5)
    v_mfma_f32_16x16x32_bf16 v[56:59], v[120:123], v[204:207], v[56:59]
    buffer_load_dwordx4 v[196:199], v6, s[36:39], s88 offen offset:2048 sc1
    v_mfma_f32_16x16x32_bf16 v[84:87], v[120:123], v[208:211], v[84:87]
    ds_read_b128 v[120:123], v2 offset:9216
    v_mfma_f32_16x16x32_bf16 v[60:63], v[124:127], v[204:207], v[60:63]
    buffer_load_dwordx4 v[200:203], v6, s[36:39], s88 offen offset:2304 sc1
    v_mfma_f32_16x16x32_bf16 v[88:91], v[124:127], v[208:211], v[88:91]
    ds_read_b128 v[124:127], v2 offset:10240
    s_waitcnt lgkmcnt(5)
    v_mfma_f32_16x16x32_bf16 v[64:67], v[128:131], v[204:207], v[64:67]
    v_mfma_f32_16x16x32_bf16 v[92:95], v[128:131], v[208:211], v[92:95]
    ds_read_b128 v[128:131], v2 offset:11264
    v_mfma_f32_16x16x32_bf16 v[68:71], v[132:135], v[204:207], v[68:71]
    v_mfma_f32_16x16x32_bf16 v[96:99], v[132:135], v[208:211], v[96:99]
    ds_read_b128 v[132:135], v2 offset:12288
    s_waitcnt lgkmcnt(6)
    v_mfma_f32_16x16x32_bf16 v[72:75], v[136:139], v[204:207], v[72:75]
    v_mfma_f32_16x16x32_bf16 v[100:103], v[136:139], v[208:211], v[100:103]
    ds_read_b128 v[136:139], v2 offset:13312
    s_waitcnt lgkmcnt(0)
    v_mfma_f32_16x16x32_bf16 v[72:75], v[136:139], v[212:215], v[72:75]
    s_add_u32 s88, s90, 17055744
    buffer_load_dwordx4 v[204:207], v6, s[36:39], s88 offen offset:0 sc1
    v_mfma_f32_16x16x32_bf16 v[100:103], v[136:139], v[216:219], v[100:103]
    ds_read_b128 v[136:139], v2 offset:6144
    v_mfma_f32_16x16x32_bf16 v[48:51], v[112:115], v[212:215], v[48:51]
    buffer_load_dwordx4 v[208:211], v6, s[36:39], s88 offen offset:256 sc1
    v_mfma_f32_16x16x32_bf16 v[76:79], v[112:115], v[216:219], v[76:79]
    ds_read_b128 v[112:115], v2 offset:0
    v_mfma_f32_16x16x32_bf16 v[52:55], v[116:119], v[212:215], v[52:55]
    v_mfma_f32_16x16x32_bf16 v[80:83], v[116:119], v[216:219], v[80:83]
    ds_read_b128 v[116:119], v2 offset:1024
    v_mfma_f32_16x16x32_bf16 v[56:59], v[120:123], v[212:215], v[56:59]
    v_mfma_f32_16x16x32_bf16 v[84:87], v[120:123], v[216:219], v[84:87]
    ds_read_b128 v[120:123], v2 offset:2048
    v_mfma_f32_16x16x32_bf16 v[60:63], v[124:127], v[212:215], v[60:63]
    v_mfma_f32_16x16x32_bf16 v[88:91], v[124:127], v[216:219], v[88:91]
    ds_read_b128 v[124:127], v2 offset:3072
    v_mfma_f32_16x16x32_bf16 v[64:67], v[128:131], v[212:215], v[64:67]
    v_mfma_f32_16x16x32_bf16 v[92:95], v[128:131], v[216:219], v[92:95]
    ds_read_b128 v[128:131], v2 offset:4096
    v_mfma_f32_16x16x32_bf16 v[68:71], v[132:135], v[212:215], v[68:71]
    v_mfma_f32_16x16x32_bf16 v[96:99], v[132:135], v[216:219], v[96:99]
    ds_read_b128 v[132:135], v2 offset:5120
    s_waitcnt lgkmcnt(5)
    v_mfma_f32_16x16x32_bf16 v[72:75], v[136:139], v[220:223], v[72:75]
    buffer_load_dwordx4 v[212:215], v6, s[36:39], s88 offen offset:2048 sc1
    v_mfma_f32_16x16x32_bf16 v[100:103], v[136:139], v[224:227], v[100:103]
    ds_read_b128 v[136:139], v0 offset:0
    v_mfma_f32_16x16x32_bf16 v[48:51], v[112:115], v[220:223], v[48:51]
    buffer_load_dwordx4 v[216:219], v6, s[36:39], s88 offen offset:2304 sc1
    v_mfma_f32_16x16x32_bf16 v[76:79], v[112:115], v[224:227], v[76:79]
    ds_read_b128 v[112:115], v0 offset:43008
    s_waitcnt lgkmcnt(5)
    v_mfma_f32_16x16x32_bf16 v[52:55], v[116:119], v[220:223], v[52:55]
    v_mfma_f32_16x16x32_bf16 v[80:83], v[116:119], v[224:227], v[80:83]
    ds_read_b128 v[116:119], v0 offset:35840
    v_mfma_f32_16x16x32_bf16 v[56:59], v[120:123], v[220:223], v[56:59]
    ds_bpermute_b32 v104, v10, v74
    ds_bpermute_b32 v106, v10, v102
    v_mfma_f32_16x16x32_bf16 v[84:87], v[120:123], v[224:227], v[84:87]
    ds_read_b128 v[120:123], v0 offset:28672
    s_waitcnt lgkmcnt(7)
    v_mfma_f32_16x16x32_bf16 v[60:63], v[124:127], v[220:223], v[60:63]
    v_mfma_f32_16x16x32_bf16 v[88:91], v[124:127], v[224:227], v[88:91]
    ds_read_b128 v[124:127], v0 offset:21504
    v_mfma_f32_16x16x32_bf16 v[64:67], v[128:131], v[220:223], v[64:67]
    v_mfma_f32_16x16x32_bf16 v[92:95], v[128:131], v[224:227], v[92:95]
    ds_read_b128 v[128:131], v0 offset:14336
    s_waitcnt lgkmcnt(8)
    v_mfma_f32_16x16x32_bf16 v[68:71], v[132:135], v[220:223], v[68:71]
    s_waitcnt lgkmcnt(3)
    v_mul_f32 v104, 0x3acccccd, v104
    v_mfma_f32_16x16x32_bf16 v[96:99], v[132:135], v[224:227], v[96:99]
    ds_read_b128 v[132:135], v0 offset:7168
    v_mul_f32 v106, 0x3acccccd, v106
    v_cvt_pk_bf16_f32 v104, v104, v104
    v_cvt_pk_bf16_f32 v106, v106, v106
    v_lshlrev_b32 v104, 16, v104
    v_lshlrev_b32 v106, 16, v106
    s_add_u32 s72, s95, 33554432
    s_add_u32 s88, s90, 17059840
    buffer_load_dwordx4 v[220:223], v6, s[36:39], s88 offen offset:0 sc1
    buffer_load_dwordx4 v[224:227], v6, s[36:39], s88 offen offset:256 sc1
    v_pk_fma_f32 v[72:73], v[136:137], v[104:105], v[72:73] op_sel_hi:[1,0,1] neg_lo:[0,1,0] neg_hi:[0,1,0]
    v_pk_fma_f32 v[74:75], v[138:139], v[104:105], v[74:75] op_sel_hi:[1,0,1] neg_lo:[0,1,0] neg_hi:[0,1,0]
    v_pk_fma_f32 v[48:49], v[112:113], v[104:105], v[48:49] op_sel_hi:[1,0,1] neg_lo:[0,1,0] neg_hi:[0,1,0]
    v_pk_fma_f32 v[50:51], v[114:115], v[104:105], v[50:51] op_sel_hi:[1,0,1] neg_lo:[0,1,0] neg_hi:[0,1,0]
    v_pk_fma_f32 v[52:53], v[116:117], v[104:105], v[52:53] op_sel_hi:[1,0,1] neg_lo:[0,1,0] neg_hi:[0,1,0]
    v_pk_fma_f32 v[54:55], v[118:119], v[104:105], v[54:55] op_sel_hi:[1,0,1] neg_lo:[0,1,0] neg_hi:[0,1,0]
    s_waitcnt lgkmcnt(3)
    v_pk_fma_f32 v[56:57], v[120:121], v[104:105], v[56:57] op_sel_hi:[1,0,1] neg_lo:[0,1,0] neg_hi:[0,1,0]
    v_pk_fma_f32 v[58:59], v[122:123], v[104:105], v[58:59] op_sel_hi:[1,0,1] neg_lo:[0,1,0] neg_hi:[0,1,0]
    s_waitcnt lgkmcnt(2)
    v_pk_fma_f32 v[60:61], v[124:125], v[104:105], v[60:61] op_sel_hi:[1,0,1] neg_lo:[0,1,0] neg_hi:[0,1,0]
    v_pk_fma_f32 v[62:63], v[126:127], v[104:105], v[62:63] op_sel_hi:[1,0,1] neg_lo:[0,1,0] neg_hi:[0,1,0]
    s_waitcnt lgkmcnt(1)
    v_pk_fma_f32 v[64:65], v[128:129], v[104:105], v[64:65] op_sel_hi:[1,0,1] neg_lo:[0,1,0] neg_hi:[0,1,0]
    v_pk_fma_f32 v[66:67], v[130:131], v[104:105], v[66:67] op_sel_hi:[1,0,1] neg_lo:[0,1,0] neg_hi:[0,1,0]
    s_waitcnt lgkmcnt(0)
    v_pk_fma_f32 v[68:69], v[132:133], v[104:105], v[68:69] op_sel_hi:[1,0,1] neg_lo:[0,1,0] neg_hi:[0,1,0]
    v_pk_fma_f32 v[70:71], v[134:135], v[104:105], v[70:71] op_sel_hi:[1,0,1] neg_lo:[0,1,0] neg_hi:[0,1,0]
    v_permlane32_swap_b32 v72, v74
    v_permlane32_swap_b32 v73, v75
    v_pk_mul_f32 v[48:49], v[48:49], v[60:61]
    v_pk_mul_f32 v[50:51], v[50:51], v[62:63]
    v_pk_mul_f32 v[52:53], v[52:53], v[64:65]
    v_pk_mul_f32 v[54:55], v[54:55], v[66:67]
    v_pk_mul_f32 v[56:57], v[56:57], v[68:69]
    v_pk_mul_f32 v[58:59], v[58:59], v[70:71]
    v_pk_mul_f32 v[60:61], v[72:73], v[74:75]
    v_cvt_pk_bf16_f32 v72, v56, v57
    v_cvt_pk_bf16_f32 v73, v58, v59
    v_mov_b32 v71, 0
    v_cvt_pk_bf16_f32 v64, v48, v49
    v_cvt_pk_bf16_f32 v65, v50, v51
    v_cvt_pk_bf16_f32 v66, v52, v53
    v_cvt_pk_bf16_f32 v67, v54, v55
    v_permlane16_swap_b32 v72, v73
    v_cvt_pk_bf16_f32 v68, v56, v57
    v_cvt_pk_bf16_f32 v69, v58, v59
    v_cvt_pk_bf16_f32 v70, v60, v61
    v_permlane32_swap_b32 v73, v71
    s_cmp_eq_u32 s30, 0
    s_cbranch_scc1 Lg_140
    buffer_store_dwordx4 v[64:67], v2, s[36:39], s72 offen
    s_mov_b32 exec_hi, 0xffff
    buffer_store_dwordx4 v[68:71], v2, s[36:39], s72 offen offset:1024
    s_mov_b64 exec, -1
Lgb_141:
    s_add_u32 s72, s72, 57344
    v_pk_fma_f32 v[100:101], v[136:137], v[106:107], v[100:101] op_sel_hi:[1,0,1] neg_lo:[0,1,0] neg_hi:[0,1,0]
    v_pk_fma_f32 v[102:103], v[138:139], v[106:107], v[102:103] op_sel_hi:[1,0,1] neg_lo:[0,1,0] neg_hi:[0,1,0]
    v_pk_fma_f32 v[76:77], v[112:113], v[106:107], v[76:77] op_sel_hi:[1,0,1] neg_lo:[0,1,0] neg_hi:[0,1,0]
    v_pk_fma_f32 v[78:79], v[114:115], v[106:107], v[78:79] op_sel_hi:[1,0,1] neg_lo:[0,1,0] neg_hi:[0,1,0]
    v_pk_fma_f32 v[80:81], v[116:117], v[106:107], v[80:81] op_sel_hi:[1,0,1] neg_lo:[0,1,0] neg_hi:[0,1,0]
    v_pk_fma_f32 v[82:83], v[118:119], v[106:107], v[82:83] op_sel_hi:[1,0,1] neg_lo:[0,1,0] neg_hi:[0,1,0]
    v_pk_fma_f32 v[84:85], v[120:121], v[106:107], v[84:85] op_sel_hi:[1,0,1] neg_lo:[0,1,0] neg_hi:[0,1,0]
    v_pk_fma_f32 v[86:87], v[122:123], v[106:107], v[86:87] op_sel_hi:[1,0,1] neg_lo:[0,1,0] neg_hi:[0,1,0]
    v_pk_fma_f32 v[88:89], v[124:125], v[106:107], v[88:89] op_sel_hi:[1,0,1] neg_lo:[0,1,0] neg_hi:[0,1,0]
    v_pk_fma_f32 v[90:91], v[126:127], v[106:107], v[90:91] op_sel_hi:[1,0,1] neg_lo:[0,1,0] neg_hi:[0,1,0]
    v_pk_fma_f32 v[92:93], v[128:129], v[106:107], v[92:93] op_sel_hi:[1,0,1] neg_lo:[0,1,0] neg_hi:[0,1,0]
    v_pk_fma_f32 v[94:95], v[130:131], v[106:107], v[94:95] op_sel_hi:[1,0,1] neg_lo:[0,1,0] neg_hi:[0,1,0]
    v_pk_fma_f32 v[96:97], v[132:133], v[106:107], v[96:97] op_sel_hi:[1,0,1] neg_lo:[0,1,0] neg_hi:[0,1,0]
    v_pk_fma_f32 v[98:99], v[134:135], v[106:107], v[98:99] op_sel_hi:[1,0,1] neg_lo:[0,1,0] neg_hi:[0,1,0]
    v_permlane32_swap_b32 v100, v102
    v_permlane32_swap_b32 v101, v103
    v_pk_mul_f32 v[76:77], v[76:77], v[88:89]
    v_pk_mul_f32 v[78:79], v[78:79], v[90:91]
    v_pk_mul_f32 v[80:81], v[80:81], v[92:93]
    v_pk_mul_f32 v[82:83], v[82:83], v[94:95]
    v_pk_mul_f32 v[84:85], v[84:85], v[96:97]
    v_pk_mul_f32 v[86:87], v[86:87], v[98:99]
    v_pk_mul_f32 v[88:89], v[100:101], v[102:103]
    v_cvt_pk_bf16_f32 v100, v84, v85
    v_cvt_pk_bf16_f32 v101, v86, v87
    v_mov_b32 v99, 0
    v_cvt_pk_bf16_f32 v92, v76, v77
    v_cvt_pk_bf16_f32 v93, v78, v79
    v_cvt_pk_bf16_f32 v94, v80, v81
    v_cvt_pk_bf16_f32 v95, v82, v83
    v_permlane16_swap_b32 v100, v101
    v_cvt_pk_bf16_f32 v96, v84, v85
    v_cvt_pk_bf16_f32 v97, v86, v87
    v_cvt_pk_bf16_f32 v98, v88, v89
    v_permlane32_swap_b32 v101, v99
    s_cmp_eq_u32 s30, 0
    s_cbranch_scc1 Lg_142
    buffer_store_dwordx4 v[92:95], v2, s[36:39], s72 offen
    s_mov_b32 exec_hi, 0xffff
    buffer_store_dwordx4 v[96:99], v2, s[36:39], s72 offen offset:1024
    s_mov_b64 exec, -1
Lgb_143:
    ds_read_b128 v[112:115], v8 offset:21504
    ds_read_b128 v[116:119], v8 offset:22528
    ds_read_b128 v[120:123], v8 offset:23552
    ds_read_b128 v[124:127], v8 offset:24576
    ds_read_b128 v[128:131], v8 offset:25600
    ds_read_b128 v[132:135], v8 offset:26624
    ds_read_b128 v[136:139], v8 offset:27648
    s_waitcnt vmcnt(24)
    s_waitcnt lgkmcnt(5)
    v_mfma_f32_16x16x32_bf16 v[48:51], v[112:115], v[140:143], 0
    v_mfma_f32_16x16x32_bf16 v[76:79], v[112:115], v[144:147], 0
    ds_read_b128 v[112:115], v8 offset:14336
    v_mfma_f32_16x16x32_bf16 v[52:55], v[116:119], v[140:143], 0
    v_lshlrev_b32 v40, 16, v16
    v_and_b32 v41, 0xffff0000, v16
    v_mfma_f32_16x16x32_bf16 v[80:83], v[116:119], v[144:147], 0
    ds_read_b128 v[116:119], v8 offset:15360
    s_waitcnt lgkmcnt(5)
    v_mfma_f32_16x16x32_bf16 v[56:59], v[120:123], v[140:143], 0
    v_add_f32 v32, v40, v41
    v_mul_f32 v36, v40, v40
    v_mfma_f32_16x16x32_bf16 v[84:87], v[120:123], v[144:147], 0
    ds_read_b128 v[120:123], v8 offset:16384
    v_fmac_f32 v36, v41, v41
    v_mfma_f32_16x16x32_bf16 v[60:63], v[124:127], v[140:143], 0
    s_waitcnt vmcnt(22)
    v_lshlrev_b32 v40, 16, v17
    v_mfma_f32_16x16x32_bf16 v[88:91], v[124:127], v[144:147], 0
    ds_read_b128 v[124:127], v8 offset:17408
    s_waitcnt lgkmcnt(5)
    v_mfma_f32_16x16x32_bf16 v[64:67], v[128:131], v[140:143], 0
    v_and_b32 v41, 0xffff0000, v17
    v_add_f32 v32, v32, v40
    v_mfma_f32_16x16x32_bf16 v[92:95], v[128:131], v[144:147], 0
    ds_read_b128 v[128:131], v8 offset:18432
    v_fmac_f32 v36, v40, v40
    v_mfma_f32_16x16x32_bf16 v[68:71], v[132:135], v[140:143], 0
    v_add_f32 v32, v32, v41
    v_fmac_f32 v36, v41, v41
    v_mfma_f32_16x16x32_bf16 v[96:99], v[132:135], v[144:147], 0
    ds_read_b128 v[132:135], v8 offset:19456
    s_waitcnt lgkmcnt(6)
    v_mfma_f32_16x16x32_bf16 v[72:75], v[136:139], v[140:143], 0
    v_lshlrev_b32 v40, 16, v18
    v_and_b32 v41, 0xffff0000, v18
    v_mfma_f32_16x16x32_bf16 v[100:103], v[136:139], v[144:147], 0
    ds_read_b128 v[136:139], v8 offset:20480
    s_waitcnt lgkmcnt(5)
    v_mfma_f32_16x16x32_bf16 v[48:51], v[112:115], v[148:151], v[48:51]
    buffer_load_dwordx4 v[140:143], v6, s[36:39], s88 offen offset:2048 sc1
    v_add_f32 v32, v32, v40
    v_mfma_f32_16x16x32_bf16 v[76:79], v[112:115], v[152:155], v[76:79]
    ds_read_b128 v[112:115], v8 offset:7168
    v_fmac_f32 v36, v40, v40
    v_mfma_f32_16x16x32_bf16 v[52:55], v[116:119], v[148:151], v[52:55]
    buffer_load_dwordx4 v[144:147], v6, s[36:39], s88 offen offset:2304 sc1
    v_add_f32 v32, v32, v41
    v_mfma_f32_16x16x32_bf16 v[80:83], v[116:119], v[152:155], v[80:83]
    ds_read_b128 v[116:119], v8 offset:8192
    s_waitcnt lgkmcnt(5)
    v_mfma_f32_16x16x32_bf16 v[56:59], v[120:123], v[148:151], v[56:59]
    v_fmac_f32 v36, v41, v41
    v_lshlrev_b32 v40, 16, v19
    v_mfma_f32_16x16x32_bf16 v[84:87], v[120:123], v[152:155], v[84:87]
    ds_read_b128 v[120:123], v8 offset:9216
    v_and_b32 v41, 0xffff0000, v19
    v_mfma_f32_16x16x32_bf16 v[60:63], v[124:127], v[148:151], v[60:63]
    s_waitcnt vmcnt(22)
    v_add_f32 v32, v32, v40
    v_mfma_f32_16x16x32_bf16 v[88:91], v[124:127], v[152:155], v[88:91]
    ds_read_b128 v[124:127], v8 offset:10240
    s_waitcnt lgkmcnt(5)
    v_mfma_f32_16x16x32_bf16 v[64:67], v[128:131], v[148:151], v[64:67]
    v_fmac_f32 v36, v40, v40
    v_add_f32 v32, v32, v41
    v_mfma_f32_16x16x32_bf16 v[92:95], v[128:131], v[152:155], v[92:95]
    ds_read_b128 v[128:131], v8 offset:11264
    v_fmac_f32 v36, v41, v41
    v_mfma_f32_16x16x32_bf16 v[68:71], v[132:135], v[148:151], v[68:71]
    v_lshlrev_b32 v40, 16, v20
    v_and_b32 v41, 0xffff0000, v20
    v_mfma_f32_16x16x32_bf16 v[96:99], v[132:135], v[152:155], v[96:99]
    ds_read_b128 v[132:135], v8 offset:12288
    s_waitcnt lgkmcnt(6)
    v_mfma_f32_16x16x32_bf16 v[72:75], v[136:139], v[148:151], v[72:75]
    v_add_f32 v33, v40, v41
    v_mul_f32 v37, v40, v40
    v_mfma_f32_16x16x32_bf16 v[100:103], v[136:139], v[152:155], v[100:103]
    ds_read_b128 v[136:139], v8 offset:13312
    s_waitcnt lgkmcnt(5)
    v_mfma_f32_16x16x32_bf16 v[48:51], v[112:115], v[156:159], v[48:51]
    s_add_u32 s88, s90, 17063936
    buffer_load_dwordx4 v[148:151], v6, s[36:39], s88 offen offset:0 sc1
    v_fmac_f32 v37, v41, v41
    v_mfma_f32_16x16x32_bf16 v[76:79], v[112:115], v[160:163], v[76:79]
    ds_read_b128 v[112:115], v8 offset:0
    v_lshlrev_b32 v40, 16, v21
    v_mfma_f32_16x16x32_bf16 v[52:55], v[116:119], v[156:159], v[52:55]
    buffer_load_dwordx4 v[152:155], v6, s[36:39], s88 offen offset:256 sc1
    v_and_b32 v41, 0xffff0000, v21
    v_mfma_f32_16x16x32_bf16 v[80:83], v[116:119], v[160:163], v[80:83]
    ds_read_b128 v[116:119], v8 offset:1024
    s_waitcnt lgkmcnt(5)
    v_mfma_f32_16x16x32_bf16 v[56:59], v[120:123], v[156:159], v[56:59]
    v_add_f32 v33, v33, v40
    v_fmac_f32 v37, v40, v40
    v_mfma_f32_16x16x32_bf16 v[84:87], v[120:123], v[160:163], v[84:87]
    ds_read_b128 v[120:123], v8 offset:2048
    v_add_f32 v33, v33, v41
    v_mfma_f32_16x16x32_bf16 v[60:63], v[124:127], v[156:159], v[60:63]
    s_waitcnt vmcnt(22)
    v_fmac_f32 v37, v41, v41
    v_mfma_f32_16x16x32_bf16 v[88:91], v[124:127], v[160:163], v[88:91]
    ds_read_b128 v[124:127], v8 offset:3072
    s_waitcnt lgkmcnt(5)
    v_mfma_f32_16x16x32_bf16 v[64:67], v[128:131], v[156:159], v[64:67]
    v_lshlrev_b32 v40, 16, v22
    v_and_b32 v41, 0xffff0000, v22
    v_mfma_f32_16x16x32_bf16 v[92:95], v[128:131], v[160:163], v[92:95]
    ds_read_b128 v[128:131], v8 offset:4096
    v_add_f32 v33, v33, v40
    v_mfma_f32_16x16x32_bf16 v[68:71], v[132:135], v[156:159], v[68:71]
    v_fmac_f32 v37, v40, v40
    v_add_f32 v33, v33, v41
    v_mfma_f32_16x16x32_bf16 v[96:99], v[132:135], v[160:163], v[96:99]
    ds_read_b128 v[132:135], v8 offset:5120
    s_waitcnt lgkmcnt(6)
    v_mfma_f32_16x16x32_bf16 v[72:75], v[136:139], v[156:159], v[72:75]
    v_fmac_f32 v37, v41, v41
    v_lshlrev_b32 v40, 16, v23
    v_mfma_f32_16x16x32_bf16 v[100:103], v[136:139], v[160:163], v[100:103]
    ds_read_b128 v[136:139], v8 offset:6144
    s_waitcnt lgkmcnt(5)
    v_mfma_f32_16x16x32_bf16 v[48:51], v[112:115], v[164:167], v[48:51]
    buffer_load_dwordx4 v[156:159], v6, s[36:39], s88 offen offset:2048 sc1
    v_and_b32 v41, 0xffff0000, v23
    v_mfma_f32_16x16x32_bf16 v[76:79], v[112:115], v[168:171], v[76:79]
    ds_read_b128 v[112:115], v7 offset:50176
    v_add_f32 v33, v33, v40
    v_mfma_f32_16x16x32_bf16 v[52:55], v[116:119], v[164:167], v[52:55]
    buffer_load_dwordx4 v[160:163], v6, s[36:39], s88 offen offset:2304 sc1
    v_fmac_f32 v37, v40, v40
    v_mfma_f32_16x16x32_bf16 v[80:83], v[116:119], v[168:171], v[80:83]
    ds_read_b128 v[116:119], v7 offset:51200
    s_waitcnt lgkmcnt(5)
    v_mfma_f32_16x16x32_bf16 v[56:59], v[120:123], v[164:167], v[56:59]
    v_add_f32 v33, v33, v41
    v_fmac_f32 v37, v41, v41
    v_mfma_f32_16x16x32_bf16 v[84:87], v[120:123], v[168:171], v[84:87]
    ds_read_b128 v[120:123], v7 offset:52224
    v_lshlrev_b32 v40, 16, v24
    v_mfma_f32_16x16x32_bf16 v[60:63], v[124:127], v[164:167], v[60:63]
    s_waitcnt vmcnt(22)
    s_add_u32 s73, s66, 8
    v_mfma_f32_16x16x32_bf16 v[88:91], v[124:127], v[168:171], v[88:91]
    ds_read_b128 v[124:127], v7 offset:53248
    s_waitcnt lgkmcnt(5)
    v_mfma_f32_16x16x32_bf16 v[64:67], v[128:131], v[164:167], v[64:67]
    s_waitcnt vmcnt(6)
    v_and_b32 v41, 0xffff0000, v24
    v_mfma_f32_16x16x32_bf16 v[92:95], v[128:131], v[168:171], v[92:95]
    ds_read_b128 v[128:131], v7 offset:54272
    s_cmp_eq_u32 s30, 0
    s_cbranch_scc1 Lg_144
    s_mov_b64 exec, 1
    buffer_store_dword v14, off, s[36:39], s73
    s_mov_b64 exec, -1
Lgb_145:
    v_mfma_f32_16x16x32_bf16 v[68:71], v[132:135], v[164:167], v[68:71]
    v_add_f32 v34, v40, v41
    v_mul_f32 v38, v40, v40
    v_mfma_f32_16x16x32_bf16 v[96:99], v[132:135], v[168:171], v[96:99]
    ds_read_b128 v[132:135], v7 offset:55296
    s_waitcnt lgkmcnt(6)
    v_mfma_f32_16x16x32_bf16 v[72:75], v[136:139], v[164:167], v[72:75]
    v_fmac_f32 v38, v41, v41
    v_lshlrev_b32 v40, 16, v25
    v_mfma_f32_16x16x32_bf16 v[100:103], v[136:139], v[168:171], v[100:103]
    ds_read_b128 v[136:139], v7 offset:56320
    s_waitcnt lgkmcnt(5)
    v_mfma_f32_16x16x32_bf16 v[48:51], v[112:115], v[172:175], v[48:51]
    s_add_u32 s88, s90, 17068032
    buffer_load_dwordx4 v[164:167], v6, s[36:39], s88 offen offset:0 sc1
    v_and_b32 v41, 0xffff0000, v25
    v_mfma_f32_16x16x32_bf16 v[76:79], v[112:115], v[176:179], v[76:79]
    ds_read_b128 v[112:115], v7 offset:43008
    v_add_f32 v34, v34, v40
    v_mfma_f32_16x16x32_bf16 v[52:55], v[116:119], v[172:175], v[52:55]
    buffer_load_dwordx4 v[168:171], v6, s[36:39], s88 offen offset:256 sc1
    v_fmac_f32 v38, v40, v40
    v_mfma_f32_16x16x32_bf16 v[80:83], v[116:119], v[176:179], v[80:83]
    ds_read_b128 v[116:119], v7 offset:44032
    s_waitcnt lgkmcnt(5)
    v_mfma_f32_16x16x32_bf16 v[56:59], v[120:123], v[172:175], v[56:59]
    v_add_f32 v34, v34, v41
    v_fmac_f32 v38, v41, v41
    v_mfma_f32_16x16x32_bf16 v[84:87], v[120:123], v[176:179], v[84:87]
    ds_read_b128 v[120:123], v7 offset:45056
    v_lshlrev_b32 v40, 16, v26
    v_mfma_f32_16x16x32_bf16 v[60:63], v[124:127], v[172:175], v[60:63]
    v_and_b32 v41, 0xffff0000, v26
    v_mfma_f32_16x16x32_bf16 v[88:91], v[124:127], v[176:179], v[88:91]
    ds_read_b128 v[124:127], v7 offset:46080
    s_waitcnt lgkmcnt(5)
    v_mfma_f32_16x16x32_bf16 v[64:67], v[128:131], v[172:175], v[64:67]
    v_add_f32 v34, v34, v40
    v_fmac_f32 v38, v40, v40
    v_mfma_f32_16x16x32_bf16 v[92:95], v[128:131], v[176:179], v[92:95]
    ds_read_b128 v[128:131], v7 offset:47104
    v_add_f32 v34, v34, v41
    v_mfma_f32_16x16x32_bf16 v[68:71], v[132:135], v[172:175], v[68:71]
    v_fmac_f32 v38, v41, v41
    v_lshlrev_b32 v40, 16, v27
    v_mfma_f32_16x16x32_bf16 v[96:99], v[132:135], v[176:179], v[96:99]
    ds_read_b128 v[132:135], v7 offset:48128
    s_waitcnt lgkmcnt(6)
    v_mfma_f32_16x16x32_bf16 v[72:75], v[136:139], v[172:175], v[72:75]
    v_and_b32 v41, 0xffff0000, v27
    v_add_f32 v34, v34, v40
    v_mfma_f32_16x16x32_bf16 v[100:103], v[136:139], v[176:179], v[100:103]
    ds_read_b128 v[136:139], v7 offset:49152
    s_waitcnt lgkmcnt(5)
    v_mfma_f32_16x16x32_bf16 v[48:51], v[112:115], v[180:183], v[48:51]
    buffer_load_dwordx4 v[172:175], v6, s[36:39], s88 offen offset:2048 sc1
    v_fmac_f32 v38, v40, v40
    v_mfma_f32_16x16x32_bf16 v[76:79], v[112:115], v[184:187], v[76:79]
    ds_read_b128 v[112:115], v7 offset:35840
    v_add_f32 v34, v34, v41
    v_mfma_f32_16x16x32_bf16 v[52:55], v[116:119], v[180:183], v[52:55]
    buffer_load_dwordx4 v[176:179], v6, s[36:39], s88 offen offset:2304 sc1
    v_fmac_f32 v38, v41, v41
    v_mfma_f32_16x16x32_bf16 v[80:83], v[116:119], v[184:187], v[80:83]
    ds_read_b128 v[116:119], v7 offset:36864
    s_waitcnt lgkmcnt(5)
    v_mfma_f32_16x16x32_bf16 v[56:59], v[120:123], v[180:183], v[56:59]
    v_lshlrev_b32 v40, 16, v28
    v_and_b32 v41, 0xffff0000, v28
    v_mfma_f32_16x16x32_bf16 v[84:87], v[120:123], v[184:187], v[84:87]
    ds_read_b128 v[120:123], v7 offset:37888
    v_add_f32 v35, v40, v41
    v_mfma_f32_16x16x32_bf16 v[60:63], v[124:127], v[180:183], v[60:63]
    v_mul_f32 v39, v40, v40
    v_mfma_f32_16x16x32_bf16 v[88:91], v[124:127], v[184:187], v[88:91]
    ds_read_b128 v[124:127], v7 offset:38912
    s_waitcnt lgkmcnt(5)
    v_mfma_f32_16x16x32_bf16 v[64:67], v[128:131], v[180:183], v[64:67]
    v_fmac_f32 v39, v41, v41
    v_lshlrev_b32 v40, 16, v29
    v_mfma_f32_16x16x32_bf16 v[92:95], v[128:131], v[184:187], v[92:95]
    ds_read_b128 v[128:131], v7 offset:39936
    v_and_b32 v41, 0xffff0000, v29
    v_mfma_f32_16x16x32_bf16 v[68:71], v[132:135], v[180:183], v[68:71]
    v_add_f32 v35, v35, v40
    v_fmac_f32 v39, v40, v40
    v_mfma_f32_16x16x32_bf16 v[96:99], v[132:135], v[184:187], v[96:99]
    ds_read_b128 v[132:135], v7 offset:40960
    s_waitcnt lgkmcnt(6)
    v_mfma_f32_16x16x32_bf16 v[72:75], v[136:139], v[180:183], v[72:75]
    v_add_f32 v35, v35, v41
    v_fmac_f32 v39, v41, v41
    v_mfma_f32_16x16x32_bf16 v[100:103], v[136:139], v[184:187], v[100:103]
    ds_read_b128 v[136:139], v7 offset:41984
    s_waitcnt lgkmcnt(5)
    v_mfma_f32_16x16x32_bf16 v[48:51], v[112:115], v[188:191], v[48:51]
    s_add_u32 s88, s90, 17072128
    buffer_load_dwordx4 v[180:183], v6, s[36:39], s88 offen offset:0 sc1
    v_lshlrev_b32 v40, 16, v30
    v_mfma_f32_16x16x32_bf16 v[76:79], v[112:115], v[192:195], v[76:79]
    ds_read_b128 v[112:115], v7 offset:28672
    v_and_b32 v41, 0xffff0000, v30
    v_mfma_f32_16x16x32_bf16 v[52:55], v[116:119], v[188:191], v[52:55]
    buffer_load_dwordx4 v[184:187], v6, s[36:39], s88 offen offset:256 sc1
    v_add_f32 v35, v35, v40
    v_mfma_f32_16x16x32_bf16 v[80:83], v[116:119], v[192:195], v[80:83]
    ds_read_b128 v[116:119], v7 offset:29696
    s_waitcnt lgkmcnt(5)
    v_mfma_f32_16x16x32_bf16 v[56:59], v[120:123], v[188:191], v[56:59]
    v_fmac_f32 v39, v40, v40
    v_add_f32 v35, v35, v41
    v_mfma_f32_16x16x32_bf16 v[84:87], v[120:123], v[192:195], v[84:87]
    ds_read_b128 v[120:123], v7 offset:30720
    v_fmac_f32 v39, v41, v41
    v_mfma_f32_16x16x32_bf16 v[60:63], v[124:127], v[188:191], v[60:63]
    v_min_u32 v231, 7, v1
    v_mfma_f32_16x16x32_bf16 v[88:91], v[124:127], v[192:195], v[88:91]
    ds_read_b128 v[124:127], v7 offset:31744
    s_waitcnt lgkmcnt(5)
    v_mfma_f32_16x16x32_bf16 v[64:67], v[128:131], v[188:191], v[64:67]
    v_lshlrev_b32 v231, 7, v231
    v_lshlrev_b32 v40, 16, v31
    v_mfma_f32_16x16x32_bf16 v[92:95], v[128:131], v[192:195], v[92:95]
    ds_read_b128 v[128:131], v7 offset:32768
    s_add_u32 s75, s64, 8
    v_mfma_f32_16x16x32_bf16 v[68:71], v[132:135], v[188:191], v[68:71]
    buffer_load_dword v228, v231, s[36:39], s75 offen sc1
    v_and_b32 v41, 0xffff0000, v31
    v_mfma_f32_16x16x32_bf16 v[96:99], v[132:135], v[192:195], v[96:99]
    ds_read_b128 v[132:135], v7 offset:33792
    s_waitcnt lgkmcnt(6)
    v_mfma_f32_16x16x32_bf16 v[72:75], v[136:139], v[188:191], v[72:75]
    v_add_f32 v35, v35, v40
    v_mfma_f32_16x16x32_bf16 v[100:103], v[136:139], v[192:195], v[100:103]
    ds_read_b128 v[136:139], v7 offset:34816
    s_waitcnt lgkmcnt(5)
    v_mfma_f32_16x16x32_bf16 v[48:51], v[112:115], v[196:199], v[48:51]
    buffer_load_dwordx4 v[188:191], v6, s[36:39], s88 offen offset:2048 sc1
    v_fmac_f32 v39, v40, v40
    v_mfma_f32_16x16x32_bf16 v[76:79], v[112:115], v[200:203], v[76:79]
    ds_read_b128 v[112:115], v7 offset:21504
    v_add_f32 v35, v35, v41
    v_mfma_f32_16x16x32_bf16 v[52:55], v[116:119], v[196:199], v[52:55]
    buffer_load_dwordx4 v[192:195], v6, s[36:39], s88 offen offset:2304 sc1
    v_fmac_f32 v39, v41, v41
    v_mfma_f32_16x16x32_bf16 v[80:83], v[116:119], v[200:203], v[80:83]
    ds_read_b128 v[116:119], v7 offset:22528
    s_waitcnt lgkmcnt(5)
    v_mfma_f32_16x16x32_bf16 v[56:59], v[120:123], v[196:199], v[56:59]
    v_cndmask_b32 v32, 0, v32, s[86:87]
    v_cndmask_b32 v33, 0, v33, s[86:87]
    v_mfma_f32_16x16x32_bf16 v[84:87], v[120:123], v[200:203], v[84:87]
    ds_read_b128 v[120:123], v7 offset:23552
    v_cndmask_b32 v34, 0, v34, s[86:87]
    v_mfma_f32_16x16x32_bf16 v[60:63], v[124:127], v[196:199], v[60:63]
    v_cndmask_b32 v35, 0, v35, s[86:87]
    v_mfma_f32_16x16x32_bf16 v[88:91], v[124:127], v[200:203], v[88:91]
    ds_read_b128 v[124:127], v7 offset:24576
    s_waitcnt lgkmcnt(5)
    v_mfma_f32_16x16x32_bf16 v[64:67], v[128:131], v[196:199], v[64:67]
    v_cndmask_b32 v36, 0, v36, s[86:87]
    v_cndmask_b32 v37, 0, v37, s[86:87]
    v_mfma_f32_16x16x32_bf16 v[92:95], v[128:131], v[200:203], v[92:95]
    ds_read_b128 v[128:131], v7 offset:25600
    v_cndmask_b32 v38, 0, v38, s[86:87]
    v_mfma_f32_16x16x32_bf16 v[68:71], v[132:135], v[196:199], v[68:71]
    v_cndmask_b32 v39, 0, v39, s[86:87]
    v_add_f32_dpp v40, v32, v32 row_ror:8 row_mask:0xf bank_mask:0x3
    v_mfma_f32_16x16x32_bf16 v[96:99], v[132:135], v[200:203], v[96:99]
    ds_read_b128 v[132:135], v7 offset:26624
    s_waitcnt lgkmcnt(6)
    v_mfma_f32_16x16x32_bf16 v[72:75], v[136:139], v[196:199], v[72:75]
    v_add_f32_dpp v40, v34, v34 row_ror:8 row_mask:0xf bank_mask:0xc
    v_add_f32_dpp v41, v33, v33 row_ror:8 row_mask:0xf bank_mask:0x3
    v_mfma_f32_16x16x32_bf16 v[100:103], v[136:139], v[200:203], v[100:103]
    ds_read_b128 v[136:139], v7 offset:27648
    s_waitcnt lgkmcnt(5)
    v_mfma_f32_16x16x32_bf16 v[48:51], v[112:115], v[204:207], v[48:51]
    s_add_u32 s88, s90, 17076224
    buffer_load_dwordx4 v[196:199], v6, s[36:39], s88 offen offset:0 sc1
    v_add_f32_dpp v41, v35, v35 row_ror:8 row_mask:0xf bank_mask:0xc
    v_mfma_f32_16x16x32_bf16 v[76:79], v[112:115], v[208:211], v[76:79]
    ds_read_b128 v[112:115], v7 offset:14336
    v_add_f32_dpp v42, v36, v36 row_ror:8 row_mask:0xf bank_mask:0x3
    v_mfma_f32_16x16x32_bf16 v[52:55], v[116:119], v[204:207], v[52:55]
    buffer_load_dwordx4 v[200:203], v6, s[36:39], s88 offen offset:256 sc1
    v_add_f32_dpp v42, v38, v38 row_ror:8 row_mask:0xf bank_mask:0xc
    v_mfma_f32_16x16x32_bf16 v[80:83], v[116:119], v[208:211], v[80:83]
    ds_read_b128 v[116:119], v7 offset:15360
    s_waitcnt lgkmcnt(5)
    v_mfma_f32_16x16x32_bf16 v[56:59], v[120:123], v[204:207], v[56:59]
    v_add_f32_dpp v43, v37, v37 row_ror:8 row_mask:0xf bank_mask:0x3
    s_nop 1
    v_add_f32_dpp v43, v39, v39 row_ror:8 row_mask:0xf bank_mask:0xc
    v_mfma_f32_16x16x32_bf16 v[84:87], v[120:123], v[208:211], v[84:87]
    ds_read_b128 v[120:123], v7 offset:16384
    v_add_f32_dpp v44, v40, v40 row_half_mirror row_mask:0xf bank_mask:0x5
    v_mfma_f32_16x16x32_bf16 v[60:63], v[124:127], v[204:207], v[60:63]
    s_nop 0
    v_add_f32_dpp v44, v41, v41 row_half_mirror row_mask:0xf bank_mask:0xa
    v_mfma_f32_16x16x32_bf16 v[88:91], v[124:127], v[208:211], v[88:91]
    ds_read_b128 v[124:127], v7 offset:17408
    s_waitcnt lgkmcnt(5)
    v_mfma_f32_16x16x32_bf16 v[64:67], v[128:131], v[204:207], v[64:67]
    v_add_f32_dpp v45, v42, v42 row_half_mirror row_mask:0xf bank_mask:0x5
    s_nop 1
    v_add_f32_dpp v45, v43, v43 row_half_mirror row_mask:0xf bank_mask:0xa
    v_mfma_f32_16x16x32_bf16 v[92:95], v[128:131], v[208:211], v[92:95]
    ds_read_b128 v[128:131], v7 offset:18432
    v_mov_b32 v46, v14
    v_mfma_f32_16x16x32_bf16 v[68:71], v[132:135], v[204:207], v[68:71]
    v_mov_b32 v47, v14
    v_add_u32 v229, v4, v3
    v_mfma_f32_16x16x32_bf16 v[96:99], v[132:135], v[208:211], v[96:99]
    ds_read_b128 v[132:135], v7 offset:19456
    s_waitcnt lgkmcnt(6)
    v_mfma_f32_16x16x32_bf16 v[72:75], v[136:139], v[204:207], v[72:75]
    v_lshlrev_b32 v229, 4, v229
    v_add_f32_dpp v44, v44, v44 quad_perm:[1,0,3,2] row_mask:0xf bank_mask:0xf
    v_mfma_f32_16x16x32_bf16 v[100:103], v[136:139], v[208:211], v[100:103]
    ds_read_b128 v[136:139], v7 offset:20480
    s_waitcnt lgkmcnt(5)
    v_mfma_f32_16x16x32_bf16 v[48:51], v[112:115], v[212:215], v[48:51]
    buffer_load_dwordx4 v[204:207], v6, s[36:39], s88 offen offset:2048 sc1
    v_add_f32_dpp v45, v45, v45 quad_perm:[1,0,3,2] row_mask:0xf bank_mask:0xf
    v_mfma_f32_16x16x32_bf16 v[76:79], v[112:115], v[216:219], v[76:79]
    ds_read_b128 v[112:115], v7 offset:7168
    v_add_f32_dpp v44, v44, v44 quad_perm:[2,3,0,1] row_mask:0xf bank_mask:0xf
    v_mfma_f32_16x16x32_bf16 v[52:55], v[116:119], v[212:215], v[52:55]
    buffer_load_dwordx4 v[208:211], v6, s[36:39], s88 offen offset:2304 sc1
    s_waitcnt vmcnt(6)
    v_cmp_ne_u32 vcc, v228, v14
    s_cbranch_vccnz Lps_149
Lpd_148:
    v_mfma_f32_16x16x32_bf16 v[80:83], v[116:119], v[216:219], v[80:83]
    ds_read_b128 v[116:119], v7 offset:8192
    s_waitcnt lgkmcnt(5)
    v_mfma_f32_16x16x32_bf16 v[56:59], v[120:123], v[212:215], v[56:59]
    v_add_f32_dpp v45, v45, v45 quad_perm:[2,3,0,1] row_mask:0xf bank_mask:0xf
    s_cmp_eq_u32 s30, 0
    s_cbranch_scc1 Lg_146
    s_add_u32 s74, s78, 512
    s_mov_b32 exec_lo, 0x11111111
    s_mov_b32 exec_hi, 0x11111111
    buffer_store_dwordx4 v[44:47], v229, s[36:39], s74 offen
    s_mov_b64 exec, -1
Lgb_147:
    v_mfma_f32_16x16x32_bf16 v[84:87], v[120:123], v[216:219], v[84:87]
    ds_read_b128 v[120:123], v7 offset:9216
    v_mfma_f32_16x16x32_bf16 v[60:63], v[124:127], v[212:215], v[60:63]
    v_mfma_f32_16x16x32_bf16 v[88:91], v[124:127], v[216:219], v[88:91]
    ds_read_b128 v[124:127], v7 offset:10240
    s_waitcnt lgkmcnt(5)
    v_mfma_f32_16x16x32_bf16 v[64:67], v[128:131], v[212:215], v[64:67]
    v_mfma_f32_16x16x32_bf16 v[92:95], v[128:131], v[216:219], v[92:95]
    ds_read_b128 v[128:131], v7 offset:11264
    v_mfma_f32_16x16x32_bf16 v[68:71], v[132:135], v[212:215], v[68:71]
    v_mfma_f32_16x16x32_bf16 v[96:99], v[132:135], v[216:219], v[96:99]
    ds_read_b128 v[132:135], v7 offset:12288
    s_waitcnt lgkmcnt(6)
    v_mfma_f32_16x16x32_bf16 v[72:75], v[136:139], v[212:215], v[72:75]
    v_mfma_f32_16x16x32_bf16 v[100:103], v[136:139], v[216:219], v[100:103]
    ds_read_b128 v[136:139], v7 offset:13312
    s_waitcnt lgkmcnt(5)
    v_mfma_f32_16x16x32_bf16 v[48:51], v[112:115], v[220:223], v[48:51]
    s_add_u32 s88, s91, 33554432
    buffer_load_dwordx4 v[212:215], v2, s[36:39], s88 offen offset:0 sc1
    v_mfma_f32_16x16x32_bf16 v[76:79], v[112:115], v[224:227], v[76:79]
    ds_read_b128 v[112:115], v7 offset:0
    v_mfma_f32_16x16x32_bf16 v[52:55], v[116:119], v[220:223], v[52:55]
    buffer_load_dwordx4 v[216:219], v2, s[36:39], s88 offen offset:1024 sc1
    v_mfma_f32_16x16x32_bf16 v[80:83], v[116:119], v[224:227], v[80:83]
    ds_read_b128 v[116:119], v7 offset:1024
    s_waitcnt lgkmcnt(5)
    v_mfma_f32_16x16x32_bf16 v[56:59], v[120:123], v[220:223], v[56:59]
    v_mfma_f32_16x16x32_bf16 v[84:87], v[120:123], v[224:227], v[84:87]
    ds_read_b128 v[120:123], v7 offset:2048
    v_mfma_f32_16x16x32_bf16 v[60:63], v[124:127], v[220:223], v[60:63]
    v_mfma_f32_16x16x32_bf16 v[88:91], v[124:127], v[224:227], v[88:91]
    ds_read_b128 v[124:127], v7 offset:3072
    s_waitcnt lgkmcnt(5)
    v_mfma_f32_16x16x32_bf16 v[64:67], v[128:131], v[220:223], v[64:67]
    v_mfma_f32_16x16x32_bf16 v[92:95], v[128:131], v[224:227], v[92:95]
    ds_read_b128 v[128:131], v7 offset:4096
    v_mfma_f32_16x16x32_bf16 v[68:71], v[132:135], v[220:223], v[68:71]
    v_mfma_f32_16x16x32_bf16 v[96:99], v[132:135], v[224:227], v[96:99]
    ds_read_b128 v[132:135], v7 offset:5120
    s_waitcnt lgkmcnt(6)
    v_mfma_f32_16x16x32_bf16 v[72:75], v[136:139], v[220:223], v[72:75]
    v_mfma_f32_16x16x32_bf16 v[100:103], v[136:139], v[224:227], v[100:103]
    ds_read_b128 v[136:139], v7 offset:6144
    s_waitcnt lgkmcnt(5)
    v_mfma_f32_16x16x32_bf16 v[48:51], v[112:115], v[140:143], v[48:51]
    buffer_load_dwordx4 v[220:223], v2, s[36:39], s88 offen offset:2048 sc1
    v_mfma_f32_16x16x32_bf16 v[76:79], v[112:115], v[144:147], v[76:79]
    ds_read_b128 v[112:115], v2 offset:50176
    v_mfma_f32_16x16x32_bf16 v[52:55], v[116:119], v[140:143], v[52:55]
    buffer_load_dwordx4 v[224:227], v2, s[36:39], s88 offen offset:3072 sc1
    v_mfma_f32_16x16x32_bf16 v[80:83], v[116:119], v[144:147], v[80:83]
    ds_read_b128 v[116:119], v2 offset:51200
    s_waitcnt lgkmcnt(5)
    v_mfma_f32_16x16x32_bf16 v[56:59], v[120:123], v[140:143], v[56:59]
    v_mfma_f32_16x16x32_bf16 v[84:87], v[120:123], v[144:147], v[84:87]
    ds_read_b128 v[120:123], v2 offset:52224
    v_mfma_f32_16x16x32_bf16 v[60:63], v[124:127], v[140:143], v[60:63]
    v_mfma_f32_16x16x32_bf16 v[88:91], v[124:127], v[144:147], v[88:91]
    ds_read_b128 v[124:127], v2 offset:53248
    s_waitcnt lgkmcnt(5)
    v_mfma_f32_16x16x32_bf16 v[64:67], v[128:131], v[140:143], v[64:67]
    v_mfma_f32_16x16x32_bf16 v[92:95], v[128:131], v[144:147], v[92:95]
    ds_read_b128 v[128:131], v2 offset:54272
    v_mfma_f32_16x16x32_bf16 v[68:71], v[132:135], v[140:143], v[68:71]
    v_mfma_f32_16x16x32_bf16 v[96:99], v[132:135], v[144:147], v[96:99]
    ds_read_b128 v[132:135], v2 offset:55296
    s_waitcnt lgkmcnt(6)
    v_mfma_f32_16x16x32_bf16 v[72:75], v[136:139], v[140:143], v[72:75]
    v_mfma_f32_16x16x32_bf16 v[100:103], v[136:139], v[144:147], v[100:103]
    ds_read_b128 v[136:139], v2 offset:56320
    s_waitcnt lgkmcnt(5)
    v_mfma_f32_16x16x32_bf16 v[48:51], v[112:115], v[148:151], v[48:51]
    s_add_u32 s88, s91, 33558528
    buffer_load_dwordx4 v[140:143], v2, s[36:39], s88 offen offset:0 sc1
    v_mfma_f32_16x16x32_bf16 v[76:79], v[112:115], v[152:155], v[76:79]
    ds_read_b128 v[112:115], v2 offset:43008
    v_mfma_f32_16x16x32_bf16 v[52:55], v[116:119], v[148:151], v[52:55]
    buffer_load_dwordx4 v[144:147], v2, s[36:39], s88 offen offset:1024 sc1
    v_mfma_f32_16x16x32_bf16 v[80:83], v[116:119], v[152:155], v[80:83]
    ds_read_b128 v[116:119], v2 offset:44032
    s_waitcnt lgkmcnt(5)
    v_mfma_f32_16x16x32_bf16 v[56:59], v[120:123], v[148:151], v[56:59]
    v_mfma_f32_16x16x32_bf16 v[84:87], v[120:123], v[152:155], v[84:87]
    ds_read_b128 v[120:123], v2 offset:45056
    v_mfma_f32_16x16x32_bf16 v[60:63], v[124:127], v[148:151], v[60:63]
    v_mfma_f32_16x16x32_bf16 v[88:91], v[124:127], v[152:155], v[88:91]
    ds_read_b128 v[124:127], v2 offset:46080
    s_waitcnt lgkmcnt(5)
    v_mfma_f32_16x16x32_bf16 v[64:67], v[128:131], v[148:151], v[64:67]
    v_mfma_f32_16x16x32_bf16 v[92:95], v[128:131], v[152:155], v[92:95]
    ds_read_b128 v[128:131], v2 offset:47104
    v_mfma_f32_16x16x32_bf16 v[68:71], v[132:135], v[148:151], v[68:71]
    v_mfma_f32_16x16x32_bf16 v[96:99], v[132:135], v[152:155], v[96:99]
    ds_read_b128 v[132:135], v2 offset:48128
    s_waitcnt lgkmcnt(6)
    v_mfma_f32_16x16x32_bf16 v[72:75], v[136:139], v[148:151], v[72:75]
    v_mfma_f32_16x16x32_bf16 v[100:103], v[136:139], v[152:155], v[100:103]
    ds_read_b128 v[136:139], v2 offset:49152
    s_waitcnt lgkmcnt(5)
    v_mfma_f32_16x16x32_bf16 v[48:51], v[112:115], v[156:159], v[48:51]
    buffer_load_dwordx4 v[148:151], v2, s[36:39], s88 offen offset:2048 sc1
    v_mfma_f32_16x16x32_bf16 v[76:79], v[112:115], v[160:163], v[76:79]
    ds_read_b128 v[112:115], v2 offset:35840
    v_mfma_f32_16x16x32_bf16 v[52:55], v[116:119], v[156:159], v[52:55]
    buffer_load_dwordx4 v[152:155], v2, s[36:39], s88 offen offset:3072 sc1
    v_mfma_f32_16x16x32_bf16 v[80:83], v[116:119], v[160:163], v[80:83]
    ds_read_b128 v[116:119], v2 offset:36864
    s_waitcnt lgkmcnt(5)
    v_mfma_f32_16x16x32_bf16 v[56:59], v[120:123], v[156:159], v[56:59]
    v_mfma_f32_16x16x32_bf16 v[84:87], v[120:123], v[160:163], v[84:87]
    ds_read_b128 v[120:123], v2 offset:37888
    v_mfma_f32_16x16x32_bf16 v[60:63], v[124:127], v[156:159], v[60:63]
    v_mfma_f32_16x16x32_bf16 v[88:91], v[124:127], v[160:163], v[88:91]
    ds_read_b128 v[124:127], v2 offset:38912
    s_waitcnt lgkmcnt(5)
    v_mfma_f32_16x16x32_bf16 v[64:67], v[128:131], v[156:159], v[64:67]
    v_mfma_f32_16x16x32_bf16 v[92:95], v[128:131], v[160:163], v[92:95]
    ds_read_b128 v[128:131], v2 offset:39936
    v_mfma_f32_16x16x32_bf16 v[68:71], v[132:135], v[156:159], v[68:71]
    v_mfma_f32_16x16x32_bf16 v[96:99], v[132:135], v[160:163], v[96:99]
    ds_read_b128 v[132:135], v2 offset:40960
    s_waitcnt lgkmcnt(6)
    v_mfma_f32_16x16x32_bf16 v[72:75], v[136:139], v[156:159], v[72:75]
    v_mfma_f32_16x16x32_bf16 v[100:103], v[136:139], v[160:163], v[100:103]
    ds_read_b128 v[136:139], v2 offset:41984
    s_waitcnt lgkmcnt(5)
    v_mfma_f32_16x16x32_bf16 v[48:51], v[112:115], v[164:167], v[48:51]
    s_add_u32 s88, s91, 33562624
    buffer_load_dwordx4 v[156:159], v2, s[36:39], s88 offen offset:0 sc1
    v_mfma_f32_16x16x32_bf16 v[76:79], v[112:115], v[168:171], v[76:79]
    ds_read_b128 v[112:115], v2 offset:28672
    v_mfma_f32_16x16x32_bf16 v[52:55], v[116:119], v[164:167], v[52:55]
    buffer_load_dwordx4 v[160:163], v2, s[36:39], s88 offen offset:1024 sc1
    v_mfma_f32_16x16x32_bf16 v[80:83], v[116:119], v[168:171], v[80:83]
    ds_read_b128 v[116:119], v2 offset:29696
    s_waitcnt lgkmcnt(5)
    v_mfma_f32_16x16x32_bf16 v[56:59], v[120:123], v[164:167], v[56:59]
    v_mfma_f32_16x16x32_bf16 v[84:87], v[120:123], v[168:171], v[84:87]
    ds_read_b128 v[120:123], v2 offset:30720
    v_mfma_f32_16x16x32_bf16 v[60:63], v[124:127], v[164:167], v[60:63]
    v_mfma_f32_16x16x32_bf16 v[88:91], v[124:127], v[168:171], v[88:91]
    ds_read_b128 v[124:127], v2 offset:31744
    s_waitcnt lgkmcnt(5)
    v_mfma_f32_16x16x32_bf16 v[64:67], v[128:131], v[164:167], v[64:67]
    v_mfma_f32_16x16x32_bf16 v[92:95], v[128:131], v[168:171], v[92:95]
    ds_read_b128 v[128:131], v2 offset:32768
    v_mfma_f32_16x16x32_bf16 v[68:71], v[132:135], v[164:167], v[68:71]
    v_mfma_f32_16x16x32_bf16 v[96:99], v[132:135], v[168:171], v[96:99]
    ds_read_b128 v[132:135], v2 offset:33792
    s_waitcnt lgkmcnt(6)
    v_mfma_f32_16x16x32_bf16 v[72:75], v[136:139], v[164:167], v[72:75]
    v_mfma_f32_16x16x32_bf16 v[100:103], v[136:139], v[168:171], v[100:103]
    ds_read_b128 v[136:139], v2 offset:34816
    s_waitcnt lgkmcnt(5)
    v_mfma_f32_16x16x32_bf16 v[48:51], v[112:115], v[172:175], v[48:51]
    buffer_load_dwordx4 v[164:167], v2, s[36:39], s88 offen offset:2048 sc1
    v_mfma_f32_16x16x32_bf16 v[76:79], v[112:115], v[176:179], v[76:79]
    ds_read_b128 v[112:115], v2 offset:21504
    v_mfma_f32_16x16x32_bf16 v[52:55], v[116:119], v[172:175], v[52:55]
    buffer_load_dwordx4 v[168:171], v2, s[36:39], s88 offen offset:3072 sc1
    v_mfma_f32_16x16x32_bf16 v[80:83], v[116:119], v[176:179], v[80:83]
    ds_read_b128 v[116:119], v2 offset:22528
    s_waitcnt lgkmcnt(5)
    v_mfma_f32_16x16x32_bf16 v[56:59], v[120:123], v[172:175], v[56:59]
    v_mfma_f32_16x16x32_bf16 v[84:87], v[120:123], v[176:179], v[84:87]
    ds_read_b128 v[120:123], v2 offset:23552
    v_mfma_f32_16x16x32_bf16 v[60:63], v[124:127], v[172:175], v[60:63]
    v_mfma_f32_16x16x32_bf16 v[88:91], v[124:127], v[176:179], v[88:91]
    ds_read_b128 v[124:127], v2 offset:24576
    s_waitcnt lgkmcnt(5)
    v_mfma_f32_16x16x32_bf16 v[64:67], v[128:131], v[172:175], v[64:67]
    v_mfma_f32_16x16x32_bf16 v[92:95], v[128:131], v[176:179], v[92:95]
    ds_read_b128 v[128:131], v2 offset:25600
    v_mfma_f32_16x16x32_bf16 v[68:71], v[132:135], v[172:175], v[68:71]
    v_mfma_f32_16x16x32_bf16 v[96:99], v[132:135], v[176:179], v[96:99]
    ds_read_b128 v[132:135], v2 offset:26624
    s_waitcnt lgkmcnt(6)
    v_mfma_f32_16x16x32_bf16 v[72:75], v[136:139], v[172:175], v[72:75]
    v_mfma_f32_16x16x32_bf16 v[100:103], v[136:139], v[176:179], v[100:103]
    ds_read_b128 v[136:139], v2 offset:27648
    s_waitcnt lgkmcnt(5)
    v_mfma_f32_16x16x32_bf16 v[48:51], v[112:115], v[180:183], v[48:51]
    s_add_u32 s88, s91, 33566720
    buffer_load_dwordx4 v[172:175], v2, s[36:39], s88 offen offset:0 sc1
    v_mfma_f32_16x16x32_bf16 v[76:79], v[112:115], v[184:187], v[76:79]
    ds_read_b128 v[112:115], v2 offset:14336
    v_mfma_f32_16x16x32_bf16 v[52:55], v[116:119], v[180:183], v[52:55]
    buffer_load_dwordx4 v[176:179], v2, s[36:39], s88 offen offset:1024 sc1
    v_mfma_f32_16x16x32_bf16 v[80:83], v[116:119], v[184:187], v[80:83]
    ds_read_b128 v[116:119], v2 offset:15360
    s_waitcnt lgkmcnt(5)
    v_mfma_f32_16x16x32_bf16 v[56:59], v[120:123], v[180:183], v[56:59]
    v_mfma_f32_16x16x32_bf16 v[84:87], v[120:123], v[184:187], v[84:87]
    ds_read_b128 v[120:123], v2 offset:16384
    v_mfma_f32_16x16x32_bf16 v[60:63], v[124:127], v[180:183], v[60:63]
    s_waitcnt vmcnt(19)
    v_mfma_f32_16x16x32_bf16 v[88:91], v[124:127], v[184:187], v[88:91]
    ds_read_b128 v[124:127], v2 offset:17408
    s_waitcnt lgkmcnt(5)
    v_mfma_f32_16x16x32_bf16 v[64:67], v[128:131], v[180:183], v[64:67]
    v_mfma_f32_16x16x32_bf16 v[92:95], v[128:131], v[184:187], v[92:95]
    ds_read_b128 v[128:131], v2 offset:18432
    v_mfma_f32_16x16x32_bf16 v[68:71], v[132:135], v[180:183], v[68:71]
    v_mfma_f32_16x16x32_bf16 v[96:99], v[132:135], v[184:187], v[96:99]
    ds_read_b128 v[132:135], v2 offset:19456
    s_waitcnt lgkmcnt(6)
    v_mfma_f32_16x16x32_bf16 v[72:75], v[136:139], v[180:183], v[72:75]
    v_mfma_f32_16x16x32_bf16 v[100:103], v[136:139], v[184:187], v[100:103]
    ds_read_b128 v[136:139], v2 offset:20480
    s_waitcnt lgkmcnt(5)
    v_mfma_f32_16x16x32_bf16 v[48:51], v[112:115], v[188:191], v[48:51]
    s_add_u32 s88, s91, 33611776
    buffer_load_dwordx4 v[180:183], v2, s[36:39], s88 offen offset:0 sc1
    v_mfma_f32_16x16x32_bf16 v[76:79], v[112:115], v[192:195], v[76:79]
    ds_read_b128 v[112:115], v2 offset:7168
    v_mfma_f32_16x16x32_bf16 v[52:55], v[116:119], v[188:191], v[52:55]
    buffer_load_dwordx4 v[184:187], v2, s[36:39], s88 offen offset:1024 sc1
    v_mfma_f32_16x16x32_bf16 v[80:83], v[116:119], v[192:195], v[80:83]
    ds_read_b128 v[116:119], v2 offset:8192
    s_waitcnt lgkmcnt(5)
    v_mfma_f32_16x16x32_bf16 v[56:59], v[120:123], v[188:191], v[56:59]
    v_mfma_f32_16x16x32_bf16 v[84:87], v[120:123], v[192:195], v[84:87]
    ds_read_b128 v[120:123], v2 offset:9216
    v_mfma_f32_16x16x32_bf16 v[60:63], v[124:127], v[188:191], v[60:63]
    s_waitcnt vmcnt(19)
    v_mfma_f32_16x16x32_bf16 v[88:91], v[124:127], v[192:195], v[88:91]
    ds_read_b128 v[124:127], v2 offset:10240
    s_waitcnt lgkmcnt(5)
    v_mfma_f32_16x16x32_bf16 v[64:67], v[128:131], v[188:191], v[64:67]
    v_mfma_f32_16x16x32_bf16 v[92:95], v[128:131], v[192:195], v[92:95]
    ds_read_b128 v[128:131], v2 offset:11264
    v_mfma_f32_16x16x32_bf16 v[68:71], v[132:135], v[188:191], v[68:71]
    v_mfma_f32_16x16x32_bf16 v[96:99], v[132:135], v[192:195], v[96:99]
    ds_read_b128 v[132:135], v2 offset:12288
    s_waitcnt lgkmcnt(6)
    v_mfma_f32_16x16x32_bf16 v[72:75], v[136:139], v[188:191], v[72:75]
    v_mfma_f32_16x16x32_bf16 v[100:103], v[136:139], v[192:195], v[100:103]
    ds_read_b128 v[136:139], v2 offset:13312
    s_waitcnt lgkmcnt(0)
    v_mfma_f32_16x16x32_bf16 v[72:75], v[136:139], v[196:199], v[72:75]
    buffer_load_dwordx4 v[188:191], v2, s[36:39], s88 offen offset:2048 sc1
    v_mfma_f32_16x16x32_bf16 v[100:103], v[136:139], v[200:203], v[100:103]
    ds_read_b128 v[136:139], v2 offset:6144
    v_mfma_f32_16x16x32_bf16 v[48:51], v[112:115], v[196:199], v[48:51]
    buffer_load_dwordx4 v[192:195], v2, s[36:39], s88 offen offset:3072 sc1
    v_mfma_f32_16x16x32_bf16 v[76:79], v[112:115], v[200:203], v[76:79]
    ds_read_b128 v[112:115], v2 offset:0
    v_mfma_f32_16x16x32_bf16 v[52:55], v[116:119], v[196:199], v[52:55]
    v_and_b32 v105, 7, v1
    v_lshlrev_b32 v105, 10, v105
    v_mfma_f32_16x16x32_bf16 v[80:83], v[116:119], v[200:203], v[80:83]
    ds_read_b128 v[116:119], v2 offset:1024
    v_lshl_add_u32 v105, v4, 4, v105
    v_mfma_f32_16x16x32_bf16 v[56:59], v[120:123], v[196:199], v[56:59]
    s_waitcnt vmcnt(19)
    v_and_b32 v107, 8, v1
    v_mfma_f32_16x16x32_bf16 v[84:87], v[120:123], v[200:203], v[84:87]
    ds_read_b128 v[120:123], v2 offset:2048
    v_mfma_f32_16x16x32_bf16 v[60:63], v[124:127], v[196:199], v[60:63]
    v_lshl_add_u32 v105, v107, 3, v105
    s_add_u32 s79, s69, 512
    v_mfma_f32_16x16x32_bf16 v[88:91], v[124:127], v[200:203], v[88:91]
    ds_read_b128 v[124:127], v2 offset:3072
    buffer_load_dwordx4 v[108:111], v105, s[36:39], s79 offen offset:0 sc1
    v_mfma_f32_16x16x32_bf16 v[64:67], v[128:131], v[196:199], v[64:67]
    buffer_load_dwordx4 v[228:231], v105, s[36:39], s79 offen offset:128 sc1
    v_mfma_f32_16x16x32_bf16 v[92:95], v[128:131], v[200:203], v[92:95]
    ds_read_b128 v[128:131], v2 offset:4096
    v_mfma_f32_16x16x32_bf16 v[68:71], v[132:135], v[196:199], v[68:71]
    v_mfma_f32_16x16x32_bf16 v[96:99], v[132:135], v[200:203], v[96:99]
    ds_read_b128 v[132:135], v2 offset:5120
    s_waitcnt lgkmcnt(5)
    v_mfma_f32_16x16x32_bf16 v[72:75], v[136:139], v[204:207], v[72:75]
    s_add_u32 s88, s91, 33615872
    buffer_load_dwordx4 v[196:199], v2, s[36:39], s88 offen offset:0 sc1
    v_mfma_f32_16x16x32_bf16 v[100:103], v[136:139], v[208:211], v[100:103]
    ds_read_b128 v[136:139], v0 offset:0
    v_mfma_f32_16x16x32_bf16 v[48:51], v[112:115], v[204:207], v[48:51]
    buffer_load_dwordx4 v[200:203], v2, s[36:39], s88 offen offset:1024 sc1
    v_mfma_f32_16x16x32_bf16 v[76:79], v[112:115], v[208:211], v[76:79]
    ds_read_b128 v[112:115], v0 offset:43008
    s_waitcnt lgkmcnt(5)
    v_mfma_f32_16x16x32_bf16 v[52:55], v[116:119], v[204:207], v[52:55]
    v_mfma_f32_16x16x32_bf16 v[80:83], v[116:119], v[208:211], v[80:83]
    ds_read_b128 v[116:119], v0 offset:35840
    v_mfma_f32_16x16x32_bf16 v[56:59], v[120:123], v[204:207], v[56:59]
    ds_bpermute_b32 v104, v10, v74
    ds_bpermute_b32 v106, v10, v102
    v_mfma_f32_16x16x32_bf16 v[84:87], v[120:123], v[208:211], v[84:87]
    ds_read_b128 v[120:123], v0 offset:28672
    s_waitcnt lgkmcnt(7)
    v_mfma_f32_16x16x32_bf16 v[60:63], v[124:127], v[204:207], v[60:63]
    v_mfma_f32_16x16x32_bf16 v[88:91], v[124:127], v[208:211], v[88:91]
    ds_read_b128 v[124:127], v0 offset:21504
    v_mfma_f32_16x16x32_bf16 v[64:67], v[128:131], v[204:207], v[64:67]
    v_mfma_f32_16x16x32_bf16 v[92:95], v[128:131], v[208:211], v[92:95]
    ds_read_b128 v[128:131], v0 offset:14336
    s_waitcnt lgkmcnt(8)
    v_mfma_f32_16x16x32_bf16 v[68:71], v[132:135], v[204:207], v[68:71]
    s_waitcnt lgkmcnt(3)
    v_mul_f32 v104, 0x3acccccd, v104
    v_mfma_f32_16x16x32_bf16 v[96:99], v[132:135], v[208:211], v[96:99]
    ds_read_b128 v[132:135], v0 offset:7168
    v_mul_f32 v106, 0x3acccccd, v106
    v_cvt_pk_bf16_f32 v104, v104, v104
    v_cvt_pk_bf16_f32 v106, v106, v106
    v_lshlrev_b32 v104, 16, v104
    v_lshlrev_b32 v106, 16, v106
    s_add_u32 s72, s95, 23592960
    buffer_load_dwordx4 v[204:207], v2, s[36:39], s88 offen offset:2048 sc1
    buffer_load_dwordx4 v[208:211], v2, s[36:39], s88 offen offset:3072 sc1
    v_pk_fma_f32 v[72:73], v[136:137], v[104:105], v[72:73] op_sel_hi:[1,0,1] neg_lo:[0,1,0] neg_hi:[0,1,0]
    v_pk_fma_f32 v[74:75], v[138:139], v[104:105], v[74:75] op_sel_hi:[1,0,1] neg_lo:[0,1,0] neg_hi:[0,1,0]
    v_pk_fma_f32 v[48:49], v[112:113], v[104:105], v[48:49] op_sel_hi:[1,0,1] neg_lo:[0,1,0] neg_hi:[0,1,0]
    v_pk_fma_f32 v[50:51], v[114:115], v[104:105], v[50:51] op_sel_hi:[1,0,1] neg_lo:[0,1,0] neg_hi:[0,1,0]
    v_pk_fma_f32 v[52:53], v[116:117], v[104:105], v[52:53] op_sel_hi:[1,0,1] neg_lo:[0,1,0] neg_hi:[0,1,0]
    v_pk_fma_f32 v[54:55], v[118:119], v[104:105], v[54:55] op_sel_hi:[1,0,1] neg_lo:[0,1,0] neg_hi:[0,1,0]
    s_waitcnt lgkmcnt(3)
    v_pk_fma_f32 v[56:57], v[120:121], v[104:105], v[56:57] op_sel_hi:[1,0,1] neg_lo:[0,1,0] neg_hi:[0,1,0]
    v_pk_fma_f32 v[58:59], v[122:123], v[104:105], v[58:59] op_sel_hi:[1,0,1] neg_lo:[0,1,0] neg_hi:[0,1,0]
    s_waitcnt lgkmcnt(2)
    v_pk_fma_f32 v[60:61], v[124:125], v[104:105], v[60:61] op_sel_hi:[1,0,1] neg_lo:[0,1,0] neg_hi:[0,1,0]
    v_pk_fma_f32 v[62:63], v[126:127], v[104:105], v[62:63] op_sel_hi:[1,0,1] neg_lo:[0,1,0] neg_hi:[0,1,0]
    s_waitcnt lgkmcnt(1)
    v_pk_fma_f32 v[64:65], v[128:129], v[104:105], v[64:65] op_sel_hi:[1,0,1] neg_lo:[0,1,0] neg_hi:[0,1,0]
    v_pk_fma_f32 v[66:67], v[130:131], v[104:105], v[66:67] op_sel_hi:[1,0,1] neg_lo:[0,1,0] neg_hi:[0,1,0]
    s_waitcnt lgkmcnt(0)
    v_pk_fma_f32 v[68:69], v[132:133], v[104:105], v[68:69] op_sel_hi:[1,0,1] neg_lo:[0,1,0] neg_hi:[0,1,0]
    v_pk_fma_f32 v[70:71], v[134:135], v[104:105], v[70:71] op_sel_hi:[1,0,1] neg_lo:[0,1,0] neg_hi:[0,1,0]
    v_permlane32_swap_b32 v72, v74
    v_permlane32_swap_b32 v73, v75
    v_pk_mul_f32 v[48:49], v[48:49], v[60:61]
    v_pk_mul_f32 v[50:51], v[50:51], v[62:63]
    v_pk_mul_f32 v[52:53], v[52:53], v[64:65]
    v_pk_mul_f32 v[54:55], v[54:55], v[66:67]
    v_pk_mul_f32 v[56:57], v[56:57], v[68:69]
    v_pk_mul_f32 v[58:59], v[58:59], v[70:71]
    v_pk_mul_f32 v[60:61], v[72:73], v[74:75]
    v_cvt_pk_bf16_f32 v72, v56, v57
    v_cvt_pk_bf16_f32 v73, v58, v59
    v_mov_b32 v71, 0
    v_cvt_pk_bf16_f32 v64, v48, v49
    v_cvt_pk_bf16_f32 v65, v50, v51
    v_cvt_pk_bf16_f32 v66, v52, v53
    v_cvt_pk_bf16_f32 v67, v54, v55
    v_permlane16_swap_b32 v72, v73
    v_cvt_pk_bf16_f32 v68, v56, v57
    v_cvt_pk_bf16_f32 v69, v58, v59
    v_cvt_pk_bf16_f32 v70, v60, v61
    v_permlane32_swap_b32 v73, v71
    s_cmp_eq_u32 s30, 0
    s_cbranch_scc1 Lg_150
    buffer_store_dwordx4 v[64:67], v2, s[36:39], s72 offen
    s_mov_b32 exec_hi, 0xffff
    buffer_store_dwordx4 v[68:71], v2, s[36:39], s72 offen offset:1024
    s_mov_b64 exec, -1
Lgb_151:
    s_add_u32 s72, s72, 57344
    v_pk_fma_f32 v[100:101], v[136:137], v[106:107], v[100:101] op_sel_hi:[1,0,1] neg_lo:[0,1,0] neg_hi:[0,1,0]
    v_pk_fma_f32 v[102:103], v[138:139], v[106:107], v[102:103] op_sel_hi:[1,0,1] neg_lo:[0,1,0] neg_hi:[0,1,0]
    v_pk_fma_f32 v[76:77], v[112:113], v[106:107], v[76:77] op_sel_hi:[1,0,1] neg_lo:[0,1,0] neg_hi:[0,1,0]
    v_pk_fma_f32 v[78:79], v[114:115], v[106:107], v[78:79] op_sel_hi:[1,0,1] neg_lo:[0,1,0] neg_hi:[0,1,0]
    v_pk_fma_f32 v[80:81], v[116:117], v[106:107], v[80:81] op_sel_hi:[1,0,1] neg_lo:[0,1,0] neg_hi:[0,1,0]
    v_pk_fma_f32 v[82:83], v[118:119], v[106:107], v[82:83] op_sel_hi:[1,0,1] neg_lo:[0,1,0] neg_hi:[0,1,0]
    v_pk_fma_f32 v[84:85], v[120:121], v[106:107], v[84:85] op_sel_hi:[1,0,1] neg_lo:[0,1,0] neg_hi:[0,1,0]
    v_pk_fma_f32 v[86:87], v[122:123], v[106:107], v[86:87] op_sel_hi:[1,0,1] neg_lo:[0,1,0] neg_hi:[0,1,0]
    v_pk_fma_f32 v[88:89], v[124:125], v[106:107], v[88:89] op_sel_hi:[1,0,1] neg_lo:[0,1,0] neg_hi:[0,1,0]
    v_pk_fma_f32 v[90:91], v[126:127], v[106:107], v[90:91] op_sel_hi:[1,0,1] neg_lo:[0,1,0] neg_hi:[0,1,0]
    v_pk_fma_f32 v[92:93], v[128:129], v[106:107], v[92:93] op_sel_hi:[1,0,1] neg_lo:[0,1,0] neg_hi:[0,1,0]
    v_pk_fma_f32 v[94:95], v[130:131], v[106:107], v[94:95] op_sel_hi:[1,0,1] neg_lo:[0,1,0] neg_hi:[0,1,0]
    v_pk_fma_f32 v[96:97], v[132:133], v[106:107], v[96:97] op_sel_hi:[1,0,1] neg_lo:[0,1,0] neg_hi:[0,1,0]
    v_pk_fma_f32 v[98:99], v[134:135], v[106:107], v[98:99] op_sel_hi:[1,0,1] neg_lo:[0,1,0] neg_hi:[0,1,0]
    v_permlane32_swap_b32 v100, v102
    v_permlane32_swap_b32 v101, v103
    v_pk_mul_f32 v[76:77], v[76:77], v[88:89]
    v_pk_mul_f32 v[78:79], v[78:79], v[90:91]
    v_pk_mul_f32 v[80:81], v[80:81], v[92:93]
    v_pk_mul_f32 v[82:83], v[82:83], v[94:95]
    v_pk_mul_f32 v[84:85], v[84:85], v[96:97]
    v_pk_mul_f32 v[86:87], v[86:87], v[98:99]
    v_pk_mul_f32 v[88:89], v[100:101], v[102:103]
    v_cvt_pk_bf16_f32 v100, v84, v85
    v_cvt_pk_bf16_f32 v101, v86, v87
    v_mov_b32 v99, 0
    v_cvt_pk_bf16_f32 v92, v76, v77
    v_cvt_pk_bf16_f32 v93, v78, v79
    v_cvt_pk_bf16_f32 v94, v80, v81
    v_cvt_pk_bf16_f32 v95, v82, v83
    v_permlane16_swap_b32 v100, v101
    v_cvt_pk_bf16_f32 v96, v84, v85
    v_cvt_pk_bf16_f32 v97, v86, v87
    v_cvt_pk_bf16_f32 v98, v88, v89
    v_permlane32_swap_b32 v101, v99
    s_cmp_eq_u32 s30, 0
    s_cbranch_scc1 Lg_152
    buffer_store_dwordx4 v[92:95], v2, s[36:39], s72 offen
    s_mov_b32 exec_hi, 0xffff
    buffer_store_dwordx4 v[96:99], v2, s[36:39], s72 offen offset:1024
    s_mov_b64 exec, -1
Lgb_153:
    s_waitcnt vmcnt(26)
    v_mfma_f32_16x16x32_bf16 v[48:51], a[0:3], v[212:215], 0
    v_mfma_f32_16x16x32_bf16 v[52:55], a[4:7], v[212:215], 0
    v_lshlrev_b32 v132, 9, v3
    v_lshl_add_u32 v132, v4, 4, v132
    v_mfma_f32_16x16x32_bf16 v[56:59], a[8:11], v[212:215], 0
    v_mul_u32_u24 v134, 1280, v4
    v_lshl_add_u32 v134, v3, 4, v134
    v_mfma_f32_16x16x32_bf16 v[60:63], a[12:15], v[212:215], 0
    v_lshlrev_b32 v135, 4, v4
    v_and_b32 v136, 7, v1
    v_mfma_f32_16x16x32_bf16 v[64:67], a[16:19], v[212:215], 0
    v_lshl_add_u32 v136, v136, 10, v135
    v_mov_b32 v130, v14
    v_mfma_f32_16x16x32_bf16 v[48:51], a[20:23], v[216:219], v[48:51]
    v_mov_b32 v131, v14
    s_mul_i32 s76, s62, 40960
    v_mfma_f32_16x16x32_bf16 v[52:55], a[24:27], v[216:219], v[52:55]
    s_add_u32 s88, s91, 33619968
    buffer_load_dwordx4 v[212:215], v2, s[36:39], s88 offen offset:0 sc1
    s_waitcnt vmcnt(25)
    v_mfma_f32_16x16x32_bf16 v[56:59], a[28:31], v[216:219], v[56:59]
    s_mul_i32 s77, s63, 5120
    s_add_u32 s76, s76, s77
    v_mfma_f32_16x16x32_bf16 v[60:63], a[32:35], v[216:219], v[60:63]
    s_lshl_b32 s77, s6, 6
    s_add_u32 s76, s76, s77
    v_mfma_f32_16x16x32_bf16 v[64:67], a[36:39], v[216:219], v[64:67]
    s_lshl_b32 s77, s62, 3
    s_add_u32 s77, s77, s6
    v_mfma_f32_16x16x32_bf16 v[48:51], a[40:43], v[220:223], v[48:51]
    s_mul_i32 s77, s77, 5120
    s_mul_i32 s78, s63, 160
    v_mfma_f32_16x16x32_bf16 v[52:55], a[44:47], v[220:223], v[52:55]
    s_add_u32 s77, s77, s78
    s_lshl_b32 s78, s63, 10
    v_mfma_f32_16x16x32_bf16 v[56:59], a[48:51], v[220:223], v[56:59]
    buffer_load_dwordx4 v[216:219], v2, s[36:39], s88 offen offset:1024 sc1
    s_add_u32 s78, s78, s69
    v_mfma_f32_16x16x32_bf16 v[60:63], a[52:55], v[220:223], v[60:63]
    s_waitcnt vmcnt(11)
    v_cmp_ne_u32 vcc, v111, v14
    s_cbranch_vccnz Lps_155
Lpd_154:
    v_add_f32_dpp v108, v108, v108 quad_perm:[1,0,3,2] row_mask:0xf bank_mask:0xf
    v_mfma_f32_16x16x32_bf16 v[64:67], a[56:59], v[220:223], v[64:67]
    v_add_f32_dpp v109, v109, v109 quad_perm:[1,0,3,2] row_mask:0xf bank_mask:0xf
    v_add_f32_dpp v108, v108, v108 quad_perm:[2,3,0,1] row_mask:0xf bank_mask:0xf
    v_mfma_f32_16x16x32_bf16 v[48:51], a[60:63], v[224:227], v[48:51]
    buffer_load_dwordx4 v[220:223], v2, s[36:39], s88 offen offset:2048 sc1
    v_add_f32_dpp v109, v109, v109 quad_perm:[2,3,0,1] row_mask:0xf bank_mask:0xf
    v_mfma_f32_16x16x32_bf16 v[52:55], a[64:67], v[224:227], v[52:55]
    v_add_f32_dpp v108, v108, v108 row_half_mirror row_mask:0xf bank_mask:0xf
    v_mfma_f32_16x16x32_bf16 v[56:59], a[68:71], v[224:227], v[56:59]
    v_add_f32_dpp v109, v109, v109 row_half_mirror row_mask:0xf bank_mask:0xf
    v_mul_f32 v108, 0x3acccccd, v108
    v_mfma_f32_16x16x32_bf16 v[60:63], a[72:75], v[224:227], v[60:63]
    v_mul_f32 v109, 0x3acccccd, v109
    v_fma_f32 v109, -v108, v108, v109
    v_mfma_f32_16x16x32_bf16 v[64:67], a[76:79], v[224:227], v[64:67]
    v_max_f32 v109, 0, v109
    v_cvt_pk_bf16_f32 v109, v109, v109
    v_mfma_f32_16x16x32_bf16 v[48:51], a[80:83], v[140:143], v[48:51]
    v_lshlrev_b32 v109, 16, v109
    v_add_f32 v109, 0x3727c5ac, v109
    v_mfma_f32_16x16x32_bf16 v[52:55], a[84:87], v[140:143], v[52:55]
    buffer_load_dwordx4 v[224:227], v2, s[36:39], s88 offen offset:3072 sc1
    v_cvt_pk_bf16_f32 v109, v109, v109
    v_mfma_f32_16x16x32_bf16 v[56:59], a[88:91], v[140:143], v[56:59]
    v_lshlrev_b32 v109, 16, v109
    v_sqrt_f32 v109, v109
    v_mfma_f32_16x16x32_bf16 v[60:63], a[92:95], v[140:143], v[60:63]
    v_cvt_pk_bf16_f32 v109, v109, v109
    v_lshlrev_b32 v109, 16, v109
    v_mfma_f32_16x16x32_bf16 v[64:67], a[96:99], v[140:143], v[64:67]
    v_rcp_f32 v109, v109
    s_nop 0
    v_mul_f32 v9, v109, v109
    v_mfma_f32_16x16x32_bf16 v[48:51], a[100:103], v[144:147], v[48:51]
    v_mul_f32 v5, v109, v109
    v_mul_f32 v109, v109, v109
    v_mfma_f32_16x16x32_bf16 v[52:55], a[104:107], v[144:147], v[52:55]
    s_nop 0
    v_mov_b32_dpp v9, v109 row_shr:8 row_mask:0xf bank_mask:0xf
    v_mfma_f32_16x16x32_bf16 v[56:59], a[108:111], v[144:147], v[56:59]
    s_add_u32 s88, s91, 33624064
    buffer_load_dwordx4 v[140:143], v2, s[36:39], s88 offen offset:0 sc1
    v_mov_b32_dpp v5, v109 row_shl:8 row_mask:0xf bank_mask:0xf
    v_mfma_f32_16x16x32_bf16 v[60:63], a[112:115], v[144:147], v[60:63]
    s_waitcnt vmcnt(13)
    v_cmp_ne_u32 vcc, v231, v14
    s_cbranch_vccnz Lps_157
Lpd_156:
    v_add_f32_dpp v228, v228, v228 quad_perm:[1,0,3,2] row_mask:0xf bank_mask:0xf
    v_mfma_f32_16x16x32_bf16 v[64:67], a[116:119], v[144:147], v[64:67]
    v_add_f32_dpp v229, v229, v229 quad_perm:[1,0,3,2] row_mask:0xf bank_mask:0xf
    v_add_f32_dpp v228, v228, v228 quad_perm:[2,3,0,1] row_mask:0xf bank_mask:0xf
    v_mfma_f32_16x16x32_bf16 v[48:51], a[120:123], v[148:151], v[48:51]
    buffer_load_dwordx4 v[144:147], v2, s[36:39], s88 offen offset:1024 sc1
    v_add_f32_dpp v229, v229, v229 quad_perm:[2,3,0,1] row_mask:0xf bank_mask:0xf
    v_mfma_f32_16x16x32_bf16 v[52:55], a[124:127], v[148:151], v[52:55]
    v_add_f32_dpp v228, v228, v228 row_half_mirror row_mask:0xf bank_mask:0xf
    v_add_f32_dpp v229, v229, v229 row_half_mirror row_mask:0xf bank_mask:0xf
    v_mfma_f32_16x16x32_bf16 v[56:59], a[128:131], v[148:151], v[56:59]
    v_mul_f32 v228, 0x3acccccd, v228
    v_mul_f32 v229, 0x3acccccd, v229
    v_mfma_f32_16x16x32_bf16 v[60:63], a[132:135], v[148:151], v[60:63]
    v_fma_f32 v229, -v228, v228, v229
    v_max_f32 v229, 0, v229
    v_mfma_f32_16x16x32_bf16 v[64:67], a[136:139], v[148:151], v[64:67]
    v_cvt_pk_bf16_f32 v229, v229, v229
    v_lshlrev_b32 v229, 16, v229
    v_mfma_f32_16x16x32_bf16 v[48:51], a[140:143], v[152:155], v[48:51]
    v_add_f32 v229, 0x3727c5ac, v229
    v_cvt_pk_bf16_f32 v229, v229, v229
    v_mfma_f32_16x16x32_bf16 v[52:55], a[144:147], v[152:155], v[52:55]
    v_lshlrev_b32 v229, 16, v229
    v_mfma_f32_16x16x32_bf16 v[56:59], a[148:151], v[152:155], v[56:59]
    v_sqrt_f32 v229, v229
    s_nop 0
    v_cvt_pk_bf16_f32 v229, v229, v229
    v_mfma_f32_16x16x32_bf16 v[60:63], a[152:155], v[152:155], v[60:63]
    v_lshlrev_b32 v229, 16, v229
    v_rcp_f32 v229, v229
    v_mfma_f32_16x16x32_bf16 v[64:67], a[156:159], v[152:155], v[64:67]
    v_mul_f32 v137, v229, v229
    v_mul_f32 v138, v229, v229
    v_mfma_f32_16x16x32_bf16 v[48:51], a[160:163], v[156:159], v[48:51]
    s_add_u32 s73, s66, 12
    v_mul_f32 v229, v229, v229
    v_mfma_f32_16x16x32_bf16 v[52:55], a[164:167], v[156:159], v[52:55]
    s_waitcnt vmcnt(6)
    v_mov_b32_dpp v137, v229 row_shr:8 row_mask:0xf bank_mask:0xf
    v_mfma_f32_16x16x32_bf16 v[56:59], a[168:171], v[156:159], v[56:59]
    s_cmp_eq_u32 s30, 0
    s_cbranch_scc1 Lg_158
    s_mov_b64 exec, 1
    buffer_store_dword v14, off, s[36:39], s73
    s_mov_b64 exec, -1
Lgb_159:
    v_mov_b32_dpp v138, v229 row_shl:8 row_mask:0xf bank_mask:0xf
    v_mfma_f32_16x16x32_bf16 v[60:63], a[172:175], v[156:159], v[60:63]
    v_mfma_f32_16x16x32_bf16 v[64:67], a[176:179], v[156:159], v[64:67]
    v_mfma_f32_16x16x32_bf16 v[48:51], a[180:183], v[160:163], v[48:51]
    v_mfma_f32_16x16x32_bf16 v[52:55], a[184:187], v[160:163], v[52:55]
    v_mfma_f32_16x16x32_bf16 v[56:59], a[188:191], v[160:163], v[56:59]
    v_mfma_f32_16x16x32_bf16 v[60:63], a[192:195], v[160:163], v[60:63]
    v_mfma_f32_16x16x32_bf16 v[64:67], a[196:199], v[160:163], v[64:67]
    v_mfma_f32_16x16x32_bf16 v[48:51], a[200:203], v[164:167], v[48:51]
    v_mfma_f32_16x16x32_bf16 v[52:55], a[204:207], v[164:167], v[52:55]
    v_mfma_f32_16x16x32_bf16 v[56:59], a[208:211], v[164:167], v[56:59]
    v_mfma_f32_16x16x32_bf16 v[60:63], a[212:215], v[164:167], v[60:63]
    v_mfma_f32_16x16x32_bf16 v[64:67], a[216:219], v[164:167], v[64:67]
    v_mfma_f32_16x16x32_bf16 v[48:51], a[220:223], v[168:171], v[48:51]
    v_mfma_f32_16x16x32_bf16 v[52:55], a[224:227], v[168:171], v[52:55]
    v_mfma_f32_16x16x32_bf16 v[56:59], a[228:231], v[168:171], v[56:59]
    v_mfma_f32_16x16x32_bf16 v[60:63], a[232:235], v[168:171], v[60:63]
    v_mfma_f32_16x16x32_bf16 v[64:67], a[236:239], v[168:171], v[64:67]
    v_mfma_f32_16x16x32_bf16 v[48:51], a[240:243], v[172:175], v[48:51]
    v_mfma_f32_16x16x32_bf16 v[52:55], a[244:247], v[172:175], v[52:55]
    v_mfma_f32_16x16x32_bf16 v[56:59], a[248:251], v[172:175], v[56:59]
    v_mfma_f32_16x16x32_bf16 v[60:63], a[252:255], v[172:175], v[60:63]
    v_mfma_f32_16x16x32_bf16 v[64:67], v[232:235], v[172:175], v[64:67]
    v_mfma_f32_16x16x32_bf16 v[48:51], v[236:239], v[176:179], v[48:51]
    v_mfma_f32_16x16x32_bf16 v[52:55], v[240:243], v[176:179], v[52:55]
    v_mfma_f32_16x16x32_bf16 v[56:59], v[244:247], v[176:179], v[56:59]
    v_mfma_f32_16x16x32_bf16 v[60:63], v[248:251], v[176:179], v[60:63]
    v_mfma_f32_16x16x32_bf16 v[64:67], v[252:255], v[176:179], v[64:67]
    v_mfma_f32_16x16x32_bf16 v[68:71], a[0:3], v[180:183], 0
    v_min_u32 v231, 7, v1
    v_lshlrev_b32 v231, 7, v231
    v_mfma_f32_16x16x32_bf16 v[72:75], a[4:7], v[180:183], 0
    s_add_u32 s75, s64, 12
    buffer_load_dword v228, v231, s[36:39], s75 offen sc1
    v_mfma_f32_16x16x32_bf16 v[76:79], a[8:11], v[180:183], 0
    v_mfma_f32_16x16x32_bf16 v[80:83], a[12:15], v[180:183], 0
    s_barrier
    ds_write_b128 v11, v[48:51] offset:0
    v_mfma_f32_16x16x32_bf16 v[84:87], a[16:19], v[180:183], 0
    v_lshlrev_b32 v120, 16, v16
    v_and_b32 v121, 0xffff0000, v16
    v_mfma_f32_16x16x32_bf16 v[68:71], a[20:23], v[184:187], v[68:71]
    v_mfma_f32_16x16x32_bf16 v[72:75], a[24:27], v[184:187], v[72:75]
    ds_write_b128 v12, v[52:55] offset:1024
    v_mfma_f32_16x16x32_bf16 v[76:79], a[28:31], v[184:187], v[76:79]
    v_lshlrev_b32 v122, 16, v17
    v_and_b32 v123, 0xffff0000, v17
    v_mfma_f32_16x16x32_bf16 v[80:83], a[32:35], v[184:187], v[80:83]
    v_mfma_f32_16x16x32_bf16 v[84:87], a[36:39], v[184:187], v[84:87]
    ds_write_b128 v11, v[56:59] offset:2048
    v_lshlrev_b32 v124, 16, v18
    v_mfma_f32_16x16x32_bf16 v[68:71], a[40:43], v[188:191], v[68:71]
    v_and_b32 v125, 0xffff0000, v18
    v_mfma_f32_16x16x32_bf16 v[72:75], a[44:47], v[188:191], v[72:75]
    ds_write_b128 v12, v[60:63] offset:3072
    v_lshlrev_b32 v126, 16, v19
    v_mfma_f32_16x16x32_bf16 v[76:79], a[48:51], v[188:191], v[76:79]
    v_and_b32 v127, 0xffff0000, v19
    v_mfma_f32_16x16x32_bf16 v[80:83], a[52:55], v[188:191], v[80:83]
    ds_write_b128 v11, v[64:67] offset:4096
    v_mfma_f32_16x16x32_bf16 v[84:87], a[56:59], v[188:191], v[84:87]
    v_mfma_f32_16x16x32_bf16 v[68:71], a[60:63], v[192:195], v[68:71]
    v_mfma_f32_16x16x32_bf16 v[72:75], a[64:67], v[192:195], v[72:75]
    v_mfma_f32_16x16x32_bf16 v[76:79], a[68:71], v[192:195], v[76:79]
    v_mfma_f32_16x16x32_bf16 v[80:83], a[72:75], v[192:195], v[80:83]
    v_mfma_f32_16x16x32_bf16 v[84:87], a[76:79], v[192:195], v[84:87]
    s_waitcnt lgkmcnt(0)
    s_barrier
    ds_read_b128 v[88:91], v13 offset:0
    v_mfma_f32_16x16x32_bf16 v[68:71], a[80:83], v[196:199], v[68:71]
    ds_read_b128 v[92:95], v13 offset:256
    ds_read_b128 v[96:99], v13 offset:5120
    v_mfma_f32_16x16x32_bf16 v[72:75], a[84:87], v[196:199], v[72:75]
    ds_read_b128 v[100:103], v13 offset:5376
    ds_read_b128 v[104:107], v13 offset:10240
    v_mfma_f32_16x16x32_bf16 v[76:79], a[88:91], v[196:199], v[76:79]
    s_waitcnt vmcnt(0)
    v_cmp_ne_u32 vcc, v228, v14
    s_cbranch_vccnz Lps_161
Lpd_160:
    ds_read_b128 v[108:111], v13 offset:10496
    v_mfma_f32_16x16x32_bf16 v[80:83], a[92:95], v[196:199], v[80:83]
    ds_read_b128 v[112:115], v13 offset:15360
    ds_read_b128 v[116:119], v13 offset:15616
    v_mfma_f32_16x16x32_bf16 v[84:87], a[96:99], v[196:199], v[84:87]
    s_add_u32 s88, s91, 23592960
    buffer_load_dwordx4 v[148:151], v2, s[36:39], s88 offen offset:0 sc1
    v_mfma_f32_16x16x32_bf16 v[68:71], a[100:103], v[200:203], v[68:71]
    v_mfma_f32_16x16x32_bf16 v[72:75], a[104:107], v[200:203], v[72:75]
    v_mfma_f32_16x16x32_bf16 v[76:79], a[108:111], v[200:203], v[76:79]
    buffer_load_dwordx4 v[152:155], v2, s[36:39], s88 offen offset:1024 sc1
    v_mfma_f32_16x16x32_bf16 v[80:83], a[112:115], v[200:203], v[80:83]
    v_mfma_f32_16x16x32_bf16 v[84:87], a[116:119], v[200:203], v[84:87]
    v_mfma_f32_16x16x32_bf16 v[68:71], a[120:123], v[204:207], v[68:71]
    buffer_load_dwordx4 v[156:159], v2, s[36:39], s88 offen offset:2048 sc1
    s_waitcnt lgkmcnt(4)
    v_mfma_f32_16x16x32_bf16 v[72:75], a[124:127], v[204:207], v[72:75]
    v_add_f32 v88, v88, v96
    v_add_f32 v89, v89, v97
    v_mfma_f32_16x16x32_bf16 v[76:79], a[128:131], v[204:207], v[76:79]
    v_add_f32 v90, v90, v98
    v_add_f32 v91, v91, v99
    v_mfma_f32_16x16x32_bf16 v[80:83], a[132:135], v[204:207], v[80:83]
    buffer_load_dwordx4 v[160:163], v2, s[36:39], s88 offen offset:3072 sc1
    v_add_f32 v92, v92, v100
    v_mfma_f32_16x16x32_bf16 v[84:87], a[136:139], v[204:207], v[84:87]
    v_add_f32 v93, v93, v101
    v_add_f32 v94, v94, v102
    v_mfma_f32_16x16x32_bf16 v[68:71], a[140:143], v[208:211], v[68:71]
    v_add_f32 v95, v95, v103
    s_waitcnt lgkmcnt(0)
    v_mfma_f32_16x16x32_bf16 v[72:75], a[144:147], v[208:211], v[72:75]
    s_add_u32 s88, s91, 23597056
    buffer_load_dwordx4 v[164:167], v2, s[36:39], s88 offen offset:0 sc1
    v_mfma_f32_16x16x32_bf16 v[76:79], a[148:151], v[208:211], v[76:79]
    v_add_f32 v104, v104, v112
    v_add_f32 v105, v105, v113
    v_mfma_f32_16x16x32_bf16 v[80:83], a[152:155], v[208:211], v[80:83]
    v_add_f32 v106, v106, v114
    v_add_f32 v107, v107, v115
    v_mfma_f32_16x16x32_bf16 v[84:87], a[156:159], v[208:211], v[84:87]
    buffer_load_dwordx4 v[168:171], v2, s[36:39], s88 offen offset:1024 sc1
    v_add_f32 v108, v108, v116
    v_mfma_f32_16x16x32_bf16 v[68:71], a[160:163], v[212:215], v[68:71]
    v_add_f32 v109, v109, v117
    v_add_f32 v110, v110, v118
    v_mfma_f32_16x16x32_bf16 v[72:75], a[164:167], v[212:215], v[72:75]
    v_add_f32 v111, v111, v119
    v_add_f32 v88, v88, v104
    v_mfma_f32_16x16x32_bf16 v[76:79], a[168:171], v[212:215], v[76:79]
    buffer_load_dwordx4 v[172:175], v2, s[36:39], s88 offen offset:2048 sc1
    v_add_f32 v89, v89, v105
    v_mfma_f32_16x16x32_bf16 v[80:83], a[172:175], v[212:215], v[80:83]
    v_add_f32 v90, v90, v106
    v_add_f32 v91, v91, v107
    v_mfma_f32_16x16x32_bf16 v[84:87], a[176:179], v[212:215], v[84:87]
    v_add_f32 v92, v92, v108
    v_add_f32 v93, v93, v109
    v_mfma_f32_16x16x32_bf16 v[68:71], a[180:183], v[216:219], v[68:71]
    buffer_load_dwordx4 v[176:179], v2, s[36:39], s88 offen offset:3072 sc1
    v_add_f32 v94, v94, v110
    v_mfma_f32_16x16x32_bf16 v[72:75], a[184:187], v[216:219], v[72:75]
    v_add_f32 v95, v95, v111
    v_mfma_f32_16x16x32_bf16 v[76:79], a[188:191], v[216:219], v[76:79]
    v_fmac_f32 v120, v88, v9
    v_fmac_f32 v121, v89, v9
    v_mfma_f32_16x16x32_bf16 v[80:83], a[192:195], v[216:219], v[80:83]
    s_add_u32 s88, s91, 23601152
    buffer_load_dwordx4 v[180:183], v2, s[36:39], s88 offen offset:0 sc1
    v_fmac_f32 v122, v90, v9
    v_mfma_f32_16x16x32_bf16 v[84:87], a[196:199], v[216:219], v[84:87]
    v_fmac_f32 v123, v91, v9
    v_fmac_f32 v124, v92, v9
    v_mfma_f32_16x16x32_bf16 v[68:71], a[200:203], v[220:223], v[68:71]
    v_fmac_f32 v125, v93, v9
    v_fmac_f32 v126, v94, v9
    v_mfma_f32_16x16x32_bf16 v[72:75], a[204:207], v[220:223], v[72:75]
    buffer_load_dwordx4 v[184:187], v2, s[36:39], s88 offen offset:1024 sc1
    v_fmac_f32 v127, v95, v9
    v_mfma_f32_16x16x32_bf16 v[76:79], a[208:211], v[220:223], v[76:79]
    v_cvt_pk_bf16_f32 v16, v120, v121
    v_cvt_pk_bf16_f32 v17, v122, v123
    v_mfma_f32_16x16x32_bf16 v[80:83], a[212:215], v[220:223], v[80:83]
    v_cvt_pk_bf16_f32 v18, v124, v125
    v_cvt_pk_bf16_f32 v19, v126, v127
    v_mfma_f32_16x16x32_bf16 v[84:87], a[216:219], v[220:223], v[84:87]
    buffer_load_dwordx4 v[188:191], v2, s[36:39], s88 offen offset:2048 sc1
    v_mfma_f32_16x16x32_bf16 v[68:71], a[220:223], v[224:227], v[68:71]
    v_mfma_f32_16x16x32_bf16 v[72:75], a[224:227], v[224:227], v[72:75]
    v_mfma_f32_16x16x32_bf16 v[76:79], a[228:231], v[224:227], v[76:79]
    buffer_load_dwordx4 v[192:195], v2, s[36:39], s88 offen offset:3072 sc1
    v_mfma_f32_16x16x32_bf16 v[80:83], a[232:235], v[224:227], v[80:83]
    v_mfma_f32_16x16x32_bf16 v[84:87], a[236:239], v[224:227], v[84:87]
    v_mfma_f32_16x16x32_bf16 v[68:71], a[240:243], v[140:143], v[68:71]
    s_add_u32 s88, s91, 23605248
    buffer_load_dwordx4 v[196:199], v2, s[36:39], s88 offen offset:0 sc1
    v_mfma_f32_16x16x32_bf16 v[72:75], a[244:247], v[140:143], v[72:75]
    v_mfma_f32_16x16x32_bf16 v[76:79], a[248:251], v[140:143], v[76:79]
    v_mfma_f32_16x16x32_bf16 v[80:83], a[252:255], v[140:143], v[80:83]
    buffer_load_dwordx4 v[200:203], v2, s[36:39], s88 offen offset:1024 sc1
    v_mfma_f32_16x16x32_bf16 v[84:87], v[232:235], v[140:143], v[84:87]
    v_mfma_f32_16x16x32_bf16 v[68:71], v[236:239], v[144:147], v[68:71]
    v_mfma_f32_16x16x32_bf16 v[72:75], v[240:243], v[144:147], v[72:75]
    s_add_u32 s88, s91, 23650304
    buffer_load_dwordx4 v[204:207], v2, s[36:39], s88 offen offset:0 sc1
    s_waitcnt vmcnt(13)
    v_mfma_f32_16x16x32_bf16 v[76:79], v[244:247], v[144:147], v[76:79]
    v_mfma_f32_16x16x32_bf16 v[80:83], v[248:251], v[144:147], v[80:83]
    v_mfma_f32_16x16x32_bf16 v[84:87], v[252:255], v[144:147], v[84:87]
    buffer_load_dwordx4 v[208:211], v2, s[36:39], s88 offen offset:1024 sc1
    v_mfma_f32_16x16x32_bf16 v[48:51], a[0:3], v[148:151], 0
    buffer_load_dwordx4 v[212:215], v2, s[36:39], s88 offen offset:2048 sc1
    v_mfma_f32_16x16x32_bf16 v[52:55], a[4:7], v[148:151], 0
    v_mfma_f32_16x16x32_bf16 v[56:59], a[8:11], v[148:151], 0
    v_mfma_f32_16x16x32_bf16 v[60:63], a[12:15], v[148:151], 0
    buffer_load_dwordx4 v[216:219], v2, s[36:39], s88 offen offset:3072 sc1
    s_barrier
    v_mfma_f32_16x16x32_bf16 v[64:67], a[16:19], v[148:151], 0
    ds_write_b128 v11, v[68:71] offset:0
    v_lshlrev_b32 v120, 16, v20
    v_mfma_f32_16x16x32_bf16 v[48:51], a[20:23], v[152:155], v[48:51]
    v_and_b32 v121, 0xffff0000, v20
    v_mfma_f32_16x16x32_bf16 v[52:55], a[24:27], v[152:155], v[52:55]
    s_add_u32 s88, s91, 23654400
    buffer_load_dwordx4 v[220:223], v2, s[36:39], s88 offen offset:0 sc1
    s_waitcnt vmcnt(15)
    v_mfma_f32_16x16x32_bf16 v[56:59], a[28:31], v[152:155], v[56:59]
    ds_write_b128 v12, v[72:75] offset:1024
    v_lshlrev_b32 v122, 16, v21
    v_mfma_f32_16x16x32_bf16 v[60:63], a[32:35], v[152:155], v[60:63]
    v_and_b32 v123, 0xffff0000, v21
    v_mfma_f32_16x16x32_bf16 v[64:67], a[36:39], v[152:155], v[64:67]
    buffer_load_dwordx4 v[224:227], v2, s[36:39], s88 offen offset:1024 sc1
    ds_write_b128 v11, v[76:79] offset:2048
    v_mfma_f32_16x16x32_bf16 v[48:51], a[40:43], v[156:159], v[48:51]
    v_lshlrev_b32 v124, 16, v22
    v_and_b32 v125, 0xffff0000, v22
    v_mfma_f32_16x16x32_bf16 v[52:55], a[44:47], v[156:159], v[52:55]
    v_mfma_f32_16x16x32_bf16 v[56:59], a[48:51], v[156:159], v[56:59]
    buffer_load_dwordx4 v[140:143], v2, s[36:39], s88 offen offset:2048 sc1
    ds_write_b128 v12, v[80:83] offset:3072
    v_mfma_f32_16x16x32_bf16 v[60:63], a[52:55], v[156:159], v[60:63]
    v_lshlrev_b32 v126, 16, v23
    v_and_b32 v127, 0xffff0000, v23
    v_mfma_f32_16x16x32_bf16 v[64:67], a[56:59], v[156:159], v[64:67]
    v_mfma_f32_16x16x32_bf16 v[48:51], a[60:63], v[160:163], v[48:51]
    buffer_load_dwordx4 v[144:147], v2, s[36:39], s88 offen offset:3072 sc1
    ds_write_b128 v11, v[84:87] offset:4096
    v_mfma_f32_16x16x32_bf16 v[52:55], a[64:67], v[160:163], v[52:55]
    s_waitcnt vmcnt(16)
    v_mfma_f32_16x16x32_bf16 v[56:59], a[68:71], v[160:163], v[56:59]
    v_mfma_f32_16x16x32_bf16 v[60:63], a[72:75], v[160:163], v[60:63]
    s_add_u32 s88, s91, 23658496
    buffer_load_dwordx4 v[148:151], v2, s[36:39], s88 offen offset:0 sc1
    v_mfma_f32_16x16x32_bf16 v[64:67], a[76:79], v[160:163], v[64:67]
    v_mfma_f32_16x16x32_bf16 v[48:51], a[80:83], v[164:167], v[48:51]
    v_mfma_f32_16x16x32_bf16 v[52:55], a[84:87], v[164:167], v[52:55]
    buffer_load_dwordx4 v[152:155], v2, s[36:39], s88 offen offset:1024 sc1
    v_mfma_f32_16x16x32_bf16 v[56:59], a[88:91], v[164:167], v[56:59]
    s_waitcnt lgkmcnt(0)
    s_barrier
    ds_read_b128 v[88:91], v13 offset:0
    v_mfma_f32_16x16x32_bf16 v[60:63], a[92:95], v[164:167], v[60:63]
    ds_read_b128 v[92:95], v13 offset:256
    ds_read_b128 v[96:99], v13 offset:5120
    v_mfma_f32_16x16x32_bf16 v[64:67], a[96:99], v[164:167], v[64:67]
    buffer_load_dwordx4 v[156:159], v2, s[36:39], s88 offen offset:2048 sc1
    ds_read_b128 v[100:103], v13 offset:5376
    v_mfma_f32_16x16x32_bf16 v[48:51], a[100:103], v[168:171], v[48:51]
    ds_read_b128 v[104:107], v13 offset:10240
    ds_read_b128 v[108:111], v13 offset:10496
    v_mfma_f32_16x16x32_bf16 v[52:55], a[104:107], v[168:171], v[52:55]
    s_waitcnt vmcnt(17)
    ds_read_b128 v[112:115], v13 offset:15360
    v_mfma_f32_16x16x32_bf16 v[56:59], a[108:111], v[168:171], v[56:59]
    buffer_load_dwordx4 v[160:163], v2, s[36:39], s88 offen offset:3072 sc1
    ds_read_b128 v[116:119], v13 offset:15616
    v_mfma_f32_16x16x32_bf16 v[60:63], a[112:115], v[168:171], v[60:63]
    v_mfma_f32_16x16x32_bf16 v[64:67], a[116:119], v[168:171], v[64:67]
    v_mfma_f32_16x16x32_bf16 v[48:51], a[120:123], v[172:175], v[48:51]
    s_add_u32 s88, s91, 23662592
    buffer_load_dwordx4 v[164:167], v2, s[36:39], s88 offen offset:0 sc1
    v_mfma_f32_16x16x32_bf16 v[52:55], a[124:127], v[172:175], v[52:55]
    v_mfma_f32_16x16x32_bf16 v[56:59], a[128:131], v[172:175], v[56:59]
    v_mfma_f32_16x16x32_bf16 v[60:63], a[132:135], v[172:175], v[60:63]
    buffer_load_dwordx4 v[168:171], v2, s[36:39], s88 offen offset:1024 sc1
    v_mfma_f32_16x16x32_bf16 v[64:67], a[136:139], v[172:175], v[64:67]
    s_waitcnt lgkmcnt(4)
    v_add_f32 v88, v88, v96
    v_mfma_f32_16x16x32_bf16 v[48:51], a[140:143], v[176:179], v[48:51]
    v_add_f32 v89, v89, v97
    v_add_f32 v90, v90, v98
    v_mfma_f32_16x16x32_bf16 v[52:55], a[144:147], v[176:179], v[52:55]
    s_waitcnt vmcnt(18)
    v_add_f32 v91, v91, v99
    v_mfma_f32_16x16x32_bf16 v[56:59], a[148:151], v[176:179], v[56:59]
    v_add_f32 v92, v92, v100
    v_add_f32 v93, v93, v101
    v_mfma_f32_16x16x32_bf16 v[60:63], a[152:155], v[176:179], v[60:63]
    v_add_f32 v94, v94, v102
    v_add_f32 v95, v95, v103
    v_mfma_f32_16x16x32_bf16 v[64:67], a[156:159], v[176:179], v[64:67]
    s_waitcnt lgkmcnt(0)
    v_add_f32 v104, v104, v112
    v_mfma_f32_16x16x32_bf16 v[48:51], a[160:163], v[180:183], v[48:51]
    v_add_f32 v105, v105, v113
    v_add_f32 v106, v106, v114
    v_mfma_f32_16x16x32_bf16 v[52:55], a[164:167], v[180:183], v[52:55]
    v_add_f32 v107, v107, v115
    v_add_f32 v108, v108, v116
    v_mfma_f32_16x16x32_bf16 v[56:59], a[168:171], v[180:183], v[56:59]
    v_add_f32 v109, v109, v117
    v_add_f32 v110, v110, v118
    v_mfma_f32_16x16x32_bf16 v[60:63], a[172:175], v[180:183], v[60:63]
    v_add_f32 v111, v111, v119
    v_add_f32 v88, v88, v104
    v_mfma_f32_16x16x32_bf16 v[64:67], a[176:179], v[180:183], v[64:67]
    v_add_f32 v89, v89, v105
    v_add_f32 v90, v90, v106
    v_mfma_f32_16x16x32_bf16 v[48:51], a[180:183], v[184:187], v[48:51]
    v_add_f32 v91, v91, v107
    v_add_f32 v92, v92, v108
    v_mfma_f32_16x16x32_bf16 v[52:55], a[184:187], v[184:187], v[52:55]
    s_waitcnt vmcnt(16)
    v_add_f32 v93, v93, v109
    v_mfma_f32_16x16x32_bf16 v[56:59], a[188:191], v[184:187], v[56:59]
    v_add_f32 v94, v94, v110
    v_add_f32 v95, v95, v111
    v_mfma_f32_16x16x32_bf16 v[60:63], a[192:195], v[184:187], v[60:63]
    v_fmac_f32 v120, v88, v5
    v_fmac_f32 v121, v89, v5
    v_mfma_f32_16x16x32_bf16 v[64:67], a[196:199], v[184:187], v[64:67]
    v_fmac_f32 v122, v90, v5
    v_fmac_f32 v123, v91, v5
    v_mfma_f32_16x16x32_bf16 v[48:51], a[200:203], v[188:191], v[48:51]
    v_fmac_f32 v124, v92, v5
    v_fmac_f32 v125, v93, v5
    v_mfma_f32_16x16x32_bf16 v[52:55], a[204:207], v[188:191], v[52:55]
    v_fmac_f32 v126, v94, v5
    v_fmac_f32 v127, v95, v5
    v_mfma_f32_16x16x32_bf16 v[56:59], a[208:211], v[188:191], v[56:59]
    v_cvt_pk_bf16_f32 v20, v120, v121
    v_cvt_pk_bf16_f32 v21, v122, v123
    v_mfma_f32_16x16x32_bf16 v[60:63], a[212:215], v[188:191], v[60:63]
    v_cvt_pk_bf16_f32 v22, v124, v125
    v_cvt_pk_bf16_f32 v23, v126, v127
    v_mfma_f32_16x16x32_bf16 v[64:67], a[216:219], v[188:191], v[64:67]
    v_mfma_f32_16x16x32_bf16 v[48:51], a[220:223], v[192:195], v[48:51]
    v_mfma_f32_16x16x32_bf16 v[52:55], a[224:227], v[192:195], v[52:55]
    s_waitcnt vmcnt(14)
    v_mfma_f32_16x16x32_bf16 v[56:59], a[228:231], v[192:195], v[56:59]
    v_mfma_f32_16x16x32_bf16 v[60:63], a[232:235], v[192:195], v[60:63]
    v_mfma_f32_16x16x32_bf16 v[64:67], a[236:239], v[192:195], v[64:67]
    v_mfma_f32_16x16x32_bf16 v[48:51], a[240:243], v[196:199], v[48:51]
    v_mfma_f32_16x16x32_bf16 v[52:55], a[244:247], v[196:199], v[52:55]
    v_mfma_f32_16x16x32_bf16 v[56:59], a[248:251], v[196:199], v[56:59]
    v_mfma_f32_16x16x32_bf16 v[60:63], a[252:255], v[196:199], v[60:63]
    v_mfma_f32_16x16x32_bf16 v[64:67], v[232:235], v[196:199], v[64:67]
    v_mfma_f32_16x16x32_bf16 v[48:51], v[236:239], v[200:203], v[48:51]
    v_mfma_f32_16x16x32_bf16 v[52:55], v[240:243], v[200:203], v[52:55]
    s_waitcnt vmcnt(12)
    v_mfma_f32_16x16x32_bf16 v[56:59], v[244:247], v[200:203], v[56:59]
    v_mfma_f32_16x16x32_bf16 v[60:63], v[248:251], v[200:203], v[60:63]
    v_mfma_f32_16x16x32_bf16 v[64:67], v[252:255], v[200:203], v[64:67]
    v_mfma_f32_16x16x32_bf16 v[68:71], a[0:3], v[204:207], 0
    v_mfma_f32_16x16x32_bf16 v[72:75], a[4:7], v[204:207], 0
    v_mfma_f32_16x16x32_bf16 v[76:79], a[8:11], v[204:207], 0
    v_mfma_f32_16x16x32_bf16 v[80:83], a[12:15], v[204:207], 0
    s_barrier
    ds_write_b128 v11, v[48:51] offset:0
    v_mfma_f32_16x16x32_bf16 v[84:87], a[16:19], v[204:207], 0
    v_lshlrev_b32 v120, 16, v24
    v_and_b32 v121, 0xffff0000, v24
    v_mfma_f32_16x16x32_bf16 v[68:71], a[20:23], v[208:211], v[68:71]
    v_mfma_f32_16x16x32_bf16 v[72:75], a[24:27], v[208:211], v[72:75]
    s_waitcnt vmcnt(10)
    ds_write_b128 v12, v[52:55] offset:1024
    v_mfma_f32_16x16x32_bf16 v[76:79], a[28:31], v[208:211], v[76:79]
    v_lshlrev_b32 v122, 16, v25
    v_and_b32 v123, 0xffff0000, v25
    v_mfma_f32_16x16x32_bf16 v[80:83], a[32:35], v[208:211], v[80:83]
    v_mfma_f32_16x16x32_bf16 v[84:87], a[36:39], v[208:211], v[84:87]
    ds_write_b128 v11, v[56:59] offset:2048
    v_lshlrev_b32 v124, 16, v26
    v_mfma_f32_16x16x32_bf16 v[68:71], a[40:43], v[212:215], v[68:71]
    v_and_b32 v125, 0xffff0000, v26
    v_mfma_f32_16x16x32_bf16 v[72:75], a[44:47], v[212:215], v[72:75]
    ds_write_b128 v12, v[60:63] offset:3072
    v_lshlrev_b32 v126, 16, v27
    v_mfma_f32_16x16x32_bf16 v[76:79], a[48:51], v[212:215], v[76:79]
    v_and_b32 v127, 0xffff0000, v27
    v_mfma_f32_16x16x32_bf16 v[80:83], a[52:55], v[212:215], v[80:83]
    ds_write_b128 v11, v[64:67] offset:4096
    v_mfma_f32_16x16x32_bf16 v[84:87], a[56:59], v[212:215], v[84:87]
    v_mfma_f32_16x16x32_bf16 v[68:71], a[60:63], v[216:219], v[68:71]
    v_mfma_f32_16x16x32_bf16 v[72:75], a[64:67], v[216:219], v[72:75]
    s_waitcnt vmcnt(8)
    v_mfma_f32_16x16x32_bf16 v[76:79], a[68:71], v[216:219], v[76:79]
    v_mfma_f32_16x16x32_bf16 v[80:83], a[72:75], v[216:219], v[80:83]
    v_mfma_f32_16x16x32_bf16 v[84:87], a[76:79], v[216:219], v[84:87]
    s_waitcnt lgkmcnt(0)
    s_barrier
    ds_read_b128 v[88:91], v13 offset:0
    v_mfma_f32_16x16x32_bf16 v[68:71], a[80:83], v[220:223], v[68:71]
    s_add_u32 s74, s77, 0
    s_mov_b64 exec, s[86:87]
    buffer_store_dwordx4 v[16:19], v134, s[44:47], s74 offen
    s_mov_b64 exec, -1
    s_add_u32 s74, s77, 20480
    s_mov_b64 exec, s[86:87]
    buffer_store_dwordx4 v[20:23], v134, s[44:47], s74 offen
    s_mov_b64 exec, -1
    ds_read_b128 v[92:95], v13 offset:256
    v_mfma_f32_16x16x32_bf16 v[72:75], a[84:87], v[220:223], v[72:75]
    ds_read_b128 v[96:99], v13 offset:5120
    ds_read_b128 v[100:103], v13 offset:5376
    v_mfma_f32_16x16x32_bf16 v[76:79], a[88:91], v[220:223], v[76:79]
    ds_read_b128 v[104:107], v13 offset:10240
    ds_read_b128 v[108:111], v13 offset:10496
    v_mfma_f32_16x16x32_bf16 v[80:83], a[92:95], v[220:223], v[80:83]
    ds_read_b128 v[112:115], v13 offset:15360
    ds_read_b128 v[116:119], v13 offset:15616
    v_mfma_f32_16x16x32_bf16 v[84:87], a[96:99], v[220:223], v[84:87]
    v_mfma_f32_16x16x32_bf16 v[68:71], a[100:103], v[224:227], v[68:71]
    v_mfma_f32_16x16x32_bf16 v[72:75], a[104:107], v[224:227], v[72:75]
    s_waitcnt vmcnt(8)
    v_mfma_f32_16x16x32_bf16 v[76:79], a[108:111], v[224:227], v[76:79]
    v_mfma_f32_16x16x32_bf16 v[80:83], a[112:115], v[224:227], v[80:83]
    v_mfma_f32_16x16x32_bf16 v[84:87], a[116:119], v[224:227], v[84:87]
    v_mfma_f32_16x16x32_bf16 v[68:71], a[120:123], v[140:143], v[68:71]
    s_waitcnt lgkmcnt(4)
    v_add_f32 v88, v88, v96
    v_mfma_f32_16x16x32_bf16 v[72:75], a[124:127], v[140:143], v[72:75]
    v_add_f32 v89, v89, v97
    v_add_f32 v90, v90, v98
    v_mfma_f32_16x16x32_bf16 v[76:79], a[128:131], v[140:143], v[76:79]
    v_add_f32 v91, v91, v99
    v_add_f32 v92, v92, v100
    v_mfma_f32_16x16x32_bf16 v[80:83], a[132:135], v[140:143], v[80:83]
    v_add_f32 v93, v93, v101
    v_add_f32 v94, v94, v102
    v_mfma_f32_16x16x32_bf16 v[84:87], a[136:139], v[140:143], v[84:87]
    v_add_f32 v95, v95, v103
    s_waitcnt lgkmcnt(0)
    v_mfma_f32_16x16x32_bf16 v[68:71], a[140:143], v[144:147], v[68:71]
    v_add_f32 v104, v104, v112
    v_add_f32 v105, v105, v113
    v_mfma_f32_16x16x32_bf16 v[72:75], a[144:147], v[144:147], v[72:75]
    s_waitcnt vmcnt(6)
    v_add_f32 v106, v106, v114
    v_mfma_f32_16x16x32_bf16 v[76:79], a[148:151], v[144:147], v[76:79]
    v_add_f32 v107, v107, v115
    v_add_f32 v108, v108, v116
    v_mfma_f32_16x16x32_bf16 v[80:83], a[152:155], v[144:147], v[80:83]
    v_add_f32 v109, v109, v117
    v_add_f32 v110, v110, v118
    v_mfma_f32_16x16x32_bf16 v[84:87], a[156:159], v[144:147], v[84:87]
    v_add_f32 v111, v111, v119
    v_add_f32 v88, v88, v104
    v_mfma_f32_16x16x32_bf16 v[68:71], a[160:163], v[148:151], v[68:71]
    v_add_f32 v89, v89, v105
    v_add_f32 v90, v90, v106
    v_mfma_f32_16x16x32_bf16 v[72:75], a[164:167], v[148:151], v[72:75]
    v_add_f32 v91, v91, v107
    v_add_f32 v92, v92, v108
    v_mfma_f32_16x16x32_bf16 v[76:79], a[168:171], v[148:151], v[76:79]
    v_add_f32 v93, v93, v109
    v_add_f32 v94, v94, v110
    v_mfma_f32_16x16x32_bf16 v[80:83], a[172:175], v[148:151], v[80:83]
    v_add_f32 v95, v95, v111
    v_fmac_f32 v120, v88, v137
    v_mfma_f32_16x16x32_bf16 v[84:87], a[176:179], v[148:151], v[84:87]
    v_fmac_f32 v121, v89, v137
    v_fmac_f32 v122, v90, v137
    v_mfma_f32_16x16x32_bf16 v[68:71], a[180:183], v[152:155], v[68:71]
    v_fmac_f32 v123, v91, v137
    v_fmac_f32 v124, v92, v137
    v_mfma_f32_16x16x32_bf16 v[72:75], a[184:187], v[152:155], v[72:75]
    s_waitcnt vmcnt(4)
    v_fmac_f32 v125, v93, v137
    v_mfma_f32_16x16x32_bf16 v[76:79], a[188:191], v[152:155], v[76:79]
    v_fmac_f32 v126, v94, v137
    v_fmac_f32 v127, v95, v137
    v_mfma_f32_16x16x32_bf16 v[80:83], a[192:195], v[152:155], v[80:83]
    v_cvt_pk_bf16_f32 v24, v120, v121
    v_cvt_pk_bf16_f32 v25, v122, v123
    v_mfma_f32_16x16x32_bf16 v[84:87], a[196:199], v[152:155], v[84:87]
    v_cvt_pk_bf16_f32 v26, v124, v125
    v_cvt_pk_bf16_f32 v27, v126, v127
    v_mfma_f32_16x16x32_bf16 v[68:71], a[200:203], v[156:159], v[68:71]
    s_add_u32 s74, s77, 1310720
    s_mov_b64 exec, s[86:87]
    buffer_store_dwordx4 v[24:27], v134, s[44:47], s74 offen
    s_mov_b64 exec, -1
    v_mfma_f32_16x16x32_bf16 v[72:75], a[204:207], v[156:159], v[72:75]
    v_mfma_f32_16x16x32_bf16 v[76:79], a[208:211], v[156:159], v[76:79]
    v_mfma_f32_16x16x32_bf16 v[80:83], a[212:215], v[156:159], v[80:83]
    v_mfma_f32_16x16x32_bf16 v[84:87], a[216:219], v[156:159], v[84:87]
    v_mfma_f32_16x16x32_bf16 v[68:71], a[220:223], v[160:163], v[68:71]
    v_mfma_f32_16x16x32_bf16 v[72:75], a[224:227], v[160:163], v[72:75]
    s_waitcnt vmcnt(3)
    v_mfma_f32_16x16x32_bf16 v[76:79], a[228:231], v[160:163], v[76:79]
    v_mfma_f32_16x16x32_bf16 v[80:83], a[232:235], v[160:163], v[80:83]
    v_mfma_f32_16x16x32_bf16 v[84:87], a[236:239], v[160:163], v[84:87]
    v_mfma_f32_16x16x32_bf16 v[68:71], a[240:243], v[164:167], v[68:71]
    v_mfma_f32_16x16x32_bf16 v[72:75], a[244:247], v[164:167], v[72:75]
    v_mfma_f32_16x16x32_bf16 v[76:79], a[248:251], v[164:167], v[76:79]
    v_mfma_f32_16x16x32_bf16 v[80:83], a[252:255], v[164:167], v[80:83]
    v_mfma_f32_16x16x32_bf16 v[84:87], v[232:235], v[164:167], v[84:87]
    v_mfma_f32_16x16x32_bf16 v[68:71], v[236:239], v[168:171], v[68:71]
    v_mfma_f32_16x16x32_bf16 v[72:75], v[240:243], v[168:171], v[72:75]
    v_mfma_f32_16x16x32_bf16 v[76:79], v[244:247], v[168:171], v[76:79]
    v_mfma_f32_16x16x32_bf16 v[80:83], v[248:251], v[168:171], v[80:83]
    v_mfma_f32_16x16x32_bf16 v[84:87], v[252:255], v[168:171], v[84:87]
    s_barrier
    s_nop 2
    ds_write_b128 v11, v[68:71] offset:0
    ds_write_b128 v12, v[72:75] offset:1024
    ds_write_b128 v11, v[76:79] offset:2048
    ds_write_b128 v12, v[80:83] offset:3072
    ds_write_b128 v11, v[84:87] offset:4096
    v_lshlrev_b32 v120, 16, v28
    v_and_b32 v121, 0xffff0000, v28
    v_lshlrev_b32 v122, 16, v29
    v_and_b32 v123, 0xffff0000, v29
    v_lshlrev_b32 v124, 16, v30
    v_and_b32 v125, 0xffff0000, v30
    v_lshlrev_b32 v126, 16, v31
    v_and_b32 v127, 0xffff0000, v31
    s_waitcnt lgkmcnt(0)
    s_barrier
    ds_read_b128 v[88:91], v13 offset:0
    ds_read_b128 v[92:95], v13 offset:256
    ds_read_b128 v[96:99], v13 offset:5120
    ds_read_b128 v[100:103], v13 offset:5376
    ds_read_b128 v[104:107], v13 offset:10240
    ds_read_b128 v[108:111], v13 offset:10496
    ds_read_b128 v[112:115], v13 offset:15360
    ds_read_b128 v[116:119], v13 offset:15616
    s_waitcnt lgkmcnt(4)
    v_pk_add_f32 v[88:89], v[88:89], v[96:97]
    v_pk_add_f32 v[90:91], v[90:91], v[98:99]
    v_pk_add_f32 v[92:93], v[92:93], v[100:101]
    v_pk_add_f32 v[94:95], v[94:95], v[102:103]
    s_waitcnt lgkmcnt(0)
    v_pk_add_f32 v[104:105], v[104:105], v[112:113]
    v_pk_add_f32 v[106:107], v[106:107], v[114:115]
    v_pk_add_f32 v[108:109], v[108:109], v[116:117]
    v_pk_add_f32 v[110:111], v[110:111], v[118:119]
    v_pk_add_f32 v[88:89], v[88:89], v[104:105]
    v_pk_add_f32 v[90:91], v[90:91], v[106:107]
    v_pk_add_f32 v[92:93], v[92:93], v[108:109]
    v_pk_add_f32 v[94:95], v[94:95], v[110:111]
    v_fmac_f32 v120, v88, v138
    v_fmac_f32 v121, v89, v138
    v_fmac_f32 v122, v90, v138
    v_fmac_f32 v123, v91, v138
    v_fmac_f32 v124, v92, v138
    v_fmac_f32 v125, v93, v138
    v_fmac_f32 v126, v94, v138
    v_fmac_f32 v127, v95, v138
    v_cvt_pk_bf16_f32 v28, v120, v121
    v_cvt_pk_bf16_f32 v29, v122, v123
    v_cvt_pk_bf16_f32 v30, v124, v125
    v_cvt_pk_bf16_f32 v31, v126, v127
    s_add_u32 s74, s77, 1331200
    s_mov_b64 exec, s[86:87]
    buffer_store_dwordx4 v[28:31], v134, s[44:47], s74 offen
    s_mov_b64 exec, -1
L_end:
    s_endpgm
Lxc_17:
    s_mov_b32 s96, 0
Lxc_17x:
    s_sleep 1
    buffer_load_dword v60, v62, s[36:39], s11 offen sc1
    s_waitcnt vmcnt(0)
    v_subrev_u32 v61, s97, v60
    v_add_u32 v61, -1, v61
    v_cmp_lt_u32 vcc, 15, v61
    s_cbranch_vccz Lxd_18
    s_add_u32 s96, s96, 1
    s_cmp_lt_u32 s96, 100000
    s_cbranch_scc1 Lxc_17x
    s_branch Lxd_18
Lg_37:
    s_nop 1
    buffer_store_dwordx4 v[64:67], v2, s[36:39], s72 offen sc1
    s_mov_b32 exec_hi, 0xffff
    buffer_store_dwordx4 v[68:71], v2, s[36:39], s72 offen offset:1024 sc1
    s_mov_b64 exec, -1
    s_nop 1
    s_branch Lgb_38
Lg_39:
    s_nop 1
    buffer_store_dwordx4 v[92:95], v2, s[36:39], s72 offen sc1
    s_mov_b32 exec_hi, 0xffff
    buffer_store_dwordx4 v[96:99], v2, s[36:39], s72 offen offset:1024 sc1
    s_mov_b64 exec, -1
    s_nop 1
    s_branch Lgb_40
Lg_42:
    s_nop 1
    s_add_u32 s74, s78, 256
    s_mov_b32 exec_lo, 0x00010001
    s_mov_b32 exec_hi, 0x00010001
    buffer_store_dwordx4 v[108:111], v229, s[36:39], s74 offen sc1
    s_mov_b64 exec, -1
    s_nop 1
    s_branch Lgb_43
Lg_44:
    s_nop 1
    s_add_u32 s74, s78, 320
    s_mov_b32 exec_lo, 0x00010001
    s_mov_b32 exec_hi, 0x00010001
    buffer_store_dwordx4 v[108:111], v229, s[36:39], s74 offen sc1
    s_mov_b64 exec, -1
    s_nop 1
    s_branch Lgb_45
Lg_46:
    s_nop 1
    s_add_u32 s74, s78, 384
    s_mov_b32 exec_lo, 0x00010001
    s_mov_b32 exec_hi, 0x00010001
    buffer_store_dwordx4 v[108:111], v229, s[36:39], s74 offen sc1
    s_mov_b64 exec, -1
    s_nop 1
    s_branch Lgb_47
Lg_48:
    s_nop 1
    s_add_u32 s74, s78, 448
    s_mov_b32 exec_lo, 0x00010001
    s_mov_b32 exec_hi, 0x00010001
    buffer_store_dwordx4 v[108:111], v229, s[36:39], s74 offen sc1
    s_mov_b64 exec, -1
    s_nop 1
    s_branch Lgb_49
Lg_50:
    s_nop 1
    s_mov_b64 exec, 1
    buffer_store_dword v14, off, s[36:39], s73 sc1
    s_mov_b64 exec, -1
    s_nop 1
    s_branch Lgb_51
Lxc_75:
    s_mov_b32 s96, 0
Lxc_75x:
    s_sleep 1
    buffer_load_dword v44, v46, s[36:39], s11 offen sc1
    s_waitcnt vmcnt(0)
    v_subrev_u32 v45, s97, v44
    v_add_u32 v45, -1, v45
    v_cmp_lt_u32 vcc, 15, v45
    s_cbranch_vccz Lxd_76
    s_add_u32 s96, s96, 1
    s_cmp_lt_u32 s96, 100000
    s_cbranch_scc1 Lxc_75x
    s_branch Lxd_76
Lg_83:
    s_nop 1
    buffer_store_dwordx4 v[64:67], v2, s[36:39], s72 offen sc1
    s_mov_b32 exec_hi, 0xffff
    buffer_store_dwordx4 v[68:71], v2, s[36:39], s72 offen offset:1024 sc1
    s_mov_b64 exec, -1
    s_nop 1
    s_branch Lgb_84
Lg_85:
    s_nop 1
    buffer_store_dwordx4 v[92:95], v2, s[36:39], s72 offen sc1
    s_mov_b32 exec_hi, 0xffff
    buffer_store_dwordx4 v[96:99], v2, s[36:39], s72 offen offset:1024 sc1
    s_mov_b64 exec, -1
    s_nop 1
    s_branch Lgb_86
Lg_88:
    s_nop 1
    s_add_u32 s74, s78, 256
    s_mov_b32 exec_lo, 0x00010001
    s_mov_b32 exec_hi, 0x00010001
    buffer_store_dwordx4 v[108:111], v229, s[36:39], s74 offen sc1
    s_mov_b64 exec, -1
    s_nop 1
    s_branch Lgb_89
Lg_90:
    s_nop 1
    s_add_u32 s74, s78, 320
    s_mov_b32 exec_lo, 0x00010001
    s_mov_b32 exec_hi, 0x00010001
    buffer_store_dwordx4 v[108:111], v229, s[36:39], s74 offen sc1
    s_mov_b64 exec, -1
    s_nop 1
    s_branch Lgb_91
Lg_92:
    s_nop 1
    s_add_u32 s74, s78, 384
    s_mov_b32 exec_lo, 0x00010001
    s_mov_b32 exec_hi, 0x00010001
    buffer_store_dwordx4 v[108:111], v229, s[36:39], s74 offen sc1
    s_mov_b64 exec, -1
    s_nop 1
    s_branch Lgb_93
Lg_94:
    s_nop 1
    s_add_u32 s74, s78, 448
    s_mov_b32 exec_lo, 0x00010001
    s_mov_b32 exec_hi, 0x00010001
    buffer_store_dwordx4 v[108:111], v229, s[36:39], s74 offen sc1
    s_mov_b64 exec, -1
    s_nop 1
    s_branch Lgb_95
Lg_96:
    s_nop 1
    s_mov_b64 exec, 1
    buffer_store_dword v14, off, s[36:39], s73 sc1
    s_mov_b64 exec, -1
    s_nop 1
    s_branch Lgb_97
Lps_101:
    s_mov_b32 s96, 0
Lps_101x:
    buffer_load_dwordx4 v[108:111], v105, s[36:39], s79 offen offset:0 sc1
    s_waitcnt vmcnt(0)
    v_cmp_ne_u32 vcc, v111, v14
    s_cbranch_vccz Lpd_100
    s_sleep 1
    s_add_u32 s96, s96, 1
    s_cmp_lt_u32 s96, 100000
    s_cbranch_scc1 Lps_101x
    s_branch Lpd_100
Lps_103:
    s_mov_b32 s96, 0
Lps_103x:
    buffer_load_dwordx4 v[228:231], v105, s[36:39], s79 offen offset:128 sc1
    s_waitcnt vmcnt(0)
    v_cmp_ne_u32 vcc, v231, v14
    s_cbranch_vccz Lpd_102
    s_sleep 1
    s_add_u32 s96, s96, 1
    s_cmp_lt_u32 s96, 100000
    s_cbranch_scc1 Lps_103x
    s_branch Lpd_102
Lg_104:
    s_nop 1
    s_mov_b64 exec, 1
    buffer_store_dword v14, off, s[36:39], s73 sc1
    s_mov_b64 exec, -1
    s_nop 1
    s_branch Lgb_105
Lg_106:
    s_nop 1
    s_add_u32 s74, s78, 0
    s_mov_b32 exec_lo, 0x00010001
    s_mov_b32 exec_hi, 0x00010001
    buffer_store_dwordx4 v[128:131], v135, s[36:39], s74 offen sc1
    s_mov_b64 exec, -1
    s_nop 1
    s_branch Lgb_107
Lps_109:
    s_mov_b32 s96, 0
Lps_109x:
    buffer_load_dword v228, v231, s[36:39], s75 offen sc1
    s_waitcnt vmcnt(0)
    v_cmp_ne_u32 vcc, v228, v14
    s_cbranch_vccz Lpd_108
    s_sleep 1
    s_add_u32 s96, s96, 1
    s_cmp_lt_u32 s96, 100000
    s_cbranch_scc1 Lps_109x
    s_branch Lpd_108
Lg_110:
    s_nop 1
    s_add_u32 s74, s78, 64
    s_mov_b32 exec_lo, 0x00010001
    s_mov_b32 exec_hi, 0x00010001
    buffer_store_dwordx4 v[128:131], v135, s[36:39], s74 offen sc1
    s_mov_b64 exec, -1
    s_nop 1
    s_branch Lgb_111
Lg_112:
    s_nop 1
    s_add_u32 s74, s78, 128
    s_mov_b32 exec_lo, 0x00010001
    s_mov_b32 exec_hi, 0x00010001
    buffer_store_dwordx4 v[128:131], v135, s[36:39], s74 offen sc1
    s_mov_b64 exec, -1
    s_nop 1
    s_branch Lgb_113
Lps_115:
    s_mov_b32 s96, 0
Lps_115x:
    buffer_load_dwordx4 v[228:231], v136, s[36:39], s79 offen sc1
    s_waitcnt vmcnt(0)
    v_cmp_ne_u32 vcc, v231, v14
    s_cbranch_vccz Lpd_114
    s_sleep 1
    s_add_u32 s96, s96, 1
    s_cmp_lt_u32 s96, 100000
    s_cbranch_scc1 Lps_115x
    s_branch Lpd_114
Lg_116:
    s_nop 1
    s_add_u32 s74, s76, 15728640
    s_mov_b64 exec, s[86:87]
    buffer_store_dwordx4 v[16:19], v132, s[36:39], s74 offen sc1
    s_mov_b64 exec, -1
    s_nop 1
    s_branch Lgb_117
Lps_119:
    s_mov_b32 s96, 0
Lps_119x:
    buffer_load_dwordx4 v[48:51], v136, s[36:39], s71 offen sc1
    s_waitcnt vmcnt(0)
    v_cmp_ne_u32 vcc, v51, v14
    s_cbranch_vccz Lpd_118
    s_sleep 1
    s_add_u32 s96, s96, 1
    s_cmp_lt_u32 s96, 100000
    s_cbranch_scc1 Lps_119x
    s_branch Lpd_118
Lg_120:
    s_nop 1
    s_add_u32 s74, s76, 15728896
    s_mov_b64 exec, s[86:87]
    buffer_store_dwordx4 v[20:23], v132, s[36:39], s74 offen sc1
    s_mov_b64 exec, -1
    s_nop 1
    s_branch Lgb_121
Lg_122:
    s_nop 1
    s_add_u32 s74, s78, 192
    s_mov_b32 exec_lo, 0x00010001
    s_mov_b32 exec_hi, 0x00010001
    buffer_store_dwordx4 v[128:131], v135, s[36:39], s74 offen sc1
    s_mov_b64 exec, -1
    s_nop 1
    s_branch Lgb_123
Lg_124:
    s_nop 1
    s_mov_b64 exec, 1
    buffer_store_dword v14, off, s[36:39], s73 sc1
    s_mov_b64 exec, -1
    s_nop 1
    s_branch Lgb_125
Lps_127:
    s_mov_b32 s96, 0
Lps_127x:
    buffer_load_dwordx4 v[32:35], v136, s[36:39], s79 offen sc1
    s_waitcnt vmcnt(0)
    v_cmp_ne_u32 vcc, v35, v14
    s_cbranch_vccz Lpd_126
    s_sleep 1
    s_add_u32 s96, s96, 1
    s_cmp_lt_u32 s96, 100000
    s_cbranch_scc1 Lps_127x
    s_branch Lpd_126
Lg_128:
    s_nop 1
    s_add_u32 s74, s76, 17039360
    s_mov_b64 exec, s[86:87]
    buffer_store_dwordx4 v[24:27], v132, s[36:39], s74 offen sc1
    s_mov_b64 exec, -1
    s_nop 1
    s_branch Lgb_129
Lps_131:
    s_mov_b32 s96, 0
Lps_131x:
    buffer_load_dword v228, v231, s[36:39], s35 offen sc1
    s_waitcnt vmcnt(0)
    v_cmp_ne_u32 vcc, v228, v14
    s_cbranch_vccz Lpd_130
    s_sleep 1
    s_add_u32 s96, s96, 1
    s_cmp_lt_u32 s96, 100000
    s_cbranch_scc1 Lps_131x
    s_branch Lpd_130
Lps_133:
    s_mov_b32 s96, 0
Lps_133x:
    buffer_load_dwordx4 v[32:35], v229, s[36:39], s71 offen sc1
    s_waitcnt vmcnt(0)
    v_cmp_ne_u32 vcc, v35, v14
    s_cbranch_vccz Lpd_132
    s_sleep 1
    s_add_u32 s96, s96, 1
    s_cmp_lt_u32 s96, 100000
    s_cbranch_scc1 Lps_133x
    s_branch Lpd_132
Lg_134:
    s_nop 1
    s_add_u32 s74, s76, 17039616
    s_mov_b64 exec, s[86:87]
    buffer_store_dwordx4 v[28:31], v230, s[36:39], s74 offen sc1
    s_mov_b64 exec, -1
    s_nop 1
    s_branch Lgb_135
Lg_136:
    s_nop 1
    s_mov_b64 exec, 1
    buffer_store_dword v14, off, s[36:39], s73 sc1
    s_mov_b64 exec, -1
    s_nop 1
    s_branch Lgb_137
Lps_139:
    s_mov_b32 s96, 0
Lps_139x:
    buffer_load_dword v228, v231, s[36:39], s75 offen sc1
    s_waitcnt vmcnt(0)
    v_cmp_ne_u32 vcc, v228, v14
    s_cbranch_vccz Lpd_138
    s_sleep 1
    s_add_u32 s96, s96, 1
    s_cmp_lt_u32 s96, 100000
    s_cbranch_scc1 Lps_139x
    s_branch Lpd_138
Lg_140:
    s_nop 1
    buffer_store_dwordx4 v[64:67], v2, s[36:39], s72 offen sc1
    s_mov_b32 exec_hi, 0xffff
    buffer_store_dwordx4 v[68:71], v2, s[36:39], s72 offen offset:1024 sc1
    s_mov_b64 exec, -1
    s_nop 1
    s_branch Lgb_141
Lg_142:
    s_nop 1
    buffer_store_dwordx4 v[92:95], v2, s[36:39], s72 offen sc1
    s_mov_b32 exec_hi, 0xffff
    buffer_store_dwordx4 v[96:99], v2, s[36:39], s72 offen offset:1024 sc1
    s_mov_b64 exec, -1
    s_nop 1
    s_branch Lgb_143
Lg_144:
    s_nop 1
    s_mov_b64 exec, 1
    buffer_store_dword v14, off, s[36:39], s73 sc1
    s_mov_b64 exec, -1
    s_nop 1
    s_branch Lgb_145
Lg_146:
    s_nop 1
    s_add_u32 s74, s78, 512
    s_mov_b32 exec_lo, 0x11111111
    s_mov_b32 exec_hi, 0x11111111
    buffer_store_dwordx4 v[44:47], v229, s[36:39], s74 offen sc1
    s_mov_b64 exec, -1
    s_nop 1
    s_branch Lgb_147
Lps_149:
    s_mov_b32 s96, 0
Lps_149x:
    buffer_load_dword v228, v231, s[36:39], s75 offen sc1
    s_waitcnt vmcnt(0)
    v_cmp_ne_u32 vcc, v228, v14
    s_cbranch_vccz Lpd_148
    s_sleep 1
    s_add_u32 s96, s96, 1
    s_cmp_lt_u32 s96, 100000
    s_cbranch_scc1 Lps_149x
    s_branch Lpd_148
Lg_150:
    s_nop 1
    buffer_store_dwordx4 v[64:67], v2, s[36:39], s72 offen sc1
    s_mov_b32 exec_hi, 0xffff
    buffer_store_dwordx4 v[68:71], v2, s[36:39], s72 offen offset:1024 sc1
    s_mov_b64 exec, -1
    s_nop 1
    s_branch Lgb_151
Lg_152:
    s_nop 1
    buffer_store_dwordx4 v[92:95], v2, s[36:39], s72 offen sc1
    s_mov_b32 exec_hi, 0xffff
    buffer_store_dwordx4 v[96:99], v2, s[36:39], s72 offen offset:1024 sc1
    s_mov_b64 exec, -1
    s_nop 1
    s_branch Lgb_153
Lps_155:
    s_mov_b32 s96, 0
Lps_155x:
    buffer_load_dwordx4 v[108:111], v105, s[36:39], s79 offen offset:0 sc1
    s_waitcnt vmcnt(0)
    v_cmp_ne_u32 vcc, v111, v14
    s_cbranch_vccz Lpd_154
    s_sleep 1
    s_add_u32 s96, s96, 1
    s_cmp_lt_u32 s96, 100000
    s_cbranch_scc1 Lps_155x
    s_branch Lpd_154
Lps_157:
    s_mov_b32 s96, 0
Lps_157x:
    buffer_load_dwordx4 v[228:231], v105, s[36:39], s79 offen offset:128 sc1
    s_waitcnt vmcnt(0)
    v_cmp_ne_u32 vcc, v231, v14
    s_cbranch_vccz Lpd_156
    s_sleep 1
    s_add_u32 s96, s96, 1
    s_cmp_lt_u32 s96, 100000
    s_cbranch_scc1 Lps_157x
    s_branch Lpd_156
Lg_158:
    s_nop 1
    s_mov_b64 exec, 1
    buffer_store_dword v14, off, s[36:39], s73 sc1
    s_mov_b64 exec, -1
    s_nop 1
    s_branch Lgb_159
Lps_161:
    s_mov_b32 s96, 0
Lps_161x:
    buffer_load_dword v228, v231, s[36:39], s75 offen sc1
    s_waitcnt vmcnt(0)
    v_cmp_ne_u32 vcc, v228, v14
    s_cbranch_vccz Lpd_160
    s_sleep 1
    s_add_u32 s96, s96, 1
    s_cmp_lt_u32 s96, 100000
    s_cbranch_scc1 Lps_161x
    s_branch Lpd_160
L_last:
    s_endpgm
.section .rodata,"a"
.p2align 6
.amdhsa_kernel interleave_layers__ssm_conv_h3__glu_gated_bilinear__prompt_kernel
  .amdhsa_next_free_vgpr 512
  .amdhsa_next_free_sgpr 102
  .amdhsa_accum_offset 256
  .amdhsa_group_segment_fixed_size 0
  .amdhsa_kernarg_size 104
  .amdhsa_user_sgpr_count 2
  .amdhsa_user_sgpr_kernarg_segment_ptr 1
  .amdhsa_system_sgpr_workgroup_id_x 1
.end_amdhsa_kernel
```
